```python
import torch

def _softmax(x, axis=-1):
    return torch.softmax(x, dim=axis)

def _gelu(x):
    return torch.nn.functional.gelu(x, approximate='tanh')

def _silu(x):
    return torch.nn.functional.silu(x)

def _sigmoid(x):
    return torch.sigmoid(x)

def _layernorm(x, axis=-1, eps=1e-05):
    m = x.mean(dim=axis, keepdim=True)
    v = x.var(dim=axis, keepdim=True, unbiased=False)
    return (x - m) / torch.sqrt(v + eps)

def _scatter_add(tgt, idx, src, axis=0):
    return tgt.clone().index_add_(axis, idx, src)

def _segment_sum(src, seg, n):
    out = torch.zeros((n,) + src.shape[1:], dtype=src.dtype)
    return out.index_add_(0, seg, src)

def _pad(x, pw):
    flat = tuple((v for pair in reversed(pw) for v in pair))
    return torch.nn.functional.pad(x, flat)
kernel_name = 'standalone__dilated_atrous__vision'

def setup_inputs():

    _w = lambda a: (lambda t: t.to(torch.bfloat16) if t.is_floating_point() else t)(torch.as_tensor(a))
    H = W = 512
    C = 96
    k = 3
    return {'x': _w((lambda *s: torch.randn(*s, dtype=torch.bfloat16) * 0.05)(1, H, W, C)), 'w': _w((lambda *s: torch.randn(*s, dtype=torch.bfloat16) * 0.05)(k, k, C, C) * (1.0 / (k * C ** 0.5)))}

def reference(x, w):
    B, H, W, C = x.shape
    k = 3
    rate = 2
    pad = (k - 1) * rate // 2
    xp = _pad(x, ((0, 0), (pad, pad), (pad, pad), (0, 0)))
    out = torch.zeros_like(x)
    for i in range(k):
        for j in range(k):
            tap = xp[:, i * rate:i * rate + H, j * rate:j * rate + W, :].clone()
            out = out + torch.einsum('bhwc,co->bhwo', tap, w[i, j])
    return out
```

```asm
; @launch grid=(256,1,1) block=(256,1,1) lds=163840
.amdgcn_target "amdgcn-amd-amdhsa--gfx950"
.text
.globl standalone__dilated_atrous__vision_kernel
.p2align 8
.type standalone__dilated_atrous__vision_kernel,@function
standalone__dilated_atrous__vision_kernel:
    s_cmp_ge_u32 s2, 256
    s_cbranch_scc1 L_end
    s_load_dwordx4 s[4:7], s[0:1], 0
    s_load_dwordx2 s[8:9], s[0:1], 16
    v_lshrrev_b32 v23, 6, v0
    s_and_b32 s37, s2, 7
    v_readfirstlane_b32 s24, v23
    s_lshr_b32 s38, s2, 3
    s_and_b32 s38, s38, 1
    s_lshr_b32 s39, s2, 4
    s_lshl_b32 s39, s39, 5
    s_add_u32 s39, s39, s38
    s_mul_i32 s40, s37, 12288
    s_sub_u32 s41, s40, 384
    v_mul_u32_u24 v25, 43691, v0
    v_lshlrev_b32 v26, 4, v0
    v_lshrrev_b32 v25, 19, v25
    v_and_b32 v27, 4, v25
    v_and_b32 v28, 8, v25
    v_lshlrev_b32 v27, 3, v27
    v_lshlrev_b32 v28, 2, v28
    v_xor_b32 v27, v27, v26
    v_xor_b32 v13, v28, v26
    v_add_u32 v2, s41, v27
    v_add_u32 v24, 256, v0
    v_mul_u32_u24 v25, 43691, v24
    v_lshlrev_b32 v26, 4, v24
    v_lshrrev_b32 v25, 19, v25
    v_and_b32 v27, 4, v25
    v_and_b32 v28, 8, v25
    v_lshlrev_b32 v27, 3, v27
    v_lshlrev_b32 v28, 2, v28
    v_xor_b32 v27, v27, v26
    v_xor_b32 v14, v28, v26
    v_add_u32 v3, s41, v27
    v_add_u32 v24, 512, v0
    v_mul_u32_u24 v25, 43691, v24
    v_lshlrev_b32 v26, 4, v24
    v_lshrrev_b32 v25, 19, v25
    v_and_b32 v27, 4, v25
    v_and_b32 v28, 8, v25
    v_lshlrev_b32 v27, 3, v27
    v_lshlrev_b32 v28, 2, v28
    v_xor_b32 v27, v27, v26
    v_xor_b32 v15, v28, v26
    v_add_u32 v4, s41, v27
    s_cmp_eq_u32 s37, 0
    s_cselect_b32 s42, 24, 0
    v_mov_b32 v29, 0x80000000
    v_cmp_gt_u32 vcc, s42, v0
    v_and_b32 v30, 63, v0
    s_lshl_b32 s26, s24, 10
    v_cndmask_b32 v2, v2, v29, vcc
    s_add_u32 s27, s26, 4096
    s_add_u32 s28, s26, 8192
    s_mul_i32 s43, s24, 192
    s_add_u32 s29, s43, 12288
    s_add_u32 s44, s41, s29
    s_lshl_b32 s45, s37, 2
    s_add_u32 s45, s45, s24
    s_cmp_ge_u32 s45, 30
    s_cselect_b32 s44, 0x80000000, s44
    v_lshlrev_b32 v23, 4, v30
    v_add_u32 v5, s44, v23
    s_sub_u32 s33, s39, 2
    s_mul_i32 s32, s33, 98304
    s_add_u32 s34, s39, 33
    s_min_u32 s34, s34, 512
    s_waitcnt lgkmcnt(0)
    s_mov_b32 s12, s4
    s_and_b32 s13, s5, 0xffff
    s_cmp_lt_u32 s33, s34
    s_cselect_b32 s14, 50331648, 0
    s_mov_b32 s15, 0x20000
    s_mov_b32 s16, s6
    s_and_b32 s17, s7, 0xffff
    s_mov_b32 s18, 165888
    s_mov_b32 s19, 0x20000
    s_mov_b32 s30, 0
    s_add_u32 m0, s30, s26
    s_nop 0
    buffer_load_dwordx4 v2, s[12:15], s32 offen lds
    s_add_u32 m0, s30, s27
    s_nop 0
    buffer_load_dwordx4 v3, s[12:15], s32 offen lds
    s_add_u32 m0, s30, s28
    s_nop 0
    buffer_load_dwordx4 v4, s[12:15], s32 offen lds
    s_add_u32 m0, s30, s29
    s_nop 0
    s_mov_b64 exec, 0xfff
    buffer_load_dwordx4 v5, s[12:15], s32 offen lds
    s_mov_b64 exec, -1
    s_lshl_b32 s42, s24, 5
    s_add_u32 s42, s42, 3328
    v_add_u32 v24, s42, v30
    v_mul_u32_u24 v25, 43691, v24
    v_lshlrev_b32 v26, 4, v24
    v_lshrrev_b32 v25, 19, v25
    v_and_b32 v28, 8, v25
    v_lshlrev_b32 v28, 2, v28
    v_xor_b32 v16, v28, v26
    s_add_u32 m0, s26, 53248
    s_mov_b32 s46, 0
    buffer_load_dwordx4 v13, s[16:19], s46 offen lds
    s_add_u32 m0, s26, 57344
    s_mov_b32 s46, 0
    buffer_load_dwordx4 v14, s[16:19], s46 offen lds
    s_add_u32 m0, s26, 61440
    s_mov_b32 s46, 0
    buffer_load_dwordx4 v15, s[16:19], s46 offen lds
    s_add_u32 m0, s26, 65536
    s_mov_b32 s46, 12288
    buffer_load_dwordx4 v13, s[16:19], s46 offen lds
    s_add_u32 m0, s26, 69632
    s_mov_b32 s46, 12288
    buffer_load_dwordx4 v14, s[16:19], s46 offen lds
    s_add_u32 m0, s26, 73728
    s_mov_b32 s46, 12288
    buffer_load_dwordx4 v15, s[16:19], s46 offen lds
    s_add_u32 m0, s26, 77824
    s_mov_b32 s46, 24576
    buffer_load_dwordx4 v13, s[16:19], s46 offen lds
    s_add_u32 m0, s26, 81920
    s_mov_b32 s46, 24576
    buffer_load_dwordx4 v14, s[16:19], s46 offen lds
    s_add_u32 m0, s26, 86016
    s_mov_b32 s46, 24576
    buffer_load_dwordx4 v15, s[16:19], s46 offen lds
    s_add_u32 m0, s26, 90112
    s_mov_b32 s46, 36864
    buffer_load_dwordx4 v13, s[16:19], s46 offen lds
    s_add_u32 m0, s26, 94208
    s_mov_b32 s46, 36864
    buffer_load_dwordx4 v14, s[16:19], s46 offen lds
    s_add_u32 m0, s26, 98304
    s_mov_b32 s46, 36864
    buffer_load_dwordx4 v15, s[16:19], s46 offen lds
    s_add_u32 m0, s26, 102400
    s_mov_b32 s46, 49152
    buffer_load_dwordx4 v13, s[16:19], s46 offen lds
    s_lshr_b32 s37, s26, 1
    s_add_u32 m0, s37, 106496
    s_mov_b32 s46, 0
    s_mov_b32 exec_hi, 0
    buffer_load_dwordx4 v16, s[16:19], s46 offen lds
    s_mov_b64 exec, -1
    v_and_b32 v23, 15, v30
    v_lshrrev_b32 v24, 4, v30
    s_lshr_b32 s42, s24, 1
    s_and_b32 s43, s24, 1
    s_lshl_b32 s42, s42, 5
    s_mul_i32 s43, s43, 96
    v_lshlrev_b32 v25, 4, v24
    v_add_u32 v26, s42, v23
    v_and_b32 v27, 4, v26
    v_mul_u32_u24 v28, 192, v26
    v_lshlrev_b32 v27, 3, v27
    v_xor_b32 v27, v27, v25
    v_add_u32 v6, v28, v27
    v_mov_b32 v9, v6
    v_add_u32 v26, s42, v23
    v_add_u32 v26, 2, v26
    v_and_b32 v27, 4, v26
    v_mul_u32_u24 v28, 192, v26
    v_lshlrev_b32 v27, 3, v27
    v_xor_b32 v27, v27, v25
    v_add_u32 v7, v28, v27
    v_mov_b32 v10, v7
    v_add_u32 v26, s42, v23
    v_add_u32 v26, 4, v26
    v_and_b32 v27, 4, v26
    v_mul_u32_u24 v28, 192, v26
    v_lshlrev_b32 v27, 3, v27
    v_xor_b32 v27, v27, v25
    v_add_u32 v8, v28, v27
    v_mov_b32 v11, v8
    v_add_u32 v26, s42, v23
    v_mul_u32_u24 v26, 192, v26
    v_lshlrev_b32 v27, 3, v24
    s_add_u32 s44, s40, s43
    v_add3_u32 v12, v26, v27, s44
    v_lshrrev_b32 v26, 2, v23
    v_lshl_add_u32 v26, v24, 3, v26
    v_mul_u32_u24 v26, 192, v26
    v_and_b32 v27, 3, v23
    v_lshlrev_b32 v27, 3, v27
    v_and_b32 v28, 1, v24
    v_lshlrev_b32 v28, 5, v28
    v_add_u32 v27, s43, v27
    v_add_u32 v29, 0, v27
    v_xor_b32 v29, v29, v28
    v_add_u32 v29, v29, v26
    v_add_u32 v17, 53248, v29
    v_add_u32 v20, 108544, v29
    v_add_u32 v29, 32, v27
    v_xor_b32 v29, v29, v28
    v_add_u32 v29, v29, v26
    v_add_u32 v18, 53248, v29
    v_add_u32 v21, 108544, v29
    v_add_u32 v29, 64, v27
    v_xor_b32 v29, v29, v28
    v_add_u32 v29, v29, v26
    v_add_u32 v19, 53248, v29
    v_add_u32 v22, 108544, v29
    s_mov_b32 s20, s8
    s_and_b32 s21, s9, 0xffff
    s_mov_b32 s22, 0
    s_mov_b32 s23, 0x20000
    s_sub_u32 s35, s39, 2
    s_mul_i32 s35, s35, 98304
    s_add_u32 s32, s32, 196608
    s_add_u32 s33, s33, 2
    s_cmp_lt_u32 s33, s34
    s_cselect_b32 s14, 50331648, 0
    s_mov_b32 s31, 13312
    s_add_u32 m0, s31, s26
    s_nop 0
    buffer_load_dwordx4 v2, s[12:15], s32 offen lds
    s_add_u32 m0, s31, s27
    s_nop 0
    buffer_load_dwordx4 v3, s[12:15], s32 offen lds
    s_add_u32 m0, s31, s28
    s_nop 0
    buffer_load_dwordx4 v4, s[12:15], s32 offen lds
    s_add_u32 m0, s31, s29
    s_nop 0
    s_mov_b64 exec, 0xfff
    buffer_load_dwordx4 v5, s[12:15], s32 offen lds
    s_mov_b64 exec, -1
    s_add_u32 m0, s26, 108544
    s_mov_b32 s46, 55296
    buffer_load_dwordx4 v13, s[16:19], s46 offen lds
    s_add_u32 m0, s26, 112640
    s_mov_b32 s46, 55296
    buffer_load_dwordx4 v14, s[16:19], s46 offen lds
    s_add_u32 m0, s26, 116736
    s_mov_b32 s46, 55296
    buffer_load_dwordx4 v15, s[16:19], s46 offen lds
    s_add_u32 m0, s26, 120832
    s_mov_b32 s46, 67584
    buffer_load_dwordx4 v13, s[16:19], s46 offen lds
    s_add_u32 m0, s26, 124928
    s_mov_b32 s46, 67584
    buffer_load_dwordx4 v14, s[16:19], s46 offen lds
    s_add_u32 m0, s26, 129024
    s_mov_b32 s46, 67584
    buffer_load_dwordx4 v15, s[16:19], s46 offen lds
    s_add_u32 m0, s26, 133120
    s_mov_b32 s46, 79872
    buffer_load_dwordx4 v13, s[16:19], s46 offen lds
    s_add_u32 m0, s26, 137216
    s_mov_b32 s46, 79872
    buffer_load_dwordx4 v14, s[16:19], s46 offen lds
    s_add_u32 m0, s26, 141312
    s_mov_b32 s46, 79872
    buffer_load_dwordx4 v15, s[16:19], s46 offen lds
    s_add_u32 m0, s26, 145408
    s_mov_b32 s46, 92160
    buffer_load_dwordx4 v13, s[16:19], s46 offen lds
    s_add_u32 m0, s26, 149504
    s_mov_b32 s46, 92160
    buffer_load_dwordx4 v14, s[16:19], s46 offen lds
    s_add_u32 m0, s26, 153600
    s_mov_b32 s46, 92160
    buffer_load_dwordx4 v15, s[16:19], s46 offen lds
    s_add_u32 m0, s26, 157696
    s_mov_b32 s46, 104448
    buffer_load_dwordx4 v13, s[16:19], s46 offen lds
    s_lshr_b32 s37, s26, 1
    s_add_u32 m0, s37, 161792
    s_mov_b32 s46, 55296
    s_mov_b32 exec_hi, 0
    buffer_load_dwordx4 v16, s[16:19], s46 offen lds
    s_mov_b64 exec, -1
    s_add_u32 s32, s32, 196608
    s_add_u32 s33, s33, 2
    s_cmp_lt_u32 s33, s34
    s_cselect_b32 s14, 50331648, 0
    s_mov_b32 s31, 26624
    s_add_u32 m0, s31, s26
    s_nop 0
    buffer_load_dwordx4 v2, s[12:15], s32 offen lds
    s_add_u32 m0, s31, s27
    s_nop 0
    buffer_load_dwordx4 v3, s[12:15], s32 offen lds
    s_add_u32 m0, s31, s28
    s_nop 0
    buffer_load_dwordx4 v4, s[12:15], s32 offen lds
    s_add_u32 m0, s31, s29
    s_nop 0
    s_mov_b64 exec, 0xfff
    buffer_load_dwordx4 v5, s[12:15], s32 offen lds
    s_mov_b64 exec, -1
    s_add_u32 s32, s32, 196608
    s_add_u32 s33, s33, 2
    s_cmp_lt_u32 s33, s34
    s_cselect_b32 s14, 50331648, 0
    s_mov_b32 s31, 39936
    s_add_u32 m0, s31, s26
    s_nop 0
    buffer_load_dwordx4 v2, s[12:15], s32 offen lds
    s_add_u32 m0, s31, s27
    s_nop 0
    buffer_load_dwordx4 v3, s[12:15], s32 offen lds
    s_add_u32 m0, s31, s28
    s_nop 0
    buffer_load_dwordx4 v4, s[12:15], s32 offen lds
    s_add_u32 m0, s31, s29
    s_nop 0
    s_mov_b64 exec, 0xfff
    buffer_load_dwordx4 v5, s[12:15], s32 offen lds
    s_mov_b64 exec, -1
    s_waitcnt vmcnt(8)
    s_barrier
    ds_read_b128 v[32:35], v9 offset:0
    ds_read_b64_tr_b16 a[0:1], v17 offset:0
    ds_read_b64_tr_b16 a[2:3], v17 offset:768
    ds_read_b64_tr_b16 a[4:5], v18 offset:0
    ds_read_b64_tr_b16 a[6:7], v18 offset:768
    ds_read_b64_tr_b16 a[8:9], v19 offset:0
    ds_read_b64_tr_b16 a[10:11], v19 offset:768
    ds_read_b128 v[36:39], v9 offset:64
    ds_read_b64_tr_b16 a[12:13], v17 offset:6144
    ds_read_b64_tr_b16 a[14:15], v17 offset:6912
    ds_read_b64_tr_b16 a[16:17], v18 offset:6144
    ds_read_b64_tr_b16 a[18:19], v18 offset:6912
    ds_read_b64_tr_b16 a[20:21], v19 offset:6144
    ds_read_b64_tr_b16 a[22:23], v19 offset:6912
    ds_read_b128 v[40:43], v9 offset:128
    ds_read_b64_tr_b16 a[24:25], v17 offset:12288
    ds_read_b64_tr_b16 a[26:27], v17 offset:13056
    s_waitcnt lgkmcnt(14)
    v_mfma_f32_16x16x32_bf16 v[68:71], a[0:3], v[32:35], 0
    ds_read_b128 v[44:47], v10 offset:0
    ds_read_b64_tr_b16 a[28:29], v18 offset:12288
    ds_read_b64_tr_b16 a[30:31], v18 offset:13056
    s_waitcnt lgkmcnt(14)
    v_mfma_f32_16x16x32_bf16 v[72:75], a[4:7], v[32:35], 0
    ds_read_b64_tr_b16 a[32:33], v19 offset:12288
    ds_read_b64_tr_b16 a[34:35], v19 offset:13056
    s_waitcnt lgkmcnt(14)
    v_mfma_f32_16x16x32_bf16 v[76:79], a[8:11], v[32:35], 0
    ds_read_b64_tr_b16 a[36:37], v17 offset:18432
    ds_read_b64_tr_b16 a[38:39], v17 offset:19200
    s_waitcnt lgkmcnt(14)
    v_mfma_f32_16x16x32_bf16 v[68:71], a[12:15], v[36:39], v[68:71]
    ds_read_b128 v[48:51], v10 offset:64
    ds_read_b64_tr_b16 a[40:41], v18 offset:18432
    ds_read_b64_tr_b16 a[42:43], v18 offset:19200
    s_waitcnt lgkmcnt(14)
    v_mfma_f32_16x16x32_bf16 v[72:75], a[16:19], v[36:39], v[72:75]
    ds_read_b64_tr_b16 a[44:45], v19 offset:18432
    ds_read_b64_tr_b16 a[46:47], v19 offset:19200
    s_waitcnt lgkmcnt(14)
    v_mfma_f32_16x16x32_bf16 v[76:79], a[20:23], v[36:39], v[76:79]
    ds_read_b64_tr_b16 a[48:49], v17 offset:24576
    ds_read_b64_tr_b16 a[50:51], v17 offset:25344
    s_waitcnt lgkmcnt(14)
    v_mfma_f32_16x16x32_bf16 v[68:71], a[24:27], v[40:43], v[68:71]
    ds_read_b128 v[52:55], v10 offset:128
    ds_read_b64_tr_b16 a[52:53], v18 offset:24576
    ds_read_b64_tr_b16 a[54:55], v18 offset:25344
    s_waitcnt lgkmcnt(14)
    v_mfma_f32_16x16x32_bf16 v[72:75], a[28:31], v[40:43], v[72:75]
    ds_read_b64_tr_b16 a[56:57], v19 offset:24576
    ds_read_b64_tr_b16 a[58:59], v19 offset:25344
    s_waitcnt lgkmcnt(14)
    v_mfma_f32_16x16x32_bf16 v[76:79], a[32:35], v[40:43], v[76:79]
    ds_read_b64_tr_b16 a[60:61], v17 offset:30720
    ds_read_b64_tr_b16 a[62:63], v17 offset:31488
    s_waitcnt lgkmcnt(14)
    v_mfma_f32_16x16x32_bf16 v[68:71], a[36:39], v[44:47], v[68:71]
    ds_read_b128 v[32:35], v11 offset:0
    ds_read_b64_tr_b16 a[64:65], v18 offset:30720
    ds_read_b64_tr_b16 a[66:67], v18 offset:31488
    s_waitcnt lgkmcnt(14)
    v_mfma_f32_16x16x32_bf16 v[72:75], a[40:43], v[44:47], v[72:75]
    ds_read_b64_tr_b16 a[68:69], v19 offset:30720
    ds_read_b64_tr_b16 a[70:71], v19 offset:31488
    s_waitcnt lgkmcnt(14)
    v_mfma_f32_16x16x32_bf16 v[76:79], a[44:47], v[44:47], v[76:79]
    ds_read_b64_tr_b16 a[72:73], v17 offset:36864
    ds_read_b64_tr_b16 a[74:75], v17 offset:37632
    s_waitcnt lgkmcnt(14)
    v_mfma_f32_16x16x32_bf16 v[68:71], a[48:51], v[48:51], v[68:71]
    ds_read_b128 v[36:39], v11 offset:64
    ds_read_b64_tr_b16 a[76:77], v18 offset:36864
    ds_read_b64_tr_b16 a[78:79], v18 offset:37632
    s_waitcnt lgkmcnt(14)
    v_mfma_f32_16x16x32_bf16 v[72:75], a[52:55], v[48:51], v[72:75]
    ds_read_b64_tr_b16 a[80:81], v19 offset:36864
    ds_read_b64_tr_b16 a[82:83], v19 offset:37632
    s_waitcnt lgkmcnt(14)
    v_mfma_f32_16x16x32_bf16 v[76:79], a[56:59], v[48:51], v[76:79]
    ds_read_b64_tr_b16 a[84:85], v17 offset:43008
    ds_read_b64_tr_b16 a[86:87], v17 offset:43776
    s_waitcnt lgkmcnt(14)
    v_mfma_f32_16x16x32_bf16 v[68:71], a[60:63], v[52:55], v[68:71]
    ds_read_b128 v[40:43], v11 offset:128
    ds_read_b64_tr_b16 a[88:89], v18 offset:43008
    ds_read_b64_tr_b16 a[90:91], v18 offset:43776
    s_waitcnt lgkmcnt(14)
    v_mfma_f32_16x16x32_bf16 v[72:75], a[64:67], v[52:55], v[72:75]
    ds_read_b64_tr_b16 a[92:93], v19 offset:43008
    ds_read_b64_tr_b16 a[94:95], v19 offset:43776
    s_waitcnt lgkmcnt(14)
    v_mfma_f32_16x16x32_bf16 v[76:79], a[68:71], v[52:55], v[76:79]
    ds_read_b64_tr_b16 a[96:97], v17 offset:49152
    ds_read_b64_tr_b16 a[98:99], v17 offset:49920
    s_waitcnt lgkmcnt(14)
    v_mfma_f32_16x16x32_bf16 v[68:71], a[72:75], v[32:35], v[68:71]
    ds_read_b128 v[44:47], v9 offset:3072
    ds_read_b64_tr_b16 a[100:101], v18 offset:49152
    ds_read_b64_tr_b16 a[102:103], v18 offset:49920
    s_waitcnt lgkmcnt(14)
    v_mfma_f32_16x16x32_bf16 v[72:75], a[76:79], v[32:35], v[72:75]
    ds_read_b64_tr_b16 a[104:105], v19 offset:49152
    ds_read_b64_tr_b16 a[106:107], v19 offset:49920
    s_waitcnt lgkmcnt(14)
    v_mfma_f32_16x16x32_bf16 v[76:79], a[80:83], v[32:35], v[76:79]
    s_waitcnt lgkmcnt(12)
    v_mfma_f32_16x16x32_bf16 v[68:71], a[84:87], v[36:39], v[68:71]
    ds_read_b128 v[48:51], v9 offset:3136
    s_waitcnt lgkmcnt(10)
    v_mfma_f32_16x16x32_bf16 v[72:75], a[88:91], v[36:39], v[72:75]
    s_waitcnt lgkmcnt(8)
    v_mfma_f32_16x16x32_bf16 v[76:79], a[92:95], v[36:39], v[76:79]
    s_waitcnt lgkmcnt(6)
    v_mfma_f32_16x16x32_bf16 v[68:71], a[96:99], v[40:43], v[68:71]
    ds_read_b128 v[52:55], v9 offset:3200
    s_waitcnt lgkmcnt(4)
    v_mfma_f32_16x16x32_bf16 v[72:75], a[100:103], v[40:43], v[72:75]
    s_waitcnt lgkmcnt(2)
    v_mfma_f32_16x16x32_bf16 v[76:79], a[104:107], v[40:43], v[76:79]
    ds_read_b64_tr_b16 a[108:109], v20 offset:0
    ds_read_b64_tr_b16 a[110:111], v20 offset:768
    v_mfma_f32_16x16x32_bf16 v[80:83], a[0:3], v[44:47], 0
    ds_read_b128 v[32:35], v10 offset:3072
    ds_read_b64_tr_b16 a[112:113], v21 offset:0
    ds_read_b64_tr_b16 a[114:115], v21 offset:768
    v_mfma_f32_16x16x32_bf16 v[84:87], a[4:7], v[44:47], 0
    ds_read_b64_tr_b16 a[116:117], v22 offset:0
    ds_read_b64_tr_b16 a[118:119], v22 offset:768
    v_mfma_f32_16x16x32_bf16 v[88:91], a[8:11], v[44:47], 0
    ds_read_b64_tr_b16 a[120:121], v20 offset:6144
    ds_read_b64_tr_b16 a[122:123], v20 offset:6912
    s_waitcnt lgkmcnt(10)
    v_mfma_f32_16x16x32_bf16 v[80:83], a[12:15], v[48:51], v[80:83]
    ds_read_b128 v[36:39], v10 offset:3136
    ds_read_b64_tr_b16 a[124:125], v21 offset:6144
    ds_read_b64_tr_b16 a[126:127], v21 offset:6912
    v_mfma_f32_16x16x32_bf16 v[84:87], a[16:19], v[48:51], v[84:87]
    ds_read_b64_tr_b16 a[128:129], v22 offset:6144
    ds_read_b64_tr_b16 a[130:131], v22 offset:6912
    v_mfma_f32_16x16x32_bf16 v[88:91], a[20:23], v[48:51], v[88:91]
    ds_read_b64_tr_b16 a[132:133], v20 offset:12288
    ds_read_b64_tr_b16 a[134:135], v20 offset:13056
    s_waitcnt lgkmcnt(14)
    v_mfma_f32_16x16x32_bf16 v[80:83], a[24:27], v[52:55], v[80:83]
    ds_read_b128 v[40:43], v10 offset:3200
    ds_read_b64_tr_b16 a[136:137], v21 offset:12288
    ds_read_b64_tr_b16 a[138:139], v21 offset:13056
    v_mfma_f32_16x16x32_bf16 v[84:87], a[28:31], v[52:55], v[84:87]
    ds_read_b64_tr_b16 a[140:141], v22 offset:12288
    ds_read_b64_tr_b16 a[142:143], v22 offset:13056
    v_mfma_f32_16x16x32_bf16 v[88:91], a[32:35], v[52:55], v[88:91]
    ds_read_b64_tr_b16 a[144:145], v20 offset:18432
    ds_read_b64_tr_b16 a[146:147], v20 offset:19200
    s_waitcnt lgkmcnt(14)
    v_mfma_f32_16x16x32_bf16 v[80:83], a[36:39], v[32:35], v[80:83]
    ds_read_b128 v[44:47], v11 offset:3072
    ds_read_b64_tr_b16 a[148:149], v21 offset:18432
    ds_read_b64_tr_b16 a[150:151], v21 offset:19200
    v_mfma_f32_16x16x32_bf16 v[84:87], a[40:43], v[32:35], v[84:87]
    ds_read_b64_tr_b16 a[152:153], v22 offset:18432
    ds_read_b64_tr_b16 a[154:155], v22 offset:19200
    v_mfma_f32_16x16x32_bf16 v[88:91], a[44:47], v[32:35], v[88:91]
    ds_read_b64_tr_b16 a[156:157], v20 offset:24576
    ds_read_b64_tr_b16 a[158:159], v20 offset:25344
    s_waitcnt lgkmcnt(14)
    v_mfma_f32_16x16x32_bf16 v[80:83], a[48:51], v[36:39], v[80:83]
    ds_read_b128 v[48:51], v11 offset:3136
    ds_read_b64_tr_b16 a[160:161], v21 offset:24576
    ds_read_b64_tr_b16 a[162:163], v21 offset:25344
    v_mfma_f32_16x16x32_bf16 v[84:87], a[52:55], v[36:39], v[84:87]
    ds_read_b64_tr_b16 a[164:165], v22 offset:24576
    ds_read_b64_tr_b16 a[166:167], v22 offset:25344
    v_mfma_f32_16x16x32_bf16 v[88:91], a[56:59], v[36:39], v[88:91]
    ds_read_b64_tr_b16 a[168:169], v20 offset:30720
    ds_read_b64_tr_b16 a[170:171], v20 offset:31488
    s_waitcnt lgkmcnt(14)
    v_mfma_f32_16x16x32_bf16 v[80:83], a[60:63], v[40:43], v[80:83]
    ds_read_b128 v[52:55], v11 offset:3200
    ds_read_b64_tr_b16 a[172:173], v21 offset:30720
    ds_read_b64_tr_b16 a[174:175], v21 offset:31488
    v_mfma_f32_16x16x32_bf16 v[84:87], a[64:67], v[40:43], v[84:87]
    ds_read_b64_tr_b16 a[176:177], v22 offset:30720
    ds_read_b64_tr_b16 a[178:179], v22 offset:31488
    v_mfma_f32_16x16x32_bf16 v[88:91], a[68:71], v[40:43], v[88:91]
    s_mov_b32 s31, s30
    s_add_u32 s30, s30, 13312
    s_cmp_eq_u32 s30, 53248
    s_cselect_b32 s30, 0, s30
    ds_read_b64_tr_b16 a[180:181], v20 offset:36864
    ds_read_b64_tr_b16 a[182:183], v20 offset:37632
    s_waitcnt lgkmcnt(14)
    v_mfma_f32_16x16x32_bf16 v[80:83], a[72:75], v[44:47], v[80:83]
    s_add_u32 s32, s32, 196608
    s_add_u32 s33, s33, 2
    s_cmp_lt_u32 s33, s34
    s_cselect_b32 s14, 50331648, 0
    ds_read_b64_tr_b16 a[184:185], v21 offset:36864
    ds_read_b64_tr_b16 a[186:187], v21 offset:37632
    v_mfma_f32_16x16x32_bf16 v[84:87], a[76:79], v[44:47], v[84:87]
    v_mfma_f32_16x16x32_bf16 v[88:91], a[80:83], v[44:47], v[88:91]
    s_waitcnt lgkmcnt(0)
    s_barrier
    v_mfma_f32_16x16x32_bf16 v[80:83], a[84:87], v[48:51], v[80:83]
    v_add_u32 v9, s30, v6
    s_add_u32 m0, s31, s26
    v_mfma_f32_16x16x32_bf16 v[84:87], a[88:91], v[48:51], v[84:87]
    v_add_u32 v10, s30, v7
    ds_read_b128 v[32:35], v9 offset:0
    buffer_load_dwordx4 v2, s[12:15], s32 offen lds
    s_add_u32 m0, s31, s27
    v_mfma_f32_16x16x32_bf16 v[88:91], a[92:95], v[48:51], v[88:91]
    v_add_u32 v11, s30, v8
    buffer_load_dwordx4 v3, s[12:15], s32 offen lds
    s_add_u32 m0, s31, s28
    v_mfma_f32_16x16x32_bf16 v[80:83], a[96:99], v[52:55], v[80:83]
    buffer_load_dwordx4 v4, s[12:15], s32 offen lds
    s_add_u32 m0, s31, s29
    v_mfma_f32_16x16x32_bf16 v[84:87], a[100:103], v[52:55], v[84:87]
    ds_read_b128 v[36:39], v9 offset:64
    s_mov_b64 exec, 0xfff
    buffer_load_dwordx4 v5, s[12:15], s32 offen lds
    s_mov_b64 exec, -1
    v_mfma_f32_16x16x32_bf16 v[88:91], a[104:107], v[52:55], v[88:91]
    ds_read_b64_tr_b16 a[188:189], v22 offset:36864
    ds_read_b64_tr_b16 a[190:191], v22 offset:37632
    s_waitcnt lgkmcnt(3)
    v_mfma_f32_16x16x32_bf16 v[92:95], a[108:111], v[32:35], v[68:71]
    ds_read_b128 v[40:43], v9 offset:128
    ds_read_b64_tr_b16 a[192:193], v20 offset:43008
    ds_read_b64_tr_b16 a[194:195], v20 offset:43776
    s_add_u32 m0, s26, 53248
    s_mov_b32 s46, 110592
    v_mfma_f32_16x16x32_bf16 v[96:99], a[112:115], v[32:35], v[72:75]
    ds_read_b64_tr_b16 a[196:197], v21 offset:43008
    ds_read_b64_tr_b16 a[198:199], v21 offset:43776
    buffer_load_dwordx4 v13, s[16:19], s46 offen lds
    v_mfma_f32_16x16x32_bf16 v[100:103], a[116:119], v[32:35], v[76:79]
    ds_read_b64_tr_b16 a[200:201], v22 offset:43008
    ds_read_b64_tr_b16 a[202:203], v22 offset:43776
    v_mfma_f32_16x16x32_bf16 v[68:71], a[0:3], v[32:35], 0
    ds_read_b64_tr_b16 a[204:205], v20 offset:49152
    ds_read_b64_tr_b16 a[206:207], v20 offset:49920
    s_add_u32 m0, s26, 57344
    s_mov_b32 s46, 110592
    v_mfma_f32_16x16x32_bf16 v[72:75], a[4:7], v[32:35], 0
    ds_read_b64_tr_b16 a[208:209], v21 offset:49152
    ds_read_b64_tr_b16 a[210:211], v21 offset:49920
    buffer_load_dwordx4 v14, s[16:19], s46 offen lds
    v_mfma_f32_16x16x32_bf16 v[76:79], a[8:11], v[32:35], 0
    ds_read_b64_tr_b16 a[212:213], v22 offset:49152
    ds_read_b64_tr_b16 a[214:215], v22 offset:49920
    s_waitcnt lgkmcnt(14)
    v_mfma_f32_16x16x32_bf16 v[92:95], a[120:123], v[36:39], v[92:95]
    ds_read_b128 v[44:47], v10 offset:0
    s_add_u32 m0, s26, 61440
    s_mov_b32 s46, 110592
    s_waitcnt lgkmcnt(14)
    v_mfma_f32_16x16x32_bf16 v[96:99], a[124:127], v[36:39], v[96:99]
    buffer_load_dwordx4 v15, s[16:19], s46 offen lds
    v_mfma_f32_16x16x32_bf16 v[100:103], a[128:131], v[36:39], v[100:103]
    v_mfma_f32_16x16x32_bf16 v[68:71], a[12:15], v[36:39], v[68:71]
    s_add_u32 m0, s26, 65536
    s_mov_b32 s46, 122880
    v_mfma_f32_16x16x32_bf16 v[72:75], a[16:19], v[36:39], v[72:75]
    buffer_load_dwordx4 v13, s[16:19], s46 offen lds
    v_mfma_f32_16x16x32_bf16 v[76:79], a[20:23], v[36:39], v[76:79]
    s_waitcnt lgkmcnt(13)
    v_mfma_f32_16x16x32_bf16 v[92:95], a[132:135], v[40:43], v[92:95]
    ds_read_b128 v[48:51], v10 offset:64
    s_add_u32 m0, s26, 69632
    s_mov_b32 s46, 122880
    v_mfma_f32_16x16x32_bf16 v[96:99], a[136:139], v[40:43], v[96:99]
    buffer_load_dwordx4 v14, s[16:19], s46 offen lds
    v_mfma_f32_16x16x32_bf16 v[100:103], a[140:143], v[40:43], v[100:103]
    v_mfma_f32_16x16x32_bf16 v[68:71], a[24:27], v[40:43], v[68:71]
    s_add_u32 m0, s26, 73728
    s_mov_b32 s46, 122880
    v_mfma_f32_16x16x32_bf16 v[72:75], a[28:31], v[40:43], v[72:75]
    buffer_load_dwordx4 v15, s[16:19], s46 offen lds
    v_mfma_f32_16x16x32_bf16 v[76:79], a[32:35], v[40:43], v[76:79]
    s_waitcnt lgkmcnt(1)
    v_mfma_f32_16x16x32_bf16 v[92:95], a[144:147], v[44:47], v[92:95]
    ds_read_b128 v[52:55], v10 offset:128
    s_add_u32 m0, s26, 77824
    s_mov_b32 s46, 135168
    v_mfma_f32_16x16x32_bf16 v[96:99], a[148:151], v[44:47], v[96:99]
    buffer_load_dwordx4 v13, s[16:19], s46 offen lds
    v_mfma_f32_16x16x32_bf16 v[100:103], a[152:155], v[44:47], v[100:103]
    v_mfma_f32_16x16x32_bf16 v[68:71], a[36:39], v[44:47], v[68:71]
    s_add_u32 m0, s26, 81920
    s_mov_b32 s46, 135168
    v_mfma_f32_16x16x32_bf16 v[72:75], a[40:43], v[44:47], v[72:75]
    buffer_load_dwordx4 v14, s[16:19], s46 offen lds
    v_mfma_f32_16x16x32_bf16 v[76:79], a[44:47], v[44:47], v[76:79]
    s_waitcnt lgkmcnt(1)
    v_mfma_f32_16x16x32_bf16 v[92:95], a[156:159], v[48:51], v[92:95]
    ds_read_b128 v[32:35], v11 offset:0
    s_add_u32 m0, s26, 86016
    s_mov_b32 s46, 135168
    v_mfma_f32_16x16x32_bf16 v[96:99], a[160:163], v[48:51], v[96:99]
    buffer_load_dwordx4 v15, s[16:19], s46 offen lds
    v_mfma_f32_16x16x32_bf16 v[100:103], a[164:167], v[48:51], v[100:103]
    v_mfma_f32_16x16x32_bf16 v[68:71], a[48:51], v[48:51], v[68:71]
    s_add_u32 m0, s26, 90112
    s_mov_b32 s46, 147456
    v_mfma_f32_16x16x32_bf16 v[72:75], a[52:55], v[48:51], v[72:75]
    buffer_load_dwordx4 v13, s[16:19], s46 offen lds
    v_mfma_f32_16x16x32_bf16 v[76:79], a[56:59], v[48:51], v[76:79]
    s_waitcnt lgkmcnt(1)
    v_mfma_f32_16x16x32_bf16 v[92:95], a[168:171], v[52:55], v[92:95]
    ds_read_b128 v[36:39], v11 offset:64
    s_add_u32 m0, s26, 94208
    s_mov_b32 s46, 147456
    v_mfma_f32_16x16x32_bf16 v[96:99], a[172:175], v[52:55], v[96:99]
    buffer_load_dwordx4 v14, s[16:19], s46 offen lds
    v_mfma_f32_16x16x32_bf16 v[100:103], a[176:179], v[52:55], v[100:103]
    v_mfma_f32_16x16x32_bf16 v[68:71], a[60:63], v[52:55], v[68:71]
    s_add_u32 m0, s26, 98304
    s_mov_b32 s46, 147456
    v_mfma_f32_16x16x32_bf16 v[72:75], a[64:67], v[52:55], v[72:75]
    buffer_load_dwordx4 v15, s[16:19], s46 offen lds
    v_mfma_f32_16x16x32_bf16 v[76:79], a[68:71], v[52:55], v[76:79]
    s_waitcnt lgkmcnt(1)
    v_mfma_f32_16x16x32_bf16 v[92:95], a[180:183], v[32:35], v[92:95]
    ds_read_b128 v[40:43], v11 offset:128
    s_add_u32 m0, s26, 102400
    s_mov_b32 s46, 159744
    v_mfma_f32_16x16x32_bf16 v[96:99], a[184:187], v[32:35], v[96:99]
    buffer_load_dwordx4 v13, s[16:19], s46 offen lds
    v_mfma_f32_16x16x32_bf16 v[100:103], a[188:191], v[32:35], v[100:103]
    v_mfma_f32_16x16x32_bf16 v[68:71], a[72:75], v[32:35], v[68:71]
    s_lshr_b32 s37, s26, 1
    s_add_u32 m0, s37, 106496
    s_mov_b32 s46, 110592
    v_mfma_f32_16x16x32_bf16 v[72:75], a[76:79], v[32:35], v[72:75]
    s_mov_b32 exec_hi, 0
    buffer_load_dwordx4 v16, s[16:19], s46 offen lds
    s_mov_b64 exec, -1
    v_mfma_f32_16x16x32_bf16 v[76:79], a[80:83], v[32:35], v[76:79]
    s_waitcnt lgkmcnt(1)
    v_mfma_f32_16x16x32_bf16 v[92:95], a[192:195], v[36:39], v[92:95]
    ds_read_b128 v[44:47], v9 offset:3072
    v_mfma_f32_16x16x32_bf16 v[96:99], a[196:199], v[36:39], v[96:99]
    v_mfma_f32_16x16x32_bf16 v[100:103], a[200:203], v[36:39], v[100:103]
    v_mfma_f32_16x16x32_bf16 v[68:71], a[84:87], v[36:39], v[68:71]
    v_mfma_f32_16x16x32_bf16 v[72:75], a[88:91], v[36:39], v[72:75]
    v_mfma_f32_16x16x32_bf16 v[76:79], a[92:95], v[36:39], v[76:79]
    s_waitcnt lgkmcnt(1)
    v_mfma_f32_16x16x32_bf16 v[92:95], a[204:207], v[40:43], v[92:95]
    ds_read_b128 v[48:51], v9 offset:3136
    v_mfma_f32_16x16x32_bf16 v[96:99], a[208:211], v[40:43], v[96:99]
    v_mfma_f32_16x16x32_bf16 v[100:103], a[212:215], v[40:43], v[100:103]
    v_mfma_f32_16x16x32_bf16 v[68:71], a[96:99], v[40:43], v[68:71]
    v_mfma_f32_16x16x32_bf16 v[72:75], a[100:103], v[40:43], v[72:75]
    v_mfma_f32_16x16x32_bf16 v[76:79], a[104:107], v[40:43], v[76:79]
    s_waitcnt lgkmcnt(1)
    v_mfma_f32_16x16x32_bf16 v[104:107], a[108:111], v[44:47], v[80:83]
    ds_read_b128 v[52:55], v9 offset:3200
    v_mfma_f32_16x16x32_bf16 v[108:111], a[112:115], v[44:47], v[84:87]
    v_mfma_f32_16x16x32_bf16 v[112:115], a[116:119], v[44:47], v[88:91]
    v_mfma_f32_16x16x32_bf16 v[80:83], a[0:3], v[44:47], 0
    v_mfma_f32_16x16x32_bf16 v[84:87], a[4:7], v[44:47], 0
    v_mfma_f32_16x16x32_bf16 v[88:91], a[8:11], v[44:47], 0
    s_waitcnt lgkmcnt(1)
    v_mfma_f32_16x16x32_bf16 v[104:107], a[120:123], v[48:51], v[104:107]
    ds_read_b128 v[32:35], v10 offset:3072
    v_mfma_f32_16x16x32_bf16 v[108:111], a[124:127], v[48:51], v[108:111]
    v_mfma_f32_16x16x32_bf16 v[112:115], a[128:131], v[48:51], v[112:115]
    v_mfma_f32_16x16x32_bf16 v[80:83], a[12:15], v[48:51], v[80:83]
    v_mfma_f32_16x16x32_bf16 v[84:87], a[16:19], v[48:51], v[84:87]
    v_mfma_f32_16x16x32_bf16 v[88:91], a[20:23], v[48:51], v[88:91]
    s_waitcnt vmcnt(0)
    s_barrier
    ds_read_b64_tr_b16 a[216:217], v17 offset:0
    ds_read_b64_tr_b16 a[218:219], v17 offset:768
    s_waitcnt lgkmcnt(3)
    v_mfma_f32_16x16x32_bf16 v[104:107], a[132:135], v[52:55], v[104:107]
    ds_read_b128 v[36:39], v10 offset:3136
    ds_read_b64_tr_b16 a[220:221], v18 offset:0
    ds_read_b64_tr_b16 a[222:223], v18 offset:768
    v_mfma_f32_16x16x32_bf16 v[108:111], a[136:139], v[52:55], v[108:111]
    ds_read_b64_tr_b16 a[224:225], v19 offset:0
    ds_read_b64_tr_b16 a[226:227], v19 offset:768
    v_mfma_f32_16x16x32_bf16 v[112:115], a[140:143], v[52:55], v[112:115]
    ds_read_b64_tr_b16 a[228:229], v17 offset:6144
    ds_read_b64_tr_b16 a[230:231], v17 offset:6912
    v_mfma_f32_16x16x32_bf16 v[80:83], a[24:27], v[52:55], v[80:83]
    ds_read_b64_tr_b16 a[232:233], v18 offset:6144
    ds_read_b64_tr_b16 a[234:235], v18 offset:6912
    v_mfma_f32_16x16x32_bf16 v[84:87], a[28:31], v[52:55], v[84:87]
    ds_read_b64_tr_b16 a[236:237], v19 offset:6144
    ds_read_b64_tr_b16 a[238:239], v19 offset:6912
    v_mfma_f32_16x16x32_bf16 v[88:91], a[32:35], v[52:55], v[88:91]
    ds_read_b64_tr_b16 a[240:241], v17 offset:12288
    ds_read_b64_tr_b16 a[242:243], v17 offset:13056
    s_waitcnt lgkmcnt(14)
    v_mfma_f32_16x16x32_bf16 v[104:107], a[144:147], v[32:35], v[104:107]
    ds_read_b128 v[40:43], v10 offset:3200
    ds_read_b64_tr_b16 a[244:245], v18 offset:12288
    ds_read_b64_tr_b16 a[246:247], v18 offset:13056
    v_mfma_f32_16x16x32_bf16 v[108:111], a[148:151], v[32:35], v[108:111]
    ds_read_b64_tr_b16 a[248:249], v19 offset:12288
    ds_read_b64_tr_b16 a[250:251], v19 offset:13056
    v_mfma_f32_16x16x32_bf16 v[112:115], a[152:155], v[32:35], v[112:115]
    ds_read_b64_tr_b16 a[252:253], v17 offset:18432
    ds_read_b64_tr_b16 a[254:255], v17 offset:19200
    v_mfma_f32_16x16x32_bf16 v[80:83], a[36:39], v[32:35], v[80:83]
    ds_read_b64_tr_b16 v[140:141], v18 offset:18432
    ds_read_b64_tr_b16 v[142:143], v18 offset:19200
    v_mfma_f32_16x16x32_bf16 v[84:87], a[40:43], v[32:35], v[84:87]
    ds_read_b64_tr_b16 v[144:145], v19 offset:18432
    ds_read_b64_tr_b16 v[146:147], v19 offset:19200
    v_mfma_f32_16x16x32_bf16 v[88:91], a[44:47], v[32:35], v[88:91]
    ds_read_b64_tr_b16 v[148:149], v17 offset:24576
    ds_read_b64_tr_b16 v[150:151], v17 offset:25344
    s_waitcnt lgkmcnt(14)
    v_mfma_f32_16x16x32_bf16 v[104:107], a[156:159], v[36:39], v[104:107]
    ds_read_b128 v[44:47], v11 offset:3072
    ds_read_b64_tr_b16 v[152:153], v18 offset:24576
    ds_read_b64_tr_b16 v[154:155], v18 offset:25344
    v_mfma_f32_16x16x32_bf16 v[108:111], a[160:163], v[36:39], v[108:111]
    ds_read_b64_tr_b16 v[156:157], v19 offset:24576
    ds_read_b64_tr_b16 v[158:159], v19 offset:25344
    v_mfma_f32_16x16x32_bf16 v[112:115], a[164:167], v[36:39], v[112:115]
    ds_read_b64_tr_b16 v[160:161], v17 offset:30720
    ds_read_b64_tr_b16 v[162:163], v17 offset:31488
    v_mfma_f32_16x16x32_bf16 v[80:83], a[48:51], v[36:39], v[80:83]
    ds_read_b64_tr_b16 v[164:165], v18 offset:30720
    ds_read_b64_tr_b16 v[166:167], v18 offset:31488
    v_mfma_f32_16x16x32_bf16 v[84:87], a[52:55], v[36:39], v[84:87]
    ds_read_b64_tr_b16 v[168:169], v19 offset:30720
    ds_read_b64_tr_b16 v[170:171], v19 offset:31488
    v_mfma_f32_16x16x32_bf16 v[88:91], a[56:59], v[36:39], v[88:91]
    ds_read_b64_tr_b16 v[172:173], v17 offset:36864
    ds_read_b64_tr_b16 v[174:175], v17 offset:37632
    s_waitcnt lgkmcnt(14)
    v_mfma_f32_16x16x32_bf16 v[104:107], a[168:171], v[40:43], v[104:107]
    ds_read_b128 v[48:51], v11 offset:3136
    ds_read_b64_tr_b16 v[176:177], v18 offset:36864
    ds_read_b64_tr_b16 v[178:179], v18 offset:37632
    v_mfma_f32_16x16x32_bf16 v[108:111], a[172:175], v[40:43], v[108:111]
    ds_read_b64_tr_b16 v[180:181], v19 offset:36864
    ds_read_b64_tr_b16 v[182:183], v19 offset:37632
    v_mfma_f32_16x16x32_bf16 v[112:115], a[176:179], v[40:43], v[112:115]
    ds_read_b64_tr_b16 v[184:185], v17 offset:43008
    ds_read_b64_tr_b16 v[186:187], v17 offset:43776
    v_mfma_f32_16x16x32_bf16 v[80:83], a[60:63], v[40:43], v[80:83]
    ds_read_b64_tr_b16 v[188:189], v18 offset:43008
    ds_read_b64_tr_b16 v[190:191], v18 offset:43776
    v_mfma_f32_16x16x32_bf16 v[84:87], a[64:67], v[40:43], v[84:87]
    ds_read_b64_tr_b16 v[192:193], v19 offset:43008
    ds_read_b64_tr_b16 v[194:195], v19 offset:43776
    v_mfma_f32_16x16x32_bf16 v[88:91], a[68:71], v[40:43], v[88:91]
    s_mov_b32 s31, s30
    s_add_u32 s30, s30, 13312
    s_cmp_eq_u32 s30, 53248
    s_cselect_b32 s30, 0, s30
    ds_read_b64_tr_b16 v[196:197], v17 offset:49152
    ds_read_b64_tr_b16 v[198:199], v17 offset:49920
    s_waitcnt lgkmcnt(14)
    v_mfma_f32_16x16x32_bf16 v[104:107], a[180:183], v[44:47], v[104:107]
    ds_read_b128 v[52:55], v11 offset:3200
    s_add_u32 s32, s32, 196608
    s_add_u32 s33, s33, 2
    s_cmp_lt_u32 s33, s34
    s_cselect_b32 s14, 50331648, 0
    ds_read_b64_tr_b16 v[200:201], v18 offset:49152
    ds_read_b64_tr_b16 v[202:203], v18 offset:49920
    v_mfma_f32_16x16x32_bf16 v[108:111], a[184:187], v[44:47], v[108:111]
    ds_read_b64_tr_b16 v[204:205], v19 offset:49152
    ds_read_b64_tr_b16 v[206:207], v19 offset:49920
    v_mfma_f32_16x16x32_bf16 v[112:115], a[188:191], v[44:47], v[112:115]
    v_mfma_f32_16x16x32_bf16 v[80:83], a[72:75], v[44:47], v[80:83]
    v_mfma_f32_16x16x32_bf16 v[84:87], a[76:79], v[44:47], v[84:87]
    v_mfma_f32_16x16x32_bf16 v[88:91], a[80:83], v[44:47], v[88:91]
    s_waitcnt lgkmcnt(0)
    s_barrier
    v_mfma_f32_16x16x32_bf16 v[104:107], a[192:195], v[48:51], v[104:107]
    v_add_u32 v9, s30, v6
    v_mfma_f32_16x16x32_bf16 v[108:111], a[196:199], v[48:51], v[108:111]
    v_add_u32 v10, s30, v7
    ds_read_b128 v[32:35], v9 offset:0
    v_mfma_f32_16x16x32_bf16 v[112:115], a[200:203], v[48:51], v[112:115]
    v_add_u32 v11, s30, v8
    s_add_u32 m0, s31, s26
    v_mfma_f32_16x16x32_bf16 v[80:83], a[84:87], v[48:51], v[80:83]
    buffer_load_dwordx4 v2, s[12:15], s32 offen lds
    v_mfma_f32_16x16x32_bf16 v[84:87], a[88:91], v[48:51], v[84:87]
    s_add_u32 m0, s31, s27
    v_mfma_f32_16x16x32_bf16 v[88:91], a[92:95], v[48:51], v[88:91]
    buffer_load_dwordx4 v3, s[12:15], s32 offen lds
    v_mfma_f32_16x16x32_bf16 v[104:107], a[204:207], v[52:55], v[104:107]
    s_add_u32 m0, s31, s28
    v_mfma_f32_16x16x32_bf16 v[108:111], a[208:211], v[52:55], v[108:111]
    ds_read_b128 v[36:39], v9 offset:64
    buffer_load_dwordx4 v4, s[12:15], s32 offen lds
    v_mfma_f32_16x16x32_bf16 v[112:115], a[212:215], v[52:55], v[112:115]
    s_add_u32 m0, s31, s29
    v_mfma_f32_16x16x32_bf16 v[80:83], a[96:99], v[52:55], v[80:83]
    s_mov_b64 exec, 0xfff
    buffer_load_dwordx4 v5, s[12:15], s32 offen lds
    s_mov_b64 exec, -1
    v_mfma_f32_16x16x32_bf16 v[84:87], a[100:103], v[52:55], v[84:87]
    v_mfma_f32_16x16x32_bf16 v[88:91], a[104:107], v[52:55], v[88:91]
    s_mov_b32 s36, 14
L_loop:
    s_waitcnt lgkmcnt(1)
    v_mfma_f32_16x16x32_bf16 v[116:119], a[216:219], v[32:35], v[92:95]
    ds_read_b128 v[40:43], v9 offset:128
    v_mfma_f32_16x16x32_bf16 v[120:123], a[220:223], v[32:35], v[96:99]
    v_mfma_f32_16x16x32_bf16 v[124:127], a[224:227], v[32:35], v[100:103]
    v_mfma_f32_16x16x32_bf16 v[92:95], a[108:111], v[32:35], v[68:71]
    v_mfma_f32_16x16x32_bf16 v[96:99], a[112:115], v[32:35], v[72:75]
    v_mfma_f32_16x16x32_bf16 v[100:103], a[116:119], v[32:35], v[76:79]
    v_mfma_f32_16x16x32_bf16 v[68:71], a[0:3], v[32:35], 0
    v_mfma_f32_16x16x32_bf16 v[72:75], a[4:7], v[32:35], 0
    v_mfma_f32_16x16x32_bf16 v[76:79], a[8:11], v[32:35], 0
    s_waitcnt lgkmcnt(1)
    v_mfma_f32_16x16x32_bf16 v[116:119], a[228:231], v[36:39], v[116:119]
    ds_read_b128 v[44:47], v10 offset:0
    v_mfma_f32_16x16x32_bf16 v[120:123], a[232:235], v[36:39], v[120:123]
    v_cvt_pk_bf16_f32 v62, v128, v129
    v_mfma_f32_16x16x32_bf16 v[124:127], a[236:239], v[36:39], v[124:127]
    v_mfma_f32_16x16x32_bf16 v[92:95], a[120:123], v[36:39], v[92:95]
    v_cvt_pk_bf16_f32 v63, v130, v131
    v_mfma_f32_16x16x32_bf16 v[96:99], a[124:127], v[36:39], v[96:99]
    v_mfma_f32_16x16x32_bf16 v[100:103], a[128:131], v[36:39], v[100:103]
    buffer_store_dwordx2 v[62:63], v12, s[20:23], s35 offen offset:3072
    v_mfma_f32_16x16x32_bf16 v[68:71], a[12:15], v[36:39], v[68:71]
    v_mfma_f32_16x16x32_bf16 v[72:75], a[16:19], v[36:39], v[72:75]
    v_cvt_pk_bf16_f32 v64, v132, v133
    v_mfma_f32_16x16x32_bf16 v[76:79], a[20:23], v[36:39], v[76:79]
    s_waitcnt lgkmcnt(1)
    v_mfma_f32_16x16x32_bf16 v[116:119], a[240:243], v[40:43], v[116:119]
    ds_read_b128 v[48:51], v10 offset:64
    v_cvt_pk_bf16_f32 v65, v134, v135
    v_mfma_f32_16x16x32_bf16 v[120:123], a[244:247], v[40:43], v[120:123]
    v_mfma_f32_16x16x32_bf16 v[124:127], a[248:251], v[40:43], v[124:127]
    buffer_store_dwordx2 v[64:65], v12, s[20:23], s35 offen offset:3104
    v_mfma_f32_16x16x32_bf16 v[92:95], a[132:135], v[40:43], v[92:95]
    v_mfma_f32_16x16x32_bf16 v[96:99], a[136:139], v[40:43], v[96:99]
    v_cvt_pk_bf16_f32 v66, v136, v137
    v_mfma_f32_16x16x32_bf16 v[100:103], a[140:143], v[40:43], v[100:103]
    v_mfma_f32_16x16x32_bf16 v[68:71], a[24:27], v[40:43], v[68:71]
    v_cvt_pk_bf16_f32 v67, v138, v139
    v_mfma_f32_16x16x32_bf16 v[72:75], a[28:31], v[40:43], v[72:75]
    v_mfma_f32_16x16x32_bf16 v[76:79], a[32:35], v[40:43], v[76:79]
    buffer_store_dwordx2 v[66:67], v12, s[20:23], s35 offen offset:3136
    s_waitcnt lgkmcnt(1)
    v_mfma_f32_16x16x32_bf16 v[116:119], a[252:255], v[44:47], v[116:119]
    ds_read_b128 v[52:55], v10 offset:128
    v_mfma_f32_16x16x32_bf16 v[120:123], v[140:143], v[44:47], v[120:123]
    v_mfma_f32_16x16x32_bf16 v[124:127], v[144:147], v[44:47], v[124:127]
    v_mfma_f32_16x16x32_bf16 v[92:95], a[144:147], v[44:47], v[92:95]
    v_mfma_f32_16x16x32_bf16 v[96:99], a[148:151], v[44:47], v[96:99]
    v_mfma_f32_16x16x32_bf16 v[100:103], a[152:155], v[44:47], v[100:103]
    v_mfma_f32_16x16x32_bf16 v[68:71], a[36:39], v[44:47], v[68:71]
    v_mfma_f32_16x16x32_bf16 v[72:75], a[40:43], v[44:47], v[72:75]
    v_mfma_f32_16x16x32_bf16 v[76:79], a[44:47], v[44:47], v[76:79]
    s_waitcnt lgkmcnt(1)
    v_mfma_f32_16x16x32_bf16 v[116:119], v[148:151], v[48:51], v[116:119]
    ds_read_b128 v[32:35], v11 offset:0
    v_mfma_f32_16x16x32_bf16 v[120:123], v[152:155], v[48:51], v[120:123]
    v_mfma_f32_16x16x32_bf16 v[124:127], v[156:159], v[48:51], v[124:127]
    v_mfma_f32_16x16x32_bf16 v[92:95], a[156:159], v[48:51], v[92:95]
    v_mfma_f32_16x16x32_bf16 v[96:99], a[160:163], v[48:51], v[96:99]
    v_mfma_f32_16x16x32_bf16 v[100:103], a[164:167], v[48:51], v[100:103]
    v_mfma_f32_16x16x32_bf16 v[68:71], a[48:51], v[48:51], v[68:71]
    v_mfma_f32_16x16x32_bf16 v[72:75], a[52:55], v[48:51], v[72:75]
    v_mfma_f32_16x16x32_bf16 v[76:79], a[56:59], v[48:51], v[76:79]
    s_waitcnt lgkmcnt(1)
    v_mfma_f32_16x16x32_bf16 v[116:119], v[160:163], v[52:55], v[116:119]
    ds_read_b128 v[36:39], v11 offset:64
    v_mfma_f32_16x16x32_bf16 v[120:123], v[164:167], v[52:55], v[120:123]
    v_mfma_f32_16x16x32_bf16 v[124:127], v[168:171], v[52:55], v[124:127]
    v_mfma_f32_16x16x32_bf16 v[92:95], a[168:171], v[52:55], v[92:95]
    v_mfma_f32_16x16x32_bf16 v[96:99], a[172:175], v[52:55], v[96:99]
    v_mfma_f32_16x16x32_bf16 v[100:103], a[176:179], v[52:55], v[100:103]
    v_mfma_f32_16x16x32_bf16 v[68:71], a[60:63], v[52:55], v[68:71]
    v_mfma_f32_16x16x32_bf16 v[72:75], a[64:67], v[52:55], v[72:75]
    v_mfma_f32_16x16x32_bf16 v[76:79], a[68:71], v[52:55], v[76:79]
    s_waitcnt lgkmcnt(1)
    v_mfma_f32_16x16x32_bf16 v[116:119], v[172:175], v[32:35], v[116:119]
    ds_read_b128 v[40:43], v11 offset:128
    v_mfma_f32_16x16x32_bf16 v[120:123], v[176:179], v[32:35], v[120:123]
    v_mfma_f32_16x16x32_bf16 v[124:127], v[180:183], v[32:35], v[124:127]
    v_mfma_f32_16x16x32_bf16 v[92:95], a[180:183], v[32:35], v[92:95]
    v_mfma_f32_16x16x32_bf16 v[96:99], a[184:187], v[32:35], v[96:99]
    v_mfma_f32_16x16x32_bf16 v[100:103], a[188:191], v[32:35], v[100:103]
    v_mfma_f32_16x16x32_bf16 v[68:71], a[72:75], v[32:35], v[68:71]
    v_mfma_f32_16x16x32_bf16 v[72:75], a[76:79], v[32:35], v[72:75]
    v_mfma_f32_16x16x32_bf16 v[76:79], a[80:83], v[32:35], v[76:79]
    s_waitcnt lgkmcnt(1)
    v_mfma_f32_16x16x32_bf16 v[116:119], v[184:187], v[36:39], v[116:119]
    ds_read_b128 v[44:47], v9 offset:3072
    v_mfma_f32_16x16x32_bf16 v[120:123], v[188:191], v[36:39], v[120:123]
    v_mfma_f32_16x16x32_bf16 v[124:127], v[192:195], v[36:39], v[124:127]
    v_mfma_f32_16x16x32_bf16 v[92:95], a[192:195], v[36:39], v[92:95]
    v_mfma_f32_16x16x32_bf16 v[96:99], a[196:199], v[36:39], v[96:99]
    v_mfma_f32_16x16x32_bf16 v[100:103], a[200:203], v[36:39], v[100:103]
    v_mfma_f32_16x16x32_bf16 v[68:71], a[84:87], v[36:39], v[68:71]
    v_mfma_f32_16x16x32_bf16 v[72:75], a[88:91], v[36:39], v[72:75]
    v_mfma_f32_16x16x32_bf16 v[76:79], a[92:95], v[36:39], v[76:79]
    s_waitcnt lgkmcnt(1)
    v_mfma_f32_16x16x32_bf16 v[116:119], v[196:199], v[40:43], v[116:119]
    ds_read_b128 v[48:51], v9 offset:3136
    v_mfma_f32_16x16x32_bf16 v[120:123], v[200:203], v[40:43], v[120:123]
    v_mfma_f32_16x16x32_bf16 v[124:127], v[204:207], v[40:43], v[124:127]
    v_mfma_f32_16x16x32_bf16 v[92:95], a[204:207], v[40:43], v[92:95]
    s_add_u32 s35, s35, 196608
    s_mov_b32 s22, 50331648
    v_mfma_f32_16x16x32_bf16 v[96:99], a[208:211], v[40:43], v[96:99]
    v_mfma_f32_16x16x32_bf16 v[100:103], a[212:215], v[40:43], v[100:103]
    v_mfma_f32_16x16x32_bf16 v[68:71], a[96:99], v[40:43], v[68:71]
    v_mfma_f32_16x16x32_bf16 v[72:75], a[100:103], v[40:43], v[72:75]
    v_mfma_f32_16x16x32_bf16 v[76:79], a[104:107], v[40:43], v[76:79]
    s_waitcnt lgkmcnt(1)
    v_mfma_f32_16x16x32_bf16 v[128:131], a[216:219], v[44:47], v[104:107]
    ds_read_b128 v[52:55], v9 offset:3200
    v_mfma_f32_16x16x32_bf16 v[132:135], a[220:223], v[44:47], v[108:111]
    v_mfma_f32_16x16x32_bf16 v[136:139], a[224:227], v[44:47], v[112:115]
    v_mfma_f32_16x16x32_bf16 v[104:107], a[108:111], v[44:47], v[80:83]
    v_mfma_f32_16x16x32_bf16 v[108:111], a[112:115], v[44:47], v[84:87]
    v_mfma_f32_16x16x32_bf16 v[112:115], a[116:119], v[44:47], v[88:91]
    v_mfma_f32_16x16x32_bf16 v[80:83], a[0:3], v[44:47], 0
    v_mfma_f32_16x16x32_bf16 v[84:87], a[4:7], v[44:47], 0
    v_mfma_f32_16x16x32_bf16 v[88:91], a[8:11], v[44:47], 0
    s_waitcnt lgkmcnt(1)
    v_mfma_f32_16x16x32_bf16 v[128:131], a[228:231], v[48:51], v[128:131]
    ds_read_b128 v[32:35], v10 offset:3072
    v_mfma_f32_16x16x32_bf16 v[132:135], a[232:235], v[48:51], v[132:135]
    v_cvt_pk_bf16_f32 v56, v116, v117
    v_mfma_f32_16x16x32_bf16 v[136:139], a[236:239], v[48:51], v[136:139]
    v_mfma_f32_16x16x32_bf16 v[104:107], a[120:123], v[48:51], v[104:107]
    v_cvt_pk_bf16_f32 v57, v118, v119
    v_mfma_f32_16x16x32_bf16 v[108:111], a[124:127], v[48:51], v[108:111]
    v_mfma_f32_16x16x32_bf16 v[112:115], a[128:131], v[48:51], v[112:115]
    buffer_store_dwordx2 v[56:57], v12, s[20:23], s35 offen offset:0
    v_mfma_f32_16x16x32_bf16 v[80:83], a[12:15], v[48:51], v[80:83]
    v_mfma_f32_16x16x32_bf16 v[84:87], a[16:19], v[48:51], v[84:87]
    v_cvt_pk_bf16_f32 v58, v120, v121
    v_mfma_f32_16x16x32_bf16 v[88:91], a[20:23], v[48:51], v[88:91]
    s_waitcnt lgkmcnt(1)
    v_mfma_f32_16x16x32_bf16 v[128:131], a[240:243], v[52:55], v[128:131]
    ds_read_b128 v[36:39], v10 offset:3136
    v_cvt_pk_bf16_f32 v59, v122, v123
    v_mfma_f32_16x16x32_bf16 v[132:135], a[244:247], v[52:55], v[132:135]
    v_mfma_f32_16x16x32_bf16 v[136:139], a[248:251], v[52:55], v[136:139]
    buffer_store_dwordx2 v[58:59], v12, s[20:23], s35 offen offset:32
    v_mfma_f32_16x16x32_bf16 v[104:107], a[132:135], v[52:55], v[104:107]
    v_mfma_f32_16x16x32_bf16 v[108:111], a[136:139], v[52:55], v[108:111]
    v_cvt_pk_bf16_f32 v60, v124, v125
    v_mfma_f32_16x16x32_bf16 v[112:115], a[140:143], v[52:55], v[112:115]
    v_mfma_f32_16x16x32_bf16 v[80:83], a[24:27], v[52:55], v[80:83]
    v_cvt_pk_bf16_f32 v61, v126, v127
    v_mfma_f32_16x16x32_bf16 v[84:87], a[28:31], v[52:55], v[84:87]
    v_mfma_f32_16x16x32_bf16 v[88:91], a[32:35], v[52:55], v[88:91]
    buffer_store_dwordx2 v[60:61], v12, s[20:23], s35 offen offset:64
    s_waitcnt lgkmcnt(1)
    v_mfma_f32_16x16x32_bf16 v[128:131], a[252:255], v[32:35], v[128:131]
    ds_read_b128 v[40:43], v10 offset:3200
    v_mfma_f32_16x16x32_bf16 v[132:135], v[140:143], v[32:35], v[132:135]
    v_mfma_f32_16x16x32_bf16 v[136:139], v[144:147], v[32:35], v[136:139]
    v_mfma_f32_16x16x32_bf16 v[104:107], a[144:147], v[32:35], v[104:107]
    v_mfma_f32_16x16x32_bf16 v[108:111], a[148:151], v[32:35], v[108:111]
    v_mfma_f32_16x16x32_bf16 v[112:115], a[152:155], v[32:35], v[112:115]
    v_mfma_f32_16x16x32_bf16 v[80:83], a[36:39], v[32:35], v[80:83]
    v_mfma_f32_16x16x32_bf16 v[84:87], a[40:43], v[32:35], v[84:87]
    v_mfma_f32_16x16x32_bf16 v[88:91], a[44:47], v[32:35], v[88:91]
    s_waitcnt lgkmcnt(1)
    v_mfma_f32_16x16x32_bf16 v[128:131], v[148:151], v[36:39], v[128:131]
    ds_read_b128 v[44:47], v11 offset:3072
    v_mfma_f32_16x16x32_bf16 v[132:135], v[152:155], v[36:39], v[132:135]
    v_mfma_f32_16x16x32_bf16 v[136:139], v[156:159], v[36:39], v[136:139]
    v_mfma_f32_16x16x32_bf16 v[104:107], a[156:159], v[36:39], v[104:107]
    v_mfma_f32_16x16x32_bf16 v[108:111], a[160:163], v[36:39], v[108:111]
    v_mfma_f32_16x16x32_bf16 v[112:115], a[164:167], v[36:39], v[112:115]
    v_mfma_f32_16x16x32_bf16 v[80:83], a[48:51], v[36:39], v[80:83]
    v_mfma_f32_16x16x32_bf16 v[84:87], a[52:55], v[36:39], v[84:87]
    v_mfma_f32_16x16x32_bf16 v[88:91], a[56:59], v[36:39], v[88:91]
    s_waitcnt lgkmcnt(1)
    v_mfma_f32_16x16x32_bf16 v[128:131], v[160:163], v[40:43], v[128:131]
    ds_read_b128 v[48:51], v11 offset:3136
    v_mfma_f32_16x16x32_bf16 v[132:135], v[164:167], v[40:43], v[132:135]
    v_mfma_f32_16x16x32_bf16 v[136:139], v[168:171], v[40:43], v[136:139]
    v_mfma_f32_16x16x32_bf16 v[104:107], a[168:171], v[40:43], v[104:107]
    v_mfma_f32_16x16x32_bf16 v[108:111], a[172:175], v[40:43], v[108:111]
    v_mfma_f32_16x16x32_bf16 v[112:115], a[176:179], v[40:43], v[112:115]
    v_mfma_f32_16x16x32_bf16 v[80:83], a[60:63], v[40:43], v[80:83]
    v_mfma_f32_16x16x32_bf16 v[84:87], a[64:67], v[40:43], v[84:87]
    v_mfma_f32_16x16x32_bf16 v[88:91], a[68:71], v[40:43], v[88:91]
    s_mov_b32 s31, s30
    s_add_u32 s30, s30, 13312
    s_cmp_eq_u32 s30, 53248
    s_cselect_b32 s30, 0, s30
    s_waitcnt lgkmcnt(1)
    v_mfma_f32_16x16x32_bf16 v[128:131], v[172:175], v[44:47], v[128:131]
    ds_read_b128 v[52:55], v11 offset:3200
    s_add_u32 s32, s32, 196608
    s_add_u32 s33, s33, 2
    s_cmp_lt_u32 s33, s34
    s_cselect_b32 s14, 50331648, 0
    v_mfma_f32_16x16x32_bf16 v[132:135], v[176:179], v[44:47], v[132:135]
    v_mfma_f32_16x16x32_bf16 v[136:139], v[180:183], v[44:47], v[136:139]
    v_mfma_f32_16x16x32_bf16 v[104:107], a[180:183], v[44:47], v[104:107]
    v_mfma_f32_16x16x32_bf16 v[108:111], a[184:187], v[44:47], v[108:111]
    v_mfma_f32_16x16x32_bf16 v[112:115], a[188:191], v[44:47], v[112:115]
    v_mfma_f32_16x16x32_bf16 v[80:83], a[72:75], v[44:47], v[80:83]
    v_mfma_f32_16x16x32_bf16 v[84:87], a[76:79], v[44:47], v[84:87]
    v_mfma_f32_16x16x32_bf16 v[88:91], a[80:83], v[44:47], v[88:91]
    s_waitcnt vmcnt(26) lgkmcnt(0)
    s_barrier
    v_mfma_f32_16x16x32_bf16 v[128:131], v[184:187], v[48:51], v[128:131]
    v_add_u32 v9, s30, v6
    v_mfma_f32_16x16x32_bf16 v[132:135], v[188:191], v[48:51], v[132:135]
    v_add_u32 v10, s30, v7
    ds_read_b128 v[32:35], v9 offset:0
    v_mfma_f32_16x16x32_bf16 v[136:139], v[192:195], v[48:51], v[136:139]
    v_add_u32 v11, s30, v8
    s_add_u32 m0, s31, s26
    v_mfma_f32_16x16x32_bf16 v[104:107], a[192:195], v[48:51], v[104:107]
    buffer_load_dwordx4 v2, s[12:15], s32 offen lds
    v_mfma_f32_16x16x32_bf16 v[108:111], a[196:199], v[48:51], v[108:111]
    v_mfma_f32_16x16x32_bf16 v[112:115], a[200:203], v[48:51], v[112:115]
    s_add_u32 m0, s31, s27
    v_mfma_f32_16x16x32_bf16 v[80:83], a[84:87], v[48:51], v[80:83]
    buffer_load_dwordx4 v3, s[12:15], s32 offen lds
    v_mfma_f32_16x16x32_bf16 v[84:87], a[88:91], v[48:51], v[84:87]
    v_mfma_f32_16x16x32_bf16 v[88:91], a[92:95], v[48:51], v[88:91]
    s_add_u32 m0, s31, s28
    v_mfma_f32_16x16x32_bf16 v[128:131], v[196:199], v[52:55], v[128:131]
    buffer_load_dwordx4 v4, s[12:15], s32 offen lds
    v_mfma_f32_16x16x32_bf16 v[132:135], v[200:203], v[52:55], v[132:135]
    ds_read_b128 v[36:39], v9 offset:64
    v_mfma_f32_16x16x32_bf16 v[136:139], v[204:207], v[52:55], v[136:139]
    s_add_u32 m0, s31, s29
    v_mfma_f32_16x16x32_bf16 v[104:107], a[204:207], v[52:55], v[104:107]
    s_mov_b64 exec, 0xfff
    buffer_load_dwordx4 v5, s[12:15], s32 offen lds
    s_mov_b64 exec, -1
    v_mfma_f32_16x16x32_bf16 v[108:111], a[208:211], v[52:55], v[108:111]
    v_mfma_f32_16x16x32_bf16 v[112:115], a[212:215], v[52:55], v[112:115]
    v_mfma_f32_16x16x32_bf16 v[80:83], a[96:99], v[52:55], v[80:83]
    v_mfma_f32_16x16x32_bf16 v[84:87], a[100:103], v[52:55], v[84:87]
    v_mfma_f32_16x16x32_bf16 v[88:91], a[104:107], v[52:55], v[88:91]
    s_sub_u32 s36, s36, 1
    s_cmp_lg_u32 s36, 0
    s_cbranch_scc1 L_loop
    s_waitcnt lgkmcnt(1)
    v_mfma_f32_16x16x32_bf16 v[116:119], a[216:219], v[32:35], v[92:95]
    ds_read_b128 v[40:43], v9 offset:128
    v_mfma_f32_16x16x32_bf16 v[120:123], a[220:223], v[32:35], v[96:99]
    v_mfma_f32_16x16x32_bf16 v[124:127], a[224:227], v[32:35], v[100:103]
    v_mfma_f32_16x16x32_bf16 v[92:95], a[108:111], v[32:35], v[68:71]
    v_mfma_f32_16x16x32_bf16 v[96:99], a[112:115], v[32:35], v[72:75]
    v_mfma_f32_16x16x32_bf16 v[100:103], a[116:119], v[32:35], v[76:79]
    s_waitcnt lgkmcnt(1)
    v_mfma_f32_16x16x32_bf16 v[116:119], a[228:231], v[36:39], v[116:119]
    ds_read_b128 v[44:47], v10 offset:0
    v_mfma_f32_16x16x32_bf16 v[120:123], a[232:235], v[36:39], v[120:123]
    v_mfma_f32_16x16x32_bf16 v[124:127], a[236:239], v[36:39], v[124:127]
    v_mfma_f32_16x16x32_bf16 v[92:95], a[120:123], v[36:39], v[92:95]
    v_mfma_f32_16x16x32_bf16 v[96:99], a[124:127], v[36:39], v[96:99]
    v_mfma_f32_16x16x32_bf16 v[100:103], a[128:131], v[36:39], v[100:103]
    s_waitcnt lgkmcnt(1)
    v_mfma_f32_16x16x32_bf16 v[116:119], a[240:243], v[40:43], v[116:119]
    ds_read_b128 v[48:51], v10 offset:64
    v_mfma_f32_16x16x32_bf16 v[120:123], a[244:247], v[40:43], v[120:123]
    v_mfma_f32_16x16x32_bf16 v[124:127], a[248:251], v[40:43], v[124:127]
    v_mfma_f32_16x16x32_bf16 v[92:95], a[132:135], v[40:43], v[92:95]
    v_mfma_f32_16x16x32_bf16 v[96:99], a[136:139], v[40:43], v[96:99]
    v_mfma_f32_16x16x32_bf16 v[100:103], a[140:143], v[40:43], v[100:103]
    s_waitcnt lgkmcnt(1)
    v_mfma_f32_16x16x32_bf16 v[116:119], a[252:255], v[44:47], v[116:119]
    ds_read_b128 v[52:55], v10 offset:128
    v_mfma_f32_16x16x32_bf16 v[120:123], v[140:143], v[44:47], v[120:123]
    v_cvt_pk_bf16_f32 v62, v128, v129
    v_mfma_f32_16x16x32_bf16 v[124:127], v[144:147], v[44:47], v[124:127]
    v_mfma_f32_16x16x32_bf16 v[92:95], a[144:147], v[44:47], v[92:95]
    v_cvt_pk_bf16_f32 v63, v130, v131
    v_mfma_f32_16x16x32_bf16 v[96:99], a[148:151], v[44:47], v[96:99]
    v_mfma_f32_16x16x32_bf16 v[100:103], a[152:155], v[44:47], v[100:103]
    buffer_store_dwordx2 v[62:63], v12, s[20:23], s35 offen offset:3072
    s_waitcnt lgkmcnt(1)
    v_mfma_f32_16x16x32_bf16 v[116:119], v[148:151], v[48:51], v[116:119]
    ds_read_b128 v[32:35], v11 offset:0
    v_mfma_f32_16x16x32_bf16 v[120:123], v[152:155], v[48:51], v[120:123]
    v_cvt_pk_bf16_f32 v64, v132, v133
    v_mfma_f32_16x16x32_bf16 v[124:127], v[156:159], v[48:51], v[124:127]
    v_mfma_f32_16x16x32_bf16 v[92:95], a[156:159], v[48:51], v[92:95]
    v_cvt_pk_bf16_f32 v65, v134, v135
    v_mfma_f32_16x16x32_bf16 v[96:99], a[160:163], v[48:51], v[96:99]
    v_mfma_f32_16x16x32_bf16 v[100:103], a[164:167], v[48:51], v[100:103]
    buffer_store_dwordx2 v[64:65], v12, s[20:23], s35 offen offset:3104
    s_waitcnt lgkmcnt(1)
    v_mfma_f32_16x16x32_bf16 v[116:119], v[160:163], v[52:55], v[116:119]
    ds_read_b128 v[36:39], v11 offset:64
    v_mfma_f32_16x16x32_bf16 v[120:123], v[164:167], v[52:55], v[120:123]
    v_cvt_pk_bf16_f32 v66, v136, v137
    v_mfma_f32_16x16x32_bf16 v[124:127], v[168:171], v[52:55], v[124:127]
    v_mfma_f32_16x16x32_bf16 v[92:95], a[168:171], v[52:55], v[92:95]
    v_cvt_pk_bf16_f32 v67, v138, v139
    v_mfma_f32_16x16x32_bf16 v[96:99], a[172:175], v[52:55], v[96:99]
    v_mfma_f32_16x16x32_bf16 v[100:103], a[176:179], v[52:55], v[100:103]
    buffer_store_dwordx2 v[66:67], v12, s[20:23], s35 offen offset:3136
    s_waitcnt lgkmcnt(1)
    v_mfma_f32_16x16x32_bf16 v[116:119], v[172:175], v[32:35], v[116:119]
    ds_read_b128 v[40:43], v11 offset:128
    v_mfma_f32_16x16x32_bf16 v[120:123], v[176:179], v[32:35], v[120:123]
    v_mfma_f32_16x16x32_bf16 v[124:127], v[180:183], v[32:35], v[124:127]
    v_mfma_f32_16x16x32_bf16 v[92:95], a[180:183], v[32:35], v[92:95]
    v_mfma_f32_16x16x32_bf16 v[96:99], a[184:187], v[32:35], v[96:99]
    v_mfma_f32_16x16x32_bf16 v[100:103], a[188:191], v[32:35], v[100:103]
    s_waitcnt lgkmcnt(1)
    v_mfma_f32_16x16x32_bf16 v[116:119], v[184:187], v[36:39], v[116:119]
    ds_read_b128 v[44:47], v9 offset:3072
    v_mfma_f32_16x16x32_bf16 v[120:123], v[188:191], v[36:39], v[120:123]
    v_mfma_f32_16x16x32_bf16 v[124:127], v[192:195], v[36:39], v[124:127]
    v_mfma_f32_16x16x32_bf16 v[92:95], a[192:195], v[36:39], v[92:95]
    v_mfma_f32_16x16x32_bf16 v[96:99], a[196:199], v[36:39], v[96:99]
    v_mfma_f32_16x16x32_bf16 v[100:103], a[200:203], v[36:39], v[100:103]
    s_waitcnt lgkmcnt(1)
    v_mfma_f32_16x16x32_bf16 v[116:119], v[196:199], v[40:43], v[116:119]
    ds_read_b128 v[48:51], v9 offset:3136
    v_mfma_f32_16x16x32_bf16 v[120:123], v[200:203], v[40:43], v[120:123]
    v_mfma_f32_16x16x32_bf16 v[124:127], v[204:207], v[40:43], v[124:127]
    s_add_u32 s35, s35, 196608
    s_mov_b32 s22, 50331648
    v_mfma_f32_16x16x32_bf16 v[92:95], a[204:207], v[40:43], v[92:95]
    v_mfma_f32_16x16x32_bf16 v[96:99], a[208:211], v[40:43], v[96:99]
    v_mfma_f32_16x16x32_bf16 v[100:103], a[212:215], v[40:43], v[100:103]
    s_waitcnt lgkmcnt(1)
    v_mfma_f32_16x16x32_bf16 v[128:131], a[216:219], v[44:47], v[104:107]
    ds_read_b128 v[52:55], v9 offset:3200
    v_mfma_f32_16x16x32_bf16 v[132:135], a[220:223], v[44:47], v[108:111]
    v_mfma_f32_16x16x32_bf16 v[136:139], a[224:227], v[44:47], v[112:115]
    v_mfma_f32_16x16x32_bf16 v[104:107], a[108:111], v[44:47], v[80:83]
    v_mfma_f32_16x16x32_bf16 v[108:111], a[112:115], v[44:47], v[84:87]
    v_mfma_f32_16x16x32_bf16 v[112:115], a[116:119], v[44:47], v[88:91]
    s_waitcnt lgkmcnt(1)
    v_mfma_f32_16x16x32_bf16 v[128:131], a[228:231], v[48:51], v[128:131]
    ds_read_b128 v[32:35], v10 offset:3072
    v_mfma_f32_16x16x32_bf16 v[132:135], a[232:235], v[48:51], v[132:135]
    v_mfma_f32_16x16x32_bf16 v[136:139], a[236:239], v[48:51], v[136:139]
    v_mfma_f32_16x16x32_bf16 v[104:107], a[120:123], v[48:51], v[104:107]
    v_mfma_f32_16x16x32_bf16 v[108:111], a[124:127], v[48:51], v[108:111]
    v_mfma_f32_16x16x32_bf16 v[112:115], a[128:131], v[48:51], v[112:115]
    s_waitcnt lgkmcnt(1)
    v_mfma_f32_16x16x32_bf16 v[128:131], a[240:243], v[52:55], v[128:131]
    ds_read_b128 v[36:39], v10 offset:3136
    v_mfma_f32_16x16x32_bf16 v[132:135], a[244:247], v[52:55], v[132:135]
    v_mfma_f32_16x16x32_bf16 v[136:139], a[248:251], v[52:55], v[136:139]
    v_mfma_f32_16x16x32_bf16 v[104:107], a[132:135], v[52:55], v[104:107]
    v_mfma_f32_16x16x32_bf16 v[108:111], a[136:139], v[52:55], v[108:111]
    v_mfma_f32_16x16x32_bf16 v[112:115], a[140:143], v[52:55], v[112:115]
    s_waitcnt lgkmcnt(1)
    v_mfma_f32_16x16x32_bf16 v[128:131], a[252:255], v[32:35], v[128:131]
    ds_read_b128 v[40:43], v10 offset:3200
    v_mfma_f32_16x16x32_bf16 v[132:135], v[140:143], v[32:35], v[132:135]
    v_cvt_pk_bf16_f32 v56, v116, v117
    v_mfma_f32_16x16x32_bf16 v[136:139], v[144:147], v[32:35], v[136:139]
    v_mfma_f32_16x16x32_bf16 v[104:107], a[144:147], v[32:35], v[104:107]
    v_cvt_pk_bf16_f32 v57, v118, v119
    v_mfma_f32_16x16x32_bf16 v[108:111], a[148:151], v[32:35], v[108:111]
    v_mfma_f32_16x16x32_bf16 v[112:115], a[152:155], v[32:35], v[112:115]
    buffer_store_dwordx2 v[56:57], v12, s[20:23], s35 offen offset:0
    s_waitcnt lgkmcnt(1)
    v_mfma_f32_16x16x32_bf16 v[128:131], v[148:151], v[36:39], v[128:131]
    ds_read_b128 v[44:47], v11 offset:3072
    v_mfma_f32_16x16x32_bf16 v[132:135], v[152:155], v[36:39], v[132:135]
    v_cvt_pk_bf16_f32 v58, v120, v121
    v_mfma_f32_16x16x32_bf16 v[136:139], v[156:159], v[36:39], v[136:139]
    v_mfma_f32_16x16x32_bf16 v[104:107], a[156:159], v[36:39], v[104:107]
    v_cvt_pk_bf16_f32 v59, v122, v123
    v_mfma_f32_16x16x32_bf16 v[108:111], a[160:163], v[36:39], v[108:111]
    v_mfma_f32_16x16x32_bf16 v[112:115], a[164:167], v[36:39], v[112:115]
    buffer_store_dwordx2 v[58:59], v12, s[20:23], s35 offen offset:32
    s_waitcnt lgkmcnt(1)
    v_mfma_f32_16x16x32_bf16 v[128:131], v[160:163], v[40:43], v[128:131]
    ds_read_b128 v[48:51], v11 offset:3136
    v_mfma_f32_16x16x32_bf16 v[132:135], v[164:167], v[40:43], v[132:135]
    v_cvt_pk_bf16_f32 v60, v124, v125
    v_mfma_f32_16x16x32_bf16 v[136:139], v[168:171], v[40:43], v[136:139]
    v_mfma_f32_16x16x32_bf16 v[104:107], a[168:171], v[40:43], v[104:107]
    v_cvt_pk_bf16_f32 v61, v126, v127
    v_mfma_f32_16x16x32_bf16 v[108:111], a[172:175], v[40:43], v[108:111]
    v_mfma_f32_16x16x32_bf16 v[112:115], a[176:179], v[40:43], v[112:115]
    buffer_store_dwordx2 v[60:61], v12, s[20:23], s35 offen offset:64
    s_mov_b32 s31, s30
    s_add_u32 s30, s30, 13312
    s_cmp_eq_u32 s30, 53248
    s_cselect_b32 s30, 0, s30
    s_waitcnt lgkmcnt(1)
    v_mfma_f32_16x16x32_bf16 v[128:131], v[172:175], v[44:47], v[128:131]
    ds_read_b128 v[52:55], v11 offset:3200
    v_mfma_f32_16x16x32_bf16 v[132:135], v[176:179], v[44:47], v[132:135]
    v_mfma_f32_16x16x32_bf16 v[136:139], v[180:183], v[44:47], v[136:139]
    v_mfma_f32_16x16x32_bf16 v[104:107], a[180:183], v[44:47], v[104:107]
    v_mfma_f32_16x16x32_bf16 v[108:111], a[184:187], v[44:47], v[108:111]
    v_mfma_f32_16x16x32_bf16 v[112:115], a[188:191], v[44:47], v[112:115]
    s_waitcnt vmcnt(26) lgkmcnt(0)
    s_barrier
    v_mfma_f32_16x16x32_bf16 v[128:131], v[184:187], v[48:51], v[128:131]
    v_add_u32 v9, s30, v6
    v_mfma_f32_16x16x32_bf16 v[132:135], v[188:191], v[48:51], v[132:135]
    v_add_u32 v10, s30, v7
    ds_read_b128 v[32:35], v9 offset:0
    v_mfma_f32_16x16x32_bf16 v[136:139], v[192:195], v[48:51], v[136:139]
    v_add_u32 v11, s30, v8
    v_mfma_f32_16x16x32_bf16 v[104:107], a[192:195], v[48:51], v[104:107]
    v_mfma_f32_16x16x32_bf16 v[108:111], a[196:199], v[48:51], v[108:111]
    v_mfma_f32_16x16x32_bf16 v[112:115], a[200:203], v[48:51], v[112:115]
    v_mfma_f32_16x16x32_bf16 v[128:131], v[196:199], v[52:55], v[128:131]
    v_mfma_f32_16x16x32_bf16 v[132:135], v[200:203], v[52:55], v[132:135]
    ds_read_b128 v[36:39], v9 offset:64
    v_mfma_f32_16x16x32_bf16 v[136:139], v[204:207], v[52:55], v[136:139]
    v_mfma_f32_16x16x32_bf16 v[104:107], a[204:207], v[52:55], v[104:107]
    v_mfma_f32_16x16x32_bf16 v[108:111], a[208:211], v[52:55], v[108:111]
    v_mfma_f32_16x16x32_bf16 v[112:115], a[212:215], v[52:55], v[112:115]
    ds_read_b128 v[40:43], v9 offset:128
    s_waitcnt lgkmcnt(2)
    v_mfma_f32_16x16x32_bf16 v[116:119], a[216:219], v[32:35], v[92:95]
    ds_read_b128 v[44:47], v10 offset:0
    v_mfma_f32_16x16x32_bf16 v[120:123], a[220:223], v[32:35], v[96:99]
    v_mfma_f32_16x16x32_bf16 v[124:127], a[224:227], v[32:35], v[100:103]
    s_waitcnt lgkmcnt(2)
    v_mfma_f32_16x16x32_bf16 v[116:119], a[228:231], v[36:39], v[116:119]
    ds_read_b128 v[48:51], v10 offset:64
    v_mfma_f32_16x16x32_bf16 v[120:123], a[232:235], v[36:39], v[120:123]
    v_mfma_f32_16x16x32_bf16 v[124:127], a[236:239], v[36:39], v[124:127]
    s_waitcnt lgkmcnt(2)
    v_mfma_f32_16x16x32_bf16 v[116:119], a[240:243], v[40:43], v[116:119]
    ds_read_b128 v[52:55], v10 offset:128
    v_mfma_f32_16x16x32_bf16 v[120:123], a[244:247], v[40:43], v[120:123]
    v_mfma_f32_16x16x32_bf16 v[124:127], a[248:251], v[40:43], v[124:127]
    s_waitcnt lgkmcnt(2)
    v_mfma_f32_16x16x32_bf16 v[116:119], a[252:255], v[44:47], v[116:119]
    ds_read_b128 v[32:35], v11 offset:0
    v_mfma_f32_16x16x32_bf16 v[120:123], v[140:143], v[44:47], v[120:123]
    v_cvt_pk_bf16_f32 v62, v128, v129
    v_mfma_f32_16x16x32_bf16 v[124:127], v[144:147], v[44:47], v[124:127]
    v_cvt_pk_bf16_f32 v63, v130, v131
    s_waitcnt lgkmcnt(2)
    v_mfma_f32_16x16x32_bf16 v[116:119], v[148:151], v[48:51], v[116:119]
    ds_read_b128 v[36:39], v11 offset:64
    buffer_store_dwordx2 v[62:63], v12, s[20:23], s35 offen offset:3072
    v_mfma_f32_16x16x32_bf16 v[120:123], v[152:155], v[48:51], v[120:123]
    v_cvt_pk_bf16_f32 v64, v132, v133
    v_mfma_f32_16x16x32_bf16 v[124:127], v[156:159], v[48:51], v[124:127]
    v_cvt_pk_bf16_f32 v65, v134, v135
    s_waitcnt lgkmcnt(2)
    v_mfma_f32_16x16x32_bf16 v[116:119], v[160:163], v[52:55], v[116:119]
    ds_read_b128 v[40:43], v11 offset:128
    buffer_store_dwordx2 v[64:65], v12, s[20:23], s35 offen offset:3104
    v_mfma_f32_16x16x32_bf16 v[120:123], v[164:167], v[52:55], v[120:123]
    v_cvt_pk_bf16_f32 v66, v136, v137
    v_mfma_f32_16x16x32_bf16 v[124:127], v[168:171], v[52:55], v[124:127]
    v_cvt_pk_bf16_f32 v67, v138, v139
    s_waitcnt lgkmcnt(2)
    v_mfma_f32_16x16x32_bf16 v[116:119], v[172:175], v[32:35], v[116:119]
    ds_read_b128 v[44:47], v9 offset:3072
    buffer_store_dwordx2 v[66:67], v12, s[20:23], s35 offen offset:3136
    v_mfma_f32_16x16x32_bf16 v[120:123], v[176:179], v[32:35], v[120:123]
    v_mfma_f32_16x16x32_bf16 v[124:127], v[180:183], v[32:35], v[124:127]
    s_waitcnt lgkmcnt(2)
    v_mfma_f32_16x16x32_bf16 v[116:119], v[184:187], v[36:39], v[116:119]
    ds_read_b128 v[48:51], v9 offset:3136
    v_mfma_f32_16x16x32_bf16 v[120:123], v[188:191], v[36:39], v[120:123]
    v_mfma_f32_16x16x32_bf16 v[124:127], v[192:195], v[36:39], v[124:127]
    s_waitcnt lgkmcnt(2)
    v_mfma_f32_16x16x32_bf16 v[116:119], v[196:199], v[40:43], v[116:119]
    ds_read_b128 v[52:55], v9 offset:3200
    s_add_u32 s35, s35, 196608
    s_mov_b32 s22, 50331648
    v_mfma_f32_16x16x32_bf16 v[120:123], v[200:203], v[40:43], v[120:123]
    v_mfma_f32_16x16x32_bf16 v[124:127], v[204:207], v[40:43], v[124:127]
    s_waitcnt lgkmcnt(2)
    v_mfma_f32_16x16x32_bf16 v[128:131], a[216:219], v[44:47], v[104:107]
    ds_read_b128 v[32:35], v10 offset:3072
    v_mfma_f32_16x16x32_bf16 v[132:135], a[220:223], v[44:47], v[108:111]
    v_mfma_f32_16x16x32_bf16 v[136:139], a[224:227], v[44:47], v[112:115]
    s_waitcnt lgkmcnt(2)
    v_mfma_f32_16x16x32_bf16 v[128:131], a[228:231], v[48:51], v[128:131]
    ds_read_b128 v[36:39], v10 offset:3136
    v_mfma_f32_16x16x32_bf16 v[132:135], a[232:235], v[48:51], v[132:135]
    v_mfma_f32_16x16x32_bf16 v[136:139], a[236:239], v[48:51], v[136:139]
    s_waitcnt lgkmcnt(2)
    v_mfma_f32_16x16x32_bf16 v[128:131], a[240:243], v[52:55], v[128:131]
    ds_read_b128 v[40:43], v10 offset:3200
    v_mfma_f32_16x16x32_bf16 v[132:135], a[244:247], v[52:55], v[132:135]
    v_mfma_f32_16x16x32_bf16 v[136:139], a[248:251], v[52:55], v[136:139]
    s_waitcnt lgkmcnt(2)
    v_mfma_f32_16x16x32_bf16 v[128:131], a[252:255], v[32:35], v[128:131]
    ds_read_b128 v[44:47], v11 offset:3072
    v_mfma_f32_16x16x32_bf16 v[132:135], v[140:143], v[32:35], v[132:135]
    v_cvt_pk_bf16_f32 v56, v116, v117
    v_mfma_f32_16x16x32_bf16 v[136:139], v[144:147], v[32:35], v[136:139]
    v_cvt_pk_bf16_f32 v57, v118, v119
    s_waitcnt lgkmcnt(2)
    v_mfma_f32_16x16x32_bf16 v[128:131], v[148:151], v[36:39], v[128:131]
    ds_read_b128 v[48:51], v11 offset:3136
    buffer_store_dwordx2 v[56:57], v12, s[20:23], s35 offen offset:0
    v_mfma_f32_16x16x32_bf16 v[132:135], v[152:155], v[36:39], v[132:135]
    v_cvt_pk_bf16_f32 v58, v120, v121
    v_mfma_f32_16x16x32_bf16 v[136:139], v[156:159], v[36:39], v[136:139]
    v_cvt_pk_bf16_f32 v59, v122, v123
    s_waitcnt lgkmcnt(2)
    v_mfma_f32_16x16x32_bf16 v[128:131], v[160:163], v[40:43], v[128:131]
    ds_read_b128 v[52:55], v11 offset:3200
    buffer_store_dwordx2 v[58:59], v12, s[20:23], s35 offen offset:32
    v_mfma_f32_16x16x32_bf16 v[132:135], v[164:167], v[40:43], v[132:135]
    v_cvt_pk_bf16_f32 v60, v124, v125
    v_mfma_f32_16x16x32_bf16 v[136:139], v[168:171], v[40:43], v[136:139]
    v_cvt_pk_bf16_f32 v61, v126, v127
    s_waitcnt lgkmcnt(2)
    v_mfma_f32_16x16x32_bf16 v[128:131], v[172:175], v[44:47], v[128:131]
    buffer_store_dwordx2 v[60:61], v12, s[20:23], s35 offen offset:64
    v_mfma_f32_16x16x32_bf16 v[132:135], v[176:179], v[44:47], v[132:135]
    v_mfma_f32_16x16x32_bf16 v[136:139], v[180:183], v[44:47], v[136:139]
    s_waitcnt lgkmcnt(1)
    v_mfma_f32_16x16x32_bf16 v[128:131], v[184:187], v[48:51], v[128:131]
    v_mfma_f32_16x16x32_bf16 v[132:135], v[188:191], v[48:51], v[132:135]
    v_mfma_f32_16x16x32_bf16 v[136:139], v[192:195], v[48:51], v[136:139]
    s_waitcnt lgkmcnt(0)
    v_mfma_f32_16x16x32_bf16 v[128:131], v[196:199], v[52:55], v[128:131]
    v_mfma_f32_16x16x32_bf16 v[132:135], v[200:203], v[52:55], v[132:135]
    v_mfma_f32_16x16x32_bf16 v[136:139], v[204:207], v[52:55], v[136:139]
    s_nop 7
    s_nop 1
    v_cvt_pk_bf16_f32 v62, v128, v129
    v_cvt_pk_bf16_f32 v63, v130, v131
    buffer_store_dwordx2 v[62:63], v12, s[20:23], s35 offen offset:3072
    v_cvt_pk_bf16_f32 v64, v132, v133
    v_cvt_pk_bf16_f32 v65, v134, v135
    buffer_store_dwordx2 v[64:65], v12, s[20:23], s35 offen offset:3104
    v_cvt_pk_bf16_f32 v66, v136, v137
    v_cvt_pk_bf16_f32 v67, v138, v139
    buffer_store_dwordx2 v[66:67], v12, s[20:23], s35 offen offset:3136
L_end:
    s_endpgm
.section .rodata,"a"
.p2align 6
.amdhsa_kernel standalone__dilated_atrous__vision_kernel
  .amdhsa_next_free_vgpr 512
  .amdhsa_next_free_sgpr 64
  .amdhsa_accum_offset 256
  .amdhsa_group_segment_fixed_size 0
  .amdhsa_kernarg_size 40
  .amdhsa_user_sgpr_count 2
  .amdhsa_user_sgpr_kernarg_segment_ptr 1
  .amdhsa_system_sgpr_workgroup_id_x 1
.end_amdhsa_kernel
```

```asm
; @launch grid=(256,1,1) block=(256,1,1) lds=163840
.amdgcn_target "amdgcn-amd-amdhsa--gfx950"
.text
.globl standalone__dilated_atrous__vision_kernel
.p2align 8
.type standalone__dilated_atrous__vision_kernel,@function
standalone__dilated_atrous__vision_kernel:
    s_cmp_ge_u32 s2, 256
    s_cbranch_scc1 L_end
    s_load_dwordx4 s[4:7], s[0:1], 0
    s_load_dwordx2 s[8:9], s[0:1], 16
    v_lshrrev_b32 v29, 6, v0
    s_and_b32 s37, s2, 7
    v_readfirstlane_b32 s24, v29
    s_lshr_b32 s38, s2, 3
    s_and_b32 s38, s38, 1
    s_lshr_b32 s39, s2, 4
    s_lshl_b32 s39, s39, 5
    s_add_u32 s25, s39, s38
    s_mul_i32 s40, s37, 12288
    s_sub_u32 s41, s40, 384
    v_mul_u32_u24 v31, 43691, v0
    v_lshlrev_b32 v32, 4, v0
    v_lshrrev_b32 v31, 19, v31
    v_and_b32 v33, 4, v31
    v_and_b32 v34, 8, v31
    v_lshlrev_b32 v33, 3, v33
    v_lshlrev_b32 v34, 2, v34
    v_xor_b32 v33, v33, v32
    v_xor_b32 v19, v34, v32
    v_add_u32 v2, s41, v33
    v_add_u32 v30, 256, v0
    v_mul_u32_u24 v31, 43691, v30
    v_lshlrev_b32 v32, 4, v30
    v_lshrrev_b32 v31, 19, v31
    v_and_b32 v33, 4, v31
    v_and_b32 v34, 8, v31
    v_lshlrev_b32 v33, 3, v33
    v_lshlrev_b32 v34, 2, v34
    v_xor_b32 v33, v33, v32
    v_xor_b32 v20, v34, v32
    v_add_u32 v3, s41, v33
    v_add_u32 v30, 512, v0
    v_mul_u32_u24 v31, 43691, v30
    v_lshlrev_b32 v32, 4, v30
    v_lshrrev_b32 v31, 19, v31
    v_and_b32 v33, 4, v31
    v_and_b32 v34, 8, v31
    v_lshlrev_b32 v33, 3, v33
    v_lshlrev_b32 v34, 2, v34
    v_xor_b32 v33, v33, v32
    v_xor_b32 v21, v34, v32
    v_add_u32 v4, s41, v33
    s_cmp_eq_u32 s37, 0
    s_cselect_b32 s42, 24, 0
    v_mov_b32 v35, 0x80000000
    v_cmp_gt_u32 vcc, s42, v0
    v_and_b32 v36, 63, v0
    s_lshl_b32 s26, s24, 10
    v_cndmask_b32 v2, v2, v35, vcc
    s_add_u32 s27, s26, 4096
    s_add_u32 s28, s26, 8192
    s_mov_b32 s29, 12288
    s_cmp_eq_u32 s37, 7
    s_cselect_b32 s45, 24, 48
    s_add_u32 s44, s41, 12288
    v_cmp_gt_u32 vcc, s45, v36
    v_lshlrev_b32 v29, 4, v36
    v_add_u32 v29, s44, v29
    v_cndmask_b32 v5, v35, v29, vcc
    s_lshr_b32 s45, s2, 3
    s_lshl_b32 s45, s45, 2
    s_add_u32 s45, s45, s24
    s_mul_i32 s45, s45, 1344
    v_lshl_add_u32 v39, v36, 6, s45
    s_mov_b32 s33, s25
    s_mul_i32 s32, s33, 98304
    s_add_u32 s34, s25, 33
    s_min_u32 s34, s34, 512
    s_mov_b32 s14, 50331648
    s_mov_b32 s15, 0x20000
    s_mov_b32 s18, 165888
    s_mov_b32 s19, 0x20000
    s_mov_b32 s30, 0
    s_mov_b32 s31, 0
    s_waitcnt lgkmcnt(0)
    s_mov_b32 s12, s4
    s_and_b32 s13, s5, 0xffff
    s_mov_b32 s16, s6
    s_and_b32 s17, s7, 0xffff
    s_mov_b64 exec, 0x1fffff
    buffer_load_dword v38, v39, s[16:19], 0 offen
    s_mov_b64 exec, -1
    s_add_u32 m0, s31, s26
    s_nop 0
    buffer_load_dwordx4 v2, s[12:15], s32 offen lds
    s_add_u32 m0, s31, s27
    s_nop 0
    buffer_load_dwordx4 v3, s[12:15], s32 offen lds
    s_add_u32 m0, s31, s28
    s_nop 0
    buffer_load_dwordx4 v4, s[12:15], s32 offen lds
    s_add_u32 m0, s31, s29
    s_nop 0
    buffer_load_dwordx4 v5, s[12:15], s32 offen lds
    s_mov_b32 s16, s6
    s_and_b32 s17, s7, 0xffff
    s_lshl_b32 s42, s24, 5
    s_add_u32 s42, s42, 3328
    v_add_u32 v30, s42, v36
    v_mul_u32_u24 v31, 43691, v30
    v_lshlrev_b32 v32, 4, v30
    v_lshrrev_b32 v31, 19, v31
    v_and_b32 v34, 8, v31
    v_lshlrev_b32 v34, 2, v34
    v_xor_b32 v22, v34, v32
    s_add_u32 m0, s26, 53248
    s_mov_b32 s46, 0
    buffer_load_dwordx4 v19, s[16:19], s46 offen lds
    s_add_u32 m0, s26, 57344
    s_mov_b32 s46, 0
    buffer_load_dwordx4 v20, s[16:19], s46 offen lds
    s_add_u32 m0, s26, 61440
    s_mov_b32 s46, 0
    buffer_load_dwordx4 v21, s[16:19], s46 offen lds
    s_add_u32 m0, s26, 65536
    s_mov_b32 s46, 12288
    buffer_load_dwordx4 v19, s[16:19], s46 offen lds
    s_add_u32 m0, s26, 69632
    s_mov_b32 s46, 12288
    buffer_load_dwordx4 v20, s[16:19], s46 offen lds
    s_add_u32 m0, s26, 73728
    s_mov_b32 s46, 12288
    buffer_load_dwordx4 v21, s[16:19], s46 offen lds
    s_add_u32 m0, s26, 77824
    s_mov_b32 s46, 24576
    buffer_load_dwordx4 v19, s[16:19], s46 offen lds
    s_add_u32 m0, s26, 81920
    s_mov_b32 s46, 24576
    buffer_load_dwordx4 v20, s[16:19], s46 offen lds
    s_add_u32 m0, s26, 86016
    s_mov_b32 s46, 24576
    buffer_load_dwordx4 v21, s[16:19], s46 offen lds
    s_add_u32 m0, s26, 90112
    s_mov_b32 s46, 36864
    buffer_load_dwordx4 v19, s[16:19], s46 offen lds
    s_add_u32 m0, s26, 94208
    s_mov_b32 s46, 36864
    buffer_load_dwordx4 v20, s[16:19], s46 offen lds
    s_add_u32 m0, s26, 98304
    s_mov_b32 s46, 36864
    buffer_load_dwordx4 v21, s[16:19], s46 offen lds
    s_add_u32 m0, s26, 102400
    s_mov_b32 s46, 49152
    buffer_load_dwordx4 v19, s[16:19], s46 offen lds
    s_lshr_b32 s37, s26, 1
    s_add_u32 m0, s37, 106496
    s_mov_b32 s46, 0
    s_mov_b32 exec_hi, 0
    buffer_load_dwordx4 v22, s[16:19], s46 offen lds
    s_mov_b64 exec, -1
    v_and_b32 v29, 15, v36
    v_lshrrev_b32 v30, 4, v36
    s_lshr_b32 s42, s24, 1
    s_and_b32 s43, s24, 1
    s_lshl_b32 s42, s42, 5
    s_mul_i32 s43, s43, 96
    v_lshlrev_b32 v31, 4, v30
    v_add_u32 v32, s42, v29
    v_and_b32 v33, 4, v32
    v_mul_u32_u24 v34, 192, v32
    v_lshlrev_b32 v33, 3, v33
    v_xor_b32 v33, v33, v31
    v_add_u32 v6, v34, v33
    v_mov_b32 v9, v6
    v_add_u32 v32, s42, v29
    v_add_u32 v32, 2, v32
    v_and_b32 v33, 4, v32
    v_mul_u32_u24 v34, 192, v32
    v_lshlrev_b32 v33, 3, v33
    v_xor_b32 v33, v33, v31
    v_add_u32 v7, v34, v33
    v_mov_b32 v10, v7
    v_add_u32 v32, s42, v29
    v_add_u32 v32, 4, v32
    v_and_b32 v33, 4, v32
    v_mul_u32_u24 v34, 192, v32
    v_lshlrev_b32 v33, 3, v33
    v_xor_b32 v33, v33, v31
    v_add_u32 v8, v34, v33
    v_mov_b32 v11, v8
    v_lshrrev_b32 v32, 2, v29
    v_lshl_add_u32 v32, v30, 3, v32
    v_mul_u32_u24 v32, 192, v32
    v_and_b32 v33, 3, v29
    v_lshlrev_b32 v33, 3, v33
    v_and_b32 v34, 1, v30
    v_lshlrev_b32 v34, 5, v34
    v_add_u32 v33, s43, v33
    v_add_u32 v35, 0, v33
    v_xor_b32 v35, v35, v34
    v_add_u32 v35, v35, v32
    v_add_u32 v23, 53248, v35
    v_add_u32 v26, 108544, v35
    v_add_u32 v35, 32, v33
    v_xor_b32 v35, v35, v34
    v_add_u32 v35, v35, v32
    v_add_u32 v24, 53248, v35
    v_add_u32 v27, 108544, v35
    v_add_u32 v35, 64, v33
    v_xor_b32 v35, v35, v34
    v_add_u32 v35, v35, v32
    v_add_u32 v25, 53248, v35
    v_add_u32 v28, 108544, v35
    v_add_u32 v32, s42, v29
    v_mul_u32_u24 v32, 192, v32
    v_add_u32 v32, 65536, v32
    v_lshlrev_b32 v33, 3, v29
    v_and_b32 v33, 0x30, v33
    v_lshlrev_b32 v34, 3, v30
    v_add_u32 v34, s43, v34
    v_add_u32 v35, 0, v34
    v_xor_b32 v35, v35, v33
    v_add_u32 v12, v35, v32
    v_add_u32 v35, 32, v34
    v_xor_b32 v35, v35, v33
    v_add_u32 v13, v35, v32
    v_add_u32 v35, 64, v34
    v_xor_b32 v35, v35, v33
    v_add_u32 v14, v35, v32
    s_mul_i32 s44, s24, 192
    v_add_u32 v32, s44, v36
    v_mul_u32_u24 v33, 43691, v32
    v_lshlrev_b32 v34, 4, v32
    v_lshrrev_b32 v33, 16, v33
    v_and_b32 v33, 0x30, v33
    v_xor_b32 v34, v34, v33
    v_add_u32 v15, 65536, v34
    v_add_u32 v32, s44, v36
    v_add_u32 v32, 64, v32
    v_mul_u32_u24 v33, 43691, v32
    v_lshlrev_b32 v34, 4, v32
    v_lshrrev_b32 v33, 16, v33
    v_and_b32 v33, 0x30, v33
    v_xor_b32 v34, v34, v33
    v_add_u32 v16, 65536, v34
    v_add_u32 v32, s44, v36
    v_add_u32 v32, 128, v32
    v_mul_u32_u24 v33, 43691, v32
    v_lshlrev_b32 v34, 4, v32
    v_lshrrev_b32 v33, 16, v33
    v_and_b32 v33, 0x30, v33
    v_xor_b32 v34, v34, v33
    v_add_u32 v17, 65536, v34
    s_mul_i32 s45, s24, 3072
    s_add_u32 s45, s45, s40
    v_lshlrev_b32 v32, 4, v36
    v_add_u32 v18, s45, v32
    s_mov_b32 s20, s8
    s_and_b32 s21, s9, 0xffff
    s_mov_b32 s22, 50331648
    s_mov_b32 s23, 0x20000
    s_mul_i32 s35, s25, 98304
    s_waitcnt vmcnt(0)
    s_barrier
    ds_read_b128 v[40:43], v9 offset:0
    ds_read_b64_tr_b16 a[0:1], v23 offset:0
    ds_read_b64_tr_b16 a[2:3], v23 offset:768
    ds_read_b128 v[44:47], v9 offset:64
    ds_read_b64_tr_b16 a[12:13], v23 offset:6144
    ds_read_b64_tr_b16 a[14:15], v23 offset:6912
    ds_read_b128 v[48:51], v9 offset:128
    ds_read_b64_tr_b16 a[24:25], v23 offset:12288
    ds_read_b64_tr_b16 a[26:27], v23 offset:13056
    ds_read_b128 v[52:55], v10 offset:0
    ds_read_b64_tr_b16 a[36:37], v23 offset:18432
    ds_read_b64_tr_b16 a[38:39], v23 offset:19200
    ds_read_b128 v[56:59], v10 offset:64
    ds_read_b64_tr_b16 a[48:49], v23 offset:24576
    ds_read_b64_tr_b16 a[50:51], v23 offset:25344
    ds_read_b128 v[60:63], v10 offset:128
    ds_read_b64_tr_b16 a[60:61], v23 offset:30720
    ds_read_b64_tr_b16 a[62:63], v23 offset:31488
    ds_read_b128 v[64:67], v11 offset:0
    ds_read_b64_tr_b16 a[72:73], v23 offset:36864
    ds_read_b64_tr_b16 a[74:75], v23 offset:37632
    ds_read_b128 v[68:71], v11 offset:64
    ds_read_b64_tr_b16 a[84:85], v23 offset:43008
    ds_read_b64_tr_b16 a[86:87], v23 offset:43776
    ds_read_b128 v[72:75], v11 offset:128
    ds_read_b64_tr_b16 a[96:97], v23 offset:49152
    ds_read_b64_tr_b16 a[98:99], v23 offset:49920
    ds_read_b64_tr_b16 a[4:5], v24 offset:0
    ds_read_b64_tr_b16 a[6:7], v24 offset:768
    s_add_u32 m0, s26, 108544
    s_mov_b32 s46, 55296
    s_waitcnt lgkmcnt(14)
    v_mfma_f32_16x16x32_bf16 v[120:123], a[0:3], v[40:43], 0
    ds_read_b64_tr_b16 a[16:17], v24 offset:6144
    ds_read_b64_tr_b16 a[18:19], v24 offset:6912
    buffer_load_dwordx4 v19, s[16:19], s46 offen lds
    v_mfma_f32_16x16x32_bf16 v[120:123], a[12:15], v[44:47], v[120:123]
    ds_read_b64_tr_b16 a[28:29], v24 offset:12288
    ds_read_b64_tr_b16 a[30:31], v24 offset:13056
    s_add_u32 m0, s26, 112640
    s_mov_b32 s46, 55296
    v_mfma_f32_16x16x32_bf16 v[120:123], a[24:27], v[48:51], v[120:123]
    ds_read_b64_tr_b16 a[40:41], v24 offset:18432
    ds_read_b64_tr_b16 a[42:43], v24 offset:19200
    buffer_load_dwordx4 v20, s[16:19], s46 offen lds
    s_waitcnt lgkmcnt(14)
    v_mfma_f32_16x16x32_bf16 v[120:123], a[36:39], v[52:55], v[120:123]
    ds_read_b64_tr_b16 a[52:53], v24 offset:24576
    ds_read_b64_tr_b16 a[54:55], v24 offset:25344
    s_add_u32 m0, s26, 116736
    s_mov_b32 s46, 55296
    v_mfma_f32_16x16x32_bf16 v[120:123], a[48:51], v[56:59], v[120:123]
    ds_read_b64_tr_b16 a[64:65], v24 offset:30720
    ds_read_b64_tr_b16 a[66:67], v24 offset:31488
    buffer_load_dwordx4 v21, s[16:19], s46 offen lds
    v_mfma_f32_16x16x32_bf16 v[120:123], a[60:63], v[60:63], v[120:123]
    ds_read_b64_tr_b16 a[76:77], v24 offset:36864
    ds_read_b64_tr_b16 a[78:79], v24 offset:37632
    s_add_u32 m0, s26, 120832
    s_mov_b32 s46, 67584
    s_waitcnt lgkmcnt(14)
    v_mfma_f32_16x16x32_bf16 v[120:123], a[72:75], v[64:67], v[120:123]
    ds_read_b64_tr_b16 a[88:89], v24 offset:43008
    ds_read_b64_tr_b16 a[90:91], v24 offset:43776
    buffer_load_dwordx4 v19, s[16:19], s46 offen lds
    v_mfma_f32_16x16x32_bf16 v[120:123], a[84:87], v[68:71], v[120:123]
    ds_read_b64_tr_b16 a[100:101], v24 offset:49152
    ds_read_b64_tr_b16 a[102:103], v24 offset:49920
    s_add_u32 m0, s26, 124928
    s_mov_b32 s46, 67584
    v_mfma_f32_16x16x32_bf16 v[120:123], a[96:99], v[72:75], v[120:123]
    ds_read_b64_tr_b16 a[8:9], v25 offset:0
    ds_read_b64_tr_b16 a[10:11], v25 offset:768
    buffer_load_dwordx4 v20, s[16:19], s46 offen lds
    s_waitcnt lgkmcnt(14)
    v_mfma_f32_16x16x32_bf16 v[124:127], a[4:7], v[40:43], 0
    ds_read_b64_tr_b16 a[20:21], v25 offset:6144
    ds_read_b64_tr_b16 a[22:23], v25 offset:6912
    s_add_u32 m0, s26, 129024
    s_mov_b32 s46, 67584
    v_mfma_f32_16x16x32_bf16 v[124:127], a[16:19], v[44:47], v[124:127]
    ds_read_b64_tr_b16 a[32:33], v25 offset:12288
    ds_read_b64_tr_b16 a[34:35], v25 offset:13056
    buffer_load_dwordx4 v21, s[16:19], s46 offen lds
    v_mfma_f32_16x16x32_bf16 v[124:127], a[28:31], v[48:51], v[124:127]
    ds_read_b64_tr_b16 a[44:45], v25 offset:18432
    ds_read_b64_tr_b16 a[46:47], v25 offset:19200
    s_add_u32 m0, s26, 133120
    s_mov_b32 s46, 79872
    s_waitcnt lgkmcnt(14)
    v_mfma_f32_16x16x32_bf16 v[124:127], a[40:43], v[52:55], v[124:127]
    ds_read_b64_tr_b16 a[56:57], v25 offset:24576
    ds_read_b64_tr_b16 a[58:59], v25 offset:25344
    buffer_load_dwordx4 v19, s[16:19], s46 offen lds
    v_mfma_f32_16x16x32_bf16 v[124:127], a[52:55], v[56:59], v[124:127]
    ds_read_b64_tr_b16 a[68:69], v25 offset:30720
    ds_read_b64_tr_b16 a[70:71], v25 offset:31488
    s_add_u32 m0, s26, 137216
    s_mov_b32 s46, 79872
    v_mfma_f32_16x16x32_bf16 v[124:127], a[64:67], v[60:63], v[124:127]
    ds_read_b64_tr_b16 a[80:81], v25 offset:36864
    ds_read_b64_tr_b16 a[82:83], v25 offset:37632
    buffer_load_dwordx4 v20, s[16:19], s46 offen lds
    s_waitcnt lgkmcnt(14)
    v_mfma_f32_16x16x32_bf16 v[124:127], a[76:79], v[64:67], v[124:127]
    ds_read_b64_tr_b16 a[92:93], v25 offset:43008
    ds_read_b64_tr_b16 a[94:95], v25 offset:43776
    s_add_u32 m0, s26, 141312
    s_mov_b32 s46, 79872
    v_mfma_f32_16x16x32_bf16 v[124:127], a[88:91], v[68:71], v[124:127]
    ds_read_b64_tr_b16 a[104:105], v25 offset:49152
    ds_read_b64_tr_b16 a[106:107], v25 offset:49920
    buffer_load_dwordx4 v21, s[16:19], s46 offen lds
    v_mfma_f32_16x16x32_bf16 v[124:127], a[100:103], v[72:75], v[124:127]
    s_add_u32 m0, s26, 145408
    s_mov_b32 s46, 92160
    s_waitcnt lgkmcnt(12)
    v_mfma_f32_16x16x32_bf16 v[128:131], a[8:11], v[40:43], 0
    ds_read_b128 v[40:43], v9 offset:3072
    buffer_load_dwordx4 v19, s[16:19], s46 offen lds
    v_mfma_f32_16x16x32_bf16 v[128:131], a[20:23], v[44:47], v[128:131]
    ds_read_b128 v[44:47], v9 offset:3136
    s_add_u32 m0, s26, 149504
    s_mov_b32 s46, 92160
    v_mfma_f32_16x16x32_bf16 v[128:131], a[32:35], v[48:51], v[128:131]
    ds_read_b128 v[48:51], v9 offset:3200
    buffer_load_dwordx4 v20, s[16:19], s46 offen lds
    s_waitcnt lgkmcnt(9)
    v_mfma_f32_16x16x32_bf16 v[128:131], a[44:47], v[52:55], v[128:131]
    ds_read_b128 v[52:55], v10 offset:3072
    s_add_u32 m0, s26, 153600
    s_mov_b32 s46, 92160
    v_mfma_f32_16x16x32_bf16 v[128:131], a[56:59], v[56:59], v[128:131]
    ds_read_b128 v[56:59], v10 offset:3136
    buffer_load_dwordx4 v21, s[16:19], s46 offen lds
    v_mfma_f32_16x16x32_bf16 v[128:131], a[68:71], v[60:63], v[128:131]
    ds_read_b128 v[60:63], v10 offset:3200
    s_add_u32 m0, s26, 157696
    s_mov_b32 s46, 104448
    s_waitcnt lgkmcnt(6)
    v_mfma_f32_16x16x32_bf16 v[128:131], a[80:83], v[64:67], v[128:131]
    ds_read_b128 v[64:67], v11 offset:3072
    buffer_load_dwordx4 v19, s[16:19], s46 offen lds
    v_mfma_f32_16x16x32_bf16 v[128:131], a[92:95], v[68:71], v[128:131]
    ds_read_b128 v[68:71], v11 offset:3136
    s_lshr_b32 s37, s26, 1
    s_add_u32 m0, s37, 161792
    s_mov_b32 s46, 55296
    v_mfma_f32_16x16x32_bf16 v[128:131], a[104:107], v[72:75], v[128:131]
    ds_read_b128 v[72:75], v11 offset:3200
    s_mov_b32 exec_hi, 0
    buffer_load_dwordx4 v22, s[16:19], s46 offen lds
    s_mov_b64 exec, -1
    s_waitcnt lgkmcnt(6)
    v_mfma_f32_16x16x32_bf16 v[132:135], a[0:3], v[40:43], 0
    s_add_u32 s32, s32, 196608
    v_mfma_f32_16x16x32_bf16 v[132:135], a[12:15], v[44:47], v[132:135]
    s_add_u32 s33, s33, 2
    v_mfma_f32_16x16x32_bf16 v[132:135], a[24:27], v[48:51], v[132:135]
    s_cmp_lt_u32 s33, s34
    v_mfma_f32_16x16x32_bf16 v[136:139], a[4:7], v[40:43], 0
    s_cselect_b32 s14, 50331648, 0
    v_mfma_f32_16x16x32_bf16 v[136:139], a[16:19], v[44:47], v[136:139]
    s_add_u32 s31, s31, 13312
    v_mfma_f32_16x16x32_bf16 v[136:139], a[28:31], v[48:51], v[136:139]
    s_cmp_eq_u32 s31, 53248
    v_mfma_f32_16x16x32_bf16 v[140:143], a[8:11], v[40:43], 0
    ds_read_b128 v[40:43], v9 offset:0
    s_cselect_b32 s31, 0, s31
    v_mfma_f32_16x16x32_bf16 v[140:143], a[20:23], v[44:47], v[140:143]
    ds_read_b128 v[44:47], v9 offset:64
    s_add_u32 m0, s31, s26
    v_mfma_f32_16x16x32_bf16 v[140:143], a[32:35], v[48:51], v[140:143]
    ds_read_b128 v[48:51], v9 offset:128
    buffer_load_dwordx4 v2, s[12:15], s32 offen lds
    s_waitcnt lgkmcnt(6)
    v_mfma_f32_16x16x32_bf16 v[132:135], a[36:39], v[52:55], v[132:135]
    s_add_u32 m0, s31, s27
    v_mfma_f32_16x16x32_bf16 v[132:135], a[48:51], v[56:59], v[132:135]
    buffer_load_dwordx4 v3, s[12:15], s32 offen lds
    v_mfma_f32_16x16x32_bf16 v[132:135], a[60:63], v[60:63], v[132:135]
    s_add_u32 m0, s31, s28
    v_mfma_f32_16x16x32_bf16 v[136:139], a[40:43], v[52:55], v[136:139]
    buffer_load_dwordx4 v4, s[12:15], s32 offen lds
    v_mfma_f32_16x16x32_bf16 v[136:139], a[52:55], v[56:59], v[136:139]
    s_add_u32 m0, s31, s29
    v_mfma_f32_16x16x32_bf16 v[136:139], a[64:67], v[60:63], v[136:139]
    buffer_load_dwordx4 v5, s[12:15], s32 offen lds
    v_mfma_f32_16x16x32_bf16 v[140:143], a[44:47], v[52:55], v[140:143]
    ds_read_b128 v[52:55], v10 offset:0
    v_mfma_f32_16x16x32_bf16 v[140:143], a[56:59], v[56:59], v[140:143]
    ds_read_b128 v[56:59], v10 offset:64
    v_mfma_f32_16x16x32_bf16 v[140:143], a[68:71], v[60:63], v[140:143]
    ds_read_b128 v[60:63], v10 offset:128
    s_waitcnt lgkmcnt(6)
    v_mfma_f32_16x16x32_bf16 v[132:135], a[72:75], v[64:67], v[132:135]
    v_mfma_f32_16x16x32_bf16 v[132:135], a[84:87], v[68:71], v[132:135]
    v_mfma_f32_16x16x32_bf16 v[132:135], a[96:99], v[72:75], v[132:135]
    s_waitcnt vmcnt(4) lgkmcnt(0)
    s_barrier
    ds_read_b64_tr_b16 a[108:109], v26 offset:0
    ds_read_b64_tr_b16 a[110:111], v26 offset:768
    v_mfma_f32_16x16x32_bf16 v[136:139], a[76:79], v[64:67], v[136:139]
    ds_read_b64_tr_b16 a[120:121], v26 offset:6144
    ds_read_b64_tr_b16 a[122:123], v26 offset:6912
    s_add_u32 m0, s26, 53248
    s_mov_b32 s46, 110592
    v_mfma_f32_16x16x32_bf16 v[136:139], a[88:91], v[68:71], v[136:139]
    ds_read_b64_tr_b16 a[132:133], v26 offset:12288
    ds_read_b64_tr_b16 a[134:135], v26 offset:13056
    buffer_load_dwordx4 v19, s[16:19], s46 offen lds
    v_mfma_f32_16x16x32_bf16 v[136:139], a[100:103], v[72:75], v[136:139]
    ds_read_b64_tr_b16 a[144:145], v26 offset:18432
    ds_read_b64_tr_b16 a[146:147], v26 offset:19200
    v_mfma_f32_16x16x32_bf16 v[140:143], a[80:83], v[64:67], v[140:143]
    ds_read_b128 v[64:67], v11 offset:0
    ds_read_b64_tr_b16 a[156:157], v26 offset:24576
    ds_read_b64_tr_b16 a[158:159], v26 offset:25344
    v_mfma_f32_16x16x32_bf16 v[140:143], a[92:95], v[68:71], v[140:143]
    ds_read_b128 v[68:71], v11 offset:64
    ds_read_b64_tr_b16 a[168:169], v26 offset:30720
    ds_read_b64_tr_b16 a[170:171], v26 offset:31488
    s_add_u32 m0, s26, 57344
    s_mov_b32 s46, 110592
    v_mfma_f32_16x16x32_bf16 v[140:143], a[104:107], v[72:75], v[140:143]
    ds_read_b128 v[72:75], v11 offset:128
    ds_read_b64_tr_b16 a[180:181], v26 offset:36864
    ds_read_b64_tr_b16 a[182:183], v26 offset:37632
    buffer_load_dwordx4 v20, s[16:19], s46 offen lds
    s_waitcnt lgkmcnt(11)
    v_mfma_f32_16x16x32_bf16 v[144:147], a[108:111], v[40:43], 0
    ds_read_b64_tr_b16 a[192:193], v26 offset:43008
    ds_read_b64_tr_b16 a[194:195], v26 offset:43776
    v_mfma_f32_16x16x32_bf16 v[144:147], a[120:123], v[44:47], v[144:147]
    ds_read_b64_tr_b16 a[204:205], v26 offset:49152
    ds_read_b64_tr_b16 a[206:207], v26 offset:49920
    v_mfma_f32_16x16x32_bf16 v[144:147], a[132:135], v[48:51], v[144:147]
    ds_read_b64_tr_b16 a[112:113], v27 offset:0
    ds_read_b64_tr_b16 a[114:115], v27 offset:768
    s_add_u32 m0, s26, 61440
    s_mov_b32 s46, 110592
    s_waitcnt lgkmcnt(9)
    v_mfma_f32_16x16x32_bf16 v[144:147], a[144:147], v[52:55], v[144:147]
    ds_read_b64_tr_b16 a[124:125], v27 offset:6144
    ds_read_b64_tr_b16 a[126:127], v27 offset:6912
    buffer_load_dwordx4 v21, s[16:19], s46 offen lds
    v_mfma_f32_16x16x32_bf16 v[144:147], a[156:159], v[56:59], v[144:147]
    ds_read_b64_tr_b16 a[136:137], v27 offset:12288
    ds_read_b64_tr_b16 a[138:139], v27 offset:13056
    v_mfma_f32_16x16x32_bf16 v[144:147], a[168:171], v[60:63], v[144:147]
    ds_read_b64_tr_b16 a[148:149], v27 offset:18432
    ds_read_b64_tr_b16 a[150:151], v27 offset:19200
    s_waitcnt lgkmcnt(8)
    v_mfma_f32_16x16x32_bf16 v[144:147], a[180:183], v[64:67], v[144:147]
    ds_read_b64_tr_b16 a[160:161], v27 offset:24576
    ds_read_b64_tr_b16 a[162:163], v27 offset:25344
    s_add_u32 m0, s26, 65536
    s_mov_b32 s46, 122880
    v_mfma_f32_16x16x32_bf16 v[144:147], a[192:195], v[68:71], v[144:147]
    ds_read_b64_tr_b16 a[172:173], v27 offset:30720
    ds_read_b64_tr_b16 a[174:175], v27 offset:31488
    buffer_load_dwordx4 v19, s[16:19], s46 offen lds
    v_mfma_f32_16x16x32_bf16 v[144:147], a[204:207], v[72:75], v[144:147]
    ds_read_b64_tr_b16 a[184:185], v27 offset:36864
    ds_read_b64_tr_b16 a[186:187], v27 offset:37632
    s_waitcnt lgkmcnt(8)
    v_mfma_f32_16x16x32_bf16 v[148:151], a[112:115], v[40:43], 0
    ds_read_b64_tr_b16 a[196:197], v27 offset:43008
    ds_read_b64_tr_b16 a[198:199], v27 offset:43776
    v_mfma_f32_16x16x32_bf16 v[148:151], a[124:127], v[44:47], v[148:151]
    ds_read_b64_tr_b16 a[208:209], v27 offset:49152
    ds_read_b64_tr_b16 a[210:211], v27 offset:49920
    s_add_u32 m0, s26, 69632
    s_mov_b32 s46, 122880
    v_mfma_f32_16x16x32_bf16 v[148:151], a[136:139], v[48:51], v[148:151]
    ds_read_b64_tr_b16 a[116:117], v28 offset:0
    ds_read_b64_tr_b16 a[118:119], v28 offset:768
    buffer_load_dwordx4 v20, s[16:19], s46 offen lds
    s_waitcnt lgkmcnt(8)
    v_mfma_f32_16x16x32_bf16 v[148:151], a[148:151], v[52:55], v[148:151]
    ds_read_b64_tr_b16 a[128:129], v28 offset:6144
    ds_read_b64_tr_b16 a[130:131], v28 offset:6912
    v_mfma_f32_16x16x32_bf16 v[148:151], a[160:163], v[56:59], v[148:151]
    ds_read_b64_tr_b16 a[140:141], v28 offset:12288
    ds_read_b64_tr_b16 a[142:143], v28 offset:13056
    v_mfma_f32_16x16x32_bf16 v[148:151], a[172:175], v[60:63], v[148:151]
    ds_read_b64_tr_b16 a[152:153], v28 offset:18432
    ds_read_b64_tr_b16 a[154:155], v28 offset:19200
    s_add_u32 m0, s26, 73728
    s_mov_b32 s46, 122880
    s_waitcnt lgkmcnt(8)
    v_mfma_f32_16x16x32_bf16 v[148:151], a[184:187], v[64:67], v[148:151]
    ds_read_b64_tr_b16 a[164:165], v28 offset:24576
    ds_read_b64_tr_b16 a[166:167], v28 offset:25344
    buffer_load_dwordx4 v21, s[16:19], s46 offen lds
    v_mfma_f32_16x16x32_bf16 v[148:151], a[196:199], v[68:71], v[148:151]
    ds_read_b64_tr_b16 a[176:177], v28 offset:30720
    ds_read_b64_tr_b16 a[178:179], v28 offset:31488
    v_mfma_f32_16x16x32_bf16 v[148:151], a[208:211], v[72:75], v[148:151]
    ds_read_b64_tr_b16 a[188:189], v28 offset:36864
    ds_read_b64_tr_b16 a[190:191], v28 offset:37632
    s_waitcnt lgkmcnt(8)
    v_mfma_f32_16x16x32_bf16 v[152:155], a[116:119], v[40:43], 0
    ds_read_b128 v[40:43], v9 offset:3072
    ds_read_b64_tr_b16 a[200:201], v28 offset:43008
    ds_read_b64_tr_b16 a[202:203], v28 offset:43776
    s_add_u32 m0, s26, 77824
    s_mov_b32 s46, 135168
    v_mfma_f32_16x16x32_bf16 v[152:155], a[128:131], v[44:47], v[152:155]
    ds_read_b128 v[44:47], v9 offset:3136
    ds_read_b64_tr_b16 a[212:213], v28 offset:49152
    ds_read_b64_tr_b16 a[214:215], v28 offset:49920
    buffer_load_dwordx4 v19, s[16:19], s46 offen lds
    v_mfma_f32_16x16x32_bf16 v[152:155], a[140:143], v[48:51], v[152:155]
    ds_read_b128 v[48:51], v9 offset:3200
    s_waitcnt lgkmcnt(9)
    v_mfma_f32_16x16x32_bf16 v[152:155], a[152:155], v[52:55], v[152:155]
    ds_read_b128 v[52:55], v10 offset:3072
    v_mfma_f32_16x16x32_bf16 v[152:155], a[164:167], v[56:59], v[152:155]
    ds_read_b128 v[56:59], v10 offset:3136
    s_add_u32 m0, s26, 81920
    s_mov_b32 s46, 135168
    v_mfma_f32_16x16x32_bf16 v[152:155], a[176:179], v[60:63], v[152:155]
    ds_read_b128 v[60:63], v10 offset:3200
    buffer_load_dwordx4 v20, s[16:19], s46 offen lds
    s_waitcnt lgkmcnt(4)
    v_mfma_f32_16x16x32_bf16 v[152:155], a[188:191], v[64:67], v[152:155]
    ds_read_b128 v[64:67], v11 offset:3072
    v_mfma_f32_16x16x32_bf16 v[152:155], a[200:203], v[68:71], v[152:155]
    ds_read_b128 v[68:71], v11 offset:3136
    v_mfma_f32_16x16x32_bf16 v[152:155], a[212:215], v[72:75], v[152:155]
    ds_read_b128 v[72:75], v11 offset:3200
    s_add_u32 m0, s26, 86016
    s_mov_b32 s46, 135168
    s_waitcnt lgkmcnt(6)
    v_mfma_f32_16x16x32_bf16 v[156:159], a[108:111], v[40:43], 0
    buffer_load_dwordx4 v21, s[16:19], s46 offen lds
    s_add_u32 s30, s30, 13312
    v_mfma_f32_16x16x32_bf16 v[156:159], a[120:123], v[44:47], v[156:159]
    s_cmp_eq_u32 s30, 53248
    v_mfma_f32_16x16x32_bf16 v[156:159], a[132:135], v[48:51], v[156:159]
    s_cselect_b32 s30, 0, s30
    v_mfma_f32_16x16x32_bf16 v[160:163], a[112:115], v[40:43], 0
    s_add_u32 m0, s26, 90112
    s_mov_b32 s46, 147456
    v_add_u32 v9, s30, v6
    v_mfma_f32_16x16x32_bf16 v[160:163], a[124:127], v[44:47], v[160:163]
    buffer_load_dwordx4 v19, s[16:19], s46 offen lds
    v_add_u32 v10, s30, v7
    v_mfma_f32_16x16x32_bf16 v[160:163], a[136:139], v[48:51], v[160:163]
    v_add_u32 v11, s30, v8
    s_waitcnt vmcnt(10) lgkmcnt(0)
    s_barrier
    v_mfma_f32_16x16x32_bf16 v[164:167], a[116:119], v[40:43], 0
    ds_read_b128 v[40:43], v9 offset:0
    v_mfma_f32_16x16x32_bf16 v[164:167], a[128:131], v[44:47], v[164:167]
    s_add_u32 m0, s26, 94208
    s_mov_b32 s46, 147456
    ds_read_b128 v[44:47], v9 offset:64
    v_mfma_f32_16x16x32_bf16 v[164:167], a[140:143], v[48:51], v[164:167]
    buffer_load_dwordx4 v20, s[16:19], s46 offen lds
    ds_read_b128 v[48:51], v9 offset:128
    v_mfma_f32_16x16x32_bf16 v[156:159], a[144:147], v[52:55], v[156:159]
    v_mfma_f32_16x16x32_bf16 v[156:159], a[156:159], v[56:59], v[156:159]
    v_mfma_f32_16x16x32_bf16 v[156:159], a[168:171], v[60:63], v[156:159]
    s_add_u32 m0, s26, 98304
    s_mov_b32 s46, 147456
    v_mfma_f32_16x16x32_bf16 v[160:163], a[148:151], v[52:55], v[160:163]
    buffer_load_dwordx4 v21, s[16:19], s46 offen lds
    v_mfma_f32_16x16x32_bf16 v[160:163], a[160:163], v[56:59], v[160:163]
    v_mfma_f32_16x16x32_bf16 v[160:163], a[172:175], v[60:63], v[160:163]
    v_mfma_f32_16x16x32_bf16 v[164:167], a[152:155], v[52:55], v[164:167]
    s_add_u32 m0, s26, 102400
    s_mov_b32 s46, 159744
    ds_read_b128 v[52:55], v10 offset:0
    v_mfma_f32_16x16x32_bf16 v[164:167], a[164:167], v[56:59], v[164:167]
    buffer_load_dwordx4 v19, s[16:19], s46 offen lds
    ds_read_b128 v[56:59], v10 offset:64
    v_mfma_f32_16x16x32_bf16 v[164:167], a[176:179], v[60:63], v[164:167]
    ds_read_b128 v[60:63], v10 offset:128
    v_mfma_f32_16x16x32_bf16 v[156:159], a[180:183], v[64:67], v[156:159]
    v_mfma_f32_16x16x32_bf16 v[156:159], a[192:195], v[68:71], v[156:159]
    s_lshr_b32 s37, s26, 1
    s_add_u32 m0, s37, 106496
    s_mov_b32 s46, 110592
    v_mfma_f32_16x16x32_bf16 v[156:159], a[204:207], v[72:75], v[156:159]
    s_mov_b32 exec_hi, 0
    buffer_load_dwordx4 v22, s[16:19], s46 offen lds
    s_mov_b64 exec, -1
    v_mfma_f32_16x16x32_bf16 v[160:163], a[184:187], v[64:67], v[160:163]
    v_mfma_f32_16x16x32_bf16 v[160:163], a[196:199], v[68:71], v[160:163]
    v_mfma_f32_16x16x32_bf16 v[160:163], a[208:211], v[72:75], v[160:163]
    v_mfma_f32_16x16x32_bf16 v[164:167], a[188:191], v[64:67], v[164:167]
    ds_read_b128 v[64:67], v11 offset:0
    v_mfma_f32_16x16x32_bf16 v[164:167], a[200:203], v[68:71], v[164:167]
    ds_read_b128 v[68:71], v11 offset:64
    v_mfma_f32_16x16x32_bf16 v[164:167], a[212:215], v[72:75], v[164:167]
    ds_read_b128 v[72:75], v11 offset:128
    s_waitcnt lgkmcnt(6)
    v_mfma_f32_16x16x32_bf16 v[96:99], a[0:3], v[40:43], 0
    s_sub_u32 s32, s32, 393216
    v_mfma_f32_16x16x32_bf16 v[96:99], a[12:15], v[44:47], v[96:99]
    s_sub_u32 s33, s33, 4
    v_mfma_f32_16x16x32_bf16 v[96:99], a[24:27], v[48:51], v[96:99]
    s_cmp_lt_u32 s33, s34
    s_waitcnt lgkmcnt(3)
    v_mfma_f32_16x16x32_bf16 v[96:99], a[36:39], v[52:55], v[96:99]
    s_cselect_b32 s14, 50331648, 0
    v_mfma_f32_16x16x32_bf16 v[96:99], a[48:51], v[56:59], v[96:99]
    s_add_u32 s31, s31, 13312
    v_mfma_f32_16x16x32_bf16 v[96:99], a[60:63], v[60:63], v[96:99]
    s_cmp_eq_u32 s31, 53248
    s_waitcnt lgkmcnt(0)
    v_mfma_f32_16x16x32_bf16 v[96:99], a[72:75], v[64:67], v[96:99]
    s_cselect_b32 s31, 0, s31
    v_mfma_f32_16x16x32_bf16 v[96:99], a[84:87], v[68:71], v[96:99]
    s_add_u32 m0, s31, s26
    v_mfma_f32_16x16x32_bf16 v[96:99], a[96:99], v[72:75], v[96:99]
    buffer_load_dwordx4 v2, s[12:15], s32 offen lds
    v_mfma_f32_16x16x32_bf16 v[100:103], a[4:7], v[40:43], 0
    v_mfma_f32_16x16x32_bf16 v[100:103], a[16:19], v[44:47], v[100:103]
    s_add_u32 m0, s31, s27
    v_mfma_f32_16x16x32_bf16 v[100:103], a[28:31], v[48:51], v[100:103]
    buffer_load_dwordx4 v3, s[12:15], s32 offen lds
    v_mfma_f32_16x16x32_bf16 v[100:103], a[40:43], v[52:55], v[100:103]
    v_mfma_f32_16x16x32_bf16 v[100:103], a[52:55], v[56:59], v[100:103]
    s_add_u32 m0, s31, s28
    v_mfma_f32_16x16x32_bf16 v[100:103], a[64:67], v[60:63], v[100:103]
    buffer_load_dwordx4 v4, s[12:15], s32 offen lds
    v_mfma_f32_16x16x32_bf16 v[100:103], a[76:79], v[64:67], v[100:103]
    v_mfma_f32_16x16x32_bf16 v[100:103], a[88:91], v[68:71], v[100:103]
    s_add_u32 m0, s31, s29
    v_mfma_f32_16x16x32_bf16 v[100:103], a[100:103], v[72:75], v[100:103]
    buffer_load_dwordx4 v5, s[12:15], s32 offen lds
    v_mfma_f32_16x16x32_bf16 v[104:107], a[8:11], v[40:43], 0
    v_mfma_f32_16x16x32_bf16 v[104:107], a[20:23], v[44:47], v[104:107]
    v_mfma_f32_16x16x32_bf16 v[104:107], a[32:35], v[48:51], v[104:107]
    v_mfma_f32_16x16x32_bf16 v[104:107], a[44:47], v[52:55], v[104:107]
    v_mfma_f32_16x16x32_bf16 v[104:107], a[56:59], v[56:59], v[104:107]
    v_mfma_f32_16x16x32_bf16 v[104:107], a[68:71], v[60:63], v[104:107]
    v_mfma_f32_16x16x32_bf16 v[104:107], a[80:83], v[64:67], v[104:107]
    v_mfma_f32_16x16x32_bf16 v[104:107], a[92:95], v[68:71], v[104:107]
    s_waitcnt vmcnt(4)
    s_barrier
    ds_read_b64_tr_b16 a[216:217], v23 offset:0
    ds_read_b64_tr_b16 a[218:219], v23 offset:768
    v_mfma_f32_16x16x32_bf16 v[104:107], a[104:107], v[72:75], v[104:107]
    ds_read_b64_tr_b16 a[228:229], v23 offset:6144
    ds_read_b64_tr_b16 a[230:231], v23 offset:6912
    v_mfma_f32_16x16x32_bf16 v[120:123], a[108:111], v[40:43], v[120:123]
    ds_read_b64_tr_b16 a[240:241], v23 offset:12288
    ds_read_b64_tr_b16 a[242:243], v23 offset:13056
    v_mfma_f32_16x16x32_bf16 v[120:123], a[120:123], v[44:47], v[120:123]
    ds_read_b64_tr_b16 a[252:253], v23 offset:18432
    ds_read_b64_tr_b16 a[254:255], v23 offset:19200
    v_mfma_f32_16x16x32_bf16 v[120:123], a[132:135], v[48:51], v[120:123]
    ds_read_b64_tr_b16 v[176:177], v23 offset:24576
    ds_read_b64_tr_b16 v[178:179], v23 offset:25344
    v_mfma_f32_16x16x32_bf16 v[120:123], a[144:147], v[52:55], v[120:123]
    ds_read_b64_tr_b16 v[188:189], v23 offset:30720
    ds_read_b64_tr_b16 v[190:191], v23 offset:31488
    v_mfma_f32_16x16x32_bf16 v[120:123], a[156:159], v[56:59], v[120:123]
    ds_read_b64_tr_b16 v[200:201], v23 offset:36864
    ds_read_b64_tr_b16 v[202:203], v23 offset:37632
    v_mfma_f32_16x16x32_bf16 v[120:123], a[168:171], v[60:63], v[120:123]
    ds_read_b64_tr_b16 v[212:213], v23 offset:43008
    ds_read_b64_tr_b16 v[214:215], v23 offset:43776
    s_waitcnt lgkmcnt(14)
    v_mfma_f32_16x16x32_bf16 v[120:123], a[180:183], v[64:67], v[120:123]
    ds_read_b64_tr_b16 v[224:225], v23 offset:49152
    ds_read_b64_tr_b16 v[226:227], v23 offset:49920
    v_mfma_f32_16x16x32_bf16 v[120:123], a[192:195], v[68:71], v[120:123]
    ds_read_b64_tr_b16 a[220:221], v24 offset:0
    ds_read_b64_tr_b16 a[222:223], v24 offset:768
    v_mfma_f32_16x16x32_bf16 v[120:123], a[204:207], v[72:75], v[120:123]
    ds_read_b64_tr_b16 a[232:233], v24 offset:6144
    ds_read_b64_tr_b16 a[234:235], v24 offset:6912
    s_waitcnt lgkmcnt(14)
    v_mfma_f32_16x16x32_bf16 v[124:127], a[112:115], v[40:43], v[124:127]
    ds_read_b64_tr_b16 a[244:245], v24 offset:12288
    ds_read_b64_tr_b16 a[246:247], v24 offset:13056
    v_mfma_f32_16x16x32_bf16 v[124:127], a[124:127], v[44:47], v[124:127]
    ds_read_b64_tr_b16 v[168:169], v24 offset:18432
    ds_read_b64_tr_b16 v[170:171], v24 offset:19200
    v_mfma_f32_16x16x32_bf16 v[124:127], a[136:139], v[48:51], v[124:127]
    ds_read_b64_tr_b16 v[180:181], v24 offset:24576
    ds_read_b64_tr_b16 v[182:183], v24 offset:25344
    s_waitcnt lgkmcnt(14)
    v_mfma_f32_16x16x32_bf16 v[124:127], a[148:151], v[52:55], v[124:127]
    ds_read_b64_tr_b16 v[192:193], v24 offset:30720
    ds_read_b64_tr_b16 v[194:195], v24 offset:31488
    v_mfma_f32_16x16x32_bf16 v[124:127], a[160:163], v[56:59], v[124:127]
    ds_read_b64_tr_b16 v[204:205], v24 offset:36864
    ds_read_b64_tr_b16 v[206:207], v24 offset:37632
    v_mfma_f32_16x16x32_bf16 v[124:127], a[172:175], v[60:63], v[124:127]
    ds_read_b64_tr_b16 v[216:217], v24 offset:43008
    ds_read_b64_tr_b16 v[218:219], v24 offset:43776
    s_waitcnt lgkmcnt(14)
    v_mfma_f32_16x16x32_bf16 v[124:127], a[184:187], v[64:67], v[124:127]
    ds_read_b64_tr_b16 v[228:229], v24 offset:49152
    ds_read_b64_tr_b16 v[230:231], v24 offset:49920
    v_mfma_f32_16x16x32_bf16 v[124:127], a[196:199], v[68:71], v[124:127]
    ds_read_b64_tr_b16 a[224:225], v25 offset:0
    ds_read_b64_tr_b16 a[226:227], v25 offset:768
    v_mfma_f32_16x16x32_bf16 v[124:127], a[208:211], v[72:75], v[124:127]
    ds_read_b64_tr_b16 a[236:237], v25 offset:6144
    ds_read_b64_tr_b16 a[238:239], v25 offset:6912
    s_waitcnt lgkmcnt(14)
    v_mfma_f32_16x16x32_bf16 v[128:131], a[116:119], v[40:43], v[128:131]
    ds_read_b64_tr_b16 a[248:249], v25 offset:12288
    ds_read_b64_tr_b16 a[250:251], v25 offset:13056
    v_mfma_f32_16x16x32_bf16 v[128:131], a[128:131], v[44:47], v[128:131]
    ds_read_b64_tr_b16 v[172:173], v25 offset:18432
    ds_read_b64_tr_b16 v[174:175], v25 offset:19200
    v_mfma_f32_16x16x32_bf16 v[128:131], a[140:143], v[48:51], v[128:131]
    ds_read_b64_tr_b16 v[184:185], v25 offset:24576
    ds_read_b64_tr_b16 v[186:187], v25 offset:25344
    s_waitcnt lgkmcnt(14)
    v_mfma_f32_16x16x32_bf16 v[128:131], a[152:155], v[52:55], v[128:131]
    ds_read_b64_tr_b16 v[196:197], v25 offset:30720
    ds_read_b64_tr_b16 v[198:199], v25 offset:31488
    v_mfma_f32_16x16x32_bf16 v[128:131], a[164:167], v[56:59], v[128:131]
    ds_read_b64_tr_b16 v[208:209], v25 offset:36864
    ds_read_b64_tr_b16 v[210:211], v25 offset:37632
    v_mfma_f32_16x16x32_bf16 v[128:131], a[176:179], v[60:63], v[128:131]
    ds_read_b64_tr_b16 v[220:221], v25 offset:43008
    ds_read_b64_tr_b16 v[222:223], v25 offset:43776
    s_waitcnt lgkmcnt(14)
    v_mfma_f32_16x16x32_bf16 v[128:131], a[188:191], v[64:67], v[128:131]
    ds_read_b64_tr_b16 v[232:233], v25 offset:49152
    ds_read_b64_tr_b16 v[234:235], v25 offset:49920
    v_mfma_f32_16x16x32_bf16 v[128:131], a[200:203], v[68:71], v[128:131]
    v_mfma_f32_16x16x32_bf16 v[128:131], a[212:215], v[72:75], v[128:131]
    s_waitcnt lgkmcnt(14)
    v_mfma_f32_16x16x32_bf16 v[144:147], a[216:219], v[40:43], v[144:147]
    v_mfma_f32_16x16x32_bf16 v[144:147], a[228:231], v[44:47], v[144:147]
    v_mfma_f32_16x16x32_bf16 v[144:147], a[240:243], v[48:51], v[144:147]
    v_mfma_f32_16x16x32_bf16 v[144:147], a[252:255], v[52:55], v[144:147]
    v_mfma_f32_16x16x32_bf16 v[144:147], v[176:179], v[56:59], v[144:147]
    v_mfma_f32_16x16x32_bf16 v[144:147], v[188:191], v[60:63], v[144:147]
    v_mfma_f32_16x16x32_bf16 v[144:147], v[200:203], v[64:67], v[144:147]
    v_mfma_f32_16x16x32_bf16 v[144:147], v[212:215], v[68:71], v[144:147]
    v_mfma_f32_16x16x32_bf16 v[144:147], v[224:227], v[72:75], v[144:147]
    v_mfma_f32_16x16x32_bf16 v[148:151], a[220:223], v[40:43], v[148:151]
    v_mfma_f32_16x16x32_bf16 v[148:151], a[232:235], v[44:47], v[148:151]
    v_mfma_f32_16x16x32_bf16 v[148:151], a[244:247], v[48:51], v[148:151]
    v_mfma_f32_16x16x32_bf16 v[148:151], v[168:171], v[52:55], v[148:151]
    v_mfma_f32_16x16x32_bf16 v[148:151], v[180:183], v[56:59], v[148:151]
    v_mfma_f32_16x16x32_bf16 v[148:151], v[192:195], v[60:63], v[148:151]
    v_mfma_f32_16x16x32_bf16 v[148:151], v[204:207], v[64:67], v[148:151]
    v_mfma_f32_16x16x32_bf16 v[148:151], v[216:219], v[68:71], v[148:151]
    v_mfma_f32_16x16x32_bf16 v[148:151], v[228:231], v[72:75], v[148:151]
    s_waitcnt lgkmcnt(12)
    v_mfma_f32_16x16x32_bf16 v[152:155], a[224:227], v[40:43], v[152:155]
    ds_read_b128 v[40:43], v9 offset:3072
    v_mfma_f32_16x16x32_bf16 v[152:155], a[236:239], v[44:47], v[152:155]
    ds_read_b128 v[44:47], v9 offset:3136
    v_mfma_f32_16x16x32_bf16 v[152:155], a[248:251], v[48:51], v[152:155]
    ds_read_b128 v[48:51], v9 offset:3200
    s_waitcnt lgkmcnt(9)
    v_mfma_f32_16x16x32_bf16 v[152:155], v[172:175], v[52:55], v[152:155]
    ds_read_b128 v[52:55], v10 offset:3072
    v_mfma_f32_16x16x32_bf16 v[152:155], v[184:187], v[56:59], v[152:155]
    ds_read_b128 v[56:59], v10 offset:3136
    v_mfma_f32_16x16x32_bf16 v[152:155], v[196:199], v[60:63], v[152:155]
    ds_read_b128 v[60:63], v10 offset:3200
    s_waitcnt lgkmcnt(6)
    v_mfma_f32_16x16x32_bf16 v[152:155], v[208:211], v[64:67], v[152:155]
    ds_read_b128 v[64:67], v11 offset:3072
    v_mfma_f32_16x16x32_bf16 v[152:155], v[220:223], v[68:71], v[152:155]
    ds_read_b128 v[68:71], v11 offset:3136
    v_mfma_f32_16x16x32_bf16 v[152:155], v[232:235], v[72:75], v[152:155]
    ds_read_b128 v[72:75], v11 offset:3200
    s_waitcnt lgkmcnt(6)
    v_mfma_f32_16x16x32_bf16 v[108:111], a[0:3], v[40:43], 0
    s_add_u32 s32, s32, 589824
    v_mfma_f32_16x16x32_bf16 v[108:111], a[12:15], v[44:47], v[108:111]
    s_add_u32 s33, s33, 6
    v_mfma_f32_16x16x32_bf16 v[108:111], a[24:27], v[48:51], v[108:111]
    s_cmp_lt_u32 s33, s34
    s_waitcnt lgkmcnt(3)
    v_mfma_f32_16x16x32_bf16 v[108:111], a[36:39], v[52:55], v[108:111]
    s_cselect_b32 s14, 50331648, 0
    v_mfma_f32_16x16x32_bf16 v[108:111], a[48:51], v[56:59], v[108:111]
    s_add_u32 s31, s31, 13312
    v_mfma_f32_16x16x32_bf16 v[108:111], a[60:63], v[60:63], v[108:111]
    s_cmp_eq_u32 s31, 53248
    s_waitcnt lgkmcnt(0)
    v_mfma_f32_16x16x32_bf16 v[108:111], a[72:75], v[64:67], v[108:111]
    s_cselect_b32 s31, 0, s31
    v_mfma_f32_16x16x32_bf16 v[108:111], a[84:87], v[68:71], v[108:111]
    s_add_u32 m0, s31, s26
    v_mfma_f32_16x16x32_bf16 v[108:111], a[96:99], v[72:75], v[108:111]
    buffer_load_dwordx4 v2, s[12:15], s32 offen lds
    v_mfma_f32_16x16x32_bf16 v[112:115], a[4:7], v[40:43], 0
    v_mfma_f32_16x16x32_bf16 v[112:115], a[16:19], v[44:47], v[112:115]
    s_add_u32 m0, s31, s27
    v_mfma_f32_16x16x32_bf16 v[112:115], a[28:31], v[48:51], v[112:115]
    buffer_load_dwordx4 v3, s[12:15], s32 offen lds
    v_mfma_f32_16x16x32_bf16 v[112:115], a[40:43], v[52:55], v[112:115]
    v_mfma_f32_16x16x32_bf16 v[112:115], a[52:55], v[56:59], v[112:115]
    s_add_u32 m0, s31, s28
    v_mfma_f32_16x16x32_bf16 v[112:115], a[64:67], v[60:63], v[112:115]
    buffer_load_dwordx4 v4, s[12:15], s32 offen lds
    v_mfma_f32_16x16x32_bf16 v[112:115], a[76:79], v[64:67], v[112:115]
    v_mfma_f32_16x16x32_bf16 v[112:115], a[88:91], v[68:71], v[112:115]
    s_add_u32 m0, s31, s29
    v_mfma_f32_16x16x32_bf16 v[112:115], a[100:103], v[72:75], v[112:115]
    buffer_load_dwordx4 v5, s[12:15], s32 offen lds
    v_mfma_f32_16x16x32_bf16 v[116:119], a[8:11], v[40:43], 0
    v_mfma_f32_16x16x32_bf16 v[116:119], a[20:23], v[44:47], v[116:119]
    v_mfma_f32_16x16x32_bf16 v[116:119], a[32:35], v[48:51], v[116:119]
    s_add_u32 s32, s32, 196608
    v_mfma_f32_16x16x32_bf16 v[116:119], a[44:47], v[52:55], v[116:119]
    s_add_u32 s33, s33, 2
    v_mfma_f32_16x16x32_bf16 v[116:119], a[56:59], v[56:59], v[116:119]
    s_cmp_lt_u32 s33, s34
    v_mfma_f32_16x16x32_bf16 v[116:119], a[68:71], v[60:63], v[116:119]
    s_cselect_b32 s14, 50331648, 0
    v_mfma_f32_16x16x32_bf16 v[116:119], a[80:83], v[64:67], v[116:119]
    s_add_u32 s31, s31, 13312
    v_mfma_f32_16x16x32_bf16 v[116:119], a[92:95], v[68:71], v[116:119]
    s_cmp_eq_u32 s31, 53248
    v_mfma_f32_16x16x32_bf16 v[116:119], a[104:107], v[72:75], v[116:119]
    s_cselect_b32 s31, 0, s31
    v_mfma_f32_16x16x32_bf16 v[132:135], a[108:111], v[40:43], v[132:135]
    s_add_u32 m0, s31, s26
    v_mfma_f32_16x16x32_bf16 v[132:135], a[120:123], v[44:47], v[132:135]
    buffer_load_dwordx4 v2, s[12:15], s32 offen lds
    v_mfma_f32_16x16x32_bf16 v[132:135], a[132:135], v[48:51], v[132:135]
    v_mfma_f32_16x16x32_bf16 v[132:135], a[144:147], v[52:55], v[132:135]
    s_add_u32 m0, s31, s27
    v_mfma_f32_16x16x32_bf16 v[132:135], a[156:159], v[56:59], v[132:135]
    buffer_load_dwordx4 v3, s[12:15], s32 offen lds
    v_mfma_f32_16x16x32_bf16 v[132:135], a[168:171], v[60:63], v[132:135]
    v_mfma_f32_16x16x32_bf16 v[132:135], a[180:183], v[64:67], v[132:135]
    s_add_u32 m0, s31, s28
    v_mfma_f32_16x16x32_bf16 v[132:135], a[192:195], v[68:71], v[132:135]
    buffer_load_dwordx4 v4, s[12:15], s32 offen lds
    v_mfma_f32_16x16x32_bf16 v[132:135], a[204:207], v[72:75], v[132:135]
    v_mfma_f32_16x16x32_bf16 v[136:139], a[112:115], v[40:43], v[136:139]
    s_add_u32 m0, s31, s29
    v_mfma_f32_16x16x32_bf16 v[136:139], a[124:127], v[44:47], v[136:139]
    buffer_load_dwordx4 v5, s[12:15], s32 offen lds
    v_mfma_f32_16x16x32_bf16 v[136:139], a[136:139], v[48:51], v[136:139]
    v_mfma_f32_16x16x32_bf16 v[136:139], a[148:151], v[52:55], v[136:139]
    v_mfma_f32_16x16x32_bf16 v[136:139], a[160:163], v[56:59], v[136:139]
    s_add_u32 s30, s30, 13312
    v_mfma_f32_16x16x32_bf16 v[136:139], a[172:175], v[60:63], v[136:139]
    s_cmp_eq_u32 s30, 53248
    v_mfma_f32_16x16x32_bf16 v[136:139], a[184:187], v[64:67], v[136:139]
    s_cselect_b32 s30, 0, s30
    v_mfma_f32_16x16x32_bf16 v[136:139], a[196:199], v[68:71], v[136:139]
    v_add_u32 v9, s30, v6
    v_mfma_f32_16x16x32_bf16 v[136:139], a[208:211], v[72:75], v[136:139]
    v_add_u32 v10, s30, v7
    v_mfma_f32_16x16x32_bf16 v[140:143], a[116:119], v[40:43], v[140:143]
    v_add_u32 v11, s30, v8
    v_mfma_f32_16x16x32_bf16 v[140:143], a[128:131], v[44:47], v[140:143]
    v_mfma_f32_16x16x32_bf16 v[140:143], a[140:143], v[48:51], v[140:143]
    v_mfma_f32_16x16x32_bf16 v[140:143], a[152:155], v[52:55], v[140:143]
    v_mfma_f32_16x16x32_bf16 v[140:143], a[164:167], v[56:59], v[140:143]
    v_mfma_f32_16x16x32_bf16 v[140:143], a[176:179], v[60:63], v[140:143]
    v_mfma_f32_16x16x32_bf16 v[140:143], a[188:191], v[64:67], v[140:143]
    v_mfma_f32_16x16x32_bf16 v[140:143], a[200:203], v[68:71], v[140:143]
    v_mfma_f32_16x16x32_bf16 v[140:143], a[212:215], v[72:75], v[140:143]
    v_mfma_f32_16x16x32_bf16 v[156:159], a[216:219], v[40:43], v[156:159]
    v_mfma_f32_16x16x32_bf16 v[156:159], a[228:231], v[44:47], v[156:159]
    v_mfma_f32_16x16x32_bf16 v[156:159], a[240:243], v[48:51], v[156:159]
    v_mfma_f32_16x16x32_bf16 v[160:163], a[220:223], v[40:43], v[160:163]
    v_mfma_f32_16x16x32_bf16 v[160:163], a[232:235], v[44:47], v[160:163]
    v_mfma_f32_16x16x32_bf16 v[160:163], a[244:247], v[48:51], v[160:163]
    s_waitcnt vmcnt(8)
    s_barrier
    v_mfma_f32_16x16x32_bf16 v[164:167], a[224:227], v[40:43], v[164:167]
    ds_read_b128 v[40:43], v9 offset:0
    v_mfma_f32_16x16x32_bf16 v[164:167], a[236:239], v[44:47], v[164:167]
    ds_read_b128 v[44:47], v9 offset:64
    v_mfma_f32_16x16x32_bf16 v[164:167], a[248:251], v[48:51], v[164:167]
    ds_read_b128 v[48:51], v9 offset:128
    v_mfma_f32_16x16x32_bf16 v[156:159], a[252:255], v[52:55], v[156:159]
    v_mfma_f32_16x16x32_bf16 v[156:159], v[176:179], v[56:59], v[156:159]
    v_mfma_f32_16x16x32_bf16 v[156:159], v[188:191], v[60:63], v[156:159]
    v_mfma_f32_16x16x32_bf16 v[160:163], v[168:171], v[52:55], v[160:163]
    v_mfma_f32_16x16x32_bf16 v[160:163], v[180:183], v[56:59], v[160:163]
    v_mfma_f32_16x16x32_bf16 v[160:163], v[192:195], v[60:63], v[160:163]
    v_mfma_f32_16x16x32_bf16 v[164:167], v[172:175], v[52:55], v[164:167]
    ds_read_b128 v[52:55], v10 offset:0
    v_mfma_f32_16x16x32_bf16 v[164:167], v[184:187], v[56:59], v[164:167]
    ds_read_b128 v[56:59], v10 offset:64
    v_mfma_f32_16x16x32_bf16 v[164:167], v[196:199], v[60:63], v[164:167]
    ds_read_b128 v[60:63], v10 offset:128
    v_mfma_f32_16x16x32_bf16 v[156:159], v[200:203], v[64:67], v[156:159]
    v_mfma_f32_16x16x32_bf16 v[156:159], v[212:215], v[68:71], v[156:159]
    v_mfma_f32_16x16x32_bf16 v[156:159], v[224:227], v[72:75], v[156:159]
    v_mfma_f32_16x16x32_bf16 v[160:163], v[204:207], v[64:67], v[160:163]
    v_mfma_f32_16x16x32_bf16 v[160:163], v[216:219], v[68:71], v[160:163]
    v_mfma_f32_16x16x32_bf16 v[160:163], v[228:231], v[72:75], v[160:163]
    v_mfma_f32_16x16x32_bf16 v[164:167], v[208:211], v[64:67], v[164:167]
    ds_read_b128 v[64:67], v11 offset:0
    v_mfma_f32_16x16x32_bf16 v[164:167], v[220:223], v[68:71], v[164:167]
    ds_read_b128 v[68:71], v11 offset:64
    v_mfma_f32_16x16x32_bf16 v[164:167], v[232:235], v[72:75], v[164:167]
    ds_read_b128 v[72:75], v11 offset:128
    s_waitcnt lgkmcnt(6)
    v_mfma_f32_16x16x32_bf16 v[144:147], a[0:3], v[40:43], v[144:147]
    s_add_u32 s32, s32, 196608
    v_mfma_f32_16x16x32_bf16 v[144:147], a[12:15], v[44:47], v[144:147]
    s_add_u32 s33, s33, 2
    v_mfma_f32_16x16x32_bf16 v[144:147], a[24:27], v[48:51], v[144:147]
    s_cmp_lt_u32 s33, s34
    s_waitcnt lgkmcnt(3)
    v_mfma_f32_16x16x32_bf16 v[144:147], a[36:39], v[52:55], v[144:147]
    s_cselect_b32 s14, 50331648, 0
    v_mfma_f32_16x16x32_bf16 v[144:147], a[48:51], v[56:59], v[144:147]
    s_add_u32 s31, s31, 13312
    v_mfma_f32_16x16x32_bf16 v[144:147], a[60:63], v[60:63], v[144:147]
    s_cmp_eq_u32 s31, 53248
    s_waitcnt lgkmcnt(0)
    v_mfma_f32_16x16x32_bf16 v[144:147], a[72:75], v[64:67], v[144:147]
    s_cselect_b32 s31, 0, s31
    v_mfma_f32_16x16x32_bf16 v[144:147], a[84:87], v[68:71], v[144:147]
    s_add_u32 m0, s31, s26
    v_mfma_f32_16x16x32_bf16 v[144:147], a[96:99], v[72:75], v[144:147]
    buffer_load_dwordx4 v2, s[12:15], s32 offen lds
    v_mfma_f32_16x16x32_bf16 v[148:151], a[4:7], v[40:43], v[148:151]
    s_add_u32 m0, s31, s27
    v_mfma_f32_16x16x32_bf16 v[148:151], a[16:19], v[44:47], v[148:151]
    buffer_load_dwordx4 v3, s[12:15], s32 offen lds
    v_mfma_f32_16x16x32_bf16 v[148:151], a[28:31], v[48:51], v[148:151]
    s_add_u32 m0, s31, s28
    v_mfma_f32_16x16x32_bf16 v[148:151], a[40:43], v[52:55], v[148:151]
    buffer_load_dwordx4 v4, s[12:15], s32 offen lds
    v_mfma_f32_16x16x32_bf16 v[148:151], a[52:55], v[56:59], v[148:151]
    s_add_u32 m0, s31, s29
    v_mfma_f32_16x16x32_bf16 v[148:151], a[64:67], v[60:63], v[148:151]
    buffer_load_dwordx4 v5, s[12:15], s32 offen lds
    v_mfma_f32_16x16x32_bf16 v[148:151], a[76:79], v[64:67], v[148:151]
    v_mfma_f32_16x16x32_bf16 v[148:151], a[88:91], v[68:71], v[148:151]
    v_mfma_f32_16x16x32_bf16 v[148:151], a[100:103], v[72:75], v[148:151]
    v_cvt_pk_bf16_f32 v76, v144, v145
    v_mfma_f32_16x16x32_bf16 v[152:155], a[8:11], v[40:43], v[152:155]
    ds_read_b128 v[40:43], v9 offset:3072
    v_cvt_pk_bf16_f32 v77, v146, v147
    v_mfma_f32_16x16x32_bf16 v[152:155], a[20:23], v[44:47], v[152:155]
    ds_read_b128 v[44:47], v9 offset:3136
    ds_write_b64 v12, v[76:77] offset:0
    v_mfma_f32_16x16x32_bf16 v[152:155], a[32:35], v[48:51], v[152:155]
    ds_read_b128 v[48:51], v9 offset:3200
    v_mfma_f32_16x16x32_bf16 v[152:155], a[44:47], v[52:55], v[152:155]
    ds_read_b128 v[52:55], v10 offset:3072
    v_mfma_f32_16x16x32_bf16 v[152:155], a[56:59], v[56:59], v[152:155]
    ds_read_b128 v[56:59], v10 offset:3136
    v_mfma_f32_16x16x32_bf16 v[152:155], a[68:71], v[60:63], v[152:155]
    ds_read_b128 v[60:63], v10 offset:3200
    v_mfma_f32_16x16x32_bf16 v[152:155], a[80:83], v[64:67], v[152:155]
    ds_read_b128 v[64:67], v11 offset:3072
    v_mfma_f32_16x16x32_bf16 v[152:155], a[92:95], v[68:71], v[152:155]
    ds_read_b128 v[68:71], v11 offset:3136
    v_mfma_f32_16x16x32_bf16 v[152:155], a[104:107], v[72:75], v[152:155]
    ds_read_b128 v[72:75], v11 offset:3200
    v_cvt_pk_bf16_f32 v78, v148, v149
    s_add_u32 s30, s30, 13312
    s_waitcnt lgkmcnt(6)
    v_mfma_f32_16x16x32_bf16 v[156:159], a[0:3], v[40:43], v[156:159]
    v_cvt_pk_bf16_f32 v79, v150, v151
    s_cmp_eq_u32 s30, 53248
    v_mfma_f32_16x16x32_bf16 v[156:159], a[12:15], v[44:47], v[156:159]
    ds_write_b64 v13, v[78:79] offset:0
    s_cselect_b32 s30, 0, s30
    v_mfma_f32_16x16x32_bf16 v[156:159], a[24:27], v[48:51], v[156:159]
    v_add_u32 v9, s30, v6
    v_mfma_f32_16x16x32_bf16 v[160:163], a[4:7], v[40:43], v[160:163]
    v_add_u32 v10, s30, v7
    v_mfma_f32_16x16x32_bf16 v[160:163], a[16:19], v[44:47], v[160:163]
    v_add_u32 v11, s30, v8
    v_mfma_f32_16x16x32_bf16 v[160:163], a[28:31], v[48:51], v[160:163]
    s_waitcnt vmcnt(8) lgkmcnt(0)
    s_barrier
    v_mfma_f32_16x16x32_bf16 v[164:167], a[8:11], v[40:43], v[164:167]
    ds_read_b128 v[40:43], v9 offset:0
    v_mfma_f32_16x16x32_bf16 v[164:167], a[20:23], v[44:47], v[164:167]
    ds_read_b128 v[44:47], v9 offset:64
    v_mfma_f32_16x16x32_bf16 v[164:167], a[32:35], v[48:51], v[164:167]
    v_cvt_pk_bf16_f32 v80, v152, v153
    ds_read_b128 v[48:51], v9 offset:128
    v_mfma_f32_16x16x32_bf16 v[156:159], a[36:39], v[52:55], v[156:159]
    v_cvt_pk_bf16_f32 v81, v154, v155
    v_mfma_f32_16x16x32_bf16 v[156:159], a[48:51], v[56:59], v[156:159]
    ds_write_b64 v14, v[80:81] offset:0
    v_mfma_f32_16x16x32_bf16 v[156:159], a[60:63], v[60:63], v[156:159]
    v_mfma_f32_16x16x32_bf16 v[160:163], a[40:43], v[52:55], v[160:163]
    v_mfma_f32_16x16x32_bf16 v[160:163], a[52:55], v[56:59], v[160:163]
    v_mfma_f32_16x16x32_bf16 v[160:163], a[64:67], v[60:63], v[160:163]
    v_mfma_f32_16x16x32_bf16 v[164:167], a[44:47], v[52:55], v[164:167]
    ds_read_b128 v[52:55], v10 offset:0
    v_mfma_f32_16x16x32_bf16 v[164:167], a[56:59], v[56:59], v[164:167]
    ds_read_b128 v[56:59], v10 offset:64
    v_mfma_f32_16x16x32_bf16 v[164:167], a[68:71], v[60:63], v[164:167]
    ds_read_b128 v[60:63], v10 offset:128
    v_mfma_f32_16x16x32_bf16 v[156:159], a[72:75], v[64:67], v[156:159]
    v_mfma_f32_16x16x32_bf16 v[156:159], a[84:87], v[68:71], v[156:159]
    v_mfma_f32_16x16x32_bf16 v[156:159], a[96:99], v[72:75], v[156:159]
    v_mfma_f32_16x16x32_bf16 v[160:163], a[76:79], v[64:67], v[160:163]
    v_mfma_f32_16x16x32_bf16 v[160:163], a[88:91], v[68:71], v[160:163]
    v_mfma_f32_16x16x32_bf16 v[160:163], a[100:103], v[72:75], v[160:163]
    v_mfma_f32_16x16x32_bf16 v[164:167], a[80:83], v[64:67], v[164:167]
    ds_read_b128 v[64:67], v11 offset:0
    v_mfma_f32_16x16x32_bf16 v[164:167], a[92:95], v[68:71], v[164:167]
    ds_read_b128 v[68:71], v11 offset:64
    v_mfma_f32_16x16x32_bf16 v[164:167], a[104:107], v[72:75], v[164:167]
    ds_read_b128 v[72:75], v11 offset:128
    s_nop 7
    v_cvt_pk_bf16_f32 v76, v156, v157
    v_cvt_pk_bf16_f32 v77, v158, v159
    ds_write_b64 v12, v[76:77] offset:3072
    v_cvt_pk_bf16_f32 v78, v160, v161
    v_cvt_pk_bf16_f32 v79, v162, v163
    ds_write_b64 v13, v[78:79] offset:3072
    v_cvt_pk_bf16_f32 v80, v164, v165
    v_cvt_pk_bf16_f32 v81, v166, v167
    ds_write_b64 v14, v[80:81] offset:3072
    s_waitcnt lgkmcnt(0)
    s_barrier
    s_mov_b32 s36, 13
L_loop:
    s_waitcnt lgkmcnt(6)
    v_mfma_f32_16x16x32_bf16 v[144:147], a[216:219], v[40:43], v[120:123]
    v_xor_b32 v12, 0x4000, v12
    v_mfma_f32_16x16x32_bf16 v[144:147], a[228:231], v[44:47], v[144:147]
    v_xor_b32 v13, 0x4000, v13
    v_mfma_f32_16x16x32_bf16 v[144:147], a[240:243], v[48:51], v[144:147]
    v_xor_b32 v14, 0x4000, v14
    s_waitcnt lgkmcnt(3)
    v_mfma_f32_16x16x32_bf16 v[144:147], a[252:255], v[52:55], v[144:147]
    v_mfma_f32_16x16x32_bf16 v[144:147], v[176:179], v[56:59], v[144:147]
    v_mfma_f32_16x16x32_bf16 v[144:147], v[188:191], v[60:63], v[144:147]
    s_waitcnt lgkmcnt(0)
    v_mfma_f32_16x16x32_bf16 v[144:147], v[200:203], v[64:67], v[144:147]
    ds_read_b128 v[84:87], v15
    v_mfma_f32_16x16x32_bf16 v[144:147], v[212:215], v[68:71], v[144:147]
    ds_read_b128 v[88:91], v16
    v_mfma_f32_16x16x32_bf16 v[144:147], v[224:227], v[72:75], v[144:147]
    ds_read_b128 v[92:95], v17
    v_mfma_f32_16x16x32_bf16 v[148:151], a[220:223], v[40:43], v[124:127]
    v_xor_b32 v15, 0x4000, v15
    v_mfma_f32_16x16x32_bf16 v[148:151], a[232:235], v[44:47], v[148:151]
    v_xor_b32 v16, 0x4000, v16
    v_mfma_f32_16x16x32_bf16 v[148:151], a[244:247], v[48:51], v[148:151]
    v_xor_b32 v17, 0x4000, v17
    v_mfma_f32_16x16x32_bf16 v[148:151], v[168:171], v[52:55], v[148:151]
    s_waitcnt lgkmcnt(2)
    buffer_store_dwordx4 v[84:87], v18, s[20:23], s35 offen offset:0 nt
    v_mfma_f32_16x16x32_bf16 v[148:151], v[180:183], v[56:59], v[148:151]
    v_mfma_f32_16x16x32_bf16 v[148:151], v[192:195], v[60:63], v[148:151]
    s_waitcnt lgkmcnt(1)
    buffer_store_dwordx4 v[88:91], v18, s[20:23], s35 offen offset:1024 nt
    v_mfma_f32_16x16x32_bf16 v[148:151], v[204:207], v[64:67], v[148:151]
    v_mfma_f32_16x16x32_bf16 v[148:151], v[216:219], v[68:71], v[148:151]
    s_waitcnt lgkmcnt(0)
    buffer_store_dwordx4 v[92:95], v18, s[20:23], s35 offen offset:2048 nt
    v_mfma_f32_16x16x32_bf16 v[148:151], v[228:231], v[72:75], v[148:151]
    v_cvt_pk_bf16_f32 v76, v144, v145
    v_mfma_f32_16x16x32_bf16 v[152:155], a[224:227], v[40:43], v[128:131]
    v_cvt_pk_bf16_f32 v77, v146, v147
    v_mfma_f32_16x16x32_bf16 v[152:155], a[236:239], v[44:47], v[152:155]
    ds_write_b64 v12, v[76:77] offset:0
    v_mfma_f32_16x16x32_bf16 v[152:155], a[248:251], v[48:51], v[152:155]
    s_add_u32 s35, s35, 196608
    v_mfma_f32_16x16x32_bf16 v[152:155], v[172:175], v[52:55], v[152:155]
    v_mfma_f32_16x16x32_bf16 v[152:155], v[184:187], v[56:59], v[152:155]
    v_mfma_f32_16x16x32_bf16 v[152:155], v[196:199], v[60:63], v[152:155]
    v_mfma_f32_16x16x32_bf16 v[152:155], v[208:211], v[64:67], v[152:155]
    v_mfma_f32_16x16x32_bf16 v[152:155], v[220:223], v[68:71], v[152:155]
    v_mfma_f32_16x16x32_bf16 v[152:155], v[232:235], v[72:75], v[152:155]
    v_cvt_pk_bf16_f32 v78, v148, v149
    v_mfma_f32_16x16x32_bf16 v[120:123], a[108:111], v[40:43], v[96:99]
    v_cvt_pk_bf16_f32 v79, v150, v151
    v_mfma_f32_16x16x32_bf16 v[120:123], a[120:123], v[44:47], v[120:123]
    ds_write_b64 v13, v[78:79] offset:0
    v_mfma_f32_16x16x32_bf16 v[120:123], a[132:135], v[48:51], v[120:123]
    v_mfma_f32_16x16x32_bf16 v[120:123], a[144:147], v[52:55], v[120:123]
    v_mfma_f32_16x16x32_bf16 v[120:123], a[156:159], v[56:59], v[120:123]
    v_mfma_f32_16x16x32_bf16 v[120:123], a[168:171], v[60:63], v[120:123]
    v_mfma_f32_16x16x32_bf16 v[120:123], a[180:183], v[64:67], v[120:123]
    v_mfma_f32_16x16x32_bf16 v[120:123], a[192:195], v[68:71], v[120:123]
    v_mfma_f32_16x16x32_bf16 v[120:123], a[204:207], v[72:75], v[120:123]
    v_cvt_pk_bf16_f32 v80, v152, v153
    v_mfma_f32_16x16x32_bf16 v[124:127], a[112:115], v[40:43], v[100:103]
    v_cvt_pk_bf16_f32 v81, v154, v155
    v_mfma_f32_16x16x32_bf16 v[124:127], a[124:127], v[44:47], v[124:127]
    ds_write_b64 v14, v[80:81] offset:0
    v_mfma_f32_16x16x32_bf16 v[124:127], a[136:139], v[48:51], v[124:127]
    v_mfma_f32_16x16x32_bf16 v[124:127], a[148:151], v[52:55], v[124:127]
    s_add_u32 s32, s32, 196608
    v_mfma_f32_16x16x32_bf16 v[124:127], a[160:163], v[56:59], v[124:127]
    s_add_u32 s33, s33, 2
    v_mfma_f32_16x16x32_bf16 v[124:127], a[172:175], v[60:63], v[124:127]
    s_cmp_lt_u32 s33, s34
    v_mfma_f32_16x16x32_bf16 v[124:127], a[184:187], v[64:67], v[124:127]
    s_cselect_b32 s14, 50331648, 0
    v_mfma_f32_16x16x32_bf16 v[124:127], a[196:199], v[68:71], v[124:127]
    s_add_u32 s31, s31, 13312
    v_mfma_f32_16x16x32_bf16 v[124:127], a[208:211], v[72:75], v[124:127]
    s_cmp_eq_u32 s31, 53248
    v_mfma_f32_16x16x32_bf16 v[128:131], a[116:119], v[40:43], v[104:107]
    s_cselect_b32 s31, 0, s31
    v_mfma_f32_16x16x32_bf16 v[128:131], a[128:131], v[44:47], v[128:131]
    s_add_u32 m0, s31, s26
    v_mfma_f32_16x16x32_bf16 v[128:131], a[140:143], v[48:51], v[128:131]
    buffer_load_dwordx4 v2, s[12:15], s32 offen lds
    v_mfma_f32_16x16x32_bf16 v[128:131], a[152:155], v[52:55], v[128:131]
    v_mfma_f32_16x16x32_bf16 v[128:131], a[164:167], v[56:59], v[128:131]
    v_mfma_f32_16x16x32_bf16 v[128:131], a[176:179], v[60:63], v[128:131]
    s_add_u32 m0, s31, s27
    v_mfma_f32_16x16x32_bf16 v[128:131], a[188:191], v[64:67], v[128:131]
    buffer_load_dwordx4 v3, s[12:15], s32 offen lds
    v_mfma_f32_16x16x32_bf16 v[128:131], a[200:203], v[68:71], v[128:131]
    v_mfma_f32_16x16x32_bf16 v[128:131], a[212:215], v[72:75], v[128:131]
    v_mfma_f32_16x16x32_bf16 v[96:99], a[0:3], v[40:43], 0
    s_add_u32 m0, s31, s28
    v_mfma_f32_16x16x32_bf16 v[96:99], a[12:15], v[44:47], v[96:99]
    buffer_load_dwordx4 v4, s[12:15], s32 offen lds
    v_mfma_f32_16x16x32_bf16 v[96:99], a[24:27], v[48:51], v[96:99]
    v_mfma_f32_16x16x32_bf16 v[100:103], a[4:7], v[40:43], 0
    v_mfma_f32_16x16x32_bf16 v[100:103], a[16:19], v[44:47], v[100:103]
    s_add_u32 m0, s31, s29
    v_mfma_f32_16x16x32_bf16 v[100:103], a[28:31], v[48:51], v[100:103]
    buffer_load_dwordx4 v5, s[12:15], s32 offen lds
    v_mfma_f32_16x16x32_bf16 v[104:107], a[8:11], v[40:43], 0
    ds_read_b128 v[40:43], v9 offset:3072
    v_mfma_f32_16x16x32_bf16 v[104:107], a[20:23], v[44:47], v[104:107]
    ds_read_b128 v[44:47], v9 offset:3136
    v_mfma_f32_16x16x32_bf16 v[104:107], a[32:35], v[48:51], v[104:107]
    ds_read_b128 v[48:51], v9 offset:3200
    v_mfma_f32_16x16x32_bf16 v[96:99], a[36:39], v[52:55], v[96:99]
    v_mfma_f32_16x16x32_bf16 v[96:99], a[48:51], v[56:59], v[96:99]
    v_mfma_f32_16x16x32_bf16 v[96:99], a[60:63], v[60:63], v[96:99]
    v_mfma_f32_16x16x32_bf16 v[100:103], a[40:43], v[52:55], v[100:103]
    v_mfma_f32_16x16x32_bf16 v[100:103], a[52:55], v[56:59], v[100:103]
    v_mfma_f32_16x16x32_bf16 v[100:103], a[64:67], v[60:63], v[100:103]
    v_mfma_f32_16x16x32_bf16 v[104:107], a[44:47], v[52:55], v[104:107]
    ds_read_b128 v[52:55], v10 offset:3072
    v_mfma_f32_16x16x32_bf16 v[104:107], a[56:59], v[56:59], v[104:107]
    ds_read_b128 v[56:59], v10 offset:3136
    v_mfma_f32_16x16x32_bf16 v[104:107], a[68:71], v[60:63], v[104:107]
    ds_read_b128 v[60:63], v10 offset:3200
    v_mfma_f32_16x16x32_bf16 v[96:99], a[72:75], v[64:67], v[96:99]
    v_mfma_f32_16x16x32_bf16 v[96:99], a[84:87], v[68:71], v[96:99]
    v_mfma_f32_16x16x32_bf16 v[96:99], a[96:99], v[72:75], v[96:99]
    v_mfma_f32_16x16x32_bf16 v[100:103], a[76:79], v[64:67], v[100:103]
    v_mfma_f32_16x16x32_bf16 v[100:103], a[88:91], v[68:71], v[100:103]
    v_mfma_f32_16x16x32_bf16 v[100:103], a[100:103], v[72:75], v[100:103]
    v_mfma_f32_16x16x32_bf16 v[104:107], a[80:83], v[64:67], v[104:107]
    ds_read_b128 v[64:67], v11 offset:3072
    v_mfma_f32_16x16x32_bf16 v[104:107], a[92:95], v[68:71], v[104:107]
    ds_read_b128 v[68:71], v11 offset:3136
    v_mfma_f32_16x16x32_bf16 v[104:107], a[104:107], v[72:75], v[104:107]
    ds_read_b128 v[72:75], v11 offset:3200
    s_waitcnt lgkmcnt(6)
    v_mfma_f32_16x16x32_bf16 v[156:159], a[216:219], v[40:43], v[132:135]
    v_mfma_f32_16x16x32_bf16 v[156:159], a[228:231], v[44:47], v[156:159]
    v_mfma_f32_16x16x32_bf16 v[156:159], a[240:243], v[48:51], v[156:159]
    s_waitcnt lgkmcnt(3)
    v_mfma_f32_16x16x32_bf16 v[156:159], a[252:255], v[52:55], v[156:159]
    v_mfma_f32_16x16x32_bf16 v[156:159], v[176:179], v[56:59], v[156:159]
    v_mfma_f32_16x16x32_bf16 v[156:159], v[188:191], v[60:63], v[156:159]
    s_waitcnt lgkmcnt(0)
    v_mfma_f32_16x16x32_bf16 v[156:159], v[200:203], v[64:67], v[156:159]
    v_mfma_f32_16x16x32_bf16 v[156:159], v[212:215], v[68:71], v[156:159]
    v_mfma_f32_16x16x32_bf16 v[156:159], v[224:227], v[72:75], v[156:159]
    v_mfma_f32_16x16x32_bf16 v[160:163], a[220:223], v[40:43], v[136:139]
    s_add_u32 s30, s30, 13312
    v_mfma_f32_16x16x32_bf16 v[160:163], a[232:235], v[44:47], v[160:163]
    s_cmp_eq_u32 s30, 53248
    v_mfma_f32_16x16x32_bf16 v[160:163], a[244:247], v[48:51], v[160:163]
    s_cselect_b32 s30, 0, s30
    v_mfma_f32_16x16x32_bf16 v[160:163], v[168:171], v[52:55], v[160:163]
    v_add_u32 v9, s30, v6
    v_mfma_f32_16x16x32_bf16 v[160:163], v[180:183], v[56:59], v[160:163]
    v_add_u32 v10, s30, v7
    v_mfma_f32_16x16x32_bf16 v[160:163], v[192:195], v[60:63], v[160:163]
    v_add_u32 v11, s30, v8
    v_mfma_f32_16x16x32_bf16 v[160:163], v[204:207], v[64:67], v[160:163]
    v_mfma_f32_16x16x32_bf16 v[160:163], v[216:219], v[68:71], v[160:163]
    v_mfma_f32_16x16x32_bf16 v[160:163], v[228:231], v[72:75], v[160:163]
    v_cvt_pk_bf16_f32 v76, v156, v157
    v_mfma_f32_16x16x32_bf16 v[164:167], a[224:227], v[40:43], v[140:143]
    v_cvt_pk_bf16_f32 v77, v158, v159
    v_mfma_f32_16x16x32_bf16 v[164:167], a[236:239], v[44:47], v[164:167]
    ds_write_b64 v12, v[76:77] offset:3072
    v_mfma_f32_16x16x32_bf16 v[164:167], a[248:251], v[48:51], v[164:167]
    v_mfma_f32_16x16x32_bf16 v[164:167], v[172:175], v[52:55], v[164:167]
    v_mfma_f32_16x16x32_bf16 v[164:167], v[184:187], v[56:59], v[164:167]
    v_mfma_f32_16x16x32_bf16 v[164:167], v[196:199], v[60:63], v[164:167]
    v_mfma_f32_16x16x32_bf16 v[164:167], v[208:211], v[64:67], v[164:167]
    v_mfma_f32_16x16x32_bf16 v[164:167], v[220:223], v[68:71], v[164:167]
    v_mfma_f32_16x16x32_bf16 v[164:167], v[232:235], v[72:75], v[164:167]
    v_cvt_pk_bf16_f32 v78, v160, v161
    v_mfma_f32_16x16x32_bf16 v[132:135], a[108:111], v[40:43], v[108:111]
    v_cvt_pk_bf16_f32 v79, v162, v163
    v_mfma_f32_16x16x32_bf16 v[132:135], a[120:123], v[44:47], v[132:135]
    ds_write_b64 v13, v[78:79] offset:3072
    v_mfma_f32_16x16x32_bf16 v[132:135], a[132:135], v[48:51], v[132:135]
    v_mfma_f32_16x16x32_bf16 v[132:135], a[144:147], v[52:55], v[132:135]
    v_mfma_f32_16x16x32_bf16 v[132:135], a[156:159], v[56:59], v[132:135]
    v_mfma_f32_16x16x32_bf16 v[132:135], a[168:171], v[60:63], v[132:135]
    v_mfma_f32_16x16x32_bf16 v[132:135], a[180:183], v[64:67], v[132:135]
    v_mfma_f32_16x16x32_bf16 v[132:135], a[192:195], v[68:71], v[132:135]
    v_mfma_f32_16x16x32_bf16 v[132:135], a[204:207], v[72:75], v[132:135]
    v_cvt_pk_bf16_f32 v80, v164, v165
    v_mfma_f32_16x16x32_bf16 v[136:139], a[112:115], v[40:43], v[112:115]
    v_cvt_pk_bf16_f32 v81, v166, v167
    v_mfma_f32_16x16x32_bf16 v[136:139], a[124:127], v[44:47], v[136:139]
    ds_write_b64 v14, v[80:81] offset:3072
    v_mfma_f32_16x16x32_bf16 v[136:139], a[136:139], v[48:51], v[136:139]
    v_mfma_f32_16x16x32_bf16 v[136:139], a[148:151], v[52:55], v[136:139]
    v_mfma_f32_16x16x32_bf16 v[136:139], a[160:163], v[56:59], v[136:139]
    v_mfma_f32_16x16x32_bf16 v[136:139], a[172:175], v[60:63], v[136:139]
    v_mfma_f32_16x16x32_bf16 v[136:139], a[184:187], v[64:67], v[136:139]
    v_mfma_f32_16x16x32_bf16 v[136:139], a[196:199], v[68:71], v[136:139]
    v_mfma_f32_16x16x32_bf16 v[136:139], a[208:211], v[72:75], v[136:139]
    v_mfma_f32_16x16x32_bf16 v[140:143], a[116:119], v[40:43], v[116:119]
    v_mfma_f32_16x16x32_bf16 v[140:143], a[128:131], v[44:47], v[140:143]
    v_mfma_f32_16x16x32_bf16 v[140:143], a[140:143], v[48:51], v[140:143]
    v_mfma_f32_16x16x32_bf16 v[140:143], a[152:155], v[52:55], v[140:143]
    v_mfma_f32_16x16x32_bf16 v[140:143], a[164:167], v[56:59], v[140:143]
    v_mfma_f32_16x16x32_bf16 v[140:143], a[176:179], v[60:63], v[140:143]
    v_mfma_f32_16x16x32_bf16 v[140:143], a[188:191], v[64:67], v[140:143]
    v_mfma_f32_16x16x32_bf16 v[140:143], a[200:203], v[68:71], v[140:143]
    v_mfma_f32_16x16x32_bf16 v[140:143], a[212:215], v[72:75], v[140:143]
    v_mfma_f32_16x16x32_bf16 v[108:111], a[0:3], v[40:43], 0
    v_mfma_f32_16x16x32_bf16 v[108:111], a[12:15], v[44:47], v[108:111]
    v_mfma_f32_16x16x32_bf16 v[108:111], a[24:27], v[48:51], v[108:111]
    v_mfma_f32_16x16x32_bf16 v[112:115], a[4:7], v[40:43], 0
    v_mfma_f32_16x16x32_bf16 v[112:115], a[16:19], v[44:47], v[112:115]
    v_mfma_f32_16x16x32_bf16 v[112:115], a[28:31], v[48:51], v[112:115]
    s_waitcnt vmcnt(11) lgkmcnt(0)
    s_barrier
    v_mfma_f32_16x16x32_bf16 v[116:119], a[8:11], v[40:43], 0
    ds_read_b128 v[40:43], v9 offset:0
    v_mfma_f32_16x16x32_bf16 v[116:119], a[20:23], v[44:47], v[116:119]
    ds_read_b128 v[44:47], v9 offset:64
    v_mfma_f32_16x16x32_bf16 v[116:119], a[32:35], v[48:51], v[116:119]
    ds_read_b128 v[48:51], v9 offset:128
    v_mfma_f32_16x16x32_bf16 v[108:111], a[36:39], v[52:55], v[108:111]
    v_mfma_f32_16x16x32_bf16 v[108:111], a[48:51], v[56:59], v[108:111]
    v_mfma_f32_16x16x32_bf16 v[108:111], a[60:63], v[60:63], v[108:111]
    v_mfma_f32_16x16x32_bf16 v[112:115], a[40:43], v[52:55], v[112:115]
    v_mfma_f32_16x16x32_bf16 v[112:115], a[52:55], v[56:59], v[112:115]
    v_mfma_f32_16x16x32_bf16 v[112:115], a[64:67], v[60:63], v[112:115]
    v_mfma_f32_16x16x32_bf16 v[116:119], a[44:47], v[52:55], v[116:119]
    ds_read_b128 v[52:55], v10 offset:0
    v_mfma_f32_16x16x32_bf16 v[116:119], a[56:59], v[56:59], v[116:119]
    ds_read_b128 v[56:59], v10 offset:64
    v_mfma_f32_16x16x32_bf16 v[116:119], a[68:71], v[60:63], v[116:119]
    ds_read_b128 v[60:63], v10 offset:128
    v_mfma_f32_16x16x32_bf16 v[108:111], a[72:75], v[64:67], v[108:111]
    v_mfma_f32_16x16x32_bf16 v[108:111], a[84:87], v[68:71], v[108:111]
    v_mfma_f32_16x16x32_bf16 v[108:111], a[96:99], v[72:75], v[108:111]
    s_sub_u32 s36, s36, 1
    v_mfma_f32_16x16x32_bf16 v[112:115], a[76:79], v[64:67], v[112:115]
    s_cmp_lg_u32 s36, 0
    v_mfma_f32_16x16x32_bf16 v[112:115], a[88:91], v[68:71], v[112:115]
    v_mfma_f32_16x16x32_bf16 v[112:115], a[100:103], v[72:75], v[112:115]
    v_mfma_f32_16x16x32_bf16 v[116:119], a[80:83], v[64:67], v[116:119]
    ds_read_b128 v[64:67], v11 offset:0
    v_mfma_f32_16x16x32_bf16 v[116:119], a[92:95], v[68:71], v[116:119]
    ds_read_b128 v[68:71], v11 offset:64
    v_mfma_f32_16x16x32_bf16 v[116:119], a[104:107], v[72:75], v[116:119]
    ds_read_b128 v[72:75], v11 offset:128
    s_cbranch_scc1 L_loop
    s_waitcnt lgkmcnt(6)
    v_mfma_f32_16x16x32_bf16 v[144:147], a[216:219], v[40:43], v[120:123]
    v_xor_b32 v12, 0x4000, v12
    v_mfma_f32_16x16x32_bf16 v[144:147], a[228:231], v[44:47], v[144:147]
    v_xor_b32 v13, 0x4000, v13
    v_mfma_f32_16x16x32_bf16 v[144:147], a[240:243], v[48:51], v[144:147]
    v_xor_b32 v14, 0x4000, v14
    s_waitcnt lgkmcnt(3)
    v_mfma_f32_16x16x32_bf16 v[144:147], a[252:255], v[52:55], v[144:147]
    v_mfma_f32_16x16x32_bf16 v[144:147], v[176:179], v[56:59], v[144:147]
    v_mfma_f32_16x16x32_bf16 v[144:147], v[188:191], v[60:63], v[144:147]
    s_waitcnt lgkmcnt(0)
    v_mfma_f32_16x16x32_bf16 v[144:147], v[200:203], v[64:67], v[144:147]
    ds_read_b128 v[84:87], v15
    v_mfma_f32_16x16x32_bf16 v[144:147], v[212:215], v[68:71], v[144:147]
    ds_read_b128 v[88:91], v16
    v_mfma_f32_16x16x32_bf16 v[144:147], v[224:227], v[72:75], v[144:147]
    ds_read_b128 v[92:95], v17
    v_mfma_f32_16x16x32_bf16 v[148:151], a[220:223], v[40:43], v[124:127]
    v_xor_b32 v15, 0x4000, v15
    v_mfma_f32_16x16x32_bf16 v[148:151], a[232:235], v[44:47], v[148:151]
    v_xor_b32 v16, 0x4000, v16
    v_mfma_f32_16x16x32_bf16 v[148:151], a[244:247], v[48:51], v[148:151]
    v_xor_b32 v17, 0x4000, v17
    v_mfma_f32_16x16x32_bf16 v[148:151], v[168:171], v[52:55], v[148:151]
    s_waitcnt lgkmcnt(2)
    buffer_store_dwordx4 v[84:87], v18, s[20:23], s35 offen offset:0 nt
    v_mfma_f32_16x16x32_bf16 v[148:151], v[180:183], v[56:59], v[148:151]
    v_mfma_f32_16x16x32_bf16 v[148:151], v[192:195], v[60:63], v[148:151]
    s_waitcnt lgkmcnt(1)
    buffer_store_dwordx4 v[88:91], v18, s[20:23], s35 offen offset:1024 nt
    v_mfma_f32_16x16x32_bf16 v[148:151], v[204:207], v[64:67], v[148:151]
    v_mfma_f32_16x16x32_bf16 v[148:151], v[216:219], v[68:71], v[148:151]
    s_waitcnt lgkmcnt(0)
    buffer_store_dwordx4 v[92:95], v18, s[20:23], s35 offen offset:2048 nt
    v_mfma_f32_16x16x32_bf16 v[148:151], v[228:231], v[72:75], v[148:151]
    v_cvt_pk_bf16_f32 v76, v144, v145
    v_mfma_f32_16x16x32_bf16 v[152:155], a[224:227], v[40:43], v[128:131]
    v_cvt_pk_bf16_f32 v77, v146, v147
    v_mfma_f32_16x16x32_bf16 v[152:155], a[236:239], v[44:47], v[152:155]
    ds_write_b64 v12, v[76:77] offset:0
    v_mfma_f32_16x16x32_bf16 v[152:155], a[248:251], v[48:51], v[152:155]
    s_add_u32 s35, s35, 196608
    v_mfma_f32_16x16x32_bf16 v[152:155], v[172:175], v[52:55], v[152:155]
    v_mfma_f32_16x16x32_bf16 v[152:155], v[184:187], v[56:59], v[152:155]
    v_mfma_f32_16x16x32_bf16 v[152:155], v[196:199], v[60:63], v[152:155]
    v_mfma_f32_16x16x32_bf16 v[152:155], v[208:211], v[64:67], v[152:155]
    v_mfma_f32_16x16x32_bf16 v[152:155], v[220:223], v[68:71], v[152:155]
    v_mfma_f32_16x16x32_bf16 v[152:155], v[232:235], v[72:75], v[152:155]
    v_cvt_pk_bf16_f32 v78, v148, v149
    v_mfma_f32_16x16x32_bf16 v[120:123], a[108:111], v[40:43], v[96:99]
    v_cvt_pk_bf16_f32 v79, v150, v151
    v_mfma_f32_16x16x32_bf16 v[120:123], a[120:123], v[44:47], v[120:123]
    ds_write_b64 v13, v[78:79] offset:0
    v_mfma_f32_16x16x32_bf16 v[120:123], a[132:135], v[48:51], v[120:123]
    v_mfma_f32_16x16x32_bf16 v[124:127], a[112:115], v[40:43], v[100:103]
    v_mfma_f32_16x16x32_bf16 v[124:127], a[124:127], v[44:47], v[124:127]
    v_mfma_f32_16x16x32_bf16 v[124:127], a[136:139], v[48:51], v[124:127]
    v_mfma_f32_16x16x32_bf16 v[128:131], a[116:119], v[40:43], v[104:107]
    ds_read_b128 v[40:43], v9 offset:3072
    v_mfma_f32_16x16x32_bf16 v[128:131], a[128:131], v[44:47], v[128:131]
    ds_read_b128 v[44:47], v9 offset:3136
    v_mfma_f32_16x16x32_bf16 v[128:131], a[140:143], v[48:51], v[128:131]
    v_cvt_pk_bf16_f32 v80, v152, v153
    ds_read_b128 v[48:51], v9 offset:3200
    v_mfma_f32_16x16x32_bf16 v[120:123], a[144:147], v[52:55], v[120:123]
    v_cvt_pk_bf16_f32 v81, v154, v155
    v_mfma_f32_16x16x32_bf16 v[120:123], a[156:159], v[56:59], v[120:123]
    ds_write_b64 v14, v[80:81] offset:0
    v_mfma_f32_16x16x32_bf16 v[120:123], a[168:171], v[60:63], v[120:123]
    v_mfma_f32_16x16x32_bf16 v[124:127], a[148:151], v[52:55], v[124:127]
    v_mfma_f32_16x16x32_bf16 v[124:127], a[160:163], v[56:59], v[124:127]
    v_mfma_f32_16x16x32_bf16 v[124:127], a[172:175], v[60:63], v[124:127]
    v_mfma_f32_16x16x32_bf16 v[128:131], a[152:155], v[52:55], v[128:131]
    ds_read_b128 v[52:55], v10 offset:3072
    v_mfma_f32_16x16x32_bf16 v[128:131], a[164:167], v[56:59], v[128:131]
    ds_read_b128 v[56:59], v10 offset:3136
    v_mfma_f32_16x16x32_bf16 v[128:131], a[176:179], v[60:63], v[128:131]
    ds_read_b128 v[60:63], v10 offset:3200
    v_mfma_f32_16x16x32_bf16 v[120:123], a[180:183], v[64:67], v[120:123]
    v_mfma_f32_16x16x32_bf16 v[120:123], a[192:195], v[68:71], v[120:123]
    v_mfma_f32_16x16x32_bf16 v[120:123], a[204:207], v[72:75], v[120:123]
    v_mfma_f32_16x16x32_bf16 v[124:127], a[184:187], v[64:67], v[124:127]
    v_mfma_f32_16x16x32_bf16 v[124:127], a[196:199], v[68:71], v[124:127]
    v_mfma_f32_16x16x32_bf16 v[124:127], a[208:211], v[72:75], v[124:127]
    v_mfma_f32_16x16x32_bf16 v[128:131], a[188:191], v[64:67], v[128:131]
    ds_read_b128 v[64:67], v11 offset:3072
    v_mfma_f32_16x16x32_bf16 v[128:131], a[200:203], v[68:71], v[128:131]
    ds_read_b128 v[68:71], v11 offset:3136
    v_mfma_f32_16x16x32_bf16 v[128:131], a[212:215], v[72:75], v[128:131]
    ds_read_b128 v[72:75], v11 offset:3200
    s_waitcnt lgkmcnt(7)
    v_mfma_f32_16x16x32_bf16 v[156:159], a[216:219], v[40:43], v[132:135]
    v_mfma_f32_16x16x32_bf16 v[156:159], a[228:231], v[44:47], v[156:159]
    v_mfma_f32_16x16x32_bf16 v[156:159], a[240:243], v[48:51], v[156:159]
    s_waitcnt lgkmcnt(3)
    v_mfma_f32_16x16x32_bf16 v[156:159], a[252:255], v[52:55], v[156:159]
    v_mfma_f32_16x16x32_bf16 v[156:159], v[176:179], v[56:59], v[156:159]
    v_mfma_f32_16x16x32_bf16 v[156:159], v[188:191], v[60:63], v[156:159]
    s_waitcnt lgkmcnt(0)
    v_mfma_f32_16x16x32_bf16 v[156:159], v[200:203], v[64:67], v[156:159]
    v_mfma_f32_16x16x32_bf16 v[156:159], v[212:215], v[68:71], v[156:159]
    v_mfma_f32_16x16x32_bf16 v[156:159], v[224:227], v[72:75], v[156:159]
    v_mfma_f32_16x16x32_bf16 v[160:163], a[220:223], v[40:43], v[136:139]
    s_add_u32 s30, s30, 13312
    v_mfma_f32_16x16x32_bf16 v[160:163], a[232:235], v[44:47], v[160:163]
    s_cmp_eq_u32 s30, 53248
    v_mfma_f32_16x16x32_bf16 v[160:163], a[244:247], v[48:51], v[160:163]
    s_cselect_b32 s30, 0, s30
    v_mfma_f32_16x16x32_bf16 v[160:163], v[168:171], v[52:55], v[160:163]
    v_add_u32 v9, s30, v6
    v_mfma_f32_16x16x32_bf16 v[160:163], v[180:183], v[56:59], v[160:163]
    v_add_u32 v10, s30, v7
    v_mfma_f32_16x16x32_bf16 v[160:163], v[192:195], v[60:63], v[160:163]
    v_add_u32 v11, s30, v8
    v_mfma_f32_16x16x32_bf16 v[160:163], v[204:207], v[64:67], v[160:163]
    v_mfma_f32_16x16x32_bf16 v[160:163], v[216:219], v[68:71], v[160:163]
    v_mfma_f32_16x16x32_bf16 v[160:163], v[228:231], v[72:75], v[160:163]
    v_cvt_pk_bf16_f32 v76, v156, v157
    v_mfma_f32_16x16x32_bf16 v[164:167], a[224:227], v[40:43], v[140:143]
    v_cvt_pk_bf16_f32 v77, v158, v159
    v_mfma_f32_16x16x32_bf16 v[164:167], a[236:239], v[44:47], v[164:167]
    ds_write_b64 v12, v[76:77] offset:3072
    v_mfma_f32_16x16x32_bf16 v[164:167], a[248:251], v[48:51], v[164:167]
    v_mfma_f32_16x16x32_bf16 v[164:167], v[172:175], v[52:55], v[164:167]
    v_mfma_f32_16x16x32_bf16 v[164:167], v[184:187], v[56:59], v[164:167]
    v_mfma_f32_16x16x32_bf16 v[164:167], v[196:199], v[60:63], v[164:167]
    v_mfma_f32_16x16x32_bf16 v[164:167], v[208:211], v[64:67], v[164:167]
    v_mfma_f32_16x16x32_bf16 v[164:167], v[220:223], v[68:71], v[164:167]
    v_mfma_f32_16x16x32_bf16 v[164:167], v[232:235], v[72:75], v[164:167]
    v_cvt_pk_bf16_f32 v78, v160, v161
    v_mfma_f32_16x16x32_bf16 v[132:135], a[108:111], v[40:43], v[108:111]
    v_cvt_pk_bf16_f32 v79, v162, v163
    v_mfma_f32_16x16x32_bf16 v[132:135], a[120:123], v[44:47], v[132:135]
    ds_write_b64 v13, v[78:79] offset:3072
    v_mfma_f32_16x16x32_bf16 v[132:135], a[132:135], v[48:51], v[132:135]
    v_mfma_f32_16x16x32_bf16 v[136:139], a[112:115], v[40:43], v[112:115]
    v_mfma_f32_16x16x32_bf16 v[136:139], a[124:127], v[44:47], v[136:139]
    v_mfma_f32_16x16x32_bf16 v[136:139], a[136:139], v[48:51], v[136:139]
    s_waitcnt vmcnt(10) lgkmcnt(0)
    s_barrier
    v_mfma_f32_16x16x32_bf16 v[140:143], a[116:119], v[40:43], v[116:119]
    ds_read_b128 v[40:43], v9 offset:0
    v_mfma_f32_16x16x32_bf16 v[140:143], a[128:131], v[44:47], v[140:143]
    ds_read_b128 v[44:47], v9 offset:64
    v_mfma_f32_16x16x32_bf16 v[140:143], a[140:143], v[48:51], v[140:143]
    v_cvt_pk_bf16_f32 v80, v164, v165
    ds_read_b128 v[48:51], v9 offset:128
    v_mfma_f32_16x16x32_bf16 v[132:135], a[144:147], v[52:55], v[132:135]
    v_cvt_pk_bf16_f32 v81, v166, v167
    v_mfma_f32_16x16x32_bf16 v[132:135], a[156:159], v[56:59], v[132:135]
    ds_write_b64 v14, v[80:81] offset:3072
    v_mfma_f32_16x16x32_bf16 v[132:135], a[168:171], v[60:63], v[132:135]
    v_mfma_f32_16x16x32_bf16 v[136:139], a[148:151], v[52:55], v[136:139]
    v_mfma_f32_16x16x32_bf16 v[136:139], a[160:163], v[56:59], v[136:139]
    v_mfma_f32_16x16x32_bf16 v[136:139], a[172:175], v[60:63], v[136:139]
    v_mfma_f32_16x16x32_bf16 v[140:143], a[152:155], v[52:55], v[140:143]
    ds_read_b128 v[52:55], v10 offset:0
    v_mfma_f32_16x16x32_bf16 v[140:143], a[164:167], v[56:59], v[140:143]
    ds_read_b128 v[56:59], v10 offset:64
    v_mfma_f32_16x16x32_bf16 v[140:143], a[176:179], v[60:63], v[140:143]
    ds_read_b128 v[60:63], v10 offset:128
    v_mfma_f32_16x16x32_bf16 v[132:135], a[180:183], v[64:67], v[132:135]
    v_mfma_f32_16x16x32_bf16 v[132:135], a[192:195], v[68:71], v[132:135]
    v_mfma_f32_16x16x32_bf16 v[132:135], a[204:207], v[72:75], v[132:135]
    v_mfma_f32_16x16x32_bf16 v[136:139], a[184:187], v[64:67], v[136:139]
    v_mfma_f32_16x16x32_bf16 v[136:139], a[196:199], v[68:71], v[136:139]
    v_mfma_f32_16x16x32_bf16 v[136:139], a[208:211], v[72:75], v[136:139]
    v_mfma_f32_16x16x32_bf16 v[140:143], a[188:191], v[64:67], v[140:143]
    ds_read_b128 v[64:67], v11 offset:0
    v_mfma_f32_16x16x32_bf16 v[140:143], a[200:203], v[68:71], v[140:143]
    ds_read_b128 v[68:71], v11 offset:64
    v_mfma_f32_16x16x32_bf16 v[140:143], a[212:215], v[72:75], v[140:143]
    ds_read_b128 v[72:75], v11 offset:128
    s_waitcnt lgkmcnt(7)
    v_mfma_f32_16x16x32_bf16 v[144:147], a[216:219], v[40:43], v[120:123]
    v_xor_b32 v12, 0x4000, v12
    v_mfma_f32_16x16x32_bf16 v[144:147], a[228:231], v[44:47], v[144:147]
    v_xor_b32 v13, 0x4000, v13
    v_mfma_f32_16x16x32_bf16 v[144:147], a[240:243], v[48:51], v[144:147]
    v_xor_b32 v14, 0x4000, v14
    s_waitcnt lgkmcnt(3)
    v_mfma_f32_16x16x32_bf16 v[144:147], a[252:255], v[52:55], v[144:147]
    v_mfma_f32_16x16x32_bf16 v[144:147], v[176:179], v[56:59], v[144:147]
    v_mfma_f32_16x16x32_bf16 v[144:147], v[188:191], v[60:63], v[144:147]
    s_waitcnt lgkmcnt(0)
    s_barrier
    v_mfma_f32_16x16x32_bf16 v[144:147], v[200:203], v[64:67], v[144:147]
    ds_read_b128 v[84:87], v15
    v_mfma_f32_16x16x32_bf16 v[144:147], v[212:215], v[68:71], v[144:147]
    ds_read_b128 v[88:91], v16
    v_mfma_f32_16x16x32_bf16 v[144:147], v[224:227], v[72:75], v[144:147]
    ds_read_b128 v[92:95], v17
    v_mfma_f32_16x16x32_bf16 v[148:151], a[220:223], v[40:43], v[124:127]
    v_xor_b32 v15, 0x4000, v15
    v_mfma_f32_16x16x32_bf16 v[148:151], a[232:235], v[44:47], v[148:151]
    v_xor_b32 v16, 0x4000, v16
    v_mfma_f32_16x16x32_bf16 v[148:151], a[244:247], v[48:51], v[148:151]
    v_xor_b32 v17, 0x4000, v17
    v_mfma_f32_16x16x32_bf16 v[148:151], v[168:171], v[52:55], v[148:151]
    s_waitcnt lgkmcnt(2)
    buffer_store_dwordx4 v[84:87], v18, s[20:23], s35 offen offset:0 nt
    v_mfma_f32_16x16x32_bf16 v[148:151], v[180:183], v[56:59], v[148:151]
    v_mfma_f32_16x16x32_bf16 v[148:151], v[192:195], v[60:63], v[148:151]
    s_waitcnt lgkmcnt(1)
    buffer_store_dwordx4 v[88:91], v18, s[20:23], s35 offen offset:1024 nt
    v_mfma_f32_16x16x32_bf16 v[148:151], v[204:207], v[64:67], v[148:151]
    v_mfma_f32_16x16x32_bf16 v[148:151], v[216:219], v[68:71], v[148:151]
    s_waitcnt lgkmcnt(0)
    buffer_store_dwordx4 v[92:95], v18, s[20:23], s35 offen offset:2048 nt
    v_mfma_f32_16x16x32_bf16 v[148:151], v[228:231], v[72:75], v[148:151]
    v_cvt_pk_bf16_f32 v76, v144, v145
    v_mfma_f32_16x16x32_bf16 v[152:155], a[224:227], v[40:43], v[128:131]
    ds_read_b128 v[40:43], v9 offset:3072
    v_cvt_pk_bf16_f32 v77, v146, v147
    v_mfma_f32_16x16x32_bf16 v[152:155], a[236:239], v[44:47], v[152:155]
    ds_read_b128 v[44:47], v9 offset:3136
    ds_write_b64 v12, v[76:77] offset:0
    v_mfma_f32_16x16x32_bf16 v[152:155], a[248:251], v[48:51], v[152:155]
    s_add_u32 s35, s35, 196608
    ds_read_b128 v[48:51], v9 offset:3200
    v_mfma_f32_16x16x32_bf16 v[152:155], v[172:175], v[52:55], v[152:155]
    ds_read_b128 v[52:55], v10 offset:3072
    v_mfma_f32_16x16x32_bf16 v[152:155], v[184:187], v[56:59], v[152:155]
    ds_read_b128 v[56:59], v10 offset:3136
    v_mfma_f32_16x16x32_bf16 v[152:155], v[196:199], v[60:63], v[152:155]
    ds_read_b128 v[60:63], v10 offset:3200
    v_mfma_f32_16x16x32_bf16 v[152:155], v[208:211], v[64:67], v[152:155]
    ds_read_b128 v[64:67], v11 offset:3072
    v_mfma_f32_16x16x32_bf16 v[152:155], v[220:223], v[68:71], v[152:155]
    ds_read_b128 v[68:71], v11 offset:3136
    v_mfma_f32_16x16x32_bf16 v[152:155], v[232:235], v[72:75], v[152:155]
    ds_read_b128 v[72:75], v11 offset:3200
    v_cvt_pk_bf16_f32 v78, v148, v149
    s_waitcnt lgkmcnt(6)
    v_mfma_f32_16x16x32_bf16 v[156:159], a[216:219], v[40:43], v[132:135]
    v_cvt_pk_bf16_f32 v79, v150, v151
    v_mfma_f32_16x16x32_bf16 v[156:159], a[228:231], v[44:47], v[156:159]
    ds_write_b64 v13, v[78:79] offset:0
    v_mfma_f32_16x16x32_bf16 v[156:159], a[240:243], v[48:51], v[156:159]
    s_waitcnt lgkmcnt(4)
    v_mfma_f32_16x16x32_bf16 v[156:159], a[252:255], v[52:55], v[156:159]
    v_mfma_f32_16x16x32_bf16 v[156:159], v[176:179], v[56:59], v[156:159]
    v_mfma_f32_16x16x32_bf16 v[156:159], v[188:191], v[60:63], v[156:159]
    s_waitcnt lgkmcnt(1)
    v_mfma_f32_16x16x32_bf16 v[156:159], v[200:203], v[64:67], v[156:159]
    v_mfma_f32_16x16x32_bf16 v[156:159], v[212:215], v[68:71], v[156:159]
    v_mfma_f32_16x16x32_bf16 v[156:159], v[224:227], v[72:75], v[156:159]
    v_cvt_pk_bf16_f32 v80, v152, v153
    v_mfma_f32_16x16x32_bf16 v[160:163], a[220:223], v[40:43], v[136:139]
    v_cvt_pk_bf16_f32 v81, v154, v155
    v_mfma_f32_16x16x32_bf16 v[160:163], a[232:235], v[44:47], v[160:163]
    ds_write_b64 v14, v[80:81] offset:0
    v_mfma_f32_16x16x32_bf16 v[160:163], a[244:247], v[48:51], v[160:163]
    v_mfma_f32_16x16x32_bf16 v[160:163], v[168:171], v[52:55], v[160:163]
    v_mfma_f32_16x16x32_bf16 v[160:163], v[180:183], v[56:59], v[160:163]
    v_mfma_f32_16x16x32_bf16 v[160:163], v[192:195], v[60:63], v[160:163]
    v_mfma_f32_16x16x32_bf16 v[160:163], v[204:207], v[64:67], v[160:163]
    v_mfma_f32_16x16x32_bf16 v[160:163], v[216:219], v[68:71], v[160:163]
    v_mfma_f32_16x16x32_bf16 v[160:163], v[228:231], v[72:75], v[160:163]
    v_cvt_pk_bf16_f32 v76, v156, v157
    v_mfma_f32_16x16x32_bf16 v[164:167], a[224:227], v[40:43], v[140:143]
    v_cvt_pk_bf16_f32 v77, v158, v159
    v_mfma_f32_16x16x32_bf16 v[164:167], a[236:239], v[44:47], v[164:167]
    ds_write_b64 v12, v[76:77] offset:3072
    v_mfma_f32_16x16x32_bf16 v[164:167], a[248:251], v[48:51], v[164:167]
    v_mfma_f32_16x16x32_bf16 v[164:167], v[172:175], v[52:55], v[164:167]
    v_mfma_f32_16x16x32_bf16 v[164:167], v[184:187], v[56:59], v[164:167]
    v_mfma_f32_16x16x32_bf16 v[164:167], v[196:199], v[60:63], v[164:167]
    v_mfma_f32_16x16x32_bf16 v[164:167], v[208:211], v[64:67], v[164:167]
    v_mfma_f32_16x16x32_bf16 v[164:167], v[220:223], v[68:71], v[164:167]
    v_mfma_f32_16x16x32_bf16 v[164:167], v[232:235], v[72:75], v[164:167]
    v_cvt_pk_bf16_f32 v78, v160, v161
    s_nop 7
    v_cvt_pk_bf16_f32 v79, v162, v163
    ds_write_b64 v13, v[78:79] offset:3072
    v_cvt_pk_bf16_f32 v80, v164, v165
    v_cvt_pk_bf16_f32 v81, v166, v167
    ds_write_b64 v14, v[80:81] offset:3072
    s_waitcnt lgkmcnt(0)
    s_barrier
    ds_read_b128 v[84:87], v15
    ds_read_b128 v[88:91], v16
    ds_read_b128 v[92:95], v17
    s_waitcnt lgkmcnt(2)
    buffer_store_dwordx4 v[84:87], v18, s[20:23], s35 offen offset:0 nt
    s_waitcnt lgkmcnt(1)
    buffer_store_dwordx4 v[88:91], v18, s[20:23], s35 offen offset:1024 nt
    s_waitcnt lgkmcnt(0)
    buffer_store_dwordx4 v[92:95], v18, s[20:23], s35 offen offset:2048 nt
L_end:
    s_endpgm
.section .rodata,"a"
.p2align 6
.amdhsa_kernel standalone__dilated_atrous__vision_kernel
  .amdhsa_next_free_vgpr 512
  .amdhsa_next_free_sgpr 96
  .amdhsa_accum_offset 256
  .amdhsa_group_segment_fixed_size 0
  .amdhsa_kernarg_size 40
  .amdhsa_user_sgpr_count 2
  .amdhsa_user_sgpr_kernarg_segment_ptr 1
  .amdhsa_system_sgpr_workgroup_id_x 1
.end_amdhsa_kernel
```

```asm
; @launch grid=(256,1,1) block=(256,1,1) lds=163840
.amdgcn_target "amdgcn-amd-amdhsa--gfx950"
.text
.globl standalone__dilated_atrous__vision_kernel
.p2align 8
.type standalone__dilated_atrous__vision_kernel,@function
standalone__dilated_atrous__vision_kernel:
    s_cmp_ge_u32 s2, 256
    s_cbranch_scc1 L_end
    s_load_dwordx4 s[4:7], s[0:1], 0
    s_load_dwordx2 s[8:9], s[0:1], 16
    v_lshrrev_b32 v29, 6, v0
    s_and_b32 s37, s2, 7
    v_readfirstlane_b32 s24, v29
    s_lshr_b32 s38, s2, 3
    s_and_b32 s38, s38, 1
    s_lshr_b32 s39, s2, 4
    s_lshl_b32 s39, s39, 5
    s_add_u32 s25, s39, s38
    s_mul_i32 s40, s37, 12288
    s_sub_u32 s41, s40, 384
    v_mul_u32_u24 v31, 43691, v0
    v_lshlrev_b32 v32, 4, v0
    v_lshrrev_b32 v31, 19, v31
    v_and_b32 v33, 4, v31
    v_and_b32 v34, 8, v31
    v_lshlrev_b32 v33, 3, v33
    v_lshlrev_b32 v34, 2, v34
    v_xor_b32 v33, v33, v32
    v_xor_b32 v19, v34, v32
    v_add_u32 v2, s41, v33
    v_add_u32 v30, 256, v0
    v_mul_u32_u24 v31, 43691, v30
    v_lshlrev_b32 v32, 4, v30
    v_lshrrev_b32 v31, 19, v31
    v_and_b32 v33, 4, v31
    v_and_b32 v34, 8, v31
    v_lshlrev_b32 v33, 3, v33
    v_lshlrev_b32 v34, 2, v34
    v_xor_b32 v33, v33, v32
    v_xor_b32 v20, v34, v32
    v_add_u32 v3, s41, v33
    v_add_u32 v30, 512, v0
    v_mul_u32_u24 v31, 43691, v30
    v_lshlrev_b32 v32, 4, v30
    v_lshrrev_b32 v31, 19, v31
    v_and_b32 v33, 4, v31
    v_and_b32 v34, 8, v31
    v_lshlrev_b32 v33, 3, v33
    v_lshlrev_b32 v34, 2, v34
    v_xor_b32 v33, v33, v32
    v_xor_b32 v21, v34, v32
    v_add_u32 v4, s41, v33
    s_cmp_eq_u32 s37, 0
    s_cselect_b32 s42, 24, 0
    v_mov_b32 v35, 0x80000000
    v_cmp_gt_u32 vcc, s42, v0
    v_and_b32 v36, 63, v0
    s_lshl_b32 s26, s24, 10
    v_cndmask_b32 v2, v2, v35, vcc
    s_add_u32 s27, s26, 4096
    s_add_u32 s28, s26, 8192
    s_mov_b32 s29, 12288
    s_cmp_eq_u32 s37, 7
    s_cselect_b32 s45, 24, 48
    s_add_u32 s44, s41, 12288
    v_cmp_gt_u32 vcc, s45, v36
    v_lshlrev_b32 v29, 4, v36
    v_add_u32 v29, s44, v29
    v_cndmask_b32 v5, v35, v29, vcc
    s_lshl_b32 s47, s24, 9
    s_mul_i32 s43, s24, 192
    s_add_u32 s62, s43, 12288
    s_add_u32 s44, s41, s62
    s_lshl_b32 s45, s37, 2
    s_add_u32 s45, s45, s24
    s_cmp_ge_u32 s45, 30
    s_cselect_b32 s44, 0x80000000, s44
    v_lshlrev_b32 v29, 4, v36
    v_add_u32 v1, s44, v29
    s_lshr_b32 s45, s2, 3
    s_lshl_b32 s45, s45, 2
    s_add_u32 s45, s45, s24
    s_mul_i32 s45, s45, 1408
    v_lshl_add_u32 v39, v36, 7, s45
    s_mov_b32 s33, s25
    s_mul_i32 s32, s33, 98304
    s_add_u32 s34, s25, 33
    s_min_u32 s34, s34, 512
    s_mov_b32 s14, 50331648
    s_mov_b32 s15, 0x20000
    s_mov_b32 s18, 165888
    s_mov_b32 s19, 0x20000
    s_mov_b32 s30, 0
    s_mov_b32 s31, 0
    s_waitcnt lgkmcnt(0)
    s_mov_b32 s12, s4
    s_and_b32 s13, s5, 0xffff
    s_mov_b32 s16, s6
    s_and_b32 s17, s7, 0xffff
    s_mov_b64 exec, 0x7ff
    buffer_load_dword v38, v39, s[16:19], 0 offen
    s_mov_b64 exec, -1
    s_add_u32 m0, s31, s26
    s_nop 0
    buffer_load_dwordx4 v2, s[12:15], s32 offen nt lds
    s_add_u32 m0, s31, s27
    s_nop 0
    buffer_load_dwordx4 v3, s[12:15], s32 offen nt lds
    s_add_u32 m0, s31, s28
    s_nop 0
    buffer_load_dwordx4 v4, s[12:15], s32 offen nt lds
    s_add_u32 m0, s31, s62
    s_nop 0
    s_mov_b64 exec, 0xfff
    buffer_load_dwordx4 v1, s[12:15], s32 offen nt lds
    s_mov_b64 exec, -1
    s_mov_b32 s16, s6
    s_and_b32 s17, s7, 0xffff
    s_lshl_b32 s42, s24, 5
    s_add_u32 s42, s42, 3328
    v_add_u32 v30, s42, v36
    v_mul_u32_u24 v31, 43691, v30
    v_lshlrev_b32 v32, 4, v30
    v_lshrrev_b32 v31, 19, v31
    v_and_b32 v34, 8, v31
    v_lshlrev_b32 v34, 2, v34
    v_xor_b32 v22, v34, v32
    s_add_u32 m0, s26, 53248
    s_mov_b32 s46, 0
    buffer_load_dwordx4 v19, s[16:19], s46 offen lds
    s_add_u32 m0, s26, 57344
    s_nop 0
    buffer_load_dwordx4 v20, s[16:19], s46 offen lds
    s_add_u32 m0, s26, 61440
    s_nop 0
    buffer_load_dwordx4 v21, s[16:19], s46 offen lds
    s_add_u32 m0, s26, 65536
    s_mov_b32 s46, 12288
    buffer_load_dwordx4 v19, s[16:19], s46 offen lds
    s_add_u32 m0, s26, 69632
    s_nop 0
    buffer_load_dwordx4 v20, s[16:19], s46 offen lds
    s_add_u32 m0, s26, 73728
    s_nop 0
    buffer_load_dwordx4 v21, s[16:19], s46 offen lds
    s_add_u32 m0, s26, 77824
    s_mov_b32 s46, 24576
    buffer_load_dwordx4 v19, s[16:19], s46 offen lds
    s_add_u32 m0, s26, 81920
    s_nop 0
    buffer_load_dwordx4 v20, s[16:19], s46 offen lds
    s_add_u32 m0, s26, 86016
    s_nop 0
    buffer_load_dwordx4 v21, s[16:19], s46 offen lds
    v_and_b32 v29, 15, v36
    v_lshrrev_b32 v30, 4, v36
    s_lshr_b32 s42, s24, 1
    s_and_b32 s43, s24, 1
    s_lshl_b32 s42, s42, 5
    s_mul_i32 s43, s43, 96
    v_lshlrev_b32 v31, 4, v30
    v_add_u32 v32, s42, v29
    v_and_b32 v33, 4, v32
    v_mul_u32_u24 v34, 192, v32
    v_lshlrev_b32 v33, 3, v33
    v_xor_b32 v33, v33, v31
    v_add_u32 v6, v34, v33
    v_mov_b32 v9, v6
    v_add_u32 v32, s42, v29
    v_add_u32 v32, 2, v32
    v_and_b32 v33, 4, v32
    v_mul_u32_u24 v34, 192, v32
    v_lshlrev_b32 v33, 3, v33
    v_xor_b32 v33, v33, v31
    v_add_u32 v7, v34, v33
    v_mov_b32 v10, v7
    v_add_u32 v32, s42, v29
    v_add_u32 v32, 4, v32
    v_and_b32 v33, 4, v32
    v_mul_u32_u24 v34, 192, v32
    v_lshlrev_b32 v33, 3, v33
    v_xor_b32 v33, v33, v31
    v_add_u32 v8, v34, v33
    v_mov_b32 v11, v8
    v_lshrrev_b32 v32, 2, v29
    v_lshl_add_u32 v32, v30, 3, v32
    v_mul_u32_u24 v32, 192, v32
    v_and_b32 v33, 3, v29
    v_lshlrev_b32 v33, 3, v33
    v_and_b32 v34, 1, v30
    v_lshlrev_b32 v34, 5, v34
    v_add_u32 v33, s43, v33
    v_add_u32 v35, 0, v33
    v_xor_b32 v35, v35, v34
    v_add_u32 v35, v35, v32
    v_add_u32 v23, 53248, v35
    v_add_u32 v26, 108544, v35
    v_add_u32 v35, 32, v33
    v_xor_b32 v35, v35, v34
    v_add_u32 v35, v35, v32
    v_add_u32 v24, 53248, v35
    v_add_u32 v27, 108544, v35
    v_add_u32 v35, 64, v33
    v_xor_b32 v35, v35, v34
    v_add_u32 v35, v35, v32
    v_add_u32 v25, 53248, v35
    v_add_u32 v28, 108544, v35
    v_add_u32 v32, s42, v29
    v_mul_u32_u24 v32, 192, v32
    v_add_u32 v32, 65536, v32
    v_lshlrev_b32 v33, 3, v29
    v_and_b32 v33, 0x30, v33
    v_lshlrev_b32 v34, 3, v30
    v_add_u32 v34, s43, v34
    v_add_u32 v35, 0, v34
    v_xor_b32 v35, v35, v33
    v_add_u32 v12, v35, v32
    v_add_u32 v35, 32, v34
    v_xor_b32 v35, v35, v33
    v_add_u32 v13, v35, v32
    v_add_u32 v35, 64, v34
    v_xor_b32 v35, v35, v33
    v_add_u32 v14, v35, v32
    s_mul_i32 s44, s24, 192
    v_add_u32 v32, s44, v36
    v_mul_u32_u24 v33, 43691, v32
    v_lshlrev_b32 v34, 4, v32
    v_lshrrev_b32 v33, 16, v33
    v_and_b32 v33, 0x30, v33
    v_xor_b32 v34, v34, v33
    v_add_u32 v15, 65536, v34
    v_add_u32 v32, s44, v36
    v_add_u32 v32, 64, v32
    v_mul_u32_u24 v33, 43691, v32
    v_lshlrev_b32 v34, 4, v32
    v_lshrrev_b32 v33, 16, v33
    v_and_b32 v33, 0x30, v33
    v_xor_b32 v34, v34, v33
    v_add_u32 v16, 65536, v34
    v_add_u32 v32, s44, v36
    v_add_u32 v32, 128, v32
    v_mul_u32_u24 v33, 43691, v32
    v_lshlrev_b32 v34, 4, v32
    v_lshrrev_b32 v33, 16, v33
    v_and_b32 v33, 0x30, v33
    v_xor_b32 v34, v34, v33
    v_add_u32 v17, 65536, v34
    s_lshl_b32 s45, s24, 8
    v_lshlrev_b32 v32, 2, v36
    v_add_u32 v32, s45, v32
    v_add_u32 v242, 108608, v32
    s_lshl_b32 s45, s24, 2
    s_add_u32 s45, s45, 108544
    v_cmp_eq_u32 vcc, 0, v36
    v_mov_b32 v32, s45
    v_mov_b32 v244, 108544
    v_cndmask_b32 v242, v242, v32, vcc
    v_mov_b32 v243, 2
    s_mov_b32 s63, 2
    s_mul_i32 s45, s24, 3072
    s_add_u32 s45, s45, s40
    v_lshlrev_b32 v32, 4, v36
    v_add_u32 v18, s45, v32
    s_mov_b32 s20, s8
    s_and_b32 s21, s9, 0xffff
    s_mov_b32 s22, 50331648
    s_mov_b32 s23, 0x20000
    s_mul_i32 s35, s25, 98304
    s_waitcnt vmcnt(4)
    s_barrier
    ds_read_b128 v[40:43], v9 offset:0
    ds_read_b64_tr_b16 a[0:1], v23 offset:0
    ds_read_b64_tr_b16 a[2:3], v23 offset:768
    ds_read_b128 v[44:47], v9 offset:64
    ds_read_b64_tr_b16 a[12:13], v23 offset:6144
    ds_read_b64_tr_b16 a[14:15], v23 offset:6912
    ds_read_b128 v[48:51], v9 offset:128
    ds_read_b64_tr_b16 a[24:25], v23 offset:12288
    ds_read_b64_tr_b16 a[26:27], v23 offset:13056
    ds_read_b64_tr_b16 a[4:5], v24 offset:0
    ds_read_b64_tr_b16 a[6:7], v24 offset:768
    ds_read_b64_tr_b16 a[16:17], v24 offset:6144
    ds_read_b64_tr_b16 a[18:19], v24 offset:6912
    ds_read_b64_tr_b16 a[28:29], v24 offset:12288
    ds_read_b64_tr_b16 a[30:31], v24 offset:13056
    ds_read_b64_tr_b16 a[8:9], v25 offset:0
    ds_read_b64_tr_b16 a[10:11], v25 offset:768
    ds_read_b64_tr_b16 a[20:21], v25 offset:6144
    ds_read_b64_tr_b16 a[22:23], v25 offset:6912
    ds_read_b64_tr_b16 a[32:33], v25 offset:12288
    ds_read_b64_tr_b16 a[34:35], v25 offset:13056
    ds_read_b128 v[52:55], v9 offset:3072
    ds_read_b128 v[56:59], v9 offset:3136
    ds_read_b128 v[60:63], v9 offset:3200
    s_add_u32 m0, s26, 90112
    s_mov_b32 s46, 36864
    s_waitcnt lgkmcnt(14)
    v_mfma_f32_16x16x32_bf16 v[120:123], a[0:3], v[40:43], 0
    ds_read_b128 v[64:67], v10 offset:0
    buffer_load_dwordx4 v19, s[16:19], s46 offen lds
    s_add_u32 m0, s26, 94208
    v_mfma_f32_16x16x32_bf16 v[120:123], a[12:15], v[44:47], v[120:123]
    ds_read_b128 v[68:71], v10 offset:64
    buffer_load_dwordx4 v20, s[16:19], s46 offen lds
    s_add_u32 m0, s26, 98304
    v_mfma_f32_16x16x32_bf16 v[120:123], a[24:27], v[48:51], v[120:123]
    ds_read_b128 v[72:75], v10 offset:128
    buffer_load_dwordx4 v21, s[16:19], s46 offen lds
    s_waitcnt lgkmcnt(12)
    v_mfma_f32_16x16x32_bf16 v[124:127], a[4:7], v[40:43], 0
    s_add_u32 m0, s26, 102400
    s_mov_b32 s46, 49152
    buffer_load_dwordx4 v19, s[16:19], s46 offen lds
    v_mfma_f32_16x16x32_bf16 v[124:127], a[16:19], v[44:47], v[124:127]
    s_add_u32 m0, s47, 106496
    s_mov_b32 s46, 0
    v_mfma_f32_16x16x32_bf16 v[124:127], a[28:31], v[48:51], v[124:127]
    s_mov_b32 exec_hi, 0
    buffer_load_dwordx4 v22, s[16:19], s46 offen lds
    s_mov_b64 exec, -1
    s_waitcnt lgkmcnt(6)
    v_mfma_f32_16x16x32_bf16 v[128:131], a[8:11], v[40:43], 0
    s_add_u32 m0, s26, 108544
    s_mov_b32 s46, 55296
    v_mfma_f32_16x16x32_bf16 v[128:131], a[20:23], v[44:47], v[128:131]
    s_waitcnt vmcnt(5)
    s_barrier
    ds_read_b64_tr_b16 a[36:37], v23 offset:18432
    v_mfma_f32_16x16x32_bf16 v[128:131], a[32:35], v[48:51], v[128:131]
    ds_read_b64_tr_b16 a[38:39], v23 offset:19200
    buffer_load_dwordx4 v19, s[16:19], s46 offen lds
    s_waitcnt lgkmcnt(5)
    v_mfma_f32_16x16x32_bf16 v[132:135], a[0:3], v[52:55], 0
    ds_read_b64_tr_b16 a[48:49], v23 offset:24576
    ds_read_b64_tr_b16 a[50:51], v23 offset:25344
    ds_read_b64_tr_b16 a[60:61], v23 offset:30720
    v_mfma_f32_16x16x32_bf16 v[132:135], a[12:15], v[56:59], v[132:135]
    ds_read_b64_tr_b16 a[62:63], v23 offset:31488
    s_add_u32 m0, s26, 112640
    ds_read_b64_tr_b16 a[40:41], v24 offset:18432
    v_mfma_f32_16x16x32_bf16 v[132:135], a[24:27], v[60:63], v[132:135]
    ds_read_b64_tr_b16 a[42:43], v24 offset:19200
    ds_read_b128 v[40:43], v10 offset:3072
    buffer_load_dwordx4 v20, s[16:19], s46 offen lds
    v_mfma_f32_16x16x32_bf16 v[136:139], a[4:7], v[52:55], 0
    ds_read_b64_tr_b16 a[52:53], v24 offset:24576
    ds_read_b64_tr_b16 a[54:55], v24 offset:25344
    ds_read_b128 v[44:47], v10 offset:3136
    v_mfma_f32_16x16x32_bf16 v[136:139], a[16:19], v[56:59], v[136:139]
    ds_read_b64_tr_b16 a[64:65], v24 offset:30720
    ds_read_b64_tr_b16 a[66:67], v24 offset:31488
    ds_read_b128 v[48:51], v10 offset:3200
    v_mfma_f32_16x16x32_bf16 v[136:139], a[28:31], v[60:63], v[136:139]
    s_add_u32 m0, s26, 116736
    ds_read_b64_tr_b16 a[44:45], v25 offset:18432
    ds_read_b64_tr_b16 a[46:47], v25 offset:19200
    v_mfma_f32_16x16x32_bf16 v[140:143], a[8:11], v[52:55], 0
    buffer_load_dwordx4 v21, s[16:19], s46 offen lds
    ds_read_b64_tr_b16 a[56:57], v25 offset:24576
    ds_read_b64_tr_b16 a[58:59], v25 offset:25344
    v_mfma_f32_16x16x32_bf16 v[140:143], a[20:23], v[56:59], v[140:143]
    ds_read_b64_tr_b16 a[68:69], v25 offset:30720
    ds_read_b64_tr_b16 a[70:71], v25 offset:31488
    s_add_u32 m0, s26, 120832
    v_mfma_f32_16x16x32_bf16 v[140:143], a[32:35], v[60:63], v[140:143]
    s_mov_b32 s46, 67584
    buffer_load_dwordx4 v19, s[16:19], s46 offen lds
    s_waitcnt lgkmcnt(14)
    v_mfma_f32_16x16x32_bf16 v[120:123], a[36:39], v[64:67], v[120:123]
    s_add_u32 m0, s26, 124928
    v_mfma_f32_16x16x32_bf16 v[120:123], a[48:51], v[68:71], v[120:123]
    buffer_load_dwordx4 v20, s[16:19], s46 offen lds
    ds_read_b128 v[52:55], v11 offset:0
    ds_read_b128 v[56:59], v11 offset:64
    v_mfma_f32_16x16x32_bf16 v[120:123], a[60:63], v[72:75], v[120:123]
    s_add_u32 m0, s26, 129024
    ds_read_b128 v[60:63], v11 offset:128
    s_waitcnt lgkmcnt(10)
    v_mfma_f32_16x16x32_bf16 v[124:127], a[40:43], v[64:67], v[124:127]
    buffer_load_dwordx4 v21, s[16:19], s46 offen lds
    v_mfma_f32_16x16x32_bf16 v[124:127], a[52:55], v[68:71], v[124:127]
    s_add_u32 m0, s26, 133120
    s_mov_b32 s46, 79872
    v_mfma_f32_16x16x32_bf16 v[124:127], a[64:67], v[72:75], v[124:127]
    s_waitcnt vmcnt(6)
    s_barrier
    s_waitcnt lgkmcnt(3)
    v_mfma_f32_16x16x32_bf16 v[128:131], a[44:47], v[64:67], v[128:131]
    ds_read_b64_tr_b16 a[72:73], v23 offset:36864
    ds_read_b64_tr_b16 a[74:75], v23 offset:37632
    buffer_load_dwordx4 v19, s[16:19], s46 offen lds
    v_mfma_f32_16x16x32_bf16 v[128:131], a[56:59], v[68:71], v[128:131]
    ds_read_b64_tr_b16 a[84:85], v23 offset:43008
    ds_read_b64_tr_b16 a[86:87], v23 offset:43776
    ds_read_b64_tr_b16 a[96:97], v23 offset:49152
    v_mfma_f32_16x16x32_bf16 v[128:131], a[68:71], v[72:75], v[128:131]
    ds_read_b64_tr_b16 a[98:99], v23 offset:49920
    s_add_u32 m0, s26, 137216
    v_mfma_f32_16x16x32_bf16 v[132:135], a[36:39], v[40:43], v[132:135]
    ds_read_b64_tr_b16 a[76:77], v24 offset:36864
    ds_read_b64_tr_b16 a[78:79], v24 offset:37632
    ds_read_b128 v[64:67], v11 offset:3072
    v_mfma_f32_16x16x32_bf16 v[132:135], a[48:51], v[44:47], v[132:135]
    buffer_load_dwordx4 v20, s[16:19], s46 offen lds
    ds_read_b64_tr_b16 a[88:89], v24 offset:43008
    ds_read_b64_tr_b16 a[90:91], v24 offset:43776
    v_mfma_f32_16x16x32_bf16 v[132:135], a[60:63], v[48:51], v[132:135]
    ds_read_b128 v[68:71], v11 offset:3136
    ds_read_b64_tr_b16 a[100:101], v24 offset:49152
    ds_read_b64_tr_b16 a[102:103], v24 offset:49920
    v_mfma_f32_16x16x32_bf16 v[136:139], a[40:43], v[40:43], v[136:139]
    ds_read_b128 v[72:75], v11 offset:3200
    s_add_u32 m0, s26, 141312
    ds_read_b64_tr_b16 a[80:81], v25 offset:36864
    v_mfma_f32_16x16x32_bf16 v[136:139], a[52:55], v[44:47], v[136:139]
    ds_read_b64_tr_b16 a[82:83], v25 offset:37632
    buffer_load_dwordx4 v21, s[16:19], s46 offen lds
    ds_read_b64_tr_b16 a[92:93], v25 offset:43008
    v_mfma_f32_16x16x32_bf16 v[136:139], a[64:67], v[48:51], v[136:139]
    ds_read_b64_tr_b16 a[94:95], v25 offset:43776
    ds_read_b64_tr_b16 a[104:105], v25 offset:49152
    ds_read_b64_tr_b16 a[106:107], v25 offset:49920
    v_mfma_f32_16x16x32_bf16 v[140:143], a[44:47], v[40:43], v[140:143]
    s_add_u32 m0, s26, 145408
    s_mov_b32 s46, 92160
    buffer_load_dwordx4 v19, s[16:19], s46 offen lds
    v_mfma_f32_16x16x32_bf16 v[140:143], a[56:59], v[44:47], v[140:143]
    s_add_u32 m0, s26, 149504
    v_mfma_f32_16x16x32_bf16 v[140:143], a[68:71], v[48:51], v[140:143]
    buffer_load_dwordx4 v20, s[16:19], s46 offen lds
    s_waitcnt lgkmcnt(14)
    v_mfma_f32_16x16x32_bf16 v[120:123], a[72:75], v[52:55], v[120:123]
    ds_read_b128 v[40:43], v9 offset:0
    v_mfma_f32_16x16x32_bf16 v[120:123], a[84:87], v[56:59], v[120:123]
    ds_read_b128 v[44:47], v9 offset:64
    s_add_u32 m0, s26, 153600
    v_mfma_f32_16x16x32_bf16 v[120:123], a[96:99], v[60:63], v[120:123]
    ds_read_b128 v[48:51], v9 offset:128
    buffer_load_dwordx4 v21, s[16:19], s46 offen lds
    s_waitcnt lgkmcnt(10)
    v_mfma_f32_16x16x32_bf16 v[124:127], a[76:79], v[52:55], v[124:127]
    v_mfma_f32_16x16x32_bf16 v[124:127], a[88:91], v[56:59], v[124:127]
    s_add_u32 m0, s26, 157696
    s_mov_b32 s46, 104448
    v_mfma_f32_16x16x32_bf16 v[124:127], a[100:103], v[60:63], v[124:127]
    s_waitcnt vmcnt(7)
    s_barrier
    s_waitcnt lgkmcnt(3)
    v_mfma_f32_16x16x32_bf16 v[128:131], a[80:83], v[52:55], v[128:131]
    ds_read_b64_tr_b16 a[108:109], v26 offset:0
    ds_read_b64_tr_b16 a[110:111], v26 offset:768
    buffer_load_dwordx4 v19, s[16:19], s46 offen lds
    v_mfma_f32_16x16x32_bf16 v[128:131], a[92:95], v[56:59], v[128:131]
    ds_read_b64_tr_b16 a[120:121], v26 offset:6144
    ds_read_b64_tr_b16 a[122:123], v26 offset:6912
    ds_read_b64_tr_b16 a[132:133], v26 offset:12288
    v_mfma_f32_16x16x32_bf16 v[128:131], a[104:107], v[60:63], v[128:131]
    ds_read_b64_tr_b16 a[134:135], v26 offset:13056
    s_add_u32 m0, s47, 161792
    v_mfma_f32_16x16x32_bf16 v[132:135], a[72:75], v[64:67], v[132:135]
    s_mov_b32 s46, 55296
    ds_read_b64_tr_b16 a[112:113], v27 offset:0
    ds_read_b64_tr_b16 a[114:115], v27 offset:768
    v_mfma_f32_16x16x32_bf16 v[132:135], a[84:87], v[68:71], v[132:135]
    ds_read_b128 v[52:55], v9 offset:3072
    v_mfma_f32_16x16x32_bf16 v[132:135], a[96:99], v[72:75], v[132:135]
    s_mov_b32 exec_hi, 0
    buffer_load_dwordx4 v22, s[16:19], s46 offen lds
    s_mov_b64 exec, -1
    v_mfma_f32_16x16x32_bf16 v[136:139], a[76:79], v[64:67], v[136:139]
    ds_read_b64_tr_b16 a[124:125], v27 offset:6144
    ds_read_b64_tr_b16 a[126:127], v27 offset:6912
    ds_read_b128 v[56:59], v9 offset:3136
    v_mfma_f32_16x16x32_bf16 v[136:139], a[88:91], v[68:71], v[136:139]
    ds_read_b64_tr_b16 a[136:137], v27 offset:12288
    ds_read_b64_tr_b16 a[138:139], v27 offset:13056
    ds_read_b128 v[60:63], v9 offset:3200
    v_mfma_f32_16x16x32_bf16 v[136:139], a[100:103], v[72:75], v[136:139]
    s_add_u32 s32, s32, 196608
    s_add_u32 s33, s33, 2
    v_mfma_f32_16x16x32_bf16 v[140:143], a[80:83], v[64:67], v[140:143]
    s_cmp_lt_u32 s33, s34
    s_cselect_b32 s14, 50331648, 0
    s_add_u32 s31, s31, 13312
    v_mfma_f32_16x16x32_bf16 v[140:143], a[92:95], v[68:71], v[140:143]
    s_cmp_eq_u32 s31, 53248
    s_cselect_b32 s31, 0, s31
    ds_read_b64_tr_b16 a[116:117], v28 offset:0
    v_mfma_f32_16x16x32_bf16 v[140:143], a[104:107], v[72:75], v[140:143]
    ds_read_b64_tr_b16 a[118:119], v28 offset:768
    s_add_u32 m0, s31, s26
    s_waitcnt lgkmcnt(11)
    v_mfma_f32_16x16x32_bf16 v[144:147], a[108:111], v[40:43], 0
    ds_read_b64_tr_b16 a[128:129], v28 offset:6144
    ds_read_b64_tr_b16 a[130:131], v28 offset:6912
    buffer_load_dwordx4 v2, s[12:15], s32 offen nt lds
    ds_read_b64_tr_b16 a[140:141], v28 offset:12288
    ds_read_b64_tr_b16 a[142:143], v28 offset:13056
    v_mfma_f32_16x16x32_bf16 v[144:147], a[120:123], v[44:47], v[144:147]
    s_add_u32 m0, s31, s27
    v_mfma_f32_16x16x32_bf16 v[144:147], a[132:135], v[48:51], v[144:147]
    buffer_load_dwordx4 v3, s[12:15], s32 offen nt lds
    s_add_u32 m0, s31, s28
    s_waitcnt lgkmcnt(7)
    v_mfma_f32_16x16x32_bf16 v[148:151], a[112:115], v[40:43], 0
    ds_read_b128 v[64:67], v10 offset:0
    buffer_load_dwordx4 v4, s[12:15], s32 offen nt lds
    ds_read_b128 v[68:71], v10 offset:64
    v_mfma_f32_16x16x32_bf16 v[148:151], a[124:127], v[44:47], v[148:151]
    ds_read_b128 v[72:75], v10 offset:128
    s_add_u32 m0, s31, s29
    v_mfma_f32_16x16x32_bf16 v[148:151], a[136:139], v[48:51], v[148:151]
    buffer_load_dwordx4 v5, s[12:15], s32 offen nt lds
    s_waitcnt lgkmcnt(3)
    v_mfma_f32_16x16x32_bf16 v[152:155], a[116:119], v[40:43], 0
    s_waitcnt vmcnt(9)
    s_barrier
    ds_read_b64_tr_b16 a[144:145], v26 offset:18432
    v_mfma_f32_16x16x32_bf16 v[152:155], a[128:131], v[44:47], v[152:155]
    ds_read_b64_tr_b16 a[146:147], v26 offset:19200
    s_add_u32 m0, s26, 53248
    s_mov_b32 s46, 110592
    v_mfma_f32_16x16x32_bf16 v[152:155], a[140:143], v[48:51], v[152:155]
    ds_read_b64_tr_b16 a[156:157], v26 offset:24576
    ds_read_b64_tr_b16 a[158:159], v26 offset:25344
    v_mfma_f32_16x16x32_bf16 v[156:159], a[108:111], v[52:55], 0
    buffer_load_dwordx4 v19, s[16:19], s46 offen lds
    ds_read_b64_tr_b16 a[168:169], v26 offset:30720
    ds_read_b64_tr_b16 a[170:171], v26 offset:31488
    v_mfma_f32_16x16x32_bf16 v[156:159], a[120:123], v[56:59], v[156:159]
    ds_read_b64_tr_b16 a[148:149], v27 offset:18432
    ds_read_b64_tr_b16 a[150:151], v27 offset:19200
    ds_read_b128 v[40:43], v10 offset:3072
    v_mfma_f32_16x16x32_bf16 v[156:159], a[132:135], v[60:63], v[156:159]
    s_add_u32 m0, s26, 57344
    ds_read_b64_tr_b16 a[160:161], v27 offset:24576
    ds_read_b64_tr_b16 a[162:163], v27 offset:25344
    v_mfma_f32_16x16x32_bf16 v[160:163], a[112:115], v[52:55], 0
    ds_read_b128 v[44:47], v10 offset:3136
    buffer_load_dwordx4 v20, s[16:19], s46 offen lds
    ds_read_b64_tr_b16 a[172:173], v27 offset:30720
    v_mfma_f32_16x16x32_bf16 v[160:163], a[124:127], v[56:59], v[160:163]
    ds_read_b64_tr_b16 a[174:175], v27 offset:31488
    ds_read_b128 v[48:51], v10 offset:3200
    ds_read_b64_tr_b16 a[152:153], v28 offset:18432
    v_mfma_f32_16x16x32_bf16 v[160:163], a[136:139], v[60:63], v[160:163]
    ds_read_b64_tr_b16 a[154:155], v28 offset:19200
    s_add_u32 m0, s26, 61440
    ds_read_b64_tr_b16 a[164:165], v28 offset:24576
    v_mfma_f32_16x16x32_bf16 v[164:167], a[116:119], v[52:55], 0
    ds_read_b64_tr_b16 a[166:167], v28 offset:25344
    buffer_load_dwordx4 v21, s[16:19], s46 offen lds
    ds_read_b64_tr_b16 a[176:177], v28 offset:30720
    v_mfma_f32_16x16x32_bf16 v[164:167], a[128:131], v[56:59], v[164:167]
    ds_read_b64_tr_b16 a[178:179], v28 offset:31488
    s_add_u32 m0, s26, 65536
    s_mov_b32 s46, 122880
    v_mfma_f32_16x16x32_bf16 v[164:167], a[140:143], v[60:63], v[164:167]
    buffer_load_dwordx4 v19, s[16:19], s46 offen lds
    s_add_u32 m0, s26, 69632
    s_waitcnt lgkmcnt(14)
    v_mfma_f32_16x16x32_bf16 v[144:147], a[144:147], v[64:67], v[144:147]
    ds_read_b128 v[52:55], v11 offset:0
    buffer_load_dwordx4 v20, s[16:19], s46 offen lds
    v_mfma_f32_16x16x32_bf16 v[144:147], a[156:159], v[68:71], v[144:147]
    ds_read_b128 v[56:59], v11 offset:64
    v_mfma_f32_16x16x32_bf16 v[144:147], a[168:171], v[72:75], v[144:147]
    ds_read_b128 v[60:63], v11 offset:128
    s_add_u32 m0, s26, 73728
    s_waitcnt lgkmcnt(10)
    v_mfma_f32_16x16x32_bf16 v[148:151], a[148:151], v[64:67], v[148:151]
    buffer_load_dwordx4 v21, s[16:19], s46 offen lds
    v_mfma_f32_16x16x32_bf16 v[148:151], a[160:163], v[68:71], v[148:151]
    v_mfma_f32_16x16x32_bf16 v[148:151], a[172:175], v[72:75], v[148:151]
    s_waitcnt vmcnt(10)
    s_barrier
    s_waitcnt lgkmcnt(3)
    v_mfma_f32_16x16x32_bf16 v[152:155], a[152:155], v[64:67], v[152:155]
    ds_read_b64_tr_b16 a[180:181], v26 offset:36864
    ds_read_b64_tr_b16 a[182:183], v26 offset:37632
    s_add_u32 m0, s26, 77824
    v_mfma_f32_16x16x32_bf16 v[152:155], a[164:167], v[68:71], v[152:155]
    s_mov_b32 s46, 135168
    ds_read_b64_tr_b16 a[192:193], v26 offset:43008
    ds_read_b64_tr_b16 a[194:195], v26 offset:43776
    v_mfma_f32_16x16x32_bf16 v[152:155], a[176:179], v[72:75], v[152:155]
    buffer_load_dwordx4 v19, s[16:19], s46 offen lds
    ds_read_b64_tr_b16 a[204:205], v26 offset:49152
    v_mfma_f32_16x16x32_bf16 v[156:159], a[144:147], v[40:43], v[156:159]
    ds_read_b64_tr_b16 a[206:207], v26 offset:49920
    ds_read_b64_tr_b16 a[184:185], v27 offset:36864
    ds_read_b64_tr_b16 a[186:187], v27 offset:37632
    v_mfma_f32_16x16x32_bf16 v[156:159], a[156:159], v[44:47], v[156:159]
    ds_read_b128 v[64:67], v11 offset:3072
    s_add_u32 m0, s26, 81920
    ds_read_b64_tr_b16 a[196:197], v27 offset:43008
    v_mfma_f32_16x16x32_bf16 v[156:159], a[168:171], v[48:51], v[156:159]
    ds_read_b64_tr_b16 a[198:199], v27 offset:43776
    ds_read_b128 v[68:71], v11 offset:3136
    buffer_load_dwordx4 v20, s[16:19], s46 offen lds
    v_mfma_f32_16x16x32_bf16 v[160:163], a[148:151], v[40:43], v[160:163]
    ds_read_b64_tr_b16 a[208:209], v27 offset:49152
    ds_read_b64_tr_b16 a[210:211], v27 offset:49920
    ds_read_b128 v[72:75], v11 offset:3200
    v_mfma_f32_16x16x32_bf16 v[160:163], a[160:163], v[44:47], v[160:163]
    ds_read_b64_tr_b16 a[188:189], v28 offset:36864
    ds_read_b64_tr_b16 a[190:191], v28 offset:37632
    s_add_u32 m0, s26, 86016
    v_mfma_f32_16x16x32_bf16 v[160:163], a[172:175], v[48:51], v[160:163]
    s_add_u32 s30, s30, 13312
    ds_read_b64_tr_b16 a[200:201], v28 offset:43008
    ds_read_b64_tr_b16 a[202:203], v28 offset:43776
    v_mfma_f32_16x16x32_bf16 v[164:167], a[152:155], v[40:43], v[164:167]
    buffer_load_dwordx4 v21, s[16:19], s46 offen lds
    s_cmp_eq_u32 s30, 53248
    s_cselect_b32 s30, 0, s30
    v_mfma_f32_16x16x32_bf16 v[164:167], a[164:167], v[44:47], v[164:167]
    ds_read_b64_tr_b16 a[212:213], v28 offset:49152
    ds_read_b64_tr_b16 a[214:215], v28 offset:49920
    v_add_u32 v9, s30, v6
    v_mfma_f32_16x16x32_bf16 v[164:167], a[176:179], v[48:51], v[164:167]
    s_add_u32 m0, s26, 90112
    s_mov_b32 s46, 147456
    s_waitcnt lgkmcnt(14)
    v_mfma_f32_16x16x32_bf16 v[144:147], a[180:183], v[52:55], v[144:147]
    v_add_u32 v10, s30, v7
    buffer_load_dwordx4 v19, s[16:19], s46 offen lds
    v_add_u32 v11, s30, v8
    v_mfma_f32_16x16x32_bf16 v[144:147], a[192:195], v[56:59], v[144:147]
    s_add_u32 m0, s26, 94208
    v_mfma_f32_16x16x32_bf16 v[144:147], a[204:207], v[60:63], v[144:147]
    buffer_load_dwordx4 v20, s[16:19], s46 offen lds
    s_add_u32 m0, s26, 98304
    s_waitcnt lgkmcnt(7)
    v_mfma_f32_16x16x32_bf16 v[148:151], a[184:187], v[52:55], v[148:151]
    buffer_load_dwordx4 v21, s[16:19], s46 offen lds
    v_mfma_f32_16x16x32_bf16 v[148:151], a[196:199], v[56:59], v[148:151]
    v_mfma_f32_16x16x32_bf16 v[148:151], a[208:211], v[60:63], v[148:151]
    s_add_u32 m0, s26, 102400
    s_mov_b32 s46, 159744
    s_waitcnt lgkmcnt(0)
    v_mfma_f32_16x16x32_bf16 v[152:155], a[188:191], v[52:55], v[152:155]
    s_waitcnt vmcnt(12)
    s_barrier
    buffer_load_dwordx4 v19, s[16:19], s46 offen lds
    v_mfma_f32_16x16x32_bf16 v[152:155], a[200:203], v[56:59], v[152:155]
    ds_read_b128 v[40:43], v9 offset:0
    ds_read_b128 v[44:47], v9 offset:64
    v_mfma_f32_16x16x32_bf16 v[152:155], a[212:215], v[60:63], v[152:155]
    s_add_u32 m0, s47, 106496
    s_mov_b32 s46, 110592
    v_mfma_f32_16x16x32_bf16 v[156:159], a[180:183], v[64:67], v[156:159]
    ds_read_b128 v[48:51], v9 offset:128
    v_mfma_f32_16x16x32_bf16 v[156:159], a[192:195], v[68:71], v[156:159]
    s_mov_b32 exec_hi, 0
    buffer_load_dwordx4 v22, s[16:19], s46 offen lds
    s_mov_b64 exec, -1
    v_mfma_f32_16x16x32_bf16 v[156:159], a[204:207], v[72:75], v[156:159]
    ds_read_b128 v[52:55], v10 offset:0
    ds_read_b128 v[56:59], v10 offset:64
    ds_read_b128 v[60:63], v10 offset:128
    v_mfma_f32_16x16x32_bf16 v[160:163], a[184:187], v[64:67], v[160:163]
    v_mfma_f32_16x16x32_bf16 v[160:163], a[196:199], v[68:71], v[160:163]
    v_mfma_f32_16x16x32_bf16 v[160:163], a[208:211], v[72:75], v[160:163]
    v_mfma_f32_16x16x32_bf16 v[164:167], a[188:191], v[64:67], v[164:167]
    ds_read_b128 v[64:67], v11 offset:0
    v_mfma_f32_16x16x32_bf16 v[164:167], a[200:203], v[68:71], v[164:167]
    ds_read_b128 v[68:71], v11 offset:64
    v_mfma_f32_16x16x32_bf16 v[164:167], a[212:215], v[72:75], v[164:167]
    ds_read_b128 v[72:75], v11 offset:128
    s_waitcnt lgkmcnt(6)
    v_mfma_f32_16x16x32_bf16 v[96:99], a[0:3], v[40:43], 0
    v_mfma_f32_16x16x32_bf16 v[96:99], a[12:15], v[44:47], v[96:99]
    v_mfma_f32_16x16x32_bf16 v[96:99], a[24:27], v[48:51], v[96:99]
    v_mfma_f32_16x16x32_bf16 v[100:103], a[4:7], v[40:43], 0
    v_mfma_f32_16x16x32_bf16 v[100:103], a[16:19], v[44:47], v[100:103]
    v_mfma_f32_16x16x32_bf16 v[100:103], a[28:31], v[48:51], v[100:103]
    v_mfma_f32_16x16x32_bf16 v[104:107], a[8:11], v[40:43], 0
    v_mfma_f32_16x16x32_bf16 v[104:107], a[20:23], v[44:47], v[104:107]
    v_mfma_f32_16x16x32_bf16 v[104:107], a[32:35], v[48:51], v[104:107]
    s_waitcnt lgkmcnt(3)
    v_mfma_f32_16x16x32_bf16 v[96:99], a[36:39], v[52:55], v[96:99]
    v_mfma_f32_16x16x32_bf16 v[96:99], a[48:51], v[56:59], v[96:99]
    v_mfma_f32_16x16x32_bf16 v[96:99], a[60:63], v[60:63], v[96:99]
    s_sub_u32 s32, s32, 393216
    v_mfma_f32_16x16x32_bf16 v[100:103], a[40:43], v[52:55], v[100:103]
    s_sub_u32 s33, s33, 4
    v_mfma_f32_16x16x32_bf16 v[100:103], a[52:55], v[56:59], v[100:103]
    s_cmp_lt_u32 s33, s34
    s_cselect_b32 s14, 50331648, 0
    v_mfma_f32_16x16x32_bf16 v[100:103], a[64:67], v[60:63], v[100:103]
    s_add_u32 s31, s31, 13312
    v_mfma_f32_16x16x32_bf16 v[104:107], a[44:47], v[52:55], v[104:107]
    s_cmp_eq_u32 s31, 53248
    s_cselect_b32 s31, 0, s31
    v_mfma_f32_16x16x32_bf16 v[104:107], a[56:59], v[56:59], v[104:107]
    v_mfma_f32_16x16x32_bf16 v[104:107], a[68:71], v[60:63], v[104:107]
    s_waitcnt lgkmcnt(0)
    v_mfma_f32_16x16x32_bf16 v[96:99], a[72:75], v[64:67], v[96:99]
    s_add_u32 m0, s31, s26
    v_mfma_f32_16x16x32_bf16 v[96:99], a[84:87], v[68:71], v[96:99]
    buffer_load_dwordx4 v2, s[12:15], s32 offen nt lds
    v_mfma_f32_16x16x32_bf16 v[96:99], a[96:99], v[72:75], v[96:99]
    s_add_u32 m0, s31, s27
    v_mfma_f32_16x16x32_bf16 v[100:103], a[76:79], v[64:67], v[100:103]
    buffer_load_dwordx4 v3, s[12:15], s32 offen nt lds
    v_mfma_f32_16x16x32_bf16 v[100:103], a[88:91], v[68:71], v[100:103]
    s_add_u32 m0, s31, s28
    v_mfma_f32_16x16x32_bf16 v[100:103], a[100:103], v[72:75], v[100:103]
    buffer_load_dwordx4 v4, s[12:15], s32 offen nt lds
    v_mfma_f32_16x16x32_bf16 v[104:107], a[80:83], v[64:67], v[104:107]
    s_add_u32 m0, s31, s29
    v_mfma_f32_16x16x32_bf16 v[104:107], a[92:95], v[68:71], v[104:107]
    buffer_load_dwordx4 v5, s[12:15], s32 offen nt lds
    v_mfma_f32_16x16x32_bf16 v[104:107], a[104:107], v[72:75], v[104:107]
    v_mfma_f32_16x16x32_bf16 v[120:123], a[108:111], v[40:43], v[120:123]
    v_mfma_f32_16x16x32_bf16 v[120:123], a[120:123], v[44:47], v[120:123]
    v_mfma_f32_16x16x32_bf16 v[120:123], a[132:135], v[48:51], v[120:123]
    s_waitcnt vmcnt(4)
    s_barrier
    v_mfma_f32_16x16x32_bf16 v[120:123], a[144:147], v[52:55], v[120:123]
    ds_read_b64_tr_b16 a[216:217], v23 offset:0
    ds_read_b64_tr_b16 a[218:219], v23 offset:768
    v_mfma_f32_16x16x32_bf16 v[120:123], a[156:159], v[56:59], v[120:123]
    ds_read_b64_tr_b16 a[228:229], v23 offset:6144
    ds_read_b64_tr_b16 a[230:231], v23 offset:6912
    v_mfma_f32_16x16x32_bf16 v[120:123], a[168:171], v[60:63], v[120:123]
    ds_read_b64_tr_b16 a[240:241], v23 offset:12288
    v_mfma_f32_16x16x32_bf16 v[120:123], a[180:183], v[64:67], v[120:123]
    ds_read_b64_tr_b16 a[242:243], v23 offset:13056
    ds_read_b64_tr_b16 a[252:253], v23 offset:18432
    v_mfma_f32_16x16x32_bf16 v[120:123], a[192:195], v[68:71], v[120:123]
    ds_read_b64_tr_b16 a[254:255], v23 offset:19200
    ds_read_b64_tr_b16 v[176:177], v23 offset:24576
    v_mfma_f32_16x16x32_bf16 v[120:123], a[204:207], v[72:75], v[120:123]
    ds_read_b64_tr_b16 v[178:179], v23 offset:25344
    v_mfma_f32_16x16x32_bf16 v[124:127], a[112:115], v[40:43], v[124:127]
    ds_read_b64_tr_b16 v[188:189], v23 offset:30720
    ds_read_b64_tr_b16 v[190:191], v23 offset:31488
    v_mfma_f32_16x16x32_bf16 v[124:127], a[124:127], v[44:47], v[124:127]
    ds_read_b64_tr_b16 v[200:201], v23 offset:36864
    ds_read_b64_tr_b16 v[202:203], v23 offset:37632
    v_mfma_f32_16x16x32_bf16 v[124:127], a[136:139], v[48:51], v[124:127]
    ds_read_b64_tr_b16 v[212:213], v23 offset:43008
    s_waitcnt lgkmcnt(14)
    v_mfma_f32_16x16x32_bf16 v[124:127], a[148:151], v[52:55], v[124:127]
    ds_read_b64_tr_b16 v[214:215], v23 offset:43776
    ds_read_b64_tr_b16 v[224:225], v23 offset:49152
    v_mfma_f32_16x16x32_bf16 v[124:127], a[160:163], v[56:59], v[124:127]
    ds_read_b64_tr_b16 v[226:227], v23 offset:49920
    ds_read_b64_tr_b16 a[220:221], v24 offset:0
    v_mfma_f32_16x16x32_bf16 v[124:127], a[172:175], v[60:63], v[124:127]
    ds_read_b64_tr_b16 a[222:223], v24 offset:768
    s_waitcnt lgkmcnt(14)
    v_mfma_f32_16x16x32_bf16 v[124:127], a[184:187], v[64:67], v[124:127]
    ds_read_b64_tr_b16 a[232:233], v24 offset:6144
    ds_read_b64_tr_b16 a[234:235], v24 offset:6912
    v_mfma_f32_16x16x32_bf16 v[124:127], a[196:199], v[68:71], v[124:127]
    ds_read_b64_tr_b16 a[244:245], v24 offset:12288
    ds_read_b64_tr_b16 a[246:247], v24 offset:13056
    v_mfma_f32_16x16x32_bf16 v[124:127], a[208:211], v[72:75], v[124:127]
    ds_read_b64_tr_b16 v[168:169], v24 offset:18432
    s_waitcnt lgkmcnt(14)
    v_mfma_f32_16x16x32_bf16 v[128:131], a[116:119], v[40:43], v[128:131]
    ds_read_b64_tr_b16 v[170:171], v24 offset:19200
    ds_read_b64_tr_b16 v[180:181], v24 offset:24576
    v_mfma_f32_16x16x32_bf16 v[128:131], a[128:131], v[44:47], v[128:131]
    ds_read_b64_tr_b16 v[182:183], v24 offset:25344
    ds_read_b64_tr_b16 v[192:193], v24 offset:30720
    v_mfma_f32_16x16x32_bf16 v[128:131], a[140:143], v[48:51], v[128:131]
    ds_read_b64_tr_b16 v[194:195], v24 offset:31488
    s_waitcnt lgkmcnt(14)
    v_mfma_f32_16x16x32_bf16 v[128:131], a[152:155], v[52:55], v[128:131]
    ds_read_b64_tr_b16 v[204:205], v24 offset:36864
    ds_read_b64_tr_b16 v[206:207], v24 offset:37632
    v_mfma_f32_16x16x32_bf16 v[128:131], a[164:167], v[56:59], v[128:131]
    ds_read_b64_tr_b16 v[216:217], v24 offset:43008
    ds_read_b64_tr_b16 v[218:219], v24 offset:43776
    v_mfma_f32_16x16x32_bf16 v[128:131], a[176:179], v[60:63], v[128:131]
    ds_read_b64_tr_b16 v[228:229], v24 offset:49152
    s_waitcnt lgkmcnt(14)
    v_mfma_f32_16x16x32_bf16 v[128:131], a[188:191], v[64:67], v[128:131]
    ds_read_b64_tr_b16 v[230:231], v24 offset:49920
    ds_read_b64_tr_b16 a[224:225], v25 offset:0
    v_mfma_f32_16x16x32_bf16 v[128:131], a[200:203], v[68:71], v[128:131]
    ds_read_b64_tr_b16 a[226:227], v25 offset:768
    ds_read_b64_tr_b16 a[236:237], v25 offset:6144
    v_mfma_f32_16x16x32_bf16 v[128:131], a[212:215], v[72:75], v[128:131]
    ds_read_b64_tr_b16 a[238:239], v25 offset:6912
    s_waitcnt lgkmcnt(14)
    v_mfma_f32_16x16x32_bf16 v[144:147], a[216:219], v[40:43], v[144:147]
    ds_read_b64_tr_b16 a[248:249], v25 offset:12288
    ds_read_b64_tr_b16 a[250:251], v25 offset:13056
    v_mfma_f32_16x16x32_bf16 v[144:147], a[228:231], v[44:47], v[144:147]
    ds_read_b64_tr_b16 v[172:173], v25 offset:18432
    ds_read_b64_tr_b16 v[174:175], v25 offset:19200
    v_mfma_f32_16x16x32_bf16 v[144:147], a[240:243], v[48:51], v[144:147]
    ds_read_b64_tr_b16 v[184:185], v25 offset:24576
    s_waitcnt lgkmcnt(14)
    v_mfma_f32_16x16x32_bf16 v[144:147], a[252:255], v[52:55], v[144:147]
    ds_read_b64_tr_b16 v[186:187], v25 offset:25344
    ds_read_b64_tr_b16 v[196:197], v25 offset:30720
    v_mfma_f32_16x16x32_bf16 v[144:147], v[176:179], v[56:59], v[144:147]
    ds_read_b64_tr_b16 v[198:199], v25 offset:31488
    ds_read_b64_tr_b16 v[208:209], v25 offset:36864
    v_mfma_f32_16x16x32_bf16 v[144:147], v[188:191], v[60:63], v[144:147]
    ds_read_b64_tr_b16 v[210:211], v25 offset:37632
    s_waitcnt lgkmcnt(14)
    v_mfma_f32_16x16x32_bf16 v[144:147], v[200:203], v[64:67], v[144:147]
    ds_read_b64_tr_b16 v[220:221], v25 offset:43008
    ds_read_b64_tr_b16 v[222:223], v25 offset:43776
    v_mfma_f32_16x16x32_bf16 v[144:147], v[212:215], v[68:71], v[144:147]
    ds_read_b64_tr_b16 v[232:233], v25 offset:49152
    ds_read_b64_tr_b16 v[234:235], v25 offset:49920
    v_mfma_f32_16x16x32_bf16 v[144:147], v[224:227], v[72:75], v[144:147]
    s_waitcnt lgkmcnt(14)
    v_mfma_f32_16x16x32_bf16 v[148:151], a[220:223], v[40:43], v[148:151]
    v_mfma_f32_16x16x32_bf16 v[148:151], a[232:235], v[44:47], v[148:151]
    v_mfma_f32_16x16x32_bf16 v[148:151], a[244:247], v[48:51], v[148:151]
    v_mfma_f32_16x16x32_bf16 v[148:151], v[168:171], v[52:55], v[148:151]
    v_mfma_f32_16x16x32_bf16 v[148:151], v[180:183], v[56:59], v[148:151]
    v_mfma_f32_16x16x32_bf16 v[148:151], v[192:195], v[60:63], v[148:151]
    v_mfma_f32_16x16x32_bf16 v[148:151], v[204:207], v[64:67], v[148:151]
    v_mfma_f32_16x16x32_bf16 v[148:151], v[216:219], v[68:71], v[148:151]
    v_mfma_f32_16x16x32_bf16 v[148:151], v[228:231], v[72:75], v[148:151]
    s_waitcnt lgkmcnt(12)
    v_mfma_f32_16x16x32_bf16 v[152:155], a[224:227], v[40:43], v[152:155]
    ds_read_b128 v[40:43], v9 offset:3072
    v_mfma_f32_16x16x32_bf16 v[152:155], a[236:239], v[44:47], v[152:155]
    ds_read_b128 v[44:47], v9 offset:3136
    v_mfma_f32_16x16x32_bf16 v[152:155], a[248:251], v[48:51], v[152:155]
    ds_read_b128 v[48:51], v9 offset:3200
    s_waitcnt lgkmcnt(9)
    v_mfma_f32_16x16x32_bf16 v[152:155], v[172:175], v[52:55], v[152:155]
    ds_read_b128 v[52:55], v10 offset:3072
    v_mfma_f32_16x16x32_bf16 v[152:155], v[184:187], v[56:59], v[152:155]
    ds_read_b128 v[56:59], v10 offset:3136
    v_mfma_f32_16x16x32_bf16 v[152:155], v[196:199], v[60:63], v[152:155]
    ds_read_b128 v[60:63], v10 offset:3200
    s_waitcnt lgkmcnt(6)
    v_mfma_f32_16x16x32_bf16 v[152:155], v[208:211], v[64:67], v[152:155]
    ds_read_b128 v[64:67], v11 offset:3072
    v_mfma_f32_16x16x32_bf16 v[152:155], v[220:223], v[68:71], v[152:155]
    ds_read_b128 v[68:71], v11 offset:3136
    v_mfma_f32_16x16x32_bf16 v[152:155], v[232:235], v[72:75], v[152:155]
    ds_read_b128 v[72:75], v11 offset:3200
    s_waitcnt lgkmcnt(6)
    v_mfma_f32_16x16x32_bf16 v[108:111], a[0:3], v[40:43], 0
    s_add_u32 s32, s32, 589824
    v_mfma_f32_16x16x32_bf16 v[108:111], a[12:15], v[44:47], v[108:111]
    s_add_u32 s33, s33, 6
    v_mfma_f32_16x16x32_bf16 v[108:111], a[24:27], v[48:51], v[108:111]
    s_cmp_lt_u32 s33, s34
    s_cselect_b32 s14, 50331648, 0
    s_waitcnt lgkmcnt(3)
    v_mfma_f32_16x16x32_bf16 v[108:111], a[36:39], v[52:55], v[108:111]
    s_add_u32 s31, s31, 13312
    v_mfma_f32_16x16x32_bf16 v[108:111], a[48:51], v[56:59], v[108:111]
    s_cmp_eq_u32 s31, 53248
    s_cselect_b32 s31, 0, s31
    v_mfma_f32_16x16x32_bf16 v[108:111], a[60:63], v[60:63], v[108:111]
    s_waitcnt lgkmcnt(0)
    v_mfma_f32_16x16x32_bf16 v[108:111], a[72:75], v[64:67], v[108:111]
    v_mfma_f32_16x16x32_bf16 v[108:111], a[84:87], v[68:71], v[108:111]
    s_add_u32 m0, s31, s26
    v_mfma_f32_16x16x32_bf16 v[108:111], a[96:99], v[72:75], v[108:111]
    buffer_load_dwordx4 v2, s[12:15], s32 offen nt lds
    v_mfma_f32_16x16x32_bf16 v[112:115], a[4:7], v[40:43], 0
    v_mfma_f32_16x16x32_bf16 v[112:115], a[16:19], v[44:47], v[112:115]
    s_add_u32 m0, s31, s27
    v_mfma_f32_16x16x32_bf16 v[112:115], a[28:31], v[48:51], v[112:115]
    buffer_load_dwordx4 v3, s[12:15], s32 offen nt lds
    v_mfma_f32_16x16x32_bf16 v[112:115], a[40:43], v[52:55], v[112:115]
    v_mfma_f32_16x16x32_bf16 v[112:115], a[52:55], v[56:59], v[112:115]
    s_add_u32 m0, s31, s28
    v_mfma_f32_16x16x32_bf16 v[112:115], a[64:67], v[60:63], v[112:115]
    buffer_load_dwordx4 v4, s[12:15], s32 offen nt lds
    v_mfma_f32_16x16x32_bf16 v[112:115], a[76:79], v[64:67], v[112:115]
    v_mfma_f32_16x16x32_bf16 v[112:115], a[88:91], v[68:71], v[112:115]
    s_add_u32 m0, s31, s29
    v_mfma_f32_16x16x32_bf16 v[112:115], a[100:103], v[72:75], v[112:115]
    buffer_load_dwordx4 v5, s[12:15], s32 offen nt lds
    v_mfma_f32_16x16x32_bf16 v[116:119], a[8:11], v[40:43], 0
    v_mfma_f32_16x16x32_bf16 v[116:119], a[20:23], v[44:47], v[116:119]
    v_mfma_f32_16x16x32_bf16 v[116:119], a[32:35], v[48:51], v[116:119]
    s_add_u32 s32, s32, 196608
    v_mfma_f32_16x16x32_bf16 v[116:119], a[44:47], v[52:55], v[116:119]
    s_add_u32 s33, s33, 2
    v_mfma_f32_16x16x32_bf16 v[116:119], a[56:59], v[56:59], v[116:119]
    s_cmp_lt_u32 s33, s34
    s_cselect_b32 s14, 50331648, 0
    v_mfma_f32_16x16x32_bf16 v[116:119], a[68:71], v[60:63], v[116:119]
    s_add_u32 s31, s31, 13312
    v_mfma_f32_16x16x32_bf16 v[116:119], a[80:83], v[64:67], v[116:119]
    s_cmp_eq_u32 s31, 53248
    s_cselect_b32 s31, 0, s31
    v_mfma_f32_16x16x32_bf16 v[116:119], a[92:95], v[68:71], v[116:119]
    v_mfma_f32_16x16x32_bf16 v[116:119], a[104:107], v[72:75], v[116:119]
    v_mfma_f32_16x16x32_bf16 v[132:135], a[108:111], v[40:43], v[132:135]
    s_add_u32 m0, s31, s26
    v_mfma_f32_16x16x32_bf16 v[132:135], a[120:123], v[44:47], v[132:135]
    buffer_load_dwordx4 v2, s[12:15], s32 offen nt lds
    v_mfma_f32_16x16x32_bf16 v[132:135], a[132:135], v[48:51], v[132:135]
    v_mfma_f32_16x16x32_bf16 v[132:135], a[144:147], v[52:55], v[132:135]
    s_add_u32 m0, s31, s27
    v_mfma_f32_16x16x32_bf16 v[132:135], a[156:159], v[56:59], v[132:135]
    buffer_load_dwordx4 v3, s[12:15], s32 offen nt lds
    v_mfma_f32_16x16x32_bf16 v[132:135], a[168:171], v[60:63], v[132:135]
    v_mfma_f32_16x16x32_bf16 v[132:135], a[180:183], v[64:67], v[132:135]
    s_add_u32 m0, s31, s28
    v_mfma_f32_16x16x32_bf16 v[132:135], a[192:195], v[68:71], v[132:135]
    buffer_load_dwordx4 v4, s[12:15], s32 offen nt lds
    v_mfma_f32_16x16x32_bf16 v[132:135], a[204:207], v[72:75], v[132:135]
    v_mfma_f32_16x16x32_bf16 v[136:139], a[112:115], v[40:43], v[136:139]
    s_add_u32 m0, s31, s29
    v_mfma_f32_16x16x32_bf16 v[136:139], a[124:127], v[44:47], v[136:139]
    buffer_load_dwordx4 v5, s[12:15], s32 offen nt lds
    v_mfma_f32_16x16x32_bf16 v[136:139], a[136:139], v[48:51], v[136:139]
    v_mfma_f32_16x16x32_bf16 v[136:139], a[148:151], v[52:55], v[136:139]
    v_mfma_f32_16x16x32_bf16 v[136:139], a[160:163], v[56:59], v[136:139]
    s_add_u32 s30, s30, 13312
    v_mfma_f32_16x16x32_bf16 v[136:139], a[172:175], v[60:63], v[136:139]
    s_cmp_eq_u32 s30, 53248
    s_cselect_b32 s30, 0, s30
    v_mfma_f32_16x16x32_bf16 v[136:139], a[184:187], v[64:67], v[136:139]
    v_add_u32 v9, s30, v6
    v_mfma_f32_16x16x32_bf16 v[136:139], a[196:199], v[68:71], v[136:139]
    v_add_u32 v10, s30, v7
    v_mfma_f32_16x16x32_bf16 v[136:139], a[208:211], v[72:75], v[136:139]
    v_add_u32 v11, s30, v8
    v_mfma_f32_16x16x32_bf16 v[140:143], a[116:119], v[40:43], v[140:143]
    v_mfma_f32_16x16x32_bf16 v[140:143], a[128:131], v[44:47], v[140:143]
    v_mfma_f32_16x16x32_bf16 v[140:143], a[140:143], v[48:51], v[140:143]
    v_mfma_f32_16x16x32_bf16 v[140:143], a[152:155], v[52:55], v[140:143]
    ds_write_b32 v242, v243
    v_mfma_f32_16x16x32_bf16 v[140:143], a[164:167], v[56:59], v[140:143]
    v_mfma_f32_16x16x32_bf16 v[140:143], a[176:179], v[60:63], v[140:143]
    v_mfma_f32_16x16x32_bf16 v[140:143], a[188:191], v[64:67], v[140:143]
    v_mfma_f32_16x16x32_bf16 v[140:143], a[200:203], v[68:71], v[140:143]
    v_mfma_f32_16x16x32_bf16 v[140:143], a[212:215], v[72:75], v[140:143]
    v_mfma_f32_16x16x32_bf16 v[156:159], a[216:219], v[40:43], v[156:159]
    v_mfma_f32_16x16x32_bf16 v[156:159], a[228:231], v[44:47], v[156:159]
    v_mfma_f32_16x16x32_bf16 v[156:159], a[240:243], v[48:51], v[156:159]
    v_mfma_f32_16x16x32_bf16 v[160:163], a[220:223], v[40:43], v[160:163]
    v_mfma_f32_16x16x32_bf16 v[160:163], a[232:235], v[44:47], v[160:163]
    v_mfma_f32_16x16x32_bf16 v[160:163], a[244:247], v[48:51], v[160:163]
    s_waitcnt vmcnt(8)
    s_barrier
    v_mfma_f32_16x16x32_bf16 v[164:167], a[224:227], v[40:43], v[164:167]
    ds_read_b128 v[40:43], v9 offset:0
    v_mfma_f32_16x16x32_bf16 v[164:167], a[236:239], v[44:47], v[164:167]
    ds_read_b128 v[44:47], v9 offset:64
    v_mfma_f32_16x16x32_bf16 v[164:167], a[248:251], v[48:51], v[164:167]
    ds_read_b128 v[48:51], v9 offset:128
    v_mfma_f32_16x16x32_bf16 v[156:159], a[252:255], v[52:55], v[156:159]
    v_mfma_f32_16x16x32_bf16 v[156:159], v[176:179], v[56:59], v[156:159]
    v_mfma_f32_16x16x32_bf16 v[156:159], v[188:191], v[60:63], v[156:159]
    v_mfma_f32_16x16x32_bf16 v[160:163], v[168:171], v[52:55], v[160:163]
    v_mfma_f32_16x16x32_bf16 v[160:163], v[180:183], v[56:59], v[160:163]
    v_mfma_f32_16x16x32_bf16 v[160:163], v[192:195], v[60:63], v[160:163]
    v_mfma_f32_16x16x32_bf16 v[164:167], v[172:175], v[52:55], v[164:167]
    ds_read_b128 v[52:55], v10 offset:0
    v_mfma_f32_16x16x32_bf16 v[164:167], v[184:187], v[56:59], v[164:167]
    ds_read_b128 v[56:59], v10 offset:64
    v_mfma_f32_16x16x32_bf16 v[164:167], v[196:199], v[60:63], v[164:167]
    ds_read_b128 v[60:63], v10 offset:128
    v_mfma_f32_16x16x32_bf16 v[156:159], v[200:203], v[64:67], v[156:159]
    v_mfma_f32_16x16x32_bf16 v[156:159], v[212:215], v[68:71], v[156:159]
    v_mfma_f32_16x16x32_bf16 v[156:159], v[224:227], v[72:75], v[156:159]
    v_mfma_f32_16x16x32_bf16 v[160:163], v[204:207], v[64:67], v[160:163]
    v_mfma_f32_16x16x32_bf16 v[160:163], v[216:219], v[68:71], v[160:163]
    v_mfma_f32_16x16x32_bf16 v[160:163], v[228:231], v[72:75], v[160:163]
    v_mfma_f32_16x16x32_bf16 v[164:167], v[208:211], v[64:67], v[164:167]
    ds_read_b128 v[64:67], v11 offset:0
    v_mfma_f32_16x16x32_bf16 v[164:167], v[220:223], v[68:71], v[164:167]
    ds_read_b128 v[68:71], v11 offset:64
    v_mfma_f32_16x16x32_bf16 v[164:167], v[232:235], v[72:75], v[164:167]
    ds_read_b128 v[72:75], v11 offset:128
    s_waitcnt lgkmcnt(6)
    v_mfma_f32_16x16x32_bf16 v[144:147], a[0:3], v[40:43], v[144:147]
    s_add_u32 s32, s32, 196608
    v_mfma_f32_16x16x32_bf16 v[144:147], a[12:15], v[44:47], v[144:147]
    s_add_u32 s33, s33, 2
    v_mfma_f32_16x16x32_bf16 v[144:147], a[24:27], v[48:51], v[144:147]
    s_cmp_lt_u32 s33, s34
    s_cselect_b32 s14, 50331648, 0
    s_waitcnt lgkmcnt(3)
    v_mfma_f32_16x16x32_bf16 v[144:147], a[36:39], v[52:55], v[144:147]
    s_add_u32 s31, s31, 13312
    v_mfma_f32_16x16x32_bf16 v[144:147], a[48:51], v[56:59], v[144:147]
    s_cmp_eq_u32 s31, 53248
    s_cselect_b32 s31, 0, s31
    v_mfma_f32_16x16x32_bf16 v[144:147], a[60:63], v[60:63], v[144:147]
    s_waitcnt lgkmcnt(0)
    v_mfma_f32_16x16x32_bf16 v[144:147], a[72:75], v[64:67], v[144:147]
    v_mfma_f32_16x16x32_bf16 v[144:147], a[84:87], v[68:71], v[144:147]
    s_add_u32 m0, s31, s26
    v_mfma_f32_16x16x32_bf16 v[144:147], a[96:99], v[72:75], v[144:147]
    buffer_load_dwordx4 v2, s[12:15], s32 offen nt lds
    v_mfma_f32_16x16x32_bf16 v[148:151], a[4:7], v[40:43], v[148:151]
    s_add_u32 m0, s31, s27
    v_mfma_f32_16x16x32_bf16 v[148:151], a[16:19], v[44:47], v[148:151]
    buffer_load_dwordx4 v3, s[12:15], s32 offen nt lds
    v_mfma_f32_16x16x32_bf16 v[148:151], a[28:31], v[48:51], v[148:151]
    s_add_u32 m0, s31, s28
    v_mfma_f32_16x16x32_bf16 v[148:151], a[40:43], v[52:55], v[148:151]
    buffer_load_dwordx4 v4, s[12:15], s32 offen nt lds
    v_mfma_f32_16x16x32_bf16 v[148:151], a[52:55], v[56:59], v[148:151]
    s_add_u32 m0, s31, s29
    v_mfma_f32_16x16x32_bf16 v[148:151], a[64:67], v[60:63], v[148:151]
    buffer_load_dwordx4 v5, s[12:15], s32 offen nt lds
    v_mfma_f32_16x16x32_bf16 v[148:151], a[76:79], v[64:67], v[148:151]
    v_mfma_f32_16x16x32_bf16 v[148:151], a[88:91], v[68:71], v[148:151]
    v_mfma_f32_16x16x32_bf16 v[148:151], a[100:103], v[72:75], v[148:151]
    v_cvt_pk_bf16_f32 v76, v144, v145
    v_mfma_f32_16x16x32_bf16 v[152:155], a[8:11], v[40:43], v[152:155]
    ds_read_b128 v[40:43], v9 offset:3072
    v_cvt_pk_bf16_f32 v77, v146, v147
    v_mfma_f32_16x16x32_bf16 v[152:155], a[20:23], v[44:47], v[152:155]
    ds_read_b128 v[44:47], v9 offset:3136
    ds_write_b64 v12, v[76:77] offset:0
    v_mfma_f32_16x16x32_bf16 v[152:155], a[32:35], v[48:51], v[152:155]
    ds_read_b128 v[48:51], v9 offset:3200
    v_mfma_f32_16x16x32_bf16 v[152:155], a[44:47], v[52:55], v[152:155]
    ds_read_b128 v[52:55], v10 offset:3072
    v_mfma_f32_16x16x32_bf16 v[152:155], a[56:59], v[56:59], v[152:155]
    ds_read_b128 v[56:59], v10 offset:3136
    v_mfma_f32_16x16x32_bf16 v[152:155], a[68:71], v[60:63], v[152:155]
    ds_read_b128 v[60:63], v10 offset:3200
    v_mfma_f32_16x16x32_bf16 v[152:155], a[80:83], v[64:67], v[152:155]
    ds_read_b128 v[64:67], v11 offset:3072
    v_mfma_f32_16x16x32_bf16 v[152:155], a[92:95], v[68:71], v[152:155]
    ds_read_b128 v[68:71], v11 offset:3136
    v_mfma_f32_16x16x32_bf16 v[152:155], a[104:107], v[72:75], v[152:155]
    ds_read_b128 v[72:75], v11 offset:3200
    s_waitcnt lgkmcnt(6)
    v_mfma_f32_16x16x32_bf16 v[156:159], a[0:3], v[40:43], v[156:159]
    v_cvt_pk_bf16_f32 v78, v148, v149
    s_add_u32 s30, s30, 13312
    v_mfma_f32_16x16x32_bf16 v[156:159], a[12:15], v[44:47], v[156:159]
    v_cvt_pk_bf16_f32 v79, v150, v151
    v_mfma_f32_16x16x32_bf16 v[156:159], a[24:27], v[48:51], v[156:159]
    s_cmp_eq_u32 s30, 53248
    s_cselect_b32 s30, 0, s30
    v_mfma_f32_16x16x32_bf16 v[160:163], a[4:7], v[40:43], v[160:163]
    ds_write_b64 v13, v[78:79] offset:0
    v_add_u32 v9, s30, v6
    v_mfma_f32_16x16x32_bf16 v[160:163], a[16:19], v[44:47], v[160:163]
    v_add_u32 v10, s30, v7
    v_add_u32 v11, s30, v8
    v_mfma_f32_16x16x32_bf16 v[160:163], a[28:31], v[48:51], v[160:163]
    s_waitcnt vmcnt(8)
    s_barrier
    v_mfma_f32_16x16x32_bf16 v[164:167], a[8:11], v[40:43], v[164:167]
    ds_read_b128 v[40:43], v9 offset:0
    v_mfma_f32_16x16x32_bf16 v[164:167], a[20:23], v[44:47], v[164:167]
    ds_read_b128 v[44:47], v9 offset:64
    v_mfma_f32_16x16x32_bf16 v[164:167], a[32:35], v[48:51], v[164:167]
    v_cvt_pk_bf16_f32 v80, v152, v153
    s_waitcnt lgkmcnt(6)
    v_mfma_f32_16x16x32_bf16 v[156:159], a[36:39], v[52:55], v[156:159]
    ds_read_b128 v[48:51], v9 offset:128
    v_cvt_pk_bf16_f32 v81, v154, v155
    v_mfma_f32_16x16x32_bf16 v[156:159], a[48:51], v[56:59], v[156:159]
    ds_write_b64 v14, v[80:81] offset:0
    v_mfma_f32_16x16x32_bf16 v[156:159], a[60:63], v[60:63], v[156:159]
    v_mfma_f32_16x16x32_bf16 v[160:163], a[40:43], v[52:55], v[160:163]
    v_mfma_f32_16x16x32_bf16 v[160:163], a[52:55], v[56:59], v[160:163]
    v_mfma_f32_16x16x32_bf16 v[160:163], a[64:67], v[60:63], v[160:163]
    v_mfma_f32_16x16x32_bf16 v[164:167], a[44:47], v[52:55], v[164:167]
    ds_read_b128 v[52:55], v10 offset:0
    v_mfma_f32_16x16x32_bf16 v[164:167], a[56:59], v[56:59], v[164:167]
    ds_read_b128 v[56:59], v10 offset:64
    v_mfma_f32_16x16x32_bf16 v[164:167], a[68:71], v[60:63], v[164:167]
    ds_read_b128 v[60:63], v10 offset:128
    s_waitcnt lgkmcnt(8)
    v_mfma_f32_16x16x32_bf16 v[156:159], a[72:75], v[64:67], v[156:159]
    v_mfma_f32_16x16x32_bf16 v[156:159], a[84:87], v[68:71], v[156:159]
    v_mfma_f32_16x16x32_bf16 v[156:159], a[96:99], v[72:75], v[156:159]
    v_mfma_f32_16x16x32_bf16 v[160:163], a[76:79], v[64:67], v[160:163]
    v_mfma_f32_16x16x32_bf16 v[160:163], a[88:91], v[68:71], v[160:163]
    v_mfma_f32_16x16x32_bf16 v[160:163], a[100:103], v[72:75], v[160:163]
    v_mfma_f32_16x16x32_bf16 v[164:167], a[80:83], v[64:67], v[164:167]
    ds_read_b128 v[64:67], v11 offset:0
    v_mfma_f32_16x16x32_bf16 v[164:167], a[92:95], v[68:71], v[164:167]
    ds_read_b128 v[68:71], v11 offset:64
    v_mfma_f32_16x16x32_bf16 v[164:167], a[104:107], v[72:75], v[164:167]
    ds_read_b128 v[72:75], v11 offset:128
    s_nop 7
    v_cvt_pk_bf16_f32 v76, v156, v157
    v_cvt_pk_bf16_f32 v77, v158, v159
    ds_write_b64 v12, v[76:77] offset:3072
    v_cvt_pk_bf16_f32 v78, v160, v161
    v_cvt_pk_bf16_f32 v79, v162, v163
    ds_write_b64 v13, v[78:79] offset:3072
    v_cvt_pk_bf16_f32 v80, v164, v165
    v_cvt_pk_bf16_f32 v81, v166, v167
    ds_write_b64 v14, v[80:81] offset:3072
    s_waitcnt lgkmcnt(0)
    s_barrier
    s_mov_b32 s36, 13
L_loop:
    s_waitcnt lgkmcnt(6)
    v_mfma_f32_16x16x32_bf16 v[144:147], a[216:219], v[40:43], v[120:123]
    v_xor_b32 v12, 0x4000, v12
    v_mfma_f32_16x16x32_bf16 v[144:147], a[228:231], v[44:47], v[144:147]
    v_xor_b32 v13, 0x4000, v13
    v_mfma_f32_16x16x32_bf16 v[144:147], a[240:243], v[48:51], v[144:147]
    v_xor_b32 v14, 0x4000, v14
    s_waitcnt lgkmcnt(3)
    v_mfma_f32_16x16x32_bf16 v[144:147], a[252:255], v[52:55], v[144:147]
    v_mfma_f32_16x16x32_bf16 v[144:147], v[176:179], v[56:59], v[144:147]
    v_mfma_f32_16x16x32_bf16 v[144:147], v[188:191], v[60:63], v[144:147]
    s_waitcnt lgkmcnt(0)
    v_mfma_f32_16x16x32_bf16 v[144:147], v[200:203], v[64:67], v[144:147]
    ds_read_b128 v[84:87], v15
    v_mfma_f32_16x16x32_bf16 v[144:147], v[212:215], v[68:71], v[144:147]
    ds_read_b128 v[88:91], v16
    v_mfma_f32_16x16x32_bf16 v[144:147], v[224:227], v[72:75], v[144:147]
    ds_read_b128 v[92:95], v17
    v_mfma_f32_16x16x32_bf16 v[148:151], a[220:223], v[40:43], v[124:127]
    v_xor_b32 v15, 0x4000, v15
    v_mfma_f32_16x16x32_bf16 v[148:151], a[232:235], v[44:47], v[148:151]
    v_xor_b32 v16, 0x4000, v16
    v_mfma_f32_16x16x32_bf16 v[148:151], a[244:247], v[48:51], v[148:151]
    v_xor_b32 v17, 0x4000, v17
    v_mfma_f32_16x16x32_bf16 v[148:151], v[168:171], v[52:55], v[148:151]
    s_waitcnt lgkmcnt(2)
    buffer_store_dwordx4 v[84:87], v18, s[20:23], s35 offen offset:0 nt
    v_mfma_f32_16x16x32_bf16 v[148:151], v[180:183], v[56:59], v[148:151]
    v_mfma_f32_16x16x32_bf16 v[148:151], v[192:195], v[60:63], v[148:151]
    v_mfma_f32_16x16x32_bf16 v[148:151], v[204:207], v[64:67], v[148:151]
    v_mfma_f32_16x16x32_bf16 v[148:151], v[216:219], v[68:71], v[148:151]
    v_mfma_f32_16x16x32_bf16 v[148:151], v[228:231], v[72:75], v[148:151]
    v_cvt_pk_bf16_f32 v76, v144, v145
    v_mfma_f32_16x16x32_bf16 v[152:155], a[224:227], v[40:43], v[128:131]
    v_cvt_pk_bf16_f32 v77, v146, v147
    v_mfma_f32_16x16x32_bf16 v[152:155], a[236:239], v[44:47], v[152:155]
    ds_write_b64 v12, v[76:77] offset:0
    v_mfma_f32_16x16x32_bf16 v[152:155], a[248:251], v[48:51], v[152:155]
    s_waitcnt lgkmcnt(2)
    buffer_store_dwordx4 v[88:91], v18, s[20:23], s35 offen offset:1024 nt
    v_mfma_f32_16x16x32_bf16 v[152:155], v[172:175], v[52:55], v[152:155]
    v_mfma_f32_16x16x32_bf16 v[152:155], v[184:187], v[56:59], v[152:155]
    v_mfma_f32_16x16x32_bf16 v[152:155], v[196:199], v[60:63], v[152:155]
    v_mfma_f32_16x16x32_bf16 v[152:155], v[208:211], v[64:67], v[152:155]
    v_mfma_f32_16x16x32_bf16 v[152:155], v[220:223], v[68:71], v[152:155]
    v_mfma_f32_16x16x32_bf16 v[152:155], v[232:235], v[72:75], v[152:155]
    v_cvt_pk_bf16_f32 v78, v148, v149
    v_mfma_f32_16x16x32_bf16 v[120:123], a[108:111], v[40:43], v[96:99]
    v_cvt_pk_bf16_f32 v79, v150, v151
    v_mfma_f32_16x16x32_bf16 v[120:123], a[120:123], v[44:47], v[120:123]
    s_waitcnt lgkmcnt(1)
    buffer_store_dwordx4 v[92:95], v18, s[20:23], s35 offen offset:2048 nt
    ds_write_b64 v13, v[78:79] offset:0
    v_mfma_f32_16x16x32_bf16 v[120:123], a[132:135], v[48:51], v[120:123]
    s_add_u32 s35, s35, 196608
    v_mfma_f32_16x16x32_bf16 v[120:123], a[144:147], v[52:55], v[120:123]
    v_mfma_f32_16x16x32_bf16 v[120:123], a[156:159], v[56:59], v[120:123]
    v_mfma_f32_16x16x32_bf16 v[120:123], a[168:171], v[60:63], v[120:123]
    v_mfma_f32_16x16x32_bf16 v[120:123], a[180:183], v[64:67], v[120:123]
    v_mfma_f32_16x16x32_bf16 v[120:123], a[192:195], v[68:71], v[120:123]
    v_mfma_f32_16x16x32_bf16 v[120:123], a[204:207], v[72:75], v[120:123]
    v_cvt_pk_bf16_f32 v80, v152, v153
    v_mfma_f32_16x16x32_bf16 v[124:127], a[112:115], v[40:43], v[100:103]
    v_cvt_pk_bf16_f32 v81, v154, v155
    v_mfma_f32_16x16x32_bf16 v[124:127], a[124:127], v[44:47], v[124:127]
    ds_write_b64 v14, v[80:81] offset:0
    v_mfma_f32_16x16x32_bf16 v[124:127], a[136:139], v[48:51], v[124:127]
    v_mfma_f32_16x16x32_bf16 v[124:127], a[148:151], v[52:55], v[124:127]
    s_add_u32 s32, s32, 196608
    v_mfma_f32_16x16x32_bf16 v[124:127], a[160:163], v[56:59], v[124:127]
    s_add_u32 s33, s33, 2
    v_mfma_f32_16x16x32_bf16 v[124:127], a[172:175], v[60:63], v[124:127]
    s_cmp_lt_u32 s33, s34
    s_cselect_b32 s14, 50331648, 0
    v_mfma_f32_16x16x32_bf16 v[124:127], a[184:187], v[64:67], v[124:127]
    s_add_u32 s31, s31, 13312
    v_mfma_f32_16x16x32_bf16 v[124:127], a[196:199], v[68:71], v[124:127]
    s_cmp_eq_u32 s31, 53248
    s_cselect_b32 s31, 0, s31
    v_mfma_f32_16x16x32_bf16 v[124:127], a[208:211], v[72:75], v[124:127]
    v_mfma_f32_16x16x32_bf16 v[128:131], a[116:119], v[40:43], v[104:107]
    v_mfma_f32_16x16x32_bf16 v[128:131], a[128:131], v[44:47], v[128:131]
    s_add_u32 m0, s31, s26
    v_mfma_f32_16x16x32_bf16 v[128:131], a[140:143], v[48:51], v[128:131]
    buffer_load_dwordx4 v2, s[12:15], s32 offen nt lds
    v_mfma_f32_16x16x32_bf16 v[128:131], a[152:155], v[52:55], v[128:131]
    v_mfma_f32_16x16x32_bf16 v[128:131], a[164:167], v[56:59], v[128:131]
    v_mfma_f32_16x16x32_bf16 v[128:131], a[176:179], v[60:63], v[128:131]
    s_add_u32 m0, s31, s27
    v_mfma_f32_16x16x32_bf16 v[128:131], a[188:191], v[64:67], v[128:131]
    buffer_load_dwordx4 v3, s[12:15], s32 offen nt lds
    v_mfma_f32_16x16x32_bf16 v[128:131], a[200:203], v[68:71], v[128:131]
    v_mfma_f32_16x16x32_bf16 v[128:131], a[212:215], v[72:75], v[128:131]
    v_mfma_f32_16x16x32_bf16 v[96:99], a[0:3], v[40:43], 0
    s_add_u32 m0, s31, s28
    v_mfma_f32_16x16x32_bf16 v[96:99], a[12:15], v[44:47], v[96:99]
    buffer_load_dwordx4 v4, s[12:15], s32 offen nt lds
    v_mfma_f32_16x16x32_bf16 v[96:99], a[24:27], v[48:51], v[96:99]
    v_mfma_f32_16x16x32_bf16 v[100:103], a[4:7], v[40:43], 0
    v_mfma_f32_16x16x32_bf16 v[100:103], a[16:19], v[44:47], v[100:103]
    s_add_u32 m0, s31, s29
    v_mfma_f32_16x16x32_bf16 v[100:103], a[28:31], v[48:51], v[100:103]
    buffer_load_dwordx4 v5, s[12:15], s32 offen nt lds
    v_mfma_f32_16x16x32_bf16 v[104:107], a[8:11], v[40:43], 0
    ds_read_b128 v[40:43], v9 offset:3072
    v_mfma_f32_16x16x32_bf16 v[104:107], a[20:23], v[44:47], v[104:107]
    ds_read_b128 v[44:47], v9 offset:3136
    v_mfma_f32_16x16x32_bf16 v[104:107], a[32:35], v[48:51], v[104:107]
    ds_read_b128 v[48:51], v9 offset:3200
    v_mfma_f32_16x16x32_bf16 v[96:99], a[36:39], v[52:55], v[96:99]
    v_mfma_f32_16x16x32_bf16 v[96:99], a[48:51], v[56:59], v[96:99]
    v_mfma_f32_16x16x32_bf16 v[96:99], a[60:63], v[60:63], v[96:99]
    v_mfma_f32_16x16x32_bf16 v[100:103], a[40:43], v[52:55], v[100:103]
    v_mfma_f32_16x16x32_bf16 v[100:103], a[52:55], v[56:59], v[100:103]
    v_mfma_f32_16x16x32_bf16 v[100:103], a[64:67], v[60:63], v[100:103]
    v_mfma_f32_16x16x32_bf16 v[104:107], a[44:47], v[52:55], v[104:107]
    ds_read_b128 v[52:55], v10 offset:3072
    v_mfma_f32_16x16x32_bf16 v[104:107], a[56:59], v[56:59], v[104:107]
    ds_read_b128 v[56:59], v10 offset:3136
    v_mfma_f32_16x16x32_bf16 v[104:107], a[68:71], v[60:63], v[104:107]
    ds_read_b128 v[60:63], v10 offset:3200
    v_mfma_f32_16x16x32_bf16 v[96:99], a[72:75], v[64:67], v[96:99]
    v_mfma_f32_16x16x32_bf16 v[96:99], a[84:87], v[68:71], v[96:99]
    v_mfma_f32_16x16x32_bf16 v[96:99], a[96:99], v[72:75], v[96:99]
    v_mfma_f32_16x16x32_bf16 v[100:103], a[76:79], v[64:67], v[100:103]
    v_mfma_f32_16x16x32_bf16 v[100:103], a[88:91], v[68:71], v[100:103]
    v_mfma_f32_16x16x32_bf16 v[100:103], a[100:103], v[72:75], v[100:103]
    v_mfma_f32_16x16x32_bf16 v[104:107], a[80:83], v[64:67], v[104:107]
    ds_read_b128 v[64:67], v11 offset:3072
    v_mfma_f32_16x16x32_bf16 v[104:107], a[92:95], v[68:71], v[104:107]
    ds_read_b128 v[68:71], v11 offset:3136
    v_mfma_f32_16x16x32_bf16 v[104:107], a[104:107], v[72:75], v[104:107]
    ds_read_b128 v[72:75], v11 offset:3200
    s_waitcnt lgkmcnt(6)
    v_mfma_f32_16x16x32_bf16 v[156:159], a[216:219], v[40:43], v[132:135]
    v_mfma_f32_16x16x32_bf16 v[156:159], a[228:231], v[44:47], v[156:159]
    v_mfma_f32_16x16x32_bf16 v[156:159], a[240:243], v[48:51], v[156:159]
    s_waitcnt lgkmcnt(3)
    v_mfma_f32_16x16x32_bf16 v[156:159], a[252:255], v[52:55], v[156:159]
    v_mfma_f32_16x16x32_bf16 v[156:159], v[176:179], v[56:59], v[156:159]
    v_mfma_f32_16x16x32_bf16 v[156:159], v[188:191], v[60:63], v[156:159]
    s_waitcnt lgkmcnt(0)
    v_mfma_f32_16x16x32_bf16 v[156:159], v[200:203], v[64:67], v[156:159]
    v_mfma_f32_16x16x32_bf16 v[156:159], v[212:215], v[68:71], v[156:159]
    v_mfma_f32_16x16x32_bf16 v[156:159], v[224:227], v[72:75], v[156:159]
    v_mfma_f32_16x16x32_bf16 v[160:163], a[220:223], v[40:43], v[136:139]
    s_add_u32 s30, s30, 13312
    v_mfma_f32_16x16x32_bf16 v[160:163], a[232:235], v[44:47], v[160:163]
    s_cmp_eq_u32 s30, 53248
    s_cselect_b32 s30, 0, s30
    v_mfma_f32_16x16x32_bf16 v[160:163], a[244:247], v[48:51], v[160:163]
    v_add_u32 v9, s30, v6
    v_mfma_f32_16x16x32_bf16 v[160:163], v[168:171], v[52:55], v[160:163]
    v_add_u32 v10, s30, v7
    v_mfma_f32_16x16x32_bf16 v[160:163], v[180:183], v[56:59], v[160:163]
    v_add_u32 v11, s30, v8
    v_mfma_f32_16x16x32_bf16 v[160:163], v[192:195], v[60:63], v[160:163]
    v_mfma_f32_16x16x32_bf16 v[160:163], v[204:207], v[64:67], v[160:163]
    v_mfma_f32_16x16x32_bf16 v[160:163], v[216:219], v[68:71], v[160:163]
    v_mfma_f32_16x16x32_bf16 v[160:163], v[228:231], v[72:75], v[160:163]
    v_cvt_pk_bf16_f32 v76, v156, v157
    v_mfma_f32_16x16x32_bf16 v[164:167], a[224:227], v[40:43], v[140:143]
    v_cvt_pk_bf16_f32 v77, v158, v159
    v_mfma_f32_16x16x32_bf16 v[164:167], a[236:239], v[44:47], v[164:167]
    ds_write_b64 v12, v[76:77] offset:3072
    v_mfma_f32_16x16x32_bf16 v[164:167], a[248:251], v[48:51], v[164:167]
    v_mfma_f32_16x16x32_bf16 v[164:167], v[172:175], v[52:55], v[164:167]
    v_mfma_f32_16x16x32_bf16 v[164:167], v[184:187], v[56:59], v[164:167]
    v_mfma_f32_16x16x32_bf16 v[164:167], v[196:199], v[60:63], v[164:167]
    v_mfma_f32_16x16x32_bf16 v[164:167], v[208:211], v[64:67], v[164:167]
    v_mfma_f32_16x16x32_bf16 v[164:167], v[220:223], v[68:71], v[164:167]
    v_mfma_f32_16x16x32_bf16 v[164:167], v[232:235], v[72:75], v[164:167]
    v_cvt_pk_bf16_f32 v78, v160, v161
    v_mfma_f32_16x16x32_bf16 v[132:135], a[108:111], v[40:43], v[108:111]
    v_cvt_pk_bf16_f32 v79, v162, v163
    v_mfma_f32_16x16x32_bf16 v[132:135], a[120:123], v[44:47], v[132:135]
    ds_write_b64 v13, v[78:79] offset:3072
    v_mfma_f32_16x16x32_bf16 v[132:135], a[132:135], v[48:51], v[132:135]
    v_mfma_f32_16x16x32_bf16 v[132:135], a[144:147], v[52:55], v[132:135]
    v_mfma_f32_16x16x32_bf16 v[132:135], a[156:159], v[56:59], v[132:135]
    v_mfma_f32_16x16x32_bf16 v[132:135], a[168:171], v[60:63], v[132:135]
    v_mfma_f32_16x16x32_bf16 v[132:135], a[180:183], v[64:67], v[132:135]
    v_mfma_f32_16x16x32_bf16 v[132:135], a[192:195], v[68:71], v[132:135]
    v_mfma_f32_16x16x32_bf16 v[132:135], a[204:207], v[72:75], v[132:135]
    v_cvt_pk_bf16_f32 v80, v164, v165
    v_mfma_f32_16x16x32_bf16 v[136:139], a[112:115], v[40:43], v[112:115]
    v_cvt_pk_bf16_f32 v81, v166, v167
    v_mfma_f32_16x16x32_bf16 v[136:139], a[124:127], v[44:47], v[136:139]
    ds_write_b64 v14, v[80:81] offset:3072
    v_mfma_f32_16x16x32_bf16 v[136:139], a[136:139], v[48:51], v[136:139]
    v_add_u32 v243, 1, v243
    v_mfma_f32_16x16x32_bf16 v[136:139], a[148:151], v[52:55], v[136:139]
    s_add_u32 s63, s63, 1
    v_mfma_f32_16x16x32_bf16 v[136:139], a[160:163], v[56:59], v[136:139]
    s_waitcnt vmcnt(11)
    ds_write_b32 v242, v243
    v_mfma_f32_16x16x32_bf16 v[136:139], a[172:175], v[60:63], v[136:139]
    v_mfma_f32_16x16x32_bf16 v[136:139], a[184:187], v[64:67], v[136:139]
    v_mfma_f32_16x16x32_bf16 v[136:139], a[196:199], v[68:71], v[136:139]
    v_mfma_f32_16x16x32_bf16 v[136:139], a[208:211], v[72:75], v[136:139]
    v_mfma_f32_16x16x32_bf16 v[140:143], a[116:119], v[40:43], v[116:119]
    v_mfma_f32_16x16x32_bf16 v[140:143], a[128:131], v[44:47], v[140:143]
    v_mfma_f32_16x16x32_bf16 v[140:143], a[140:143], v[48:51], v[140:143]
    v_mfma_f32_16x16x32_bf16 v[140:143], a[152:155], v[52:55], v[140:143]
    v_mfma_f32_16x16x32_bf16 v[140:143], a[164:167], v[56:59], v[140:143]
    v_mfma_f32_16x16x32_bf16 v[140:143], a[176:179], v[60:63], v[140:143]
    v_mfma_f32_16x16x32_bf16 v[140:143], a[188:191], v[64:67], v[140:143]
    v_mfma_f32_16x16x32_bf16 v[140:143], a[200:203], v[68:71], v[140:143]
    v_mfma_f32_16x16x32_bf16 v[140:143], a[212:215], v[72:75], v[140:143]
    v_mfma_f32_16x16x32_bf16 v[108:111], a[0:3], v[40:43], 0
    v_mfma_f32_16x16x32_bf16 v[108:111], a[12:15], v[44:47], v[108:111]
    v_mfma_f32_16x16x32_bf16 v[108:111], a[24:27], v[48:51], v[108:111]
    v_mfma_f32_16x16x32_bf16 v[112:115], a[4:7], v[40:43], 0
    ds_read_b128 v[236:239], v244
    v_mfma_f32_16x16x32_bf16 v[112:115], a[16:19], v[44:47], v[112:115]
    v_mfma_f32_16x16x32_bf16 v[112:115], a[28:31], v[48:51], v[112:115]
    v_mfma_f32_16x16x32_bf16 v[116:119], a[8:11], v[40:43], 0
    v_mfma_f32_16x16x32_bf16 v[116:119], a[20:23], v[44:47], v[116:119]
    v_mfma_f32_16x16x32_bf16 v[116:119], a[32:35], v[48:51], v[116:119]
    s_waitcnt lgkmcnt(0)
    v_min3_u32 v245, v236, v237, v238
    v_mfma_f32_16x16x32_bf16 v[108:111], a[36:39], v[52:55], v[108:111]
    v_min_u32 v245, v245, v239
    v_mfma_f32_16x16x32_bf16 v[108:111], a[48:51], v[56:59], v[108:111]
    v_readfirstlane_b32 s57, v245
    v_mfma_f32_16x16x32_bf16 v[108:111], a[60:63], v[60:63], v[108:111]
    s_cmp_ge_u32 s57, s63
    s_cbranch_scc0 L_slow
L_back:
    v_mfma_f32_16x16x32_bf16 v[112:115], a[40:43], v[52:55], v[112:115]
    ds_read_b128 v[40:43], v9 offset:0
    v_mfma_f32_16x16x32_bf16 v[112:115], a[52:55], v[56:59], v[112:115]
    ds_read_b128 v[44:47], v9 offset:64
    v_mfma_f32_16x16x32_bf16 v[112:115], a[64:67], v[60:63], v[112:115]
    ds_read_b128 v[48:51], v9 offset:128
    v_mfma_f32_16x16x32_bf16 v[116:119], a[44:47], v[52:55], v[116:119]
    ds_read_b128 v[52:55], v10 offset:0
    v_mfma_f32_16x16x32_bf16 v[116:119], a[56:59], v[56:59], v[116:119]
    ds_read_b128 v[56:59], v10 offset:64
    v_mfma_f32_16x16x32_bf16 v[116:119], a[68:71], v[60:63], v[116:119]
    ds_read_b128 v[60:63], v10 offset:128
    v_mfma_f32_16x16x32_bf16 v[108:111], a[72:75], v[64:67], v[108:111]
    v_mfma_f32_16x16x32_bf16 v[108:111], a[84:87], v[68:71], v[108:111]
    v_mfma_f32_16x16x32_bf16 v[108:111], a[96:99], v[72:75], v[108:111]
    s_sub_u32 s36, s36, 1
    v_mfma_f32_16x16x32_bf16 v[112:115], a[76:79], v[64:67], v[112:115]
    s_cmp_lg_u32 s36, 0
    v_mfma_f32_16x16x32_bf16 v[112:115], a[88:91], v[68:71], v[112:115]
    v_mfma_f32_16x16x32_bf16 v[112:115], a[100:103], v[72:75], v[112:115]
    v_mfma_f32_16x16x32_bf16 v[116:119], a[80:83], v[64:67], v[116:119]
    ds_read_b128 v[64:67], v11 offset:0
    v_mfma_f32_16x16x32_bf16 v[116:119], a[92:95], v[68:71], v[116:119]
    ds_read_b128 v[68:71], v11 offset:64
    v_mfma_f32_16x16x32_bf16 v[116:119], a[104:107], v[72:75], v[116:119]
    ds_read_b128 v[72:75], v11 offset:128
    s_cbranch_scc1 L_loop
    s_waitcnt lgkmcnt(6)
    v_mfma_f32_16x16x32_bf16 v[144:147], a[216:219], v[40:43], v[120:123]
    v_xor_b32 v12, 0x4000, v12
    v_mfma_f32_16x16x32_bf16 v[144:147], a[228:231], v[44:47], v[144:147]
    v_xor_b32 v13, 0x4000, v13
    v_mfma_f32_16x16x32_bf16 v[144:147], a[240:243], v[48:51], v[144:147]
    v_xor_b32 v14, 0x4000, v14
    s_waitcnt lgkmcnt(3)
    v_mfma_f32_16x16x32_bf16 v[144:147], a[252:255], v[52:55], v[144:147]
    v_mfma_f32_16x16x32_bf16 v[144:147], v[176:179], v[56:59], v[144:147]
    v_mfma_f32_16x16x32_bf16 v[144:147], v[188:191], v[60:63], v[144:147]
    s_waitcnt lgkmcnt(0)
    v_mfma_f32_16x16x32_bf16 v[144:147], v[200:203], v[64:67], v[144:147]
    ds_read_b128 v[84:87], v15
    v_mfma_f32_16x16x32_bf16 v[144:147], v[212:215], v[68:71], v[144:147]
    ds_read_b128 v[88:91], v16
    v_mfma_f32_16x16x32_bf16 v[144:147], v[224:227], v[72:75], v[144:147]
    ds_read_b128 v[92:95], v17
    v_mfma_f32_16x16x32_bf16 v[148:151], a[220:223], v[40:43], v[124:127]
    v_xor_b32 v15, 0x4000, v15
    v_mfma_f32_16x16x32_bf16 v[148:151], a[232:235], v[44:47], v[148:151]
    v_xor_b32 v16, 0x4000, v16
    v_mfma_f32_16x16x32_bf16 v[148:151], a[244:247], v[48:51], v[148:151]
    v_xor_b32 v17, 0x4000, v17
    v_mfma_f32_16x16x32_bf16 v[148:151], v[168:171], v[52:55], v[148:151]
    s_waitcnt lgkmcnt(2)
    buffer_store_dwordx4 v[84:87], v18, s[20:23], s35 offen offset:0 nt
    v_mfma_f32_16x16x32_bf16 v[148:151], v[180:183], v[56:59], v[148:151]
    v_mfma_f32_16x16x32_bf16 v[148:151], v[192:195], v[60:63], v[148:151]
    v_mfma_f32_16x16x32_bf16 v[148:151], v[204:207], v[64:67], v[148:151]
    v_mfma_f32_16x16x32_bf16 v[148:151], v[216:219], v[68:71], v[148:151]
    v_mfma_f32_16x16x32_bf16 v[148:151], v[228:231], v[72:75], v[148:151]
    v_cvt_pk_bf16_f32 v76, v144, v145
    v_mfma_f32_16x16x32_bf16 v[152:155], a[224:227], v[40:43], v[128:131]
    v_cvt_pk_bf16_f32 v77, v146, v147
    v_mfma_f32_16x16x32_bf16 v[152:155], a[236:239], v[44:47], v[152:155]
    ds_write_b64 v12, v[76:77] offset:0
    v_mfma_f32_16x16x32_bf16 v[152:155], a[248:251], v[48:51], v[152:155]
    s_waitcnt lgkmcnt(2)
    buffer_store_dwordx4 v[88:91], v18, s[20:23], s35 offen offset:1024 nt
    v_mfma_f32_16x16x32_bf16 v[152:155], v[172:175], v[52:55], v[152:155]
    v_mfma_f32_16x16x32_bf16 v[152:155], v[184:187], v[56:59], v[152:155]
    v_mfma_f32_16x16x32_bf16 v[152:155], v[196:199], v[60:63], v[152:155]
    v_mfma_f32_16x16x32_bf16 v[152:155], v[208:211], v[64:67], v[152:155]
    v_mfma_f32_16x16x32_bf16 v[152:155], v[220:223], v[68:71], v[152:155]
    v_mfma_f32_16x16x32_bf16 v[152:155], v[232:235], v[72:75], v[152:155]
    v_cvt_pk_bf16_f32 v78, v148, v149
    v_mfma_f32_16x16x32_bf16 v[120:123], a[108:111], v[40:43], v[96:99]
    v_cvt_pk_bf16_f32 v79, v150, v151
    v_mfma_f32_16x16x32_bf16 v[120:123], a[120:123], v[44:47], v[120:123]
    s_waitcnt lgkmcnt(1)
    buffer_store_dwordx4 v[92:95], v18, s[20:23], s35 offen offset:2048 nt
    ds_write_b64 v13, v[78:79] offset:0
    v_mfma_f32_16x16x32_bf16 v[120:123], a[132:135], v[48:51], v[120:123]
    s_add_u32 s35, s35, 196608
    v_mfma_f32_16x16x32_bf16 v[124:127], a[112:115], v[40:43], v[100:103]
    v_mfma_f32_16x16x32_bf16 v[124:127], a[124:127], v[44:47], v[124:127]
    v_mfma_f32_16x16x32_bf16 v[124:127], a[136:139], v[48:51], v[124:127]
    v_mfma_f32_16x16x32_bf16 v[128:131], a[116:119], v[40:43], v[104:107]
    ds_read_b128 v[40:43], v9 offset:3072
    v_mfma_f32_16x16x32_bf16 v[128:131], a[128:131], v[44:47], v[128:131]
    ds_read_b128 v[44:47], v9 offset:3136
    v_mfma_f32_16x16x32_bf16 v[128:131], a[140:143], v[48:51], v[128:131]
    v_cvt_pk_bf16_f32 v80, v152, v153
    ds_read_b128 v[48:51], v9 offset:3200
    v_mfma_f32_16x16x32_bf16 v[120:123], a[144:147], v[52:55], v[120:123]
    v_cvt_pk_bf16_f32 v81, v154, v155
    v_mfma_f32_16x16x32_bf16 v[120:123], a[156:159], v[56:59], v[120:123]
    ds_write_b64 v14, v[80:81] offset:0
    v_mfma_f32_16x16x32_bf16 v[120:123], a[168:171], v[60:63], v[120:123]
    v_mfma_f32_16x16x32_bf16 v[124:127], a[148:151], v[52:55], v[124:127]
    v_mfma_f32_16x16x32_bf16 v[124:127], a[160:163], v[56:59], v[124:127]
    v_mfma_f32_16x16x32_bf16 v[124:127], a[172:175], v[60:63], v[124:127]
    v_mfma_f32_16x16x32_bf16 v[128:131], a[152:155], v[52:55], v[128:131]
    ds_read_b128 v[52:55], v10 offset:3072
    v_mfma_f32_16x16x32_bf16 v[128:131], a[164:167], v[56:59], v[128:131]
    ds_read_b128 v[56:59], v10 offset:3136
    v_mfma_f32_16x16x32_bf16 v[128:131], a[176:179], v[60:63], v[128:131]
    ds_read_b128 v[60:63], v10 offset:3200
    v_mfma_f32_16x16x32_bf16 v[120:123], a[180:183], v[64:67], v[120:123]
    v_mfma_f32_16x16x32_bf16 v[120:123], a[192:195], v[68:71], v[120:123]
    v_mfma_f32_16x16x32_bf16 v[120:123], a[204:207], v[72:75], v[120:123]
    v_mfma_f32_16x16x32_bf16 v[124:127], a[184:187], v[64:67], v[124:127]
    v_mfma_f32_16x16x32_bf16 v[124:127], a[196:199], v[68:71], v[124:127]
    v_mfma_f32_16x16x32_bf16 v[124:127], a[208:211], v[72:75], v[124:127]
    v_mfma_f32_16x16x32_bf16 v[128:131], a[188:191], v[64:67], v[128:131]
    ds_read_b128 v[64:67], v11 offset:3072
    v_mfma_f32_16x16x32_bf16 v[128:131], a[200:203], v[68:71], v[128:131]
    ds_read_b128 v[68:71], v11 offset:3136
    v_mfma_f32_16x16x32_bf16 v[128:131], a[212:215], v[72:75], v[128:131]
    ds_read_b128 v[72:75], v11 offset:3200
    s_waitcnt lgkmcnt(7)
    v_mfma_f32_16x16x32_bf16 v[156:159], a[216:219], v[40:43], v[132:135]
    v_mfma_f32_16x16x32_bf16 v[156:159], a[228:231], v[44:47], v[156:159]
    v_mfma_f32_16x16x32_bf16 v[156:159], a[240:243], v[48:51], v[156:159]
    s_waitcnt lgkmcnt(3)
    v_mfma_f32_16x16x32_bf16 v[156:159], a[252:255], v[52:55], v[156:159]
    v_mfma_f32_16x16x32_bf16 v[156:159], v[176:179], v[56:59], v[156:159]
    v_mfma_f32_16x16x32_bf16 v[156:159], v[188:191], v[60:63], v[156:159]
    s_waitcnt lgkmcnt(0)
    v_mfma_f32_16x16x32_bf16 v[156:159], v[200:203], v[64:67], v[156:159]
    v_mfma_f32_16x16x32_bf16 v[156:159], v[212:215], v[68:71], v[156:159]
    v_mfma_f32_16x16x32_bf16 v[156:159], v[224:227], v[72:75], v[156:159]
    v_mfma_f32_16x16x32_bf16 v[160:163], a[220:223], v[40:43], v[136:139]
    s_add_u32 s30, s30, 13312
    v_mfma_f32_16x16x32_bf16 v[160:163], a[232:235], v[44:47], v[160:163]
    s_cmp_eq_u32 s30, 53248
    s_cselect_b32 s30, 0, s30
    v_mfma_f32_16x16x32_bf16 v[160:163], a[244:247], v[48:51], v[160:163]
    v_add_u32 v9, s30, v6
    v_mfma_f32_16x16x32_bf16 v[160:163], v[168:171], v[52:55], v[160:163]
    v_add_u32 v10, s30, v7
    v_mfma_f32_16x16x32_bf16 v[160:163], v[180:183], v[56:59], v[160:163]
    v_add_u32 v11, s30, v8
    v_mfma_f32_16x16x32_bf16 v[160:163], v[192:195], v[60:63], v[160:163]
    v_mfma_f32_16x16x32_bf16 v[160:163], v[204:207], v[64:67], v[160:163]
    v_mfma_f32_16x16x32_bf16 v[160:163], v[216:219], v[68:71], v[160:163]
    v_mfma_f32_16x16x32_bf16 v[160:163], v[228:231], v[72:75], v[160:163]
    v_cvt_pk_bf16_f32 v76, v156, v157
    v_mfma_f32_16x16x32_bf16 v[164:167], a[224:227], v[40:43], v[140:143]
    v_cvt_pk_bf16_f32 v77, v158, v159
    v_mfma_f32_16x16x32_bf16 v[164:167], a[236:239], v[44:47], v[164:167]
    ds_write_b64 v12, v[76:77] offset:3072
    v_mfma_f32_16x16x32_bf16 v[164:167], a[248:251], v[48:51], v[164:167]
    v_mfma_f32_16x16x32_bf16 v[164:167], v[172:175], v[52:55], v[164:167]
    v_mfma_f32_16x16x32_bf16 v[164:167], v[184:187], v[56:59], v[164:167]
    v_mfma_f32_16x16x32_bf16 v[164:167], v[196:199], v[60:63], v[164:167]
    v_mfma_f32_16x16x32_bf16 v[164:167], v[208:211], v[64:67], v[164:167]
    v_mfma_f32_16x16x32_bf16 v[164:167], v[220:223], v[68:71], v[164:167]
    v_mfma_f32_16x16x32_bf16 v[164:167], v[232:235], v[72:75], v[164:167]
    v_cvt_pk_bf16_f32 v78, v160, v161
    v_mfma_f32_16x16x32_bf16 v[132:135], a[108:111], v[40:43], v[108:111]
    v_cvt_pk_bf16_f32 v79, v162, v163
    v_mfma_f32_16x16x32_bf16 v[132:135], a[120:123], v[44:47], v[132:135]
    ds_write_b64 v13, v[78:79] offset:3072
    v_mfma_f32_16x16x32_bf16 v[132:135], a[132:135], v[48:51], v[132:135]
    v_mfma_f32_16x16x32_bf16 v[136:139], a[112:115], v[40:43], v[112:115]
    v_mfma_f32_16x16x32_bf16 v[136:139], a[124:127], v[44:47], v[136:139]
    v_mfma_f32_16x16x32_bf16 v[136:139], a[136:139], v[48:51], v[136:139]
    s_waitcnt vmcnt(10)
    s_barrier
    v_mfma_f32_16x16x32_bf16 v[140:143], a[116:119], v[40:43], v[116:119]
    ds_read_b128 v[40:43], v9 offset:0
    v_mfma_f32_16x16x32_bf16 v[140:143], a[128:131], v[44:47], v[140:143]
    ds_read_b128 v[44:47], v9 offset:64
    v_mfma_f32_16x16x32_bf16 v[140:143], a[140:143], v[48:51], v[140:143]
    v_cvt_pk_bf16_f32 v80, v164, v165
    ds_read_b128 v[48:51], v9 offset:128
    v_mfma_f32_16x16x32_bf16 v[132:135], a[144:147], v[52:55], v[132:135]
    v_cvt_pk_bf16_f32 v81, v166, v167
    v_mfma_f32_16x16x32_bf16 v[132:135], a[156:159], v[56:59], v[132:135]
    ds_write_b64 v14, v[80:81] offset:3072
    v_mfma_f32_16x16x32_bf16 v[132:135], a[168:171], v[60:63], v[132:135]
    v_mfma_f32_16x16x32_bf16 v[136:139], a[148:151], v[52:55], v[136:139]
    v_mfma_f32_16x16x32_bf16 v[136:139], a[160:163], v[56:59], v[136:139]
    v_mfma_f32_16x16x32_bf16 v[136:139], a[172:175], v[60:63], v[136:139]
    v_mfma_f32_16x16x32_bf16 v[140:143], a[152:155], v[52:55], v[140:143]
    ds_read_b128 v[52:55], v10 offset:0
    v_mfma_f32_16x16x32_bf16 v[140:143], a[164:167], v[56:59], v[140:143]
    ds_read_b128 v[56:59], v10 offset:64
    v_mfma_f32_16x16x32_bf16 v[140:143], a[176:179], v[60:63], v[140:143]
    ds_read_b128 v[60:63], v10 offset:128
    v_mfma_f32_16x16x32_bf16 v[132:135], a[180:183], v[64:67], v[132:135]
    v_mfma_f32_16x16x32_bf16 v[132:135], a[192:195], v[68:71], v[132:135]
    v_mfma_f32_16x16x32_bf16 v[132:135], a[204:207], v[72:75], v[132:135]
    v_mfma_f32_16x16x32_bf16 v[136:139], a[184:187], v[64:67], v[136:139]
    v_mfma_f32_16x16x32_bf16 v[136:139], a[196:199], v[68:71], v[136:139]
    v_mfma_f32_16x16x32_bf16 v[136:139], a[208:211], v[72:75], v[136:139]
    v_mfma_f32_16x16x32_bf16 v[140:143], a[188:191], v[64:67], v[140:143]
    ds_read_b128 v[64:67], v11 offset:0
    v_mfma_f32_16x16x32_bf16 v[140:143], a[200:203], v[68:71], v[140:143]
    ds_read_b128 v[68:71], v11 offset:64
    v_mfma_f32_16x16x32_bf16 v[140:143], a[212:215], v[72:75], v[140:143]
    ds_read_b128 v[72:75], v11 offset:128
    s_waitcnt lgkmcnt(7)
    v_mfma_f32_16x16x32_bf16 v[144:147], a[216:219], v[40:43], v[120:123]
    v_xor_b32 v12, 0x4000, v12
    v_mfma_f32_16x16x32_bf16 v[144:147], a[228:231], v[44:47], v[144:147]
    v_xor_b32 v13, 0x4000, v13
    v_mfma_f32_16x16x32_bf16 v[144:147], a[240:243], v[48:51], v[144:147]
    v_xor_b32 v14, 0x4000, v14
    s_waitcnt lgkmcnt(3)
    v_mfma_f32_16x16x32_bf16 v[144:147], a[252:255], v[52:55], v[144:147]
    v_mfma_f32_16x16x32_bf16 v[144:147], v[176:179], v[56:59], v[144:147]
    v_mfma_f32_16x16x32_bf16 v[144:147], v[188:191], v[60:63], v[144:147]
    s_barrier
    s_waitcnt lgkmcnt(0)
    v_mfma_f32_16x16x32_bf16 v[144:147], v[200:203], v[64:67], v[144:147]
    ds_read_b128 v[84:87], v15
    v_mfma_f32_16x16x32_bf16 v[144:147], v[212:215], v[68:71], v[144:147]
    ds_read_b128 v[88:91], v16
    v_mfma_f32_16x16x32_bf16 v[144:147], v[224:227], v[72:75], v[144:147]
    ds_read_b128 v[92:95], v17
    v_mfma_f32_16x16x32_bf16 v[148:151], a[220:223], v[40:43], v[124:127]
    v_xor_b32 v15, 0x4000, v15
    v_mfma_f32_16x16x32_bf16 v[148:151], a[232:235], v[44:47], v[148:151]
    v_xor_b32 v16, 0x4000, v16
    v_mfma_f32_16x16x32_bf16 v[148:151], a[244:247], v[48:51], v[148:151]
    v_xor_b32 v17, 0x4000, v17
    v_mfma_f32_16x16x32_bf16 v[148:151], v[168:171], v[52:55], v[148:151]
    s_waitcnt lgkmcnt(2)
    buffer_store_dwordx4 v[84:87], v18, s[20:23], s35 offen offset:0 nt
    v_mfma_f32_16x16x32_bf16 v[148:151], v[180:183], v[56:59], v[148:151]
    v_mfma_f32_16x16x32_bf16 v[148:151], v[192:195], v[60:63], v[148:151]
    v_mfma_f32_16x16x32_bf16 v[148:151], v[204:207], v[64:67], v[148:151]
    v_mfma_f32_16x16x32_bf16 v[148:151], v[216:219], v[68:71], v[148:151]
    v_mfma_f32_16x16x32_bf16 v[148:151], v[228:231], v[72:75], v[148:151]
    v_cvt_pk_bf16_f32 v76, v144, v145
    v_mfma_f32_16x16x32_bf16 v[152:155], a[224:227], v[40:43], v[128:131]
    ds_read_b128 v[40:43], v9 offset:3072
    v_cvt_pk_bf16_f32 v77, v146, v147
    v_mfma_f32_16x16x32_bf16 v[152:155], a[236:239], v[44:47], v[152:155]
    ds_read_b128 v[44:47], v9 offset:3136
    ds_write_b64 v12, v[76:77] offset:0
    v_mfma_f32_16x16x32_bf16 v[152:155], a[248:251], v[48:51], v[152:155]
    s_waitcnt lgkmcnt(4)
    buffer_store_dwordx4 v[88:91], v18, s[20:23], s35 offen offset:1024 nt
    ds_read_b128 v[48:51], v9 offset:3200
    v_mfma_f32_16x16x32_bf16 v[152:155], v[172:175], v[52:55], v[152:155]
    ds_read_b128 v[52:55], v10 offset:3072
    v_mfma_f32_16x16x32_bf16 v[152:155], v[184:187], v[56:59], v[152:155]
    ds_read_b128 v[56:59], v10 offset:3136
    v_mfma_f32_16x16x32_bf16 v[152:155], v[196:199], v[60:63], v[152:155]
    ds_read_b128 v[60:63], v10 offset:3200
    v_mfma_f32_16x16x32_bf16 v[152:155], v[208:211], v[64:67], v[152:155]
    ds_read_b128 v[64:67], v11 offset:3072
    v_mfma_f32_16x16x32_bf16 v[152:155], v[220:223], v[68:71], v[152:155]
    ds_read_b128 v[68:71], v11 offset:3136
    v_mfma_f32_16x16x32_bf16 v[152:155], v[232:235], v[72:75], v[152:155]
    ds_read_b128 v[72:75], v11 offset:3200
    v_cvt_pk_bf16_f32 v78, v148, v149
    s_waitcnt lgkmcnt(6)
    v_mfma_f32_16x16x32_bf16 v[156:159], a[216:219], v[40:43], v[132:135]
    v_cvt_pk_bf16_f32 v79, v150, v151
    v_mfma_f32_16x16x32_bf16 v[156:159], a[228:231], v[44:47], v[156:159]
    buffer_store_dwordx4 v[92:95], v18, s[20:23], s35 offen offset:2048 nt
    ds_write_b64 v13, v[78:79] offset:0
    v_mfma_f32_16x16x32_bf16 v[156:159], a[240:243], v[48:51], v[156:159]
    s_add_u32 s35, s35, 196608
    s_waitcnt lgkmcnt(4)
    v_mfma_f32_16x16x32_bf16 v[156:159], a[252:255], v[52:55], v[156:159]
    v_mfma_f32_16x16x32_bf16 v[156:159], v[176:179], v[56:59], v[156:159]
    v_mfma_f32_16x16x32_bf16 v[156:159], v[188:191], v[60:63], v[156:159]
    s_waitcnt lgkmcnt(1)
    v_mfma_f32_16x16x32_bf16 v[156:159], v[200:203], v[64:67], v[156:159]
    v_mfma_f32_16x16x32_bf16 v[156:159], v[212:215], v[68:71], v[156:159]
    v_mfma_f32_16x16x32_bf16 v[156:159], v[224:227], v[72:75], v[156:159]
    v_cvt_pk_bf16_f32 v80, v152, v153
    v_mfma_f32_16x16x32_bf16 v[160:163], a[220:223], v[40:43], v[136:139]
    v_cvt_pk_bf16_f32 v81, v154, v155
    v_mfma_f32_16x16x32_bf16 v[160:163], a[232:235], v[44:47], v[160:163]
    ds_write_b64 v14, v[80:81] offset:0
    v_mfma_f32_16x16x32_bf16 v[160:163], a[244:247], v[48:51], v[160:163]
    v_mfma_f32_16x16x32_bf16 v[160:163], v[168:171], v[52:55], v[160:163]
    v_mfma_f32_16x16x32_bf16 v[160:163], v[180:183], v[56:59], v[160:163]
    v_mfma_f32_16x16x32_bf16 v[160:163], v[192:195], v[60:63], v[160:163]
    v_mfma_f32_16x16x32_bf16 v[160:163], v[204:207], v[64:67], v[160:163]
    v_mfma_f32_16x16x32_bf16 v[160:163], v[216:219], v[68:71], v[160:163]
    v_mfma_f32_16x16x32_bf16 v[160:163], v[228:231], v[72:75], v[160:163]
    v_cvt_pk_bf16_f32 v76, v156, v157
    v_mfma_f32_16x16x32_bf16 v[164:167], a[224:227], v[40:43], v[140:143]
    v_cvt_pk_bf16_f32 v77, v158, v159
    v_mfma_f32_16x16x32_bf16 v[164:167], a[236:239], v[44:47], v[164:167]
    ds_write_b64 v12, v[76:77] offset:3072
    v_mfma_f32_16x16x32_bf16 v[164:167], a[248:251], v[48:51], v[164:167]
    v_mfma_f32_16x16x32_bf16 v[164:167], v[172:175], v[52:55], v[164:167]
    v_mfma_f32_16x16x32_bf16 v[164:167], v[184:187], v[56:59], v[164:167]
    v_mfma_f32_16x16x32_bf16 v[164:167], v[196:199], v[60:63], v[164:167]
    v_mfma_f32_16x16x32_bf16 v[164:167], v[208:211], v[64:67], v[164:167]
    v_mfma_f32_16x16x32_bf16 v[164:167], v[220:223], v[68:71], v[164:167]
    v_mfma_f32_16x16x32_bf16 v[164:167], v[232:235], v[72:75], v[164:167]
    v_cvt_pk_bf16_f32 v78, v160, v161
    s_nop 7
    v_cvt_pk_bf16_f32 v79, v162, v163
    ds_write_b64 v13, v[78:79] offset:3072
    v_cvt_pk_bf16_f32 v80, v164, v165
    v_cvt_pk_bf16_f32 v81, v166, v167
    ds_write_b64 v14, v[80:81] offset:3072
    s_waitcnt lgkmcnt(0)
    s_barrier
    ds_read_b128 v[84:87], v15
    ds_read_b128 v[88:91], v16
    ds_read_b128 v[92:95], v17
    s_waitcnt lgkmcnt(2)
    buffer_store_dwordx4 v[84:87], v18, s[20:23], s35 offen offset:0 nt
    s_waitcnt lgkmcnt(1)
    buffer_store_dwordx4 v[88:91], v18, s[20:23], s35 offen offset:1024 nt
    s_waitcnt lgkmcnt(0)
    buffer_store_dwordx4 v[92:95], v18, s[20:23], s35 offen offset:2048 nt
L_end:
    s_endpgm
L_slow:
    s_mov_b32 s38, 0
L_slow2:
    ds_read_b128 v[236:239], v244
    s_waitcnt lgkmcnt(0)
    v_min3_u32 v245, v236, v237, v238
    v_min_u32 v245, v245, v239
    s_add_u32 s38, s38, 1
    v_readfirstlane_b32 s57, v245
    s_cmp_gt_u32 s38, 0x20000
    s_cbranch_scc1 L_back
    s_cmp_ge_u32 s57, s63
    s_cbranch_scc0 L_slow2
    s_branch L_back
.section .rodata,"a"
.p2align 6
.amdhsa_kernel standalone__dilated_atrous__vision_kernel
  .amdhsa_next_free_vgpr 512
  .amdhsa_next_free_sgpr 100
  .amdhsa_accum_offset 256
  .amdhsa_group_segment_fixed_size 0
  .amdhsa_kernarg_size 40
  .amdhsa_user_sgpr_count 2
  .amdhsa_user_sgpr_kernarg_segment_ptr 1
  .amdhsa_system_sgpr_workgroup_id_x 1
.end_amdhsa_kernel
```

```asm
; @launch grid=(256,1,1) block=(256,1,1) lds=163840
.amdgcn_target "amdgcn-amd-amdhsa--gfx950"
.text
.globl standalone__dilated_atrous__vision_kernel
.p2align 8
.type standalone__dilated_atrous__vision_kernel,@function
standalone__dilated_atrous__vision_kernel:
    s_cmp_ge_u32 s2, 256
    s_cbranch_scc1 L_end
    s_load_dwordx4 s[4:7], s[0:1], 0
    s_load_dwordx2 s[8:9], s[0:1], 16
    v_lshrrev_b32 v29, 6, v0
    s_and_b32 s37, s2, 7
    v_readfirstlane_b32 s24, v29
    s_lshr_b32 s38, s2, 3
    s_and_b32 s38, s38, 1
    s_lshr_b32 s39, s2, 4
    s_lshl_b32 s39, s39, 5
    s_add_u32 s25, s39, s38
    s_mul_i32 s40, s37, 12288
    s_sub_u32 s41, s40, 384
    v_mul_u32_u24 v31, 43691, v0
    v_lshlrev_b32 v32, 4, v0
    v_lshrrev_b32 v31, 19, v31
    v_and_b32 v33, 4, v31
    v_and_b32 v34, 8, v31
    v_lshlrev_b32 v33, 3, v33
    v_lshlrev_b32 v34, 2, v34
    v_xor_b32 v33, v33, v32
    v_xor_b32 v19, v34, v32
    v_add_u32 v2, s41, v33
    v_add_u32 v30, 256, v0
    v_mul_u32_u24 v31, 43691, v30
    v_lshlrev_b32 v32, 4, v30
    v_lshrrev_b32 v31, 19, v31
    v_and_b32 v33, 4, v31
    v_and_b32 v34, 8, v31
    v_lshlrev_b32 v33, 3, v33
    v_lshlrev_b32 v34, 2, v34
    v_xor_b32 v33, v33, v32
    v_xor_b32 v20, v34, v32
    v_add_u32 v3, s41, v33
    v_add_u32 v30, 512, v0
    v_mul_u32_u24 v31, 43691, v30
    v_lshlrev_b32 v32, 4, v30
    v_lshrrev_b32 v31, 19, v31
    v_and_b32 v33, 4, v31
    v_and_b32 v34, 8, v31
    v_lshlrev_b32 v33, 3, v33
    v_lshlrev_b32 v34, 2, v34
    v_xor_b32 v33, v33, v32
    v_xor_b32 v21, v34, v32
    v_add_u32 v4, s41, v33
    s_cmp_eq_u32 s37, 0
    s_cselect_b32 s42, 24, 0
    v_mov_b32 v35, 0x80000000
    v_cmp_gt_u32 vcc, s42, v0
    v_and_b32 v36, 63, v0
    s_lshl_b32 s26, s24, 10
    v_cndmask_b32 v2, v2, v35, vcc
    s_add_u32 s27, s26, 4096
    s_add_u32 s28, s26, 8192
    s_mov_b32 s29, 12288
    s_cmp_eq_u32 s37, 7
    s_cselect_b32 s45, 24, 48
    s_add_u32 s44, s41, 12288
    v_cmp_gt_u32 vcc, s45, v36
    v_lshlrev_b32 v29, 4, v36
    v_add_u32 v29, s44, v29
    v_cndmask_b32 v5, v35, v29, vcc
    s_lshl_b32 s47, s24, 9
    s_mul_i32 s43, s24, 192
    s_add_u32 s62, s43, 12288
    s_add_u32 s44, s41, s62
    s_lshl_b32 s45, s37, 2
    s_add_u32 s45, s45, s24
    s_cmp_ge_u32 s45, 30
    s_cselect_b32 s44, 0x80000000, s44
    v_lshlrev_b32 v29, 4, v36
    v_add_u32 v1, s44, v29
    s_lshr_b32 s45, s2, 3
    s_lshl_b32 s45, s45, 2
    s_add_u32 s45, s45, s24
    s_mul_i32 s45, s45, 1408
    v_lshl_add_u32 v39, v36, 7, s45
    s_mov_b32 s33, s25
    s_mul_i32 s32, s33, 98304
    s_add_u32 s34, s25, 33
    s_min_u32 s34, s34, 512
    s_mov_b32 s14, 50331648
    s_mov_b32 s15, 0x20000
    s_mov_b32 s18, 165888
    s_mov_b32 s19, 0x20000
    s_mov_b32 s30, 0
    s_mov_b32 s31, 0
    s_waitcnt lgkmcnt(0)
    s_mov_b32 s12, s4
    s_and_b32 s13, s5, 0xffff
    s_mov_b32 s16, s6
    s_and_b32 s17, s7, 0xffff
    s_mov_b64 exec, 0x7ff
    buffer_load_dword v38, v39, s[16:19], 0 offen
    s_mov_b64 exec, -1
    s_add_u32 m0, s31, s26
    s_nop 0
    buffer_load_dwordx4 v2, s[12:15], s32 offen nt lds
    s_add_u32 m0, s31, s27
    s_nop 0
    buffer_load_dwordx4 v3, s[12:15], s32 offen nt lds
    s_add_u32 m0, s31, s28
    s_nop 0
    buffer_load_dwordx4 v4, s[12:15], s32 offen nt lds
    s_add_u32 m0, s31, s62
    s_nop 0
    s_mov_b64 exec, 0xfff
    buffer_load_dwordx4 v1, s[12:15], s32 offen nt lds
    s_mov_b64 exec, -1
    s_mov_b32 s16, s6
    s_and_b32 s17, s7, 0xffff
    s_lshl_b32 s42, s24, 5
    s_add_u32 s42, s42, 3328
    v_add_u32 v30, s42, v36
    v_mul_u32_u24 v31, 43691, v30
    v_lshlrev_b32 v32, 4, v30
    v_lshrrev_b32 v31, 19, v31
    v_and_b32 v34, 8, v31
    v_lshlrev_b32 v34, 2, v34
    v_xor_b32 v22, v34, v32
    s_add_u32 m0, s26, 53248
    s_mov_b32 s46, 0
    buffer_load_dwordx4 v19, s[16:19], s46 offen lds
    s_add_u32 m0, s26, 57344
    s_nop 0
    buffer_load_dwordx4 v20, s[16:19], s46 offen lds
    s_add_u32 m0, s26, 61440
    s_nop 0
    buffer_load_dwordx4 v21, s[16:19], s46 offen lds
    s_add_u32 m0, s26, 65536
    s_mov_b32 s46, 12288
    buffer_load_dwordx4 v19, s[16:19], s46 offen lds
    s_add_u32 m0, s26, 69632
    s_nop 0
    buffer_load_dwordx4 v20, s[16:19], s46 offen lds
    v_and_b32 v29, 15, v36
    v_lshrrev_b32 v30, 4, v36
    s_lshr_b32 s42, s24, 1
    s_and_b32 s43, s24, 1
    s_lshl_b32 s42, s42, 5
    s_mul_i32 s43, s43, 96
    v_lshlrev_b32 v31, 4, v30
    v_add_u32 v32, s42, v29
    v_and_b32 v33, 4, v32
    v_mul_u32_u24 v34, 192, v32
    v_lshlrev_b32 v33, 3, v33
    v_xor_b32 v33, v33, v31
    v_add_u32 v6, v34, v33
    v_mov_b32 v9, v6
    v_add_u32 v32, s42, v29
    v_add_u32 v32, 2, v32
    v_and_b32 v33, 4, v32
    v_mul_u32_u24 v34, 192, v32
    v_lshlrev_b32 v33, 3, v33
    v_xor_b32 v33, v33, v31
    v_add_u32 v7, v34, v33
    v_mov_b32 v10, v7
    v_add_u32 v32, s42, v29
    v_add_u32 v32, 4, v32
    v_and_b32 v33, 4, v32
    v_mul_u32_u24 v34, 192, v32
    v_lshlrev_b32 v33, 3, v33
    v_xor_b32 v33, v33, v31
    v_add_u32 v8, v34, v33
    v_mov_b32 v11, v8
    v_lshrrev_b32 v32, 2, v29
    v_lshl_add_u32 v32, v30, 3, v32
    v_mul_u32_u24 v32, 192, v32
    v_and_b32 v33, 3, v29
    v_lshlrev_b32 v33, 3, v33
    v_and_b32 v34, 1, v30
    v_lshlrev_b32 v34, 5, v34
    v_add_u32 v33, s43, v33
    v_add_u32 v35, 0, v33
    v_xor_b32 v35, v35, v34
    v_add_u32 v35, v35, v32
    v_add_u32 v23, 53248, v35
    v_add_u32 v26, 108544, v35
    v_add_u32 v35, 32, v33
    v_xor_b32 v35, v35, v34
    v_add_u32 v35, v35, v32
    v_add_u32 v24, 53248, v35
    v_add_u32 v27, 108544, v35
    v_add_u32 v35, 64, v33
    v_xor_b32 v35, v35, v34
    v_add_u32 v35, v35, v32
    v_add_u32 v25, 53248, v35
    v_add_u32 v28, 108544, v35
    v_add_u32 v32, s42, v29
    v_mul_u32_u24 v32, 192, v32
    v_add_u32 v32, 65536, v32
    v_lshlrev_b32 v33, 3, v29
    v_and_b32 v33, 0x30, v33
    v_lshlrev_b32 v34, 3, v30
    v_add_u32 v34, s43, v34
    v_add_u32 v35, 0, v34
    v_xor_b32 v35, v35, v33
    v_add_u32 v12, v35, v32
    v_add_u32 v35, 32, v34
    v_xor_b32 v35, v35, v33
    v_add_u32 v13, v35, v32
    v_add_u32 v35, 64, v34
    v_xor_b32 v35, v35, v33
    v_add_u32 v14, v35, v32
    s_mul_i32 s44, s24, 192
    v_add_u32 v32, s44, v36
    v_mul_u32_u24 v33, 43691, v32
    v_lshlrev_b32 v34, 4, v32
    v_lshrrev_b32 v33, 16, v33
    v_and_b32 v33, 0x30, v33
    v_xor_b32 v34, v34, v33
    v_add_u32 v15, 65536, v34
    v_add_u32 v32, s44, v36
    v_add_u32 v32, 64, v32
    v_mul_u32_u24 v33, 43691, v32
    v_lshlrev_b32 v34, 4, v32
    v_lshrrev_b32 v33, 16, v33
    v_and_b32 v33, 0x30, v33
    v_xor_b32 v34, v34, v33
    v_add_u32 v16, 65536, v34
    v_add_u32 v32, s44, v36
    v_add_u32 v32, 128, v32
    v_mul_u32_u24 v33, 43691, v32
    v_lshlrev_b32 v34, 4, v32
    v_lshrrev_b32 v33, 16, v33
    v_and_b32 v33, 0x30, v33
    v_xor_b32 v34, v34, v33
    v_add_u32 v17, 65536, v34
    s_lshl_b32 s45, s24, 8
    v_lshlrev_b32 v32, 2, v36
    v_add_u32 v32, s45, v32
    v_add_u32 v242, 108608, v32
    s_lshl_b32 s45, s24, 2
    s_add_u32 s45, s45, 108544
    v_cmp_eq_u32 vcc, 0, v36
    v_mov_b32 v32, s45
    v_mov_b32 v244, 108544
    v_cndmask_b32 v242, v242, v32, vcc
    v_mov_b32 v243, 2
    s_mov_b32 s63, 2
    s_mul_i32 s45, s24, 3072
    s_add_u32 s45, s45, s40
    v_lshlrev_b32 v32, 4, v36
    v_add_u32 v18, s45, v32
    s_mov_b32 s20, s8
    s_and_b32 s21, s9, 0xffff
    s_mov_b32 s22, 50331648
    s_mov_b32 s23, 0x20000
    s_mul_i32 s35, s25, 98304
    s_add_u32 m0, s26, 73728
    s_nop 0
    buffer_load_dwordx4 v21, s[16:19], s46 offen lds
    s_add_u32 m0, s26, 77824
    s_mov_b32 s46, 24576
    buffer_load_dwordx4 v19, s[16:19], s46 offen lds
    s_add_u32 m0, s26, 81920
    s_nop 0
    buffer_load_dwordx4 v20, s[16:19], s46 offen lds
    s_add_u32 m0, s26, 86016
    s_nop 0
    buffer_load_dwordx4 v21, s[16:19], s46 offen lds
    s_waitcnt vmcnt(4)
    s_barrier
    ds_read_b128 v[40:43], v6 offset:0
    ds_read_b64_tr_b16 a[0:1], v23 offset:0
    ds_read_b64_tr_b16 a[2:3], v23 offset:768
    ds_read_b128 v[44:47], v6 offset:64
    ds_read_b64_tr_b16 a[12:13], v23 offset:6144
    ds_read_b64_tr_b16 a[14:15], v23 offset:6912
    ds_read_b128 v[48:51], v6 offset:128
    ds_read_b64_tr_b16 a[24:25], v23 offset:12288
    ds_read_b64_tr_b16 a[26:27], v23 offset:13056
    ds_read_b64_tr_b16 a[4:5], v24 offset:0
    ds_read_b64_tr_b16 a[6:7], v24 offset:768
    s_waitcnt lgkmcnt(2)
    v_mfma_f32_16x16x32_bf16 v[120:123], a[0:3], v[40:43], 0
    s_add_u32 m0, s26, 90112
    s_mov_b32 s46, 36864
    ds_read_b64_tr_b16 a[16:17], v24 offset:6144
    ds_read_b64_tr_b16 a[18:19], v24 offset:6912
    v_mfma_f32_16x16x32_bf16 v[120:123], a[12:15], v[44:47], v[120:123]
    ds_read_b128 v[84:87], v6 offset:3072
    buffer_load_dwordx4 v19, s[16:19], s46 offen lds
    s_add_u32 m0, s26, 94208
    ds_read_b64_tr_b16 a[28:29], v24 offset:12288
    ds_read_b64_tr_b16 a[30:31], v24 offset:13056
    v_mfma_f32_16x16x32_bf16 v[120:123], a[24:27], v[48:51], v[120:123]
    ds_read_b128 v[88:91], v6 offset:3136
    buffer_load_dwordx4 v20, s[16:19], s46 offen lds
    s_add_u32 m0, s26, 98304
    ds_read_b64_tr_b16 a[8:9], v25 offset:0
    ds_read_b64_tr_b16 a[10:11], v25 offset:768
    s_waitcnt lgkmcnt(3)
    v_mfma_f32_16x16x32_bf16 v[124:127], a[4:7], v[40:43], 0
    ds_read_b128 v[92:95], v6 offset:3200
    buffer_load_dwordx4 v21, s[16:19], s46 offen lds
    s_add_u32 m0, s26, 102400
    s_mov_b32 s46, 49152
    ds_read_b64_tr_b16 a[20:21], v25 offset:6144
    ds_read_b64_tr_b16 a[22:23], v25 offset:6912
    v_mfma_f32_16x16x32_bf16 v[124:127], a[16:19], v[44:47], v[124:127]
    buffer_load_dwordx4 v19, s[16:19], s46 offen lds
    s_add_u32 m0, s47, 106496
    s_mov_b32 s46, 0
    ds_read_b64_tr_b16 a[32:33], v25 offset:12288
    ds_read_b64_tr_b16 a[34:35], v25 offset:13056
    v_mfma_f32_16x16x32_bf16 v[124:127], a[28:31], v[48:51], v[124:127]
    s_mov_b32 exec_hi, 0
    buffer_load_dwordx4 v22, s[16:19], s46 offen lds
    s_mov_b64 exec, -1
    s_waitcnt lgkmcnt(0)
    v_mfma_f32_16x16x32_bf16 v[128:131], a[8:11], v[40:43], 0
    s_add_u32 m0, s26, 108544
    s_mov_b32 s46, 55296
    v_mfma_f32_16x16x32_bf16 v[128:131], a[20:23], v[44:47], v[128:131]
    s_waitcnt vmcnt(5)
    s_barrier
    ds_read_b64_tr_b16 a[36:37], v23 offset:18432
    v_mfma_f32_16x16x32_bf16 v[128:131], a[32:35], v[48:51], v[128:131]
    ds_read_b64_tr_b16 a[38:39], v23 offset:19200
    buffer_load_dwordx4 v19, s[16:19], s46 offen lds
    v_mfma_f32_16x16x32_bf16 v[132:135], a[0:3], v[84:87], 0
    ds_read_b64_tr_b16 a[48:49], v23 offset:24576
    ds_read_b64_tr_b16 a[50:51], v23 offset:25344
    ds_read_b128 v[52:55], v7 offset:0
    v_mfma_f32_16x16x32_bf16 v[132:135], a[12:15], v[88:91], v[132:135]
    ds_read_b64_tr_b16 a[60:61], v23 offset:30720
    ds_read_b64_tr_b16 a[62:63], v23 offset:31488
    ds_read_b128 v[56:59], v7 offset:64
    v_mfma_f32_16x16x32_bf16 v[132:135], a[24:27], v[92:95], v[132:135]
    s_add_u32 m0, s26, 112640
    ds_read_b64_tr_b16 a[40:41], v24 offset:18432
    ds_read_b64_tr_b16 a[42:43], v24 offset:19200
    v_mfma_f32_16x16x32_bf16 v[136:139], a[4:7], v[84:87], 0
    ds_read_b128 v[60:63], v7 offset:128
    buffer_load_dwordx4 v20, s[16:19], s46 offen lds
    ds_read_b64_tr_b16 a[52:53], v24 offset:24576
    v_mfma_f32_16x16x32_bf16 v[136:139], a[16:19], v[88:91], v[136:139]
    ds_read_b64_tr_b16 a[54:55], v24 offset:25344
    ds_read_b64_tr_b16 a[64:65], v24 offset:30720
    ds_read_b64_tr_b16 a[66:67], v24 offset:31488
    v_mfma_f32_16x16x32_bf16 v[136:139], a[28:31], v[92:95], v[136:139]
    ds_read_b128 v[96:99], v7 offset:3072
    s_add_u32 m0, s26, 116736
    ds_read_b64_tr_b16 a[44:45], v25 offset:18432
    v_mfma_f32_16x16x32_bf16 v[140:143], a[8:11], v[84:87], 0
    ds_read_b64_tr_b16 a[46:47], v25 offset:19200
    ds_read_b128 v[100:103], v7 offset:3136
    buffer_load_dwordx4 v21, s[16:19], s46 offen lds
    v_mfma_f32_16x16x32_bf16 v[140:143], a[20:23], v[88:91], v[140:143]
    ds_read_b64_tr_b16 a[56:57], v25 offset:24576
    ds_read_b64_tr_b16 a[58:59], v25 offset:25344
    ds_read_b128 v[104:107], v7 offset:3200
    v_mfma_f32_16x16x32_bf16 v[140:143], a[32:35], v[92:95], v[140:143]
    ds_read_b64_tr_b16 a[68:69], v25 offset:30720
    ds_read_b64_tr_b16 a[70:71], v25 offset:31488
    s_waitcnt lgkmcnt(13)
    v_mfma_f32_16x16x32_bf16 v[120:123], a[36:39], v[52:55], v[120:123]
    s_add_u32 m0, s26, 120832
    s_mov_b32 s46, 67584
    buffer_load_dwordx4 v19, s[16:19], s46 offen lds
    v_mfma_f32_16x16x32_bf16 v[120:123], a[48:51], v[56:59], v[120:123]
    s_add_u32 m0, s26, 124928
    v_mfma_f32_16x16x32_bf16 v[120:123], a[60:63], v[60:63], v[120:123]
    buffer_load_dwordx4 v20, s[16:19], s46 offen lds
    s_add_u32 m0, s26, 129024
    s_waitcnt lgkmcnt(9)
    v_mfma_f32_16x16x32_bf16 v[124:127], a[40:43], v[52:55], v[124:127]
    buffer_load_dwordx4 v21, s[16:19], s46 offen lds
    v_mfma_f32_16x16x32_bf16 v[124:127], a[52:55], v[56:59], v[124:127]
    s_add_u32 m0, s26, 133120
    s_mov_b32 s46, 79872
    v_mfma_f32_16x16x32_bf16 v[124:127], a[64:67], v[60:63], v[124:127]
    s_waitcnt vmcnt(6)
    s_barrier
    s_waitcnt lgkmcnt(0)
    v_mfma_f32_16x16x32_bf16 v[128:131], a[44:47], v[52:55], v[128:131]
    ds_read_b64_tr_b16 a[72:73], v23 offset:36864
    ds_read_b64_tr_b16 a[74:75], v23 offset:37632
    buffer_load_dwordx4 v19, s[16:19], s46 offen lds
    v_mfma_f32_16x16x32_bf16 v[128:131], a[56:59], v[56:59], v[128:131]
    ds_read_b64_tr_b16 a[84:85], v23 offset:43008
    ds_read_b64_tr_b16 a[86:87], v23 offset:43776
    ds_read_b128 v[64:67], v8 offset:0
    v_mfma_f32_16x16x32_bf16 v[128:131], a[68:71], v[60:63], v[128:131]
    ds_read_b64_tr_b16 a[96:97], v23 offset:49152
    ds_read_b64_tr_b16 a[98:99], v23 offset:49920
    v_mfma_f32_16x16x32_bf16 v[132:135], a[36:39], v[96:99], v[132:135]
    ds_read_b128 v[68:71], v8 offset:64
    s_add_u32 m0, s26, 137216
    ds_read_b64_tr_b16 a[76:77], v24 offset:36864
    v_mfma_f32_16x16x32_bf16 v[132:135], a[48:51], v[100:103], v[132:135]
    ds_read_b64_tr_b16 a[78:79], v24 offset:37632
    ds_read_b128 v[72:75], v8 offset:128
    buffer_load_dwordx4 v20, s[16:19], s46 offen lds
    v_mfma_f32_16x16x32_bf16 v[132:135], a[60:63], v[104:107], v[132:135]
    ds_read_b64_tr_b16 a[88:89], v24 offset:43008
    ds_read_b64_tr_b16 a[90:91], v24 offset:43776
    ds_read_b64_tr_b16 a[100:101], v24 offset:49152
    v_mfma_f32_16x16x32_bf16 v[136:139], a[40:43], v[96:99], v[136:139]
    ds_read_b64_tr_b16 a[102:103], v24 offset:49920
    ds_read_b128 v[108:111], v8 offset:3072
    s_add_u32 m0, s26, 141312
    v_mfma_f32_16x16x32_bf16 v[136:139], a[52:55], v[100:103], v[136:139]
    ds_read_b64_tr_b16 a[80:81], v25 offset:36864
    ds_read_b64_tr_b16 a[82:83], v25 offset:37632
    ds_read_b128 v[112:115], v8 offset:3136
    v_mfma_f32_16x16x32_bf16 v[136:139], a[64:67], v[104:107], v[136:139]
    buffer_load_dwordx4 v21, s[16:19], s46 offen lds
    ds_read_b64_tr_b16 a[92:93], v25 offset:43008
    ds_read_b64_tr_b16 a[94:95], v25 offset:43776
    v_mfma_f32_16x16x32_bf16 v[140:143], a[44:47], v[96:99], v[140:143]
    ds_read_b128 v[116:119], v8 offset:3200
    ds_read_b64_tr_b16 a[104:105], v25 offset:49152
    ds_read_b64_tr_b16 a[106:107], v25 offset:49920
    v_mfma_f32_16x16x32_bf16 v[140:143], a[56:59], v[100:103], v[140:143]
    s_add_u32 m0, s26, 145408
    s_mov_b32 s46, 92160
    buffer_load_dwordx4 v19, s[16:19], s46 offen lds
    v_mfma_f32_16x16x32_bf16 v[140:143], a[68:71], v[104:107], v[140:143]
    s_add_u32 m0, s26, 149504
    s_waitcnt lgkmcnt(13)
    v_mfma_f32_16x16x32_bf16 v[120:123], a[72:75], v[64:67], v[120:123]
    buffer_load_dwordx4 v20, s[16:19], s46 offen lds
    v_mfma_f32_16x16x32_bf16 v[120:123], a[84:87], v[68:71], v[120:123]
    s_add_u32 m0, s26, 153600
    v_mfma_f32_16x16x32_bf16 v[120:123], a[96:99], v[72:75], v[120:123]
    buffer_load_dwordx4 v21, s[16:19], s46 offen lds
    s_waitcnt lgkmcnt(9)
    v_mfma_f32_16x16x32_bf16 v[124:127], a[76:79], v[64:67], v[124:127]
    v_mfma_f32_16x16x32_bf16 v[124:127], a[88:91], v[68:71], v[124:127]
    s_add_u32 m0, s26, 157696
    s_mov_b32 s46, 104448
    v_mfma_f32_16x16x32_bf16 v[124:127], a[100:103], v[72:75], v[124:127]
    s_waitcnt vmcnt(7)
    s_barrier
    s_waitcnt lgkmcnt(0)
    v_mfma_f32_16x16x32_bf16 v[128:131], a[80:83], v[64:67], v[128:131]
    ds_read_b64_tr_b16 a[108:109], v26 offset:0
    ds_read_b64_tr_b16 a[110:111], v26 offset:768
    buffer_load_dwordx4 v19, s[16:19], s46 offen lds
    v_mfma_f32_16x16x32_bf16 v[128:131], a[92:95], v[68:71], v[128:131]
    ds_read_b64_tr_b16 a[120:121], v26 offset:6144
    ds_read_b64_tr_b16 a[122:123], v26 offset:6912
    ds_read_b64_tr_b16 a[132:133], v26 offset:12288
    v_mfma_f32_16x16x32_bf16 v[128:131], a[104:107], v[72:75], v[128:131]
    ds_read_b64_tr_b16 a[134:135], v26 offset:13056
    s_add_u32 m0, s47, 161792
    v_mfma_f32_16x16x32_bf16 v[132:135], a[72:75], v[108:111], v[132:135]
    s_mov_b32 s46, 55296
    ds_read_b64_tr_b16 a[112:113], v27 offset:0
    ds_read_b64_tr_b16 a[114:115], v27 offset:768
    v_mfma_f32_16x16x32_bf16 v[132:135], a[84:87], v[112:115], v[132:135]
    s_mov_b32 exec_hi, 0
    buffer_load_dwordx4 v22, s[16:19], s46 offen lds
    s_mov_b64 exec, -1
    v_mfma_f32_16x16x32_bf16 v[132:135], a[96:99], v[116:119], v[132:135]
    ds_read_b64_tr_b16 a[124:125], v27 offset:6144
    ds_read_b64_tr_b16 a[126:127], v27 offset:6912
    ds_read_b64_tr_b16 a[136:137], v27 offset:12288
    v_mfma_f32_16x16x32_bf16 v[136:139], a[76:79], v[108:111], v[136:139]
    ds_read_b64_tr_b16 a[138:139], v27 offset:13056
    s_add_u32 s32, s32, 196608
    s_add_u32 s33, s33, 2
    v_mfma_f32_16x16x32_bf16 v[136:139], a[88:91], v[112:115], v[136:139]
    s_cmp_lt_u32 s33, s34
    s_cselect_b32 s14, 50331648, 0
    s_add_u32 s31, s31, 13312
    v_mfma_f32_16x16x32_bf16 v[136:139], a[100:103], v[116:119], v[136:139]
    s_cmp_eq_u32 s31, 53248
    s_cselect_b32 s31, 0, s31
    ds_read_b64_tr_b16 a[116:117], v28 offset:0
    v_mfma_f32_16x16x32_bf16 v[140:143], a[80:83], v[108:111], v[140:143]
    ds_read_b64_tr_b16 a[118:119], v28 offset:768
    s_add_u32 m0, s31, s26
    ds_read_b64_tr_b16 a[128:129], v28 offset:6144
    v_mfma_f32_16x16x32_bf16 v[140:143], a[92:95], v[112:115], v[140:143]
    ds_read_b64_tr_b16 a[130:131], v28 offset:6912
    buffer_load_dwordx4 v2, s[12:15], s32 offen nt lds
    ds_read_b64_tr_b16 a[140:141], v28 offset:12288
    v_mfma_f32_16x16x32_bf16 v[140:143], a[104:107], v[116:119], v[140:143]
    ds_read_b64_tr_b16 a[142:143], v28 offset:13056
    s_add_u32 m0, s31, s27
    s_waitcnt lgkmcnt(12)
    v_mfma_f32_16x16x32_bf16 v[144:147], a[108:111], v[40:43], 0
    buffer_load_dwordx4 v3, s[12:15], s32 offen nt lds
    s_add_u32 m0, s31, s28
    v_mfma_f32_16x16x32_bf16 v[144:147], a[120:123], v[44:47], v[144:147]
    buffer_load_dwordx4 v4, s[12:15], s32 offen nt lds
    v_mfma_f32_16x16x32_bf16 v[144:147], a[132:135], v[48:51], v[144:147]
    s_add_u32 m0, s31, s29
    s_waitcnt lgkmcnt(6)
    v_mfma_f32_16x16x32_bf16 v[148:151], a[112:115], v[40:43], 0
    buffer_load_dwordx4 v5, s[12:15], s32 offen nt lds
    v_mfma_f32_16x16x32_bf16 v[148:151], a[124:127], v[44:47], v[148:151]
    v_mfma_f32_16x16x32_bf16 v[148:151], a[136:139], v[48:51], v[148:151]
    s_waitcnt vmcnt(9)
    s_barrier
    s_waitcnt lgkmcnt(0)
    v_mfma_f32_16x16x32_bf16 v[152:155], a[116:119], v[40:43], 0
    ds_read_b64_tr_b16 a[144:145], v26 offset:18432
    ds_read_b64_tr_b16 a[146:147], v26 offset:19200
    s_add_u32 m0, s26, 53248
    v_mfma_f32_16x16x32_bf16 v[152:155], a[128:131], v[44:47], v[152:155]
    s_mov_b32 s46, 110592
    ds_read_b64_tr_b16 a[156:157], v26 offset:24576
    ds_read_b64_tr_b16 a[158:159], v26 offset:25344
    v_mfma_f32_16x16x32_bf16 v[152:155], a[140:143], v[48:51], v[152:155]
    buffer_load_dwordx4 v19, s[16:19], s46 offen lds
    ds_read_b64_tr_b16 a[168:169], v26 offset:30720
    ds_read_b64_tr_b16 a[170:171], v26 offset:31488
    v_mfma_f32_16x16x32_bf16 v[156:159], a[108:111], v[84:87], 0
    ds_read_b64_tr_b16 a[148:149], v27 offset:18432
    ds_read_b64_tr_b16 a[150:151], v27 offset:19200
    s_add_u32 m0, s26, 57344
    v_mfma_f32_16x16x32_bf16 v[156:159], a[120:123], v[88:91], v[156:159]
    ds_read_b64_tr_b16 a[160:161], v27 offset:24576
    ds_read_b64_tr_b16 a[162:163], v27 offset:25344
    buffer_load_dwordx4 v20, s[16:19], s46 offen lds
    v_mfma_f32_16x16x32_bf16 v[156:159], a[132:135], v[92:95], v[156:159]
    ds_read_b64_tr_b16 a[172:173], v27 offset:30720
    ds_read_b64_tr_b16 a[174:175], v27 offset:31488
    ds_read_b64_tr_b16 a[152:153], v28 offset:18432
    v_mfma_f32_16x16x32_bf16 v[160:163], a[112:115], v[84:87], 0
    ds_read_b64_tr_b16 a[154:155], v28 offset:19200
    s_add_u32 m0, s26, 61440
    ds_read_b64_tr_b16 a[164:165], v28 offset:24576
    v_mfma_f32_16x16x32_bf16 v[160:163], a[124:127], v[88:91], v[160:163]
    ds_read_b64_tr_b16 a[166:167], v28 offset:25344
    buffer_load_dwordx4 v21, s[16:19], s46 offen lds
    ds_read_b64_tr_b16 a[176:177], v28 offset:30720
    v_mfma_f32_16x16x32_bf16 v[160:163], a[136:139], v[92:95], v[160:163]
    ds_read_b64_tr_b16 a[178:179], v28 offset:31488
    s_add_u32 m0, s26, 65536
    s_mov_b32 s46, 122880
    v_mfma_f32_16x16x32_bf16 v[164:167], a[116:119], v[84:87], 0
    buffer_load_dwordx4 v19, s[16:19], s46 offen lds
    v_mfma_f32_16x16x32_bf16 v[164:167], a[128:131], v[88:91], v[164:167]
    v_mfma_f32_16x16x32_bf16 v[164:167], a[140:143], v[92:95], v[164:167]
    s_add_u32 m0, s26, 69632
    s_waitcnt lgkmcnt(12)
    v_mfma_f32_16x16x32_bf16 v[144:147], a[144:147], v[52:55], v[144:147]
    buffer_load_dwordx4 v20, s[16:19], s46 offen lds
    v_mfma_f32_16x16x32_bf16 v[144:147], a[156:159], v[56:59], v[144:147]
    v_mfma_f32_16x16x32_bf16 v[144:147], a[168:171], v[60:63], v[144:147]
    s_add_u32 m0, s26, 73728
    s_waitcnt lgkmcnt(6)
    v_mfma_f32_16x16x32_bf16 v[148:151], a[148:151], v[52:55], v[148:151]
    buffer_load_dwordx4 v21, s[16:19], s46 offen lds
    v_mfma_f32_16x16x32_bf16 v[148:151], a[160:163], v[56:59], v[148:151]
    v_mfma_f32_16x16x32_bf16 v[148:151], a[172:175], v[60:63], v[148:151]
    s_waitcnt vmcnt(10)
    s_barrier
    s_waitcnt lgkmcnt(0)
    v_mfma_f32_16x16x32_bf16 v[152:155], a[152:155], v[52:55], v[152:155]
    ds_read_b64_tr_b16 a[180:181], v26 offset:36864
    ds_read_b64_tr_b16 a[182:183], v26 offset:37632
    s_add_u32 m0, s26, 77824
    v_mfma_f32_16x16x32_bf16 v[152:155], a[164:167], v[56:59], v[152:155]
    s_mov_b32 s46, 135168
    ds_read_b64_tr_b16 a[192:193], v26 offset:43008
    ds_read_b64_tr_b16 a[194:195], v26 offset:43776
    v_mfma_f32_16x16x32_bf16 v[152:155], a[176:179], v[60:63], v[152:155]
    buffer_load_dwordx4 v19, s[16:19], s46 offen lds
    ds_read_b64_tr_b16 a[204:205], v26 offset:49152
    ds_read_b64_tr_b16 a[206:207], v26 offset:49920
    v_mfma_f32_16x16x32_bf16 v[156:159], a[144:147], v[96:99], v[156:159]
    ds_read_b64_tr_b16 a[184:185], v27 offset:36864
    ds_read_b64_tr_b16 a[186:187], v27 offset:37632
    s_add_u32 m0, s26, 81920
    v_mfma_f32_16x16x32_bf16 v[156:159], a[156:159], v[100:103], v[156:159]
    ds_read_b64_tr_b16 a[196:197], v27 offset:43008
    ds_read_b64_tr_b16 a[198:199], v27 offset:43776
    buffer_load_dwordx4 v20, s[16:19], s46 offen lds
    v_mfma_f32_16x16x32_bf16 v[156:159], a[168:171], v[104:107], v[156:159]
    ds_read_b64_tr_b16 a[208:209], v27 offset:49152
    ds_read_b64_tr_b16 a[210:211], v27 offset:49920
    ds_read_b64_tr_b16 a[188:189], v28 offset:36864
    v_mfma_f32_16x16x32_bf16 v[160:163], a[148:151], v[96:99], v[160:163]
    ds_read_b64_tr_b16 a[190:191], v28 offset:37632
    s_add_u32 m0, s26, 86016
    s_add_u32 s30, s30, 13312
    v_mfma_f32_16x16x32_bf16 v[160:163], a[160:163], v[100:103], v[160:163]
    ds_read_b64_tr_b16 a[200:201], v28 offset:43008
    ds_read_b64_tr_b16 a[202:203], v28 offset:43776
    buffer_load_dwordx4 v21, s[16:19], s46 offen lds
    v_mfma_f32_16x16x32_bf16 v[160:163], a[172:175], v[104:107], v[160:163]
    s_cmp_eq_u32 s30, 53248
    s_cselect_b32 s30, 0, s30
    ds_read_b64_tr_b16 a[212:213], v28 offset:49152
    v_mfma_f32_16x16x32_bf16 v[164:167], a[152:155], v[96:99], v[164:167]
    ds_read_b64_tr_b16 a[214:215], v28 offset:49920
    v_add_u32 v9, s30, v6
    s_add_u32 m0, s26, 90112
    v_mfma_f32_16x16x32_bf16 v[164:167], a[164:167], v[100:103], v[164:167]
    s_mov_b32 s46, 147456
    v_add_u32 v10, s30, v7
    buffer_load_dwordx4 v19, s[16:19], s46 offen lds
    v_mfma_f32_16x16x32_bf16 v[164:167], a[176:179], v[104:107], v[164:167]
    v_add_u32 v11, s30, v8
    s_add_u32 m0, s26, 94208
    s_waitcnt lgkmcnt(12)
    v_mfma_f32_16x16x32_bf16 v[144:147], a[180:183], v[64:67], v[144:147]
    buffer_load_dwordx4 v20, s[16:19], s46 offen lds
    v_mfma_f32_16x16x32_bf16 v[144:147], a[192:195], v[68:71], v[144:147]
    v_mfma_f32_16x16x32_bf16 v[144:147], a[204:207], v[72:75], v[144:147]
    s_add_u32 m0, s26, 98304
    s_waitcnt lgkmcnt(6)
    v_mfma_f32_16x16x32_bf16 v[148:151], a[184:187], v[64:67], v[148:151]
    buffer_load_dwordx4 v21, s[16:19], s46 offen lds
    v_mfma_f32_16x16x32_bf16 v[148:151], a[196:199], v[68:71], v[148:151]
    v_mfma_f32_16x16x32_bf16 v[148:151], a[208:211], v[72:75], v[148:151]
    s_add_u32 m0, s26, 102400
    s_mov_b32 s46, 159744
    s_waitcnt lgkmcnt(0)
    v_mfma_f32_16x16x32_bf16 v[152:155], a[188:191], v[64:67], v[152:155]
    s_waitcnt vmcnt(12)
    s_barrier
    buffer_load_dwordx4 v19, s[16:19], s46 offen lds
    v_mfma_f32_16x16x32_bf16 v[152:155], a[200:203], v[68:71], v[152:155]
    ds_read_b128 v[40:43], v9 offset:0
    ds_read_b128 v[44:47], v9 offset:64
    v_mfma_f32_16x16x32_bf16 v[152:155], a[212:215], v[72:75], v[152:155]
    s_add_u32 m0, s47, 106496
    s_mov_b32 s46, 110592
    ds_read_b128 v[48:51], v9 offset:128
    v_mfma_f32_16x16x32_bf16 v[156:159], a[180:183], v[108:111], v[156:159]
    s_mov_b32 exec_hi, 0
    buffer_load_dwordx4 v22, s[16:19], s46 offen lds
    s_mov_b64 exec, -1
    v_mfma_f32_16x16x32_bf16 v[156:159], a[192:195], v[112:115], v[156:159]
    ds_read_b128 v[52:55], v10 offset:0
    ds_read_b128 v[56:59], v10 offset:64
    v_mfma_f32_16x16x32_bf16 v[156:159], a[204:207], v[116:119], v[156:159]
    ds_read_b128 v[60:63], v10 offset:128
    v_mfma_f32_16x16x32_bf16 v[160:163], a[184:187], v[108:111], v[160:163]
    ds_read_b128 v[64:67], v11 offset:0
    v_mfma_f32_16x16x32_bf16 v[160:163], a[196:199], v[112:115], v[160:163]
    ds_read_b128 v[68:71], v11 offset:64
    v_mfma_f32_16x16x32_bf16 v[160:163], a[208:211], v[116:119], v[160:163]
    ds_read_b128 v[72:75], v11 offset:128
    v_mfma_f32_16x16x32_bf16 v[164:167], a[188:191], v[108:111], v[164:167]
    v_mfma_f32_16x16x32_bf16 v[164:167], a[200:203], v[112:115], v[164:167]
    v_mfma_f32_16x16x32_bf16 v[164:167], a[212:215], v[116:119], v[164:167]
    s_waitcnt lgkmcnt(6)
    v_mfma_f32_16x16x32_bf16 v[96:99], a[0:3], v[40:43], 0
    v_mfma_f32_16x16x32_bf16 v[96:99], a[12:15], v[44:47], v[96:99]
    v_mfma_f32_16x16x32_bf16 v[96:99], a[24:27], v[48:51], v[96:99]
    v_mfma_f32_16x16x32_bf16 v[100:103], a[4:7], v[40:43], 0
    v_mfma_f32_16x16x32_bf16 v[100:103], a[16:19], v[44:47], v[100:103]
    v_mfma_f32_16x16x32_bf16 v[100:103], a[28:31], v[48:51], v[100:103]
    v_mfma_f32_16x16x32_bf16 v[104:107], a[8:11], v[40:43], 0
    v_mfma_f32_16x16x32_bf16 v[104:107], a[20:23], v[44:47], v[104:107]
    v_mfma_f32_16x16x32_bf16 v[104:107], a[32:35], v[48:51], v[104:107]
    s_waitcnt lgkmcnt(3)
    v_mfma_f32_16x16x32_bf16 v[96:99], a[36:39], v[52:55], v[96:99]
    v_mfma_f32_16x16x32_bf16 v[96:99], a[48:51], v[56:59], v[96:99]
    v_mfma_f32_16x16x32_bf16 v[96:99], a[60:63], v[60:63], v[96:99]
    s_sub_u32 s32, s32, 393216
    v_mfma_f32_16x16x32_bf16 v[100:103], a[40:43], v[52:55], v[100:103]
    s_sub_u32 s33, s33, 4
    v_mfma_f32_16x16x32_bf16 v[100:103], a[52:55], v[56:59], v[100:103]
    s_cmp_lt_u32 s33, s34
    s_cselect_b32 s14, 50331648, 0
    v_mfma_f32_16x16x32_bf16 v[100:103], a[64:67], v[60:63], v[100:103]
    s_add_u32 s31, s31, 13312
    v_mfma_f32_16x16x32_bf16 v[104:107], a[44:47], v[52:55], v[104:107]
    s_cmp_eq_u32 s31, 53248
    s_cselect_b32 s31, 0, s31
    v_mfma_f32_16x16x32_bf16 v[104:107], a[56:59], v[56:59], v[104:107]
    v_mfma_f32_16x16x32_bf16 v[104:107], a[68:71], v[60:63], v[104:107]
    s_waitcnt lgkmcnt(0)
    v_mfma_f32_16x16x32_bf16 v[96:99], a[72:75], v[64:67], v[96:99]
    s_add_u32 m0, s31, s26
    v_mfma_f32_16x16x32_bf16 v[96:99], a[84:87], v[68:71], v[96:99]
    buffer_load_dwordx4 v2, s[12:15], s32 offen nt lds
    v_mfma_f32_16x16x32_bf16 v[96:99], a[96:99], v[72:75], v[96:99]
    s_add_u32 m0, s31, s27
    v_mfma_f32_16x16x32_bf16 v[100:103], a[76:79], v[64:67], v[100:103]
    buffer_load_dwordx4 v3, s[12:15], s32 offen nt lds
    v_mfma_f32_16x16x32_bf16 v[100:103], a[88:91], v[68:71], v[100:103]
    s_add_u32 m0, s31, s28
    v_mfma_f32_16x16x32_bf16 v[100:103], a[100:103], v[72:75], v[100:103]
    buffer_load_dwordx4 v4, s[12:15], s32 offen nt lds
    v_mfma_f32_16x16x32_bf16 v[104:107], a[80:83], v[64:67], v[104:107]
    s_add_u32 m0, s31, s29
    v_mfma_f32_16x16x32_bf16 v[104:107], a[92:95], v[68:71], v[104:107]
    buffer_load_dwordx4 v5, s[12:15], s32 offen nt lds
    v_mfma_f32_16x16x32_bf16 v[104:107], a[104:107], v[72:75], v[104:107]
    v_mfma_f32_16x16x32_bf16 v[120:123], a[108:111], v[40:43], v[120:123]
    v_mfma_f32_16x16x32_bf16 v[120:123], a[120:123], v[44:47], v[120:123]
    v_mfma_f32_16x16x32_bf16 v[120:123], a[132:135], v[48:51], v[120:123]
    s_waitcnt vmcnt(4)
    s_barrier
    v_mfma_f32_16x16x32_bf16 v[120:123], a[144:147], v[52:55], v[120:123]
    ds_read_b64_tr_b16 a[216:217], v23 offset:0
    ds_read_b64_tr_b16 a[218:219], v23 offset:768
    v_mfma_f32_16x16x32_bf16 v[120:123], a[156:159], v[56:59], v[120:123]
    ds_read_b64_tr_b16 a[228:229], v23 offset:6144
    ds_read_b64_tr_b16 a[230:231], v23 offset:6912
    v_mfma_f32_16x16x32_bf16 v[120:123], a[168:171], v[60:63], v[120:123]
    ds_read_b64_tr_b16 a[240:241], v23 offset:12288
    v_mfma_f32_16x16x32_bf16 v[120:123], a[180:183], v[64:67], v[120:123]
    ds_read_b64_tr_b16 a[242:243], v23 offset:13056
    ds_read_b64_tr_b16 a[252:253], v23 offset:18432
    v_mfma_f32_16x16x32_bf16 v[120:123], a[192:195], v[68:71], v[120:123]
    ds_read_b64_tr_b16 a[254:255], v23 offset:19200
    ds_read_b64_tr_b16 v[176:177], v23 offset:24576
    v_mfma_f32_16x16x32_bf16 v[120:123], a[204:207], v[72:75], v[120:123]
    ds_read_b64_tr_b16 v[178:179], v23 offset:25344
    v_mfma_f32_16x16x32_bf16 v[124:127], a[112:115], v[40:43], v[124:127]
    ds_read_b64_tr_b16 v[188:189], v23 offset:30720
    ds_read_b64_tr_b16 v[190:191], v23 offset:31488
    v_mfma_f32_16x16x32_bf16 v[124:127], a[124:127], v[44:47], v[124:127]
    ds_read_b64_tr_b16 v[200:201], v23 offset:36864
    ds_read_b64_tr_b16 v[202:203], v23 offset:37632
    v_mfma_f32_16x16x32_bf16 v[124:127], a[136:139], v[48:51], v[124:127]
    ds_read_b64_tr_b16 v[212:213], v23 offset:43008
    s_waitcnt lgkmcnt(14)
    v_mfma_f32_16x16x32_bf16 v[124:127], a[148:151], v[52:55], v[124:127]
    ds_read_b64_tr_b16 v[214:215], v23 offset:43776
    ds_read_b64_tr_b16 v[224:225], v23 offset:49152
    v_mfma_f32_16x16x32_bf16 v[124:127], a[160:163], v[56:59], v[124:127]
    ds_read_b64_tr_b16 v[226:227], v23 offset:49920
    ds_read_b64_tr_b16 a[220:221], v24 offset:0
    v_mfma_f32_16x16x32_bf16 v[124:127], a[172:175], v[60:63], v[124:127]
    ds_read_b64_tr_b16 a[222:223], v24 offset:768
    s_waitcnt lgkmcnt(14)
    v_mfma_f32_16x16x32_bf16 v[124:127], a[184:187], v[64:67], v[124:127]
    ds_read_b64_tr_b16 a[232:233], v24 offset:6144
    ds_read_b64_tr_b16 a[234:235], v24 offset:6912
    v_mfma_f32_16x16x32_bf16 v[124:127], a[196:199], v[68:71], v[124:127]
    ds_read_b64_tr_b16 a[244:245], v24 offset:12288
    ds_read_b64_tr_b16 a[246:247], v24 offset:13056
    v_mfma_f32_16x16x32_bf16 v[124:127], a[208:211], v[72:75], v[124:127]
    ds_read_b64_tr_b16 v[168:169], v24 offset:18432
    s_waitcnt lgkmcnt(14)
    v_mfma_f32_16x16x32_bf16 v[128:131], a[116:119], v[40:43], v[128:131]
    ds_read_b64_tr_b16 v[170:171], v24 offset:19200
    ds_read_b64_tr_b16 v[180:181], v24 offset:24576
    v_mfma_f32_16x16x32_bf16 v[128:131], a[128:131], v[44:47], v[128:131]
    ds_read_b64_tr_b16 v[182:183], v24 offset:25344
    ds_read_b64_tr_b16 v[192:193], v24 offset:30720
    v_mfma_f32_16x16x32_bf16 v[128:131], a[140:143], v[48:51], v[128:131]
    ds_read_b64_tr_b16 v[194:195], v24 offset:31488
    s_waitcnt lgkmcnt(14)
    v_mfma_f32_16x16x32_bf16 v[128:131], a[152:155], v[52:55], v[128:131]
    ds_read_b64_tr_b16 v[204:205], v24 offset:36864
    ds_read_b64_tr_b16 v[206:207], v24 offset:37632
    v_mfma_f32_16x16x32_bf16 v[128:131], a[164:167], v[56:59], v[128:131]
    ds_read_b64_tr_b16 v[216:217], v24 offset:43008
    ds_read_b64_tr_b16 v[218:219], v24 offset:43776
    v_mfma_f32_16x16x32_bf16 v[128:131], a[176:179], v[60:63], v[128:131]
    ds_read_b64_tr_b16 v[228:229], v24 offset:49152
    s_waitcnt lgkmcnt(14)
    v_mfma_f32_16x16x32_bf16 v[128:131], a[188:191], v[64:67], v[128:131]
    ds_read_b64_tr_b16 v[230:231], v24 offset:49920
    ds_read_b64_tr_b16 a[224:225], v25 offset:0
    v_mfma_f32_16x16x32_bf16 v[128:131], a[200:203], v[68:71], v[128:131]
    ds_read_b64_tr_b16 a[226:227], v25 offset:768
    ds_read_b64_tr_b16 a[236:237], v25 offset:6144
    v_mfma_f32_16x16x32_bf16 v[128:131], a[212:215], v[72:75], v[128:131]
    ds_read_b64_tr_b16 a[238:239], v25 offset:6912
    s_waitcnt lgkmcnt(14)
    v_mfma_f32_16x16x32_bf16 v[144:147], a[216:219], v[40:43], v[144:147]
    ds_read_b64_tr_b16 a[248:249], v25 offset:12288
    ds_read_b64_tr_b16 a[250:251], v25 offset:13056
    v_mfma_f32_16x16x32_bf16 v[144:147], a[228:231], v[44:47], v[144:147]
    ds_read_b64_tr_b16 v[172:173], v25 offset:18432
    ds_read_b64_tr_b16 v[174:175], v25 offset:19200
    v_mfma_f32_16x16x32_bf16 v[144:147], a[240:243], v[48:51], v[144:147]
    ds_read_b64_tr_b16 v[184:185], v25 offset:24576
    s_waitcnt lgkmcnt(14)
    v_mfma_f32_16x16x32_bf16 v[144:147], a[252:255], v[52:55], v[144:147]
    ds_read_b64_tr_b16 v[186:187], v25 offset:25344
    ds_read_b64_tr_b16 v[196:197], v25 offset:30720
    v_mfma_f32_16x16x32_bf16 v[144:147], v[176:179], v[56:59], v[144:147]
    ds_read_b64_tr_b16 v[198:199], v25 offset:31488
    ds_read_b64_tr_b16 v[208:209], v25 offset:36864
    v_mfma_f32_16x16x32_bf16 v[144:147], v[188:191], v[60:63], v[144:147]
    ds_read_b64_tr_b16 v[210:211], v25 offset:37632
    s_waitcnt lgkmcnt(14)
    v_mfma_f32_16x16x32_bf16 v[144:147], v[200:203], v[64:67], v[144:147]
    ds_read_b64_tr_b16 v[220:221], v25 offset:43008
    ds_read_b64_tr_b16 v[222:223], v25 offset:43776
    v_mfma_f32_16x16x32_bf16 v[144:147], v[212:215], v[68:71], v[144:147]
    ds_read_b64_tr_b16 v[232:233], v25 offset:49152
    ds_read_b64_tr_b16 v[234:235], v25 offset:49920
    v_mfma_f32_16x16x32_bf16 v[144:147], v[224:227], v[72:75], v[144:147]
    s_waitcnt lgkmcnt(14)
    v_mfma_f32_16x16x32_bf16 v[148:151], a[220:223], v[40:43], v[148:151]
    v_mfma_f32_16x16x32_bf16 v[148:151], a[232:235], v[44:47], v[148:151]
    v_mfma_f32_16x16x32_bf16 v[148:151], a[244:247], v[48:51], v[148:151]
    v_mfma_f32_16x16x32_bf16 v[148:151], v[168:171], v[52:55], v[148:151]
    v_mfma_f32_16x16x32_bf16 v[148:151], v[180:183], v[56:59], v[148:151]
    v_mfma_f32_16x16x32_bf16 v[148:151], v[192:195], v[60:63], v[148:151]
    v_mfma_f32_16x16x32_bf16 v[148:151], v[204:207], v[64:67], v[148:151]
    v_mfma_f32_16x16x32_bf16 v[148:151], v[216:219], v[68:71], v[148:151]
    v_mfma_f32_16x16x32_bf16 v[148:151], v[228:231], v[72:75], v[148:151]
    s_waitcnt lgkmcnt(12)
    v_mfma_f32_16x16x32_bf16 v[152:155], a[224:227], v[40:43], v[152:155]
    ds_read_b128 v[40:43], v9 offset:3072
    v_mfma_f32_16x16x32_bf16 v[152:155], a[236:239], v[44:47], v[152:155]
    ds_read_b128 v[44:47], v9 offset:3136
    v_mfma_f32_16x16x32_bf16 v[152:155], a[248:251], v[48:51], v[152:155]
    ds_read_b128 v[48:51], v9 offset:3200
    s_waitcnt lgkmcnt(9)
    v_mfma_f32_16x16x32_bf16 v[152:155], v[172:175], v[52:55], v[152:155]
    ds_read_b128 v[52:55], v10 offset:3072
    v_mfma_f32_16x16x32_bf16 v[152:155], v[184:187], v[56:59], v[152:155]
    ds_read_b128 v[56:59], v10 offset:3136
    v_mfma_f32_16x16x32_bf16 v[152:155], v[196:199], v[60:63], v[152:155]
    ds_read_b128 v[60:63], v10 offset:3200
    s_waitcnt lgkmcnt(6)
    v_mfma_f32_16x16x32_bf16 v[152:155], v[208:211], v[64:67], v[152:155]
    ds_read_b128 v[64:67], v11 offset:3072
    v_mfma_f32_16x16x32_bf16 v[152:155], v[220:223], v[68:71], v[152:155]
    ds_read_b128 v[68:71], v11 offset:3136
    v_mfma_f32_16x16x32_bf16 v[152:155], v[232:235], v[72:75], v[152:155]
    ds_read_b128 v[72:75], v11 offset:3200
    s_waitcnt lgkmcnt(6)
    v_mfma_f32_16x16x32_bf16 v[108:111], a[0:3], v[40:43], 0
    s_add_u32 s32, s32, 589824
    v_mfma_f32_16x16x32_bf16 v[108:111], a[12:15], v[44:47], v[108:111]
    s_add_u32 s33, s33, 6
    v_mfma_f32_16x16x32_bf16 v[108:111], a[24:27], v[48:51], v[108:111]
    s_cmp_lt_u32 s33, s34
    s_cselect_b32 s14, 50331648, 0
    s_waitcnt lgkmcnt(3)
    v_mfma_f32_16x16x32_bf16 v[108:111], a[36:39], v[52:55], v[108:111]
    s_add_u32 s31, s31, 13312
    v_mfma_f32_16x16x32_bf16 v[108:111], a[48:51], v[56:59], v[108:111]
    s_cmp_eq_u32 s31, 53248
    s_cselect_b32 s31, 0, s31
    v_mfma_f32_16x16x32_bf16 v[108:111], a[60:63], v[60:63], v[108:111]
    s_waitcnt lgkmcnt(0)
    v_mfma_f32_16x16x32_bf16 v[108:111], a[72:75], v[64:67], v[108:111]
    v_mfma_f32_16x16x32_bf16 v[108:111], a[84:87], v[68:71], v[108:111]
    s_add_u32 m0, s31, s26
    v_mfma_f32_16x16x32_bf16 v[108:111], a[96:99], v[72:75], v[108:111]
    buffer_load_dwordx4 v2, s[12:15], s32 offen nt lds
    v_mfma_f32_16x16x32_bf16 v[112:115], a[4:7], v[40:43], 0
    v_mfma_f32_16x16x32_bf16 v[112:115], a[16:19], v[44:47], v[112:115]
    s_add_u32 m0, s31, s27
    v_mfma_f32_16x16x32_bf16 v[112:115], a[28:31], v[48:51], v[112:115]
    buffer_load_dwordx4 v3, s[12:15], s32 offen nt lds
    v_mfma_f32_16x16x32_bf16 v[112:115], a[40:43], v[52:55], v[112:115]
    v_mfma_f32_16x16x32_bf16 v[112:115], a[52:55], v[56:59], v[112:115]
    s_add_u32 m0, s31, s28
    v_mfma_f32_16x16x32_bf16 v[112:115], a[64:67], v[60:63], v[112:115]
    buffer_load_dwordx4 v4, s[12:15], s32 offen nt lds
    v_mfma_f32_16x16x32_bf16 v[112:115], a[76:79], v[64:67], v[112:115]
    v_mfma_f32_16x16x32_bf16 v[112:115], a[88:91], v[68:71], v[112:115]
    s_add_u32 m0, s31, s29
    v_mfma_f32_16x16x32_bf16 v[112:115], a[100:103], v[72:75], v[112:115]
    buffer_load_dwordx4 v5, s[12:15], s32 offen nt lds
    v_mfma_f32_16x16x32_bf16 v[116:119], a[8:11], v[40:43], 0
    v_mfma_f32_16x16x32_bf16 v[116:119], a[20:23], v[44:47], v[116:119]
    v_mfma_f32_16x16x32_bf16 v[116:119], a[32:35], v[48:51], v[116:119]
    s_add_u32 s32, s32, 196608
    v_mfma_f32_16x16x32_bf16 v[116:119], a[44:47], v[52:55], v[116:119]
    s_add_u32 s33, s33, 2
    v_mfma_f32_16x16x32_bf16 v[116:119], a[56:59], v[56:59], v[116:119]
    s_cmp_lt_u32 s33, s34
    s_cselect_b32 s14, 50331648, 0
    v_mfma_f32_16x16x32_bf16 v[116:119], a[68:71], v[60:63], v[116:119]
    s_add_u32 s31, s31, 13312
    v_mfma_f32_16x16x32_bf16 v[116:119], a[80:83], v[64:67], v[116:119]
    s_cmp_eq_u32 s31, 53248
    s_cselect_b32 s31, 0, s31
    v_mfma_f32_16x16x32_bf16 v[116:119], a[92:95], v[68:71], v[116:119]
    v_mfma_f32_16x16x32_bf16 v[116:119], a[104:107], v[72:75], v[116:119]
    v_mfma_f32_16x16x32_bf16 v[132:135], a[108:111], v[40:43], v[132:135]
    s_add_u32 m0, s31, s26
    v_mfma_f32_16x16x32_bf16 v[132:135], a[120:123], v[44:47], v[132:135]
    buffer_load_dwordx4 v2, s[12:15], s32 offen nt lds
    v_mfma_f32_16x16x32_bf16 v[132:135], a[132:135], v[48:51], v[132:135]
    v_mfma_f32_16x16x32_bf16 v[132:135], a[144:147], v[52:55], v[132:135]
    s_add_u32 m0, s31, s27
    v_mfma_f32_16x16x32_bf16 v[132:135], a[156:159], v[56:59], v[132:135]
    buffer_load_dwordx4 v3, s[12:15], s32 offen nt lds
    v_mfma_f32_16x16x32_bf16 v[132:135], a[168:171], v[60:63], v[132:135]
    v_mfma_f32_16x16x32_bf16 v[132:135], a[180:183], v[64:67], v[132:135]
    s_add_u32 m0, s31, s28
    v_mfma_f32_16x16x32_bf16 v[132:135], a[192:195], v[68:71], v[132:135]
    buffer_load_dwordx4 v4, s[12:15], s32 offen nt lds
    v_mfma_f32_16x16x32_bf16 v[132:135], a[204:207], v[72:75], v[132:135]
    v_mfma_f32_16x16x32_bf16 v[136:139], a[112:115], v[40:43], v[136:139]
    s_add_u32 m0, s31, s29
    v_mfma_f32_16x16x32_bf16 v[136:139], a[124:127], v[44:47], v[136:139]
    buffer_load_dwordx4 v5, s[12:15], s32 offen nt lds
    v_mfma_f32_16x16x32_bf16 v[136:139], a[136:139], v[48:51], v[136:139]
    v_mfma_f32_16x16x32_bf16 v[136:139], a[148:151], v[52:55], v[136:139]
    v_mfma_f32_16x16x32_bf16 v[136:139], a[160:163], v[56:59], v[136:139]
    s_add_u32 s30, s30, 13312
    v_mfma_f32_16x16x32_bf16 v[136:139], a[172:175], v[60:63], v[136:139]
    s_cmp_eq_u32 s30, 53248
    s_cselect_b32 s30, 0, s30
    v_mfma_f32_16x16x32_bf16 v[136:139], a[184:187], v[64:67], v[136:139]
    v_add_u32 v9, s30, v6
    v_mfma_f32_16x16x32_bf16 v[136:139], a[196:199], v[68:71], v[136:139]
    v_add_u32 v10, s30, v7
    v_mfma_f32_16x16x32_bf16 v[136:139], a[208:211], v[72:75], v[136:139]
    v_add_u32 v11, s30, v8
    v_mfma_f32_16x16x32_bf16 v[140:143], a[116:119], v[40:43], v[140:143]
    v_mfma_f32_16x16x32_bf16 v[140:143], a[128:131], v[44:47], v[140:143]
    v_mfma_f32_16x16x32_bf16 v[140:143], a[140:143], v[48:51], v[140:143]
    v_mfma_f32_16x16x32_bf16 v[140:143], a[152:155], v[52:55], v[140:143]
    ds_write_b32 v242, v243
    v_mfma_f32_16x16x32_bf16 v[140:143], a[164:167], v[56:59], v[140:143]
    v_mfma_f32_16x16x32_bf16 v[140:143], a[176:179], v[60:63], v[140:143]
    v_mfma_f32_16x16x32_bf16 v[140:143], a[188:191], v[64:67], v[140:143]
    v_mfma_f32_16x16x32_bf16 v[140:143], a[200:203], v[68:71], v[140:143]
    v_mfma_f32_16x16x32_bf16 v[140:143], a[212:215], v[72:75], v[140:143]
    v_mfma_f32_16x16x32_bf16 v[156:159], a[216:219], v[40:43], v[156:159]
    v_mfma_f32_16x16x32_bf16 v[156:159], a[228:231], v[44:47], v[156:159]
    v_mfma_f32_16x16x32_bf16 v[156:159], a[240:243], v[48:51], v[156:159]
    v_mfma_f32_16x16x32_bf16 v[160:163], a[220:223], v[40:43], v[160:163]
    v_mfma_f32_16x16x32_bf16 v[160:163], a[232:235], v[44:47], v[160:163]
    v_mfma_f32_16x16x32_bf16 v[160:163], a[244:247], v[48:51], v[160:163]
    s_waitcnt vmcnt(8)
    s_barrier
    v_mfma_f32_16x16x32_bf16 v[164:167], a[224:227], v[40:43], v[164:167]
    ds_read_b128 v[40:43], v9 offset:0
    v_mfma_f32_16x16x32_bf16 v[164:167], a[236:239], v[44:47], v[164:167]
    ds_read_b128 v[44:47], v9 offset:64
    v_mfma_f32_16x16x32_bf16 v[164:167], a[248:251], v[48:51], v[164:167]
    ds_read_b128 v[48:51], v9 offset:128
    v_mfma_f32_16x16x32_bf16 v[156:159], a[252:255], v[52:55], v[156:159]
    v_mfma_f32_16x16x32_bf16 v[156:159], v[176:179], v[56:59], v[156:159]
    v_mfma_f32_16x16x32_bf16 v[156:159], v[188:191], v[60:63], v[156:159]
    v_mfma_f32_16x16x32_bf16 v[160:163], v[168:171], v[52:55], v[160:163]
    v_mfma_f32_16x16x32_bf16 v[160:163], v[180:183], v[56:59], v[160:163]
    v_mfma_f32_16x16x32_bf16 v[160:163], v[192:195], v[60:63], v[160:163]
    v_mfma_f32_16x16x32_bf16 v[164:167], v[172:175], v[52:55], v[164:167]
    ds_read_b128 v[52:55], v10 offset:0
    v_mfma_f32_16x16x32_bf16 v[164:167], v[184:187], v[56:59], v[164:167]
    ds_read_b128 v[56:59], v10 offset:64
    v_mfma_f32_16x16x32_bf16 v[164:167], v[196:199], v[60:63], v[164:167]
    ds_read_b128 v[60:63], v10 offset:128
    v_mfma_f32_16x16x32_bf16 v[156:159], v[200:203], v[64:67], v[156:159]
    v_mfma_f32_16x16x32_bf16 v[156:159], v[212:215], v[68:71], v[156:159]
    v_mfma_f32_16x16x32_bf16 v[156:159], v[224:227], v[72:75], v[156:159]
    v_mfma_f32_16x16x32_bf16 v[160:163], v[204:207], v[64:67], v[160:163]
    v_mfma_f32_16x16x32_bf16 v[160:163], v[216:219], v[68:71], v[160:163]
    v_mfma_f32_16x16x32_bf16 v[160:163], v[228:231], v[72:75], v[160:163]
    v_mfma_f32_16x16x32_bf16 v[164:167], v[208:211], v[64:67], v[164:167]
    ds_read_b128 v[64:67], v11 offset:0
    v_mfma_f32_16x16x32_bf16 v[164:167], v[220:223], v[68:71], v[164:167]
    ds_read_b128 v[68:71], v11 offset:64
    v_mfma_f32_16x16x32_bf16 v[164:167], v[232:235], v[72:75], v[164:167]
    ds_read_b128 v[72:75], v11 offset:128
    s_waitcnt lgkmcnt(6)
    v_mfma_f32_16x16x32_bf16 v[144:147], a[0:3], v[40:43], v[144:147]
    s_add_u32 s32, s32, 196608
    v_mfma_f32_16x16x32_bf16 v[144:147], a[12:15], v[44:47], v[144:147]
    s_add_u32 s33, s33, 2
    v_mfma_f32_16x16x32_bf16 v[144:147], a[24:27], v[48:51], v[144:147]
    s_cmp_lt_u32 s33, s34
    s_cselect_b32 s14, 50331648, 0
    s_waitcnt lgkmcnt(3)
    v_mfma_f32_16x16x32_bf16 v[144:147], a[36:39], v[52:55], v[144:147]
    s_add_u32 s31, s31, 13312
    v_mfma_f32_16x16x32_bf16 v[144:147], a[48:51], v[56:59], v[144:147]
    s_cmp_eq_u32 s31, 53248
    s_cselect_b32 s31, 0, s31
    v_mfma_f32_16x16x32_bf16 v[144:147], a[60:63], v[60:63], v[144:147]
    s_waitcnt lgkmcnt(0)
    v_mfma_f32_16x16x32_bf16 v[144:147], a[72:75], v[64:67], v[144:147]
    v_mfma_f32_16x16x32_bf16 v[144:147], a[84:87], v[68:71], v[144:147]
    s_add_u32 m0, s31, s26
    v_mfma_f32_16x16x32_bf16 v[144:147], a[96:99], v[72:75], v[144:147]
    buffer_load_dwordx4 v2, s[12:15], s32 offen nt lds
    v_mfma_f32_16x16x32_bf16 v[148:151], a[4:7], v[40:43], v[148:151]
    s_add_u32 m0, s31, s27
    v_mfma_f32_16x16x32_bf16 v[148:151], a[16:19], v[44:47], v[148:151]
    buffer_load_dwordx4 v3, s[12:15], s32 offen nt lds
    v_mfma_f32_16x16x32_bf16 v[148:151], a[28:31], v[48:51], v[148:151]
    s_add_u32 m0, s31, s28
    v_mfma_f32_16x16x32_bf16 v[148:151], a[40:43], v[52:55], v[148:151]
    buffer_load_dwordx4 v4, s[12:15], s32 offen nt lds
    v_mfma_f32_16x16x32_bf16 v[148:151], a[52:55], v[56:59], v[148:151]
    s_add_u32 m0, s31, s29
    v_mfma_f32_16x16x32_bf16 v[148:151], a[64:67], v[60:63], v[148:151]
    buffer_load_dwordx4 v5, s[12:15], s32 offen nt lds
    v_mfma_f32_16x16x32_bf16 v[148:151], a[76:79], v[64:67], v[148:151]
    v_mfma_f32_16x16x32_bf16 v[148:151], a[88:91], v[68:71], v[148:151]
    v_mfma_f32_16x16x32_bf16 v[148:151], a[100:103], v[72:75], v[148:151]
    v_cvt_pk_bf16_f32 v76, v144, v145
    v_mfma_f32_16x16x32_bf16 v[152:155], a[8:11], v[40:43], v[152:155]
    ds_read_b128 v[40:43], v9 offset:3072
    v_cvt_pk_bf16_f32 v77, v146, v147
    v_mfma_f32_16x16x32_bf16 v[152:155], a[20:23], v[44:47], v[152:155]
    ds_read_b128 v[44:47], v9 offset:3136
    ds_write_b64 v12, v[76:77] offset:0
    v_mfma_f32_16x16x32_bf16 v[152:155], a[32:35], v[48:51], v[152:155]
    ds_read_b128 v[48:51], v9 offset:3200
    v_mfma_f32_16x16x32_bf16 v[152:155], a[44:47], v[52:55], v[152:155]
    ds_read_b128 v[52:55], v10 offset:3072
    v_mfma_f32_16x16x32_bf16 v[152:155], a[56:59], v[56:59], v[152:155]
    ds_read_b128 v[56:59], v10 offset:3136
    v_mfma_f32_16x16x32_bf16 v[152:155], a[68:71], v[60:63], v[152:155]
    ds_read_b128 v[60:63], v10 offset:3200
    v_mfma_f32_16x16x32_bf16 v[152:155], a[80:83], v[64:67], v[152:155]
    ds_read_b128 v[64:67], v11 offset:3072
    v_mfma_f32_16x16x32_bf16 v[152:155], a[92:95], v[68:71], v[152:155]
    ds_read_b128 v[68:71], v11 offset:3136
    v_mfma_f32_16x16x32_bf16 v[152:155], a[104:107], v[72:75], v[152:155]
    ds_read_b128 v[72:75], v11 offset:3200
    s_waitcnt lgkmcnt(6)
    v_mfma_f32_16x16x32_bf16 v[156:159], a[0:3], v[40:43], v[156:159]
    v_cvt_pk_bf16_f32 v78, v148, v149
    s_add_u32 s30, s30, 13312
    v_mfma_f32_16x16x32_bf16 v[156:159], a[12:15], v[44:47], v[156:159]
    v_cvt_pk_bf16_f32 v79, v150, v151
    v_mfma_f32_16x16x32_bf16 v[156:159], a[24:27], v[48:51], v[156:159]
    s_cmp_eq_u32 s30, 53248
    s_cselect_b32 s30, 0, s30
    v_mfma_f32_16x16x32_bf16 v[160:163], a[4:7], v[40:43], v[160:163]
    ds_write_b64 v13, v[78:79] offset:0
    v_add_u32 v9, s30, v6
    v_mfma_f32_16x16x32_bf16 v[160:163], a[16:19], v[44:47], v[160:163]
    v_add_u32 v10, s30, v7
    v_add_u32 v11, s30, v8
    v_mfma_f32_16x16x32_bf16 v[160:163], a[28:31], v[48:51], v[160:163]
    s_waitcnt vmcnt(8)
    s_barrier
    v_mfma_f32_16x16x32_bf16 v[164:167], a[8:11], v[40:43], v[164:167]
    ds_read_b128 v[40:43], v9 offset:0
    v_mfma_f32_16x16x32_bf16 v[164:167], a[20:23], v[44:47], v[164:167]
    ds_read_b128 v[44:47], v9 offset:64
    v_mfma_f32_16x16x32_bf16 v[164:167], a[32:35], v[48:51], v[164:167]
    v_cvt_pk_bf16_f32 v80, v152, v153
    s_waitcnt lgkmcnt(6)
    v_mfma_f32_16x16x32_bf16 v[156:159], a[36:39], v[52:55], v[156:159]
    ds_read_b128 v[48:51], v9 offset:128
    v_cvt_pk_bf16_f32 v81, v154, v155
    v_mfma_f32_16x16x32_bf16 v[156:159], a[48:51], v[56:59], v[156:159]
    ds_write_b64 v14, v[80:81] offset:0
    v_mfma_f32_16x16x32_bf16 v[156:159], a[60:63], v[60:63], v[156:159]
    v_mfma_f32_16x16x32_bf16 v[160:163], a[40:43], v[52:55], v[160:163]
    v_mfma_f32_16x16x32_bf16 v[160:163], a[52:55], v[56:59], v[160:163]
    v_mfma_f32_16x16x32_bf16 v[160:163], a[64:67], v[60:63], v[160:163]
    v_mfma_f32_16x16x32_bf16 v[164:167], a[44:47], v[52:55], v[164:167]
    ds_read_b128 v[52:55], v10 offset:0
    v_mfma_f32_16x16x32_bf16 v[164:167], a[56:59], v[56:59], v[164:167]
    ds_read_b128 v[56:59], v10 offset:64
    v_mfma_f32_16x16x32_bf16 v[164:167], a[68:71], v[60:63], v[164:167]
    ds_read_b128 v[60:63], v10 offset:128
    s_waitcnt lgkmcnt(8)
    v_mfma_f32_16x16x32_bf16 v[156:159], a[72:75], v[64:67], v[156:159]
    v_mfma_f32_16x16x32_bf16 v[156:159], a[84:87], v[68:71], v[156:159]
    v_mfma_f32_16x16x32_bf16 v[156:159], a[96:99], v[72:75], v[156:159]
    v_mfma_f32_16x16x32_bf16 v[160:163], a[76:79], v[64:67], v[160:163]
    v_mfma_f32_16x16x32_bf16 v[160:163], a[88:91], v[68:71], v[160:163]
    v_mfma_f32_16x16x32_bf16 v[160:163], a[100:103], v[72:75], v[160:163]
    v_mfma_f32_16x16x32_bf16 v[164:167], a[80:83], v[64:67], v[164:167]
    ds_read_b128 v[64:67], v11 offset:0
    v_mfma_f32_16x16x32_bf16 v[164:167], a[92:95], v[68:71], v[164:167]
    ds_read_b128 v[68:71], v11 offset:64
    v_mfma_f32_16x16x32_bf16 v[164:167], a[104:107], v[72:75], v[164:167]
    ds_read_b128 v[72:75], v11 offset:128
    s_waitcnt lgkmcnt(7)
    v_mfma_f32_16x16x32_bf16 v[144:147], a[216:219], v[40:43], v[120:123]
    v_mfma_f32_16x16x32_bf16 v[144:147], a[228:231], v[44:47], v[144:147]
    v_cvt_pk_bf16_f32 v76, v156, v157
    v_mfma_f32_16x16x32_bf16 v[144:147], a[240:243], v[48:51], v[144:147]
    v_cvt_pk_bf16_f32 v77, v158, v159
    s_waitcnt lgkmcnt(3)
    v_mfma_f32_16x16x32_bf16 v[144:147], a[252:255], v[52:55], v[144:147]
    ds_write_b64 v12, v[76:77] offset:3072
    v_mfma_f32_16x16x32_bf16 v[144:147], v[176:179], v[56:59], v[144:147]
    v_cvt_pk_bf16_f32 v78, v160, v161
    v_mfma_f32_16x16x32_bf16 v[144:147], v[188:191], v[60:63], v[144:147]
    v_cvt_pk_bf16_f32 v79, v162, v163
    s_waitcnt lgkmcnt(1)
    v_mfma_f32_16x16x32_bf16 v[144:147], v[200:203], v[64:67], v[144:147]
    ds_write_b64 v13, v[78:79] offset:3072
    v_mfma_f32_16x16x32_bf16 v[144:147], v[212:215], v[68:71], v[144:147]
    v_mfma_f32_16x16x32_bf16 v[144:147], v[224:227], v[72:75], v[144:147]
    v_cvt_pk_bf16_f32 v80, v164, v165
    v_mfma_f32_16x16x32_bf16 v[148:151], a[220:223], v[40:43], v[124:127]
    v_cvt_pk_bf16_f32 v81, v166, v167
    v_mfma_f32_16x16x32_bf16 v[148:151], a[232:235], v[44:47], v[148:151]
    ds_write_b64 v14, v[80:81] offset:3072
    v_mfma_f32_16x16x32_bf16 v[148:151], a[244:247], v[48:51], v[148:151]
    v_xor_b32 v12, 0x4000, v12
    v_mfma_f32_16x16x32_bf16 v[148:151], v[168:171], v[52:55], v[148:151]
    v_xor_b32 v13, 0x4000, v13
    v_mfma_f32_16x16x32_bf16 v[148:151], v[180:183], v[56:59], v[148:151]
    v_xor_b32 v14, 0x4000, v14
    v_mfma_f32_16x16x32_bf16 v[148:151], v[192:195], v[60:63], v[148:151]
    v_mfma_f32_16x16x32_bf16 v[148:151], v[204:207], v[64:67], v[148:151]
    s_waitcnt lgkmcnt(0)
    s_barrier
    v_mfma_f32_16x16x32_bf16 v[148:151], v[216:219], v[68:71], v[148:151]
    ds_read_b128 v[84:87], v15
    v_mfma_f32_16x16x32_bf16 v[148:151], v[228:231], v[72:75], v[148:151]
    ds_read_b128 v[88:91], v16
    v_cvt_pk_bf16_f32 v76, v144, v145
    v_mfma_f32_16x16x32_bf16 v[152:155], a[224:227], v[40:43], v[128:131]
    ds_read_b128 v[92:95], v17
    v_cvt_pk_bf16_f32 v77, v146, v147
    v_mfma_f32_16x16x32_bf16 v[152:155], a[236:239], v[44:47], v[152:155]
    v_xor_b32 v15, 0x4000, v15
    ds_write_b64 v12, v[76:77] offset:0
    v_mfma_f32_16x16x32_bf16 v[152:155], a[248:251], v[48:51], v[152:155]
    v_xor_b32 v16, 0x4000, v16
    v_mfma_f32_16x16x32_bf16 v[152:155], v[172:175], v[52:55], v[152:155]
    v_xor_b32 v17, 0x4000, v17
    v_mfma_f32_16x16x32_bf16 v[152:155], v[184:187], v[56:59], v[152:155]
    s_waitcnt lgkmcnt(3)
    buffer_store_dwordx4 v[84:87], v18, s[20:23], s35 offen offset:0 sc1
    v_mfma_f32_16x16x32_bf16 v[152:155], v[196:199], v[60:63], v[152:155]
    v_mfma_f32_16x16x32_bf16 v[152:155], v[208:211], v[64:67], v[152:155]
    v_mfma_f32_16x16x32_bf16 v[152:155], v[220:223], v[68:71], v[152:155]
    v_mfma_f32_16x16x32_bf16 v[152:155], v[232:235], v[72:75], v[152:155]
    v_cvt_pk_bf16_f32 v78, v148, v149
    v_mfma_f32_16x16x32_bf16 v[120:123], a[108:111], v[40:43], v[96:99]
    v_cvt_pk_bf16_f32 v79, v150, v151
    v_mfma_f32_16x16x32_bf16 v[120:123], a[120:123], v[44:47], v[120:123]
    ds_write_b64 v13, v[78:79] offset:0
    v_mfma_f32_16x16x32_bf16 v[120:123], a[132:135], v[48:51], v[120:123]
    v_mfma_f32_16x16x32_bf16 v[120:123], a[144:147], v[52:55], v[120:123]
    s_waitcnt lgkmcnt(3)
    buffer_store_dwordx4 v[88:91], v18, s[20:23], s35 offen offset:1024 sc1
    v_mfma_f32_16x16x32_bf16 v[120:123], a[156:159], v[56:59], v[120:123]
    v_mfma_f32_16x16x32_bf16 v[120:123], a[168:171], v[60:63], v[120:123]
    v_mfma_f32_16x16x32_bf16 v[120:123], a[180:183], v[64:67], v[120:123]
    v_mfma_f32_16x16x32_bf16 v[120:123], a[192:195], v[68:71], v[120:123]
    v_mfma_f32_16x16x32_bf16 v[120:123], a[204:207], v[72:75], v[120:123]
    v_cvt_pk_bf16_f32 v80, v152, v153
    v_mfma_f32_16x16x32_bf16 v[124:127], a[112:115], v[40:43], v[100:103]
    v_cvt_pk_bf16_f32 v81, v154, v155
    v_mfma_f32_16x16x32_bf16 v[124:127], a[124:127], v[44:47], v[124:127]
    ds_write_b64 v14, v[80:81] offset:0
    v_mfma_f32_16x16x32_bf16 v[124:127], a[136:139], v[48:51], v[124:127]
    s_waitcnt lgkmcnt(3)
    buffer_store_dwordx4 v[92:95], v18, s[20:23], s35 offen offset:2048 sc1
    s_add_u32 s32, s32, 196608
    v_mfma_f32_16x16x32_bf16 v[124:127], a[148:151], v[52:55], v[124:127]
    s_add_u32 s35, s35, 196608
    s_add_u32 s33, s33, 2
    v_mfma_f32_16x16x32_bf16 v[124:127], a[160:163], v[56:59], v[124:127]
    s_cmp_lt_u32 s33, s34
    v_mfma_f32_16x16x32_bf16 v[124:127], a[172:175], v[60:63], v[124:127]
    s_cselect_b32 s14, 50331648, 0
    v_mfma_f32_16x16x32_bf16 v[124:127], a[184:187], v[64:67], v[124:127]
    s_add_u32 s31, s31, 13312
    v_mfma_f32_16x16x32_bf16 v[124:127], a[196:199], v[68:71], v[124:127]
    s_cmp_eq_u32 s31, 53248
    v_mfma_f32_16x16x32_bf16 v[124:127], a[208:211], v[72:75], v[124:127]
    s_cselect_b32 s31, 0, s31
    v_mfma_f32_16x16x32_bf16 v[128:131], a[116:119], v[40:43], v[104:107]
    v_mfma_f32_16x16x32_bf16 v[128:131], a[128:131], v[44:47], v[128:131]
    s_add_u32 m0, s31, s26
    v_mfma_f32_16x16x32_bf16 v[128:131], a[140:143], v[48:51], v[128:131]
    buffer_load_dwordx4 v2, s[12:15], s32 offen nt lds
    v_mfma_f32_16x16x32_bf16 v[128:131], a[152:155], v[52:55], v[128:131]
    v_mfma_f32_16x16x32_bf16 v[128:131], a[164:167], v[56:59], v[128:131]
    v_mfma_f32_16x16x32_bf16 v[128:131], a[176:179], v[60:63], v[128:131]
    s_add_u32 m0, s31, s27
    v_mfma_f32_16x16x32_bf16 v[128:131], a[188:191], v[64:67], v[128:131]
    buffer_load_dwordx4 v3, s[12:15], s32 offen nt lds
    v_mfma_f32_16x16x32_bf16 v[128:131], a[200:203], v[68:71], v[128:131]
    v_mfma_f32_16x16x32_bf16 v[128:131], a[212:215], v[72:75], v[128:131]
    v_mfma_f32_16x16x32_bf16 v[96:99], a[0:3], v[40:43], 0
    s_add_u32 m0, s31, s28
    v_mfma_f32_16x16x32_bf16 v[96:99], a[12:15], v[44:47], v[96:99]
    buffer_load_dwordx4 v4, s[12:15], s32 offen nt lds
    v_mfma_f32_16x16x32_bf16 v[96:99], a[24:27], v[48:51], v[96:99]
    v_mfma_f32_16x16x32_bf16 v[100:103], a[4:7], v[40:43], 0
    v_mfma_f32_16x16x32_bf16 v[100:103], a[16:19], v[44:47], v[100:103]
    s_add_u32 m0, s31, s29
    v_mfma_f32_16x16x32_bf16 v[100:103], a[28:31], v[48:51], v[100:103]
    buffer_load_dwordx4 v5, s[12:15], s32 offen nt lds
    v_mfma_f32_16x16x32_bf16 v[104:107], a[8:11], v[40:43], 0
    ds_read_b128 v[40:43], v9 offset:3072
    v_mfma_f32_16x16x32_bf16 v[104:107], a[20:23], v[44:47], v[104:107]
    ds_read_b128 v[44:47], v9 offset:3136
    v_mfma_f32_16x16x32_bf16 v[104:107], a[32:35], v[48:51], v[104:107]
    ds_read_b128 v[48:51], v9 offset:3200
    v_mfma_f32_16x16x32_bf16 v[96:99], a[36:39], v[52:55], v[96:99]
    v_mfma_f32_16x16x32_bf16 v[96:99], a[48:51], v[56:59], v[96:99]
    v_mfma_f32_16x16x32_bf16 v[96:99], a[60:63], v[60:63], v[96:99]
    v_mfma_f32_16x16x32_bf16 v[100:103], a[40:43], v[52:55], v[100:103]
    v_mfma_f32_16x16x32_bf16 v[100:103], a[52:55], v[56:59], v[100:103]
    v_mfma_f32_16x16x32_bf16 v[100:103], a[64:67], v[60:63], v[100:103]
    v_mfma_f32_16x16x32_bf16 v[104:107], a[44:47], v[52:55], v[104:107]
    ds_read_b128 v[52:55], v10 offset:3072
    v_mfma_f32_16x16x32_bf16 v[104:107], a[56:59], v[56:59], v[104:107]
    ds_read_b128 v[56:59], v10 offset:3136
    v_mfma_f32_16x16x32_bf16 v[104:107], a[68:71], v[60:63], v[104:107]
    ds_read_b128 v[60:63], v10 offset:3200
    v_mfma_f32_16x16x32_bf16 v[96:99], a[72:75], v[64:67], v[96:99]
    v_mfma_f32_16x16x32_bf16 v[96:99], a[84:87], v[68:71], v[96:99]
    v_mfma_f32_16x16x32_bf16 v[96:99], a[96:99], v[72:75], v[96:99]
    v_mfma_f32_16x16x32_bf16 v[100:103], a[76:79], v[64:67], v[100:103]
    v_mfma_f32_16x16x32_bf16 v[100:103], a[88:91], v[68:71], v[100:103]
    v_mfma_f32_16x16x32_bf16 v[100:103], a[100:103], v[72:75], v[100:103]
    v_mfma_f32_16x16x32_bf16 v[104:107], a[80:83], v[64:67], v[104:107]
    ds_read_b128 v[64:67], v11 offset:3072
    v_mfma_f32_16x16x32_bf16 v[104:107], a[92:95], v[68:71], v[104:107]
    ds_read_b128 v[68:71], v11 offset:3136
    v_mfma_f32_16x16x32_bf16 v[104:107], a[104:107], v[72:75], v[104:107]
    ds_read_b128 v[72:75], v11 offset:3200
    s_waitcnt lgkmcnt(6)
    v_mfma_f32_16x16x32_bf16 v[156:159], a[216:219], v[40:43], v[132:135]
    v_mfma_f32_16x16x32_bf16 v[156:159], a[228:231], v[44:47], v[156:159]
    v_mfma_f32_16x16x32_bf16 v[156:159], a[240:243], v[48:51], v[156:159]
    s_waitcnt lgkmcnt(3)
    v_mfma_f32_16x16x32_bf16 v[156:159], a[252:255], v[52:55], v[156:159]
    v_mfma_f32_16x16x32_bf16 v[156:159], v[176:179], v[56:59], v[156:159]
    v_mfma_f32_16x16x32_bf16 v[156:159], v[188:191], v[60:63], v[156:159]
    s_waitcnt lgkmcnt(0)
    v_mfma_f32_16x16x32_bf16 v[156:159], v[200:203], v[64:67], v[156:159]
    v_mfma_f32_16x16x32_bf16 v[156:159], v[212:215], v[68:71], v[156:159]
    v_mfma_f32_16x16x32_bf16 v[156:159], v[224:227], v[72:75], v[156:159]
    v_mfma_f32_16x16x32_bf16 v[160:163], a[220:223], v[40:43], v[136:139]
    s_add_u32 s30, s30, 13312
    v_mfma_f32_16x16x32_bf16 v[160:163], a[232:235], v[44:47], v[160:163]
    s_cmp_eq_u32 s30, 53248
    v_mfma_f32_16x16x32_bf16 v[160:163], a[244:247], v[48:51], v[160:163]
    s_cselect_b32 s30, 0, s30
    v_mfma_f32_16x16x32_bf16 v[160:163], v[168:171], v[52:55], v[160:163]
    v_add_u32 v9, s30, v6
    v_mfma_f32_16x16x32_bf16 v[160:163], v[180:183], v[56:59], v[160:163]
    v_add_u32 v10, s30, v7
    v_mfma_f32_16x16x32_bf16 v[160:163], v[192:195], v[60:63], v[160:163]
    v_add_u32 v11, s30, v8
    v_mfma_f32_16x16x32_bf16 v[160:163], v[204:207], v[64:67], v[160:163]
    v_mfma_f32_16x16x32_bf16 v[160:163], v[216:219], v[68:71], v[160:163]
    v_mfma_f32_16x16x32_bf16 v[160:163], v[228:231], v[72:75], v[160:163]
    v_cvt_pk_bf16_f32 v76, v156, v157
    v_mfma_f32_16x16x32_bf16 v[164:167], a[224:227], v[40:43], v[140:143]
    v_cvt_pk_bf16_f32 v77, v158, v159
    v_mfma_f32_16x16x32_bf16 v[164:167], a[236:239], v[44:47], v[164:167]
    ds_write_b64 v12, v[76:77] offset:3072
    v_mfma_f32_16x16x32_bf16 v[164:167], a[248:251], v[48:51], v[164:167]
    v_mfma_f32_16x16x32_bf16 v[164:167], v[172:175], v[52:55], v[164:167]
    v_mfma_f32_16x16x32_bf16 v[164:167], v[184:187], v[56:59], v[164:167]
    v_mfma_f32_16x16x32_bf16 v[164:167], v[196:199], v[60:63], v[164:167]
    v_mfma_f32_16x16x32_bf16 v[164:167], v[208:211], v[64:67], v[164:167]
    v_mfma_f32_16x16x32_bf16 v[164:167], v[220:223], v[68:71], v[164:167]
    v_mfma_f32_16x16x32_bf16 v[164:167], v[232:235], v[72:75], v[164:167]
    v_cvt_pk_bf16_f32 v78, v160, v161
    v_mfma_f32_16x16x32_bf16 v[132:135], a[108:111], v[40:43], v[108:111]
    v_cvt_pk_bf16_f32 v79, v162, v163
    v_mfma_f32_16x16x32_bf16 v[132:135], a[120:123], v[44:47], v[132:135]
    ds_write_b64 v13, v[78:79] offset:3072
    v_mfma_f32_16x16x32_bf16 v[132:135], a[132:135], v[48:51], v[132:135]
    v_mfma_f32_16x16x32_bf16 v[132:135], a[144:147], v[52:55], v[132:135]
    v_mfma_f32_16x16x32_bf16 v[132:135], a[156:159], v[56:59], v[132:135]
    v_mfma_f32_16x16x32_bf16 v[132:135], a[168:171], v[60:63], v[132:135]
    v_mfma_f32_16x16x32_bf16 v[132:135], a[180:183], v[64:67], v[132:135]
    v_mfma_f32_16x16x32_bf16 v[132:135], a[192:195], v[68:71], v[132:135]
    v_mfma_f32_16x16x32_bf16 v[132:135], a[204:207], v[72:75], v[132:135]
    v_cvt_pk_bf16_f32 v80, v164, v165
    v_mfma_f32_16x16x32_bf16 v[136:139], a[112:115], v[40:43], v[112:115]
    v_cvt_pk_bf16_f32 v81, v166, v167
    v_mfma_f32_16x16x32_bf16 v[136:139], a[124:127], v[44:47], v[136:139]
    ds_write_b64 v14, v[80:81] offset:3072
    v_mfma_f32_16x16x32_bf16 v[136:139], a[136:139], v[48:51], v[136:139]
    v_mfma_f32_16x16x32_bf16 v[136:139], a[148:151], v[52:55], v[136:139]
    v_mfma_f32_16x16x32_bf16 v[136:139], a[160:163], v[56:59], v[136:139]
    v_add_u32 v243, 1, v243
    v_mfma_f32_16x16x32_bf16 v[136:139], a[172:175], v[60:63], v[136:139]
    s_add_u32 s63, s63, 1
    v_mfma_f32_16x16x32_bf16 v[136:139], a[184:187], v[64:67], v[136:139]
    s_waitcnt vmcnt(11)
    ds_write_b32 v242, v243
    v_mfma_f32_16x16x32_bf16 v[136:139], a[196:199], v[68:71], v[136:139]
    v_mfma_f32_16x16x32_bf16 v[136:139], a[208:211], v[72:75], v[136:139]
    v_mfma_f32_16x16x32_bf16 v[140:143], a[116:119], v[40:43], v[116:119]
    v_mfma_f32_16x16x32_bf16 v[140:143], a[128:131], v[44:47], v[140:143]
    v_mfma_f32_16x16x32_bf16 v[140:143], a[140:143], v[48:51], v[140:143]
    v_mfma_f32_16x16x32_bf16 v[140:143], a[152:155], v[52:55], v[140:143]
    v_mfma_f32_16x16x32_bf16 v[140:143], a[164:167], v[56:59], v[140:143]
    v_mfma_f32_16x16x32_bf16 v[140:143], a[176:179], v[60:63], v[140:143]
    v_mfma_f32_16x16x32_bf16 v[140:143], a[188:191], v[64:67], v[140:143]
    v_mfma_f32_16x16x32_bf16 v[140:143], a[200:203], v[68:71], v[140:143]
    v_mfma_f32_16x16x32_bf16 v[140:143], a[212:215], v[72:75], v[140:143]
    ds_read_b128 v[236:239], v244
    v_mfma_f32_16x16x32_bf16 v[108:111], a[0:3], v[40:43], 0
    v_mfma_f32_16x16x32_bf16 v[108:111], a[12:15], v[44:47], v[108:111]
    v_mfma_f32_16x16x32_bf16 v[108:111], a[24:27], v[48:51], v[108:111]
    v_mfma_f32_16x16x32_bf16 v[112:115], a[4:7], v[40:43], 0
    v_mfma_f32_16x16x32_bf16 v[112:115], a[16:19], v[44:47], v[112:115]
    v_mfma_f32_16x16x32_bf16 v[112:115], a[28:31], v[48:51], v[112:115]
    s_waitcnt lgkmcnt(0)
    v_min3_u32 v245, v236, v237, v238
    v_mfma_f32_16x16x32_bf16 v[116:119], a[8:11], v[40:43], 0
    v_min_u32 v245, v245, v239
    v_mfma_f32_16x16x32_bf16 v[116:119], a[20:23], v[44:47], v[116:119]
    v_mfma_f32_16x16x32_bf16 v[116:119], a[32:35], v[48:51], v[116:119]
    v_readfirstlane_b32 s57, v245
    v_mfma_f32_16x16x32_bf16 v[108:111], a[36:39], v[52:55], v[108:111]
    v_mfma_f32_16x16x32_bf16 v[108:111], a[48:51], v[56:59], v[108:111]
    v_mfma_f32_16x16x32_bf16 v[108:111], a[60:63], v[60:63], v[108:111]
    s_cmp_ge_u32 s57, s63
    s_cbranch_scc0 L_slowP
L_backP:
    v_mfma_f32_16x16x32_bf16 v[112:115], a[40:43], v[52:55], v[112:115]
    ds_read_b128 v[40:43], v9 offset:0
    v_mfma_f32_16x16x32_bf16 v[112:115], a[52:55], v[56:59], v[112:115]
    ds_read_b128 v[44:47], v9 offset:64
    v_mfma_f32_16x16x32_bf16 v[112:115], a[64:67], v[60:63], v[112:115]
    ds_read_b128 v[48:51], v9 offset:128
    v_mfma_f32_16x16x32_bf16 v[116:119], a[44:47], v[52:55], v[116:119]
    ds_read_b128 v[52:55], v10 offset:0
    v_mfma_f32_16x16x32_bf16 v[116:119], a[56:59], v[56:59], v[116:119]
    ds_read_b128 v[56:59], v10 offset:64
    v_mfma_f32_16x16x32_bf16 v[116:119], a[68:71], v[60:63], v[116:119]
    ds_read_b128 v[60:63], v10 offset:128
    v_mfma_f32_16x16x32_bf16 v[108:111], a[72:75], v[64:67], v[108:111]
    v_mfma_f32_16x16x32_bf16 v[108:111], a[84:87], v[68:71], v[108:111]
    v_mfma_f32_16x16x32_bf16 v[108:111], a[96:99], v[72:75], v[108:111]
    v_mfma_f32_16x16x32_bf16 v[112:115], a[76:79], v[64:67], v[112:115]
    v_mfma_f32_16x16x32_bf16 v[112:115], a[88:91], v[68:71], v[112:115]
    v_mfma_f32_16x16x32_bf16 v[112:115], a[100:103], v[72:75], v[112:115]
    v_mfma_f32_16x16x32_bf16 v[116:119], a[80:83], v[64:67], v[116:119]
    ds_read_b128 v[64:67], v11 offset:0
    v_mfma_f32_16x16x32_bf16 v[116:119], a[92:95], v[68:71], v[116:119]
    ds_read_b128 v[68:71], v11 offset:64
    v_mfma_f32_16x16x32_bf16 v[116:119], a[104:107], v[72:75], v[116:119]
    ds_read_b128 v[72:75], v11 offset:128
    s_mov_b32 s36, 12
L_loop:
    s_waitcnt lgkmcnt(6)
    v_mfma_f32_16x16x32_bf16 v[144:147], a[216:219], v[40:43], v[120:123]
    v_xor_b32 v12, 0x4000, v12
    v_mfma_f32_16x16x32_bf16 v[144:147], a[228:231], v[44:47], v[144:147]
    v_xor_b32 v13, 0x4000, v13
    v_mfma_f32_16x16x32_bf16 v[144:147], a[240:243], v[48:51], v[144:147]
    v_xor_b32 v14, 0x4000, v14
    s_waitcnt lgkmcnt(3)
    v_mfma_f32_16x16x32_bf16 v[144:147], a[252:255], v[52:55], v[144:147]
    v_mfma_f32_16x16x32_bf16 v[144:147], v[176:179], v[56:59], v[144:147]
    v_mfma_f32_16x16x32_bf16 v[144:147], v[188:191], v[60:63], v[144:147]
    s_waitcnt lgkmcnt(0)
    v_mfma_f32_16x16x32_bf16 v[144:147], v[200:203], v[64:67], v[144:147]
    ds_read_b128 v[84:87], v15
    v_mfma_f32_16x16x32_bf16 v[144:147], v[212:215], v[68:71], v[144:147]
    ds_read_b128 v[88:91], v16
    v_mfma_f32_16x16x32_bf16 v[144:147], v[224:227], v[72:75], v[144:147]
    ds_read_b128 v[92:95], v17
    v_mfma_f32_16x16x32_bf16 v[148:151], a[220:223], v[40:43], v[124:127]
    v_xor_b32 v15, 0x4000, v15
    v_mfma_f32_16x16x32_bf16 v[148:151], a[232:235], v[44:47], v[148:151]
    v_xor_b32 v16, 0x4000, v16
    v_mfma_f32_16x16x32_bf16 v[148:151], a[244:247], v[48:51], v[148:151]
    v_xor_b32 v17, 0x4000, v17
    v_mfma_f32_16x16x32_bf16 v[148:151], v[168:171], v[52:55], v[148:151]
    s_waitcnt lgkmcnt(2)
    buffer_store_dwordx4 v[84:87], v18, s[20:23], s35 offen offset:0 sc1
    v_mfma_f32_16x16x32_bf16 v[148:151], v[180:183], v[56:59], v[148:151]
    v_mfma_f32_16x16x32_bf16 v[148:151], v[192:195], v[60:63], v[148:151]
    v_mfma_f32_16x16x32_bf16 v[148:151], v[204:207], v[64:67], v[148:151]
    v_mfma_f32_16x16x32_bf16 v[148:151], v[216:219], v[68:71], v[148:151]
    v_mfma_f32_16x16x32_bf16 v[148:151], v[228:231], v[72:75], v[148:151]
    v_cvt_pk_bf16_f32 v76, v144, v145
    v_mfma_f32_16x16x32_bf16 v[152:155], a[224:227], v[40:43], v[128:131]
    v_cvt_pk_bf16_f32 v77, v146, v147
    v_mfma_f32_16x16x32_bf16 v[152:155], a[236:239], v[44:47], v[152:155]
    ds_write_b64 v12, v[76:77] offset:0
    v_mfma_f32_16x16x32_bf16 v[152:155], a[248:251], v[48:51], v[152:155]
    s_waitcnt lgkmcnt(2)
    buffer_store_dwordx4 v[88:91], v18, s[20:23], s35 offen offset:1024 sc1
    v_mfma_f32_16x16x32_bf16 v[152:155], v[172:175], v[52:55], v[152:155]
    v_mfma_f32_16x16x32_bf16 v[152:155], v[184:187], v[56:59], v[152:155]
    v_mfma_f32_16x16x32_bf16 v[152:155], v[196:199], v[60:63], v[152:155]
    v_mfma_f32_16x16x32_bf16 v[152:155], v[208:211], v[64:67], v[152:155]
    v_mfma_f32_16x16x32_bf16 v[152:155], v[220:223], v[68:71], v[152:155]
    v_mfma_f32_16x16x32_bf16 v[152:155], v[232:235], v[72:75], v[152:155]
    v_cvt_pk_bf16_f32 v78, v148, v149
    v_mfma_f32_16x16x32_bf16 v[120:123], a[108:111], v[40:43], v[96:99]
    v_cvt_pk_bf16_f32 v79, v150, v151
    v_mfma_f32_16x16x32_bf16 v[120:123], a[120:123], v[44:47], v[120:123]
    s_waitcnt lgkmcnt(1)
    buffer_store_dwordx4 v[92:95], v18, s[20:23], s35 offen offset:2048 sc1
    ds_write_b64 v13, v[78:79] offset:0
    v_mfma_f32_16x16x32_bf16 v[120:123], a[132:135], v[48:51], v[120:123]
    s_add_u32 s35, s35, 196608
    v_mfma_f32_16x16x32_bf16 v[120:123], a[144:147], v[52:55], v[120:123]
    v_mfma_f32_16x16x32_bf16 v[120:123], a[156:159], v[56:59], v[120:123]
    v_mfma_f32_16x16x32_bf16 v[120:123], a[168:171], v[60:63], v[120:123]
    v_mfma_f32_16x16x32_bf16 v[120:123], a[180:183], v[64:67], v[120:123]
    v_mfma_f32_16x16x32_bf16 v[120:123], a[192:195], v[68:71], v[120:123]
    v_mfma_f32_16x16x32_bf16 v[120:123], a[204:207], v[72:75], v[120:123]
    v_cvt_pk_bf16_f32 v80, v152, v153
    v_mfma_f32_16x16x32_bf16 v[124:127], a[112:115], v[40:43], v[100:103]
    v_cvt_pk_bf16_f32 v81, v154, v155
    v_mfma_f32_16x16x32_bf16 v[124:127], a[124:127], v[44:47], v[124:127]
    ds_write_b64 v14, v[80:81] offset:0
    v_mfma_f32_16x16x32_bf16 v[124:127], a[136:139], v[48:51], v[124:127]
    s_add_u32 s32, s32, 196608
    v_mfma_f32_16x16x32_bf16 v[124:127], a[148:151], v[52:55], v[124:127]
    s_add_u32 s33, s33, 2
    v_mfma_f32_16x16x32_bf16 v[124:127], a[160:163], v[56:59], v[124:127]
    s_cmp_lt_u32 s33, s34
    v_mfma_f32_16x16x32_bf16 v[124:127], a[172:175], v[60:63], v[124:127]
    s_cselect_b32 s14, 50331648, 0
    v_mfma_f32_16x16x32_bf16 v[124:127], a[184:187], v[64:67], v[124:127]
    s_add_u32 s31, s31, 13312
    v_mfma_f32_16x16x32_bf16 v[124:127], a[196:199], v[68:71], v[124:127]
    s_cmp_eq_u32 s31, 53248
    v_mfma_f32_16x16x32_bf16 v[124:127], a[208:211], v[72:75], v[124:127]
    s_cselect_b32 s31, 0, s31
    v_mfma_f32_16x16x32_bf16 v[128:131], a[116:119], v[40:43], v[104:107]
    v_mfma_f32_16x16x32_bf16 v[128:131], a[128:131], v[44:47], v[128:131]
    s_add_u32 m0, s31, s26
    v_mfma_f32_16x16x32_bf16 v[128:131], a[140:143], v[48:51], v[128:131]
    buffer_load_dwordx4 v2, s[12:15], s32 offen nt lds
    v_mfma_f32_16x16x32_bf16 v[128:131], a[152:155], v[52:55], v[128:131]
    v_mfma_f32_16x16x32_bf16 v[128:131], a[164:167], v[56:59], v[128:131]
    v_mfma_f32_16x16x32_bf16 v[128:131], a[176:179], v[60:63], v[128:131]
    s_add_u32 m0, s31, s27
    v_mfma_f32_16x16x32_bf16 v[128:131], a[188:191], v[64:67], v[128:131]
    buffer_load_dwordx4 v3, s[12:15], s32 offen nt lds
    v_mfma_f32_16x16x32_bf16 v[128:131], a[200:203], v[68:71], v[128:131]
    v_mfma_f32_16x16x32_bf16 v[128:131], a[212:215], v[72:75], v[128:131]
    v_mfma_f32_16x16x32_bf16 v[96:99], a[0:3], v[40:43], 0
    s_add_u32 m0, s31, s28
    v_mfma_f32_16x16x32_bf16 v[96:99], a[12:15], v[44:47], v[96:99]
    buffer_load_dwordx4 v4, s[12:15], s32 offen nt lds
    v_mfma_f32_16x16x32_bf16 v[96:99], a[24:27], v[48:51], v[96:99]
    v_mfma_f32_16x16x32_bf16 v[100:103], a[4:7], v[40:43], 0
    v_mfma_f32_16x16x32_bf16 v[100:103], a[16:19], v[44:47], v[100:103]
    s_add_u32 m0, s31, s29
    v_mfma_f32_16x16x32_bf16 v[100:103], a[28:31], v[48:51], v[100:103]
    buffer_load_dwordx4 v5, s[12:15], s32 offen nt lds
    v_mfma_f32_16x16x32_bf16 v[104:107], a[8:11], v[40:43], 0
    ds_read_b128 v[40:43], v9 offset:3072
    v_mfma_f32_16x16x32_bf16 v[104:107], a[20:23], v[44:47], v[104:107]
    ds_read_b128 v[44:47], v9 offset:3136
    v_mfma_f32_16x16x32_bf16 v[104:107], a[32:35], v[48:51], v[104:107]
    ds_read_b128 v[48:51], v9 offset:3200
    v_mfma_f32_16x16x32_bf16 v[96:99], a[36:39], v[52:55], v[96:99]
    v_mfma_f32_16x16x32_bf16 v[96:99], a[48:51], v[56:59], v[96:99]
    v_mfma_f32_16x16x32_bf16 v[96:99], a[60:63], v[60:63], v[96:99]
    v_mfma_f32_16x16x32_bf16 v[100:103], a[40:43], v[52:55], v[100:103]
    v_mfma_f32_16x16x32_bf16 v[100:103], a[52:55], v[56:59], v[100:103]
    v_mfma_f32_16x16x32_bf16 v[100:103], a[64:67], v[60:63], v[100:103]
    v_mfma_f32_16x16x32_bf16 v[104:107], a[44:47], v[52:55], v[104:107]
    ds_read_b128 v[52:55], v10 offset:3072
    v_mfma_f32_16x16x32_bf16 v[104:107], a[56:59], v[56:59], v[104:107]
    ds_read_b128 v[56:59], v10 offset:3136
    v_mfma_f32_16x16x32_bf16 v[104:107], a[68:71], v[60:63], v[104:107]
    ds_read_b128 v[60:63], v10 offset:3200
    v_mfma_f32_16x16x32_bf16 v[96:99], a[72:75], v[64:67], v[96:99]
    v_mfma_f32_16x16x32_bf16 v[96:99], a[84:87], v[68:71], v[96:99]
    v_mfma_f32_16x16x32_bf16 v[96:99], a[96:99], v[72:75], v[96:99]
    v_mfma_f32_16x16x32_bf16 v[100:103], a[76:79], v[64:67], v[100:103]
    v_mfma_f32_16x16x32_bf16 v[100:103], a[88:91], v[68:71], v[100:103]
    v_mfma_f32_16x16x32_bf16 v[100:103], a[100:103], v[72:75], v[100:103]
    v_mfma_f32_16x16x32_bf16 v[104:107], a[80:83], v[64:67], v[104:107]
    ds_read_b128 v[64:67], v11 offset:3072
    v_mfma_f32_16x16x32_bf16 v[104:107], a[92:95], v[68:71], v[104:107]
    ds_read_b128 v[68:71], v11 offset:3136
    v_mfma_f32_16x16x32_bf16 v[104:107], a[104:107], v[72:75], v[104:107]
    ds_read_b128 v[72:75], v11 offset:3200
    s_waitcnt lgkmcnt(6)
    v_mfma_f32_16x16x32_bf16 v[156:159], a[216:219], v[40:43], v[132:135]
    v_mfma_f32_16x16x32_bf16 v[156:159], a[228:231], v[44:47], v[156:159]
    v_mfma_f32_16x16x32_bf16 v[156:159], a[240:243], v[48:51], v[156:159]
    s_waitcnt lgkmcnt(3)
    v_mfma_f32_16x16x32_bf16 v[156:159], a[252:255], v[52:55], v[156:159]
    v_mfma_f32_16x16x32_bf16 v[156:159], v[176:179], v[56:59], v[156:159]
    v_mfma_f32_16x16x32_bf16 v[156:159], v[188:191], v[60:63], v[156:159]
    s_waitcnt lgkmcnt(0)
    v_mfma_f32_16x16x32_bf16 v[156:159], v[200:203], v[64:67], v[156:159]
    v_mfma_f32_16x16x32_bf16 v[156:159], v[212:215], v[68:71], v[156:159]
    v_mfma_f32_16x16x32_bf16 v[156:159], v[224:227], v[72:75], v[156:159]
    v_mfma_f32_16x16x32_bf16 v[160:163], a[220:223], v[40:43], v[136:139]
    s_add_u32 s30, s30, 13312
    v_mfma_f32_16x16x32_bf16 v[160:163], a[232:235], v[44:47], v[160:163]
    s_cmp_eq_u32 s30, 53248
    v_mfma_f32_16x16x32_bf16 v[160:163], a[244:247], v[48:51], v[160:163]
    s_cselect_b32 s30, 0, s30
    v_mfma_f32_16x16x32_bf16 v[160:163], v[168:171], v[52:55], v[160:163]
    v_add_u32 v9, s30, v6
    v_mfma_f32_16x16x32_bf16 v[160:163], v[180:183], v[56:59], v[160:163]
    v_add_u32 v10, s30, v7
    v_mfma_f32_16x16x32_bf16 v[160:163], v[192:195], v[60:63], v[160:163]
    v_add_u32 v11, s30, v8
    v_mfma_f32_16x16x32_bf16 v[160:163], v[204:207], v[64:67], v[160:163]
    v_mfma_f32_16x16x32_bf16 v[160:163], v[216:219], v[68:71], v[160:163]
    v_mfma_f32_16x16x32_bf16 v[160:163], v[228:231], v[72:75], v[160:163]
    v_cvt_pk_bf16_f32 v76, v156, v157
    v_mfma_f32_16x16x32_bf16 v[164:167], a[224:227], v[40:43], v[140:143]
    v_cvt_pk_bf16_f32 v77, v158, v159
    v_mfma_f32_16x16x32_bf16 v[164:167], a[236:239], v[44:47], v[164:167]
    ds_write_b64 v12, v[76:77] offset:3072
    v_mfma_f32_16x16x32_bf16 v[164:167], a[248:251], v[48:51], v[164:167]
    v_mfma_f32_16x16x32_bf16 v[164:167], v[172:175], v[52:55], v[164:167]
    v_mfma_f32_16x16x32_bf16 v[164:167], v[184:187], v[56:59], v[164:167]
    v_mfma_f32_16x16x32_bf16 v[164:167], v[196:199], v[60:63], v[164:167]
    v_mfma_f32_16x16x32_bf16 v[164:167], v[208:211], v[64:67], v[164:167]
    v_mfma_f32_16x16x32_bf16 v[164:167], v[220:223], v[68:71], v[164:167]
    v_mfma_f32_16x16x32_bf16 v[164:167], v[232:235], v[72:75], v[164:167]
    v_cvt_pk_bf16_f32 v78, v160, v161
    v_mfma_f32_16x16x32_bf16 v[132:135], a[108:111], v[40:43], v[108:111]
    v_cvt_pk_bf16_f32 v79, v162, v163
    v_mfma_f32_16x16x32_bf16 v[132:135], a[120:123], v[44:47], v[132:135]
    ds_write_b64 v13, v[78:79] offset:3072
    v_mfma_f32_16x16x32_bf16 v[132:135], a[132:135], v[48:51], v[132:135]
    v_mfma_f32_16x16x32_bf16 v[132:135], a[144:147], v[52:55], v[132:135]
    v_mfma_f32_16x16x32_bf16 v[132:135], a[156:159], v[56:59], v[132:135]
    v_mfma_f32_16x16x32_bf16 v[132:135], a[168:171], v[60:63], v[132:135]
    v_mfma_f32_16x16x32_bf16 v[132:135], a[180:183], v[64:67], v[132:135]
    v_mfma_f32_16x16x32_bf16 v[132:135], a[192:195], v[68:71], v[132:135]
    v_mfma_f32_16x16x32_bf16 v[132:135], a[204:207], v[72:75], v[132:135]
    v_cvt_pk_bf16_f32 v80, v164, v165
    v_mfma_f32_16x16x32_bf16 v[136:139], a[112:115], v[40:43], v[112:115]
    v_cvt_pk_bf16_f32 v81, v166, v167
    v_mfma_f32_16x16x32_bf16 v[136:139], a[124:127], v[44:47], v[136:139]
    ds_write_b64 v14, v[80:81] offset:3072
    v_mfma_f32_16x16x32_bf16 v[136:139], a[136:139], v[48:51], v[136:139]
    v_mfma_f32_16x16x32_bf16 v[136:139], a[148:151], v[52:55], v[136:139]
    v_mfma_f32_16x16x32_bf16 v[136:139], a[160:163], v[56:59], v[136:139]
    v_add_u32 v243, 1, v243
    v_mfma_f32_16x16x32_bf16 v[136:139], a[172:175], v[60:63], v[136:139]
    s_add_u32 s63, s63, 1
    v_mfma_f32_16x16x32_bf16 v[136:139], a[184:187], v[64:67], v[136:139]
    s_waitcnt vmcnt(14)
    ds_write_b32 v242, v243
    v_mfma_f32_16x16x32_bf16 v[136:139], a[196:199], v[68:71], v[136:139]
    v_mfma_f32_16x16x32_bf16 v[136:139], a[208:211], v[72:75], v[136:139]
    v_mfma_f32_16x16x32_bf16 v[140:143], a[116:119], v[40:43], v[116:119]
    v_mfma_f32_16x16x32_bf16 v[140:143], a[128:131], v[44:47], v[140:143]
    v_mfma_f32_16x16x32_bf16 v[140:143], a[140:143], v[48:51], v[140:143]
    v_mfma_f32_16x16x32_bf16 v[140:143], a[152:155], v[52:55], v[140:143]
    v_mfma_f32_16x16x32_bf16 v[140:143], a[164:167], v[56:59], v[140:143]
    v_mfma_f32_16x16x32_bf16 v[140:143], a[176:179], v[60:63], v[140:143]
    v_mfma_f32_16x16x32_bf16 v[140:143], a[188:191], v[64:67], v[140:143]
    v_mfma_f32_16x16x32_bf16 v[140:143], a[200:203], v[68:71], v[140:143]
    v_mfma_f32_16x16x32_bf16 v[140:143], a[212:215], v[72:75], v[140:143]
    ds_read_b128 v[236:239], v244
    v_mfma_f32_16x16x32_bf16 v[108:111], a[0:3], v[40:43], 0
    v_mfma_f32_16x16x32_bf16 v[108:111], a[12:15], v[44:47], v[108:111]
    v_mfma_f32_16x16x32_bf16 v[108:111], a[24:27], v[48:51], v[108:111]
    v_mfma_f32_16x16x32_bf16 v[112:115], a[4:7], v[40:43], 0
    v_mfma_f32_16x16x32_bf16 v[112:115], a[16:19], v[44:47], v[112:115]
    v_mfma_f32_16x16x32_bf16 v[112:115], a[28:31], v[48:51], v[112:115]
    s_waitcnt lgkmcnt(0)
    v_min3_u32 v245, v236, v237, v238
    v_mfma_f32_16x16x32_bf16 v[116:119], a[8:11], v[40:43], 0
    v_min_u32 v245, v245, v239
    v_mfma_f32_16x16x32_bf16 v[116:119], a[20:23], v[44:47], v[116:119]
    v_mfma_f32_16x16x32_bf16 v[116:119], a[32:35], v[48:51], v[116:119]
    v_readfirstlane_b32 s57, v245
    v_mfma_f32_16x16x32_bf16 v[108:111], a[36:39], v[52:55], v[108:111]
    v_mfma_f32_16x16x32_bf16 v[108:111], a[48:51], v[56:59], v[108:111]
    v_mfma_f32_16x16x32_bf16 v[108:111], a[60:63], v[60:63], v[108:111]
    s_cmp_ge_u32 s57, s63
    s_cbranch_scc0 L_slow
L_back:
    v_mfma_f32_16x16x32_bf16 v[112:115], a[40:43], v[52:55], v[112:115]
    ds_read_b128 v[40:43], v9 offset:0
    v_mfma_f32_16x16x32_bf16 v[112:115], a[52:55], v[56:59], v[112:115]
    ds_read_b128 v[44:47], v9 offset:64
    v_mfma_f32_16x16x32_bf16 v[112:115], a[64:67], v[60:63], v[112:115]
    ds_read_b128 v[48:51], v9 offset:128
    v_mfma_f32_16x16x32_bf16 v[116:119], a[44:47], v[52:55], v[116:119]
    ds_read_b128 v[52:55], v10 offset:0
    v_mfma_f32_16x16x32_bf16 v[116:119], a[56:59], v[56:59], v[116:119]
    ds_read_b128 v[56:59], v10 offset:64
    v_mfma_f32_16x16x32_bf16 v[116:119], a[68:71], v[60:63], v[116:119]
    ds_read_b128 v[60:63], v10 offset:128
    v_mfma_f32_16x16x32_bf16 v[108:111], a[72:75], v[64:67], v[108:111]
    v_mfma_f32_16x16x32_bf16 v[108:111], a[84:87], v[68:71], v[108:111]
    v_mfma_f32_16x16x32_bf16 v[108:111], a[96:99], v[72:75], v[108:111]
    s_sub_u32 s36, s36, 1
    v_mfma_f32_16x16x32_bf16 v[112:115], a[76:79], v[64:67], v[112:115]
    s_cmp_lg_u32 s36, 0
    v_mfma_f32_16x16x32_bf16 v[112:115], a[88:91], v[68:71], v[112:115]
    v_mfma_f32_16x16x32_bf16 v[112:115], a[100:103], v[72:75], v[112:115]
    v_mfma_f32_16x16x32_bf16 v[116:119], a[80:83], v[64:67], v[116:119]
    ds_read_b128 v[64:67], v11 offset:0
    v_mfma_f32_16x16x32_bf16 v[116:119], a[92:95], v[68:71], v[116:119]
    ds_read_b128 v[68:71], v11 offset:64
    v_mfma_f32_16x16x32_bf16 v[116:119], a[104:107], v[72:75], v[116:119]
    ds_read_b128 v[72:75], v11 offset:128
    s_cbranch_scc1 L_loop
    s_waitcnt lgkmcnt(6)
    v_mfma_f32_16x16x32_bf16 v[144:147], a[216:219], v[40:43], v[120:123]
    v_xor_b32 v12, 0x4000, v12
    v_mfma_f32_16x16x32_bf16 v[144:147], a[228:231], v[44:47], v[144:147]
    v_xor_b32 v13, 0x4000, v13
    v_mfma_f32_16x16x32_bf16 v[144:147], a[240:243], v[48:51], v[144:147]
    v_xor_b32 v14, 0x4000, v14
    s_waitcnt lgkmcnt(3)
    v_mfma_f32_16x16x32_bf16 v[144:147], a[252:255], v[52:55], v[144:147]
    v_mfma_f32_16x16x32_bf16 v[144:147], v[176:179], v[56:59], v[144:147]
    v_mfma_f32_16x16x32_bf16 v[144:147], v[188:191], v[60:63], v[144:147]
    s_waitcnt lgkmcnt(0)
    v_mfma_f32_16x16x32_bf16 v[144:147], v[200:203], v[64:67], v[144:147]
    ds_read_b128 v[84:87], v15
    v_mfma_f32_16x16x32_bf16 v[144:147], v[212:215], v[68:71], v[144:147]
    ds_read_b128 v[88:91], v16
    v_mfma_f32_16x16x32_bf16 v[144:147], v[224:227], v[72:75], v[144:147]
    ds_read_b128 v[92:95], v17
    v_mfma_f32_16x16x32_bf16 v[148:151], a[220:223], v[40:43], v[124:127]
    v_xor_b32 v15, 0x4000, v15
    v_mfma_f32_16x16x32_bf16 v[148:151], a[232:235], v[44:47], v[148:151]
    v_xor_b32 v16, 0x4000, v16
    v_mfma_f32_16x16x32_bf16 v[148:151], a[244:247], v[48:51], v[148:151]
    v_xor_b32 v17, 0x4000, v17
    v_mfma_f32_16x16x32_bf16 v[148:151], v[168:171], v[52:55], v[148:151]
    s_waitcnt lgkmcnt(2)
    buffer_store_dwordx4 v[84:87], v18, s[20:23], s35 offen offset:0 sc1
    v_mfma_f32_16x16x32_bf16 v[148:151], v[180:183], v[56:59], v[148:151]
    v_mfma_f32_16x16x32_bf16 v[148:151], v[192:195], v[60:63], v[148:151]
    v_mfma_f32_16x16x32_bf16 v[148:151], v[204:207], v[64:67], v[148:151]
    v_mfma_f32_16x16x32_bf16 v[148:151], v[216:219], v[68:71], v[148:151]
    v_mfma_f32_16x16x32_bf16 v[148:151], v[228:231], v[72:75], v[148:151]
    v_cvt_pk_bf16_f32 v76, v144, v145
    v_mfma_f32_16x16x32_bf16 v[152:155], a[224:227], v[40:43], v[128:131]
    v_cvt_pk_bf16_f32 v77, v146, v147
    v_mfma_f32_16x16x32_bf16 v[152:155], a[236:239], v[44:47], v[152:155]
    ds_write_b64 v12, v[76:77] offset:0
    v_mfma_f32_16x16x32_bf16 v[152:155], a[248:251], v[48:51], v[152:155]
    s_waitcnt lgkmcnt(2)
    buffer_store_dwordx4 v[88:91], v18, s[20:23], s35 offen offset:1024 sc1
    v_mfma_f32_16x16x32_bf16 v[152:155], v[172:175], v[52:55], v[152:155]
    v_mfma_f32_16x16x32_bf16 v[152:155], v[184:187], v[56:59], v[152:155]
    v_mfma_f32_16x16x32_bf16 v[152:155], v[196:199], v[60:63], v[152:155]
    v_mfma_f32_16x16x32_bf16 v[152:155], v[208:211], v[64:67], v[152:155]
    v_mfma_f32_16x16x32_bf16 v[152:155], v[220:223], v[68:71], v[152:155]
    v_mfma_f32_16x16x32_bf16 v[152:155], v[232:235], v[72:75], v[152:155]
    v_cvt_pk_bf16_f32 v78, v148, v149
    v_mfma_f32_16x16x32_bf16 v[120:123], a[108:111], v[40:43], v[96:99]
    v_cvt_pk_bf16_f32 v79, v150, v151
    v_mfma_f32_16x16x32_bf16 v[120:123], a[120:123], v[44:47], v[120:123]
    s_waitcnt lgkmcnt(1)
    buffer_store_dwordx4 v[92:95], v18, s[20:23], s35 offen offset:2048 sc1
    ds_write_b64 v13, v[78:79] offset:0
    v_mfma_f32_16x16x32_bf16 v[120:123], a[132:135], v[48:51], v[120:123]
    s_add_u32 s35, s35, 196608
    v_mfma_f32_16x16x32_bf16 v[124:127], a[112:115], v[40:43], v[100:103]
    v_mfma_f32_16x16x32_bf16 v[124:127], a[124:127], v[44:47], v[124:127]
    v_mfma_f32_16x16x32_bf16 v[124:127], a[136:139], v[48:51], v[124:127]
    v_mfma_f32_16x16x32_bf16 v[128:131], a[116:119], v[40:43], v[104:107]
    ds_read_b128 v[40:43], v9 offset:3072
    v_mfma_f32_16x16x32_bf16 v[128:131], a[128:131], v[44:47], v[128:131]
    ds_read_b128 v[44:47], v9 offset:3136
    v_mfma_f32_16x16x32_bf16 v[128:131], a[140:143], v[48:51], v[128:131]
    v_cvt_pk_bf16_f32 v80, v152, v153
    ds_read_b128 v[48:51], v9 offset:3200
    v_mfma_f32_16x16x32_bf16 v[120:123], a[144:147], v[52:55], v[120:123]
    v_cvt_pk_bf16_f32 v81, v154, v155
    v_mfma_f32_16x16x32_bf16 v[120:123], a[156:159], v[56:59], v[120:123]
    ds_write_b64 v14, v[80:81] offset:0
    v_mfma_f32_16x16x32_bf16 v[120:123], a[168:171], v[60:63], v[120:123]
    v_mfma_f32_16x16x32_bf16 v[124:127], a[148:151], v[52:55], v[124:127]
    v_mfma_f32_16x16x32_bf16 v[124:127], a[160:163], v[56:59], v[124:127]
    v_mfma_f32_16x16x32_bf16 v[124:127], a[172:175], v[60:63], v[124:127]
    v_mfma_f32_16x16x32_bf16 v[128:131], a[152:155], v[52:55], v[128:131]
    ds_read_b128 v[52:55], v10 offset:3072
    v_mfma_f32_16x16x32_bf16 v[128:131], a[164:167], v[56:59], v[128:131]
    ds_read_b128 v[56:59], v10 offset:3136
    v_mfma_f32_16x16x32_bf16 v[128:131], a[176:179], v[60:63], v[128:131]
    ds_read_b128 v[60:63], v10 offset:3200
    v_mfma_f32_16x16x32_bf16 v[120:123], a[180:183], v[64:67], v[120:123]
    v_mfma_f32_16x16x32_bf16 v[120:123], a[192:195], v[68:71], v[120:123]
    v_mfma_f32_16x16x32_bf16 v[120:123], a[204:207], v[72:75], v[120:123]
    v_mfma_f32_16x16x32_bf16 v[124:127], a[184:187], v[64:67], v[124:127]
    v_mfma_f32_16x16x32_bf16 v[124:127], a[196:199], v[68:71], v[124:127]
    v_mfma_f32_16x16x32_bf16 v[124:127], a[208:211], v[72:75], v[124:127]
    v_mfma_f32_16x16x32_bf16 v[128:131], a[188:191], v[64:67], v[128:131]
    ds_read_b128 v[64:67], v11 offset:3072
    v_mfma_f32_16x16x32_bf16 v[128:131], a[200:203], v[68:71], v[128:131]
    ds_read_b128 v[68:71], v11 offset:3136
    v_mfma_f32_16x16x32_bf16 v[128:131], a[212:215], v[72:75], v[128:131]
    ds_read_b128 v[72:75], v11 offset:3200
    s_waitcnt lgkmcnt(7)
    v_mfma_f32_16x16x32_bf16 v[156:159], a[216:219], v[40:43], v[132:135]
    v_mfma_f32_16x16x32_bf16 v[156:159], a[228:231], v[44:47], v[156:159]
    v_mfma_f32_16x16x32_bf16 v[156:159], a[240:243], v[48:51], v[156:159]
    s_waitcnt lgkmcnt(3)
    v_mfma_f32_16x16x32_bf16 v[156:159], a[252:255], v[52:55], v[156:159]
    v_mfma_f32_16x16x32_bf16 v[156:159], v[176:179], v[56:59], v[156:159]
    v_mfma_f32_16x16x32_bf16 v[156:159], v[188:191], v[60:63], v[156:159]
    s_waitcnt lgkmcnt(0)
    v_mfma_f32_16x16x32_bf16 v[156:159], v[200:203], v[64:67], v[156:159]
    v_mfma_f32_16x16x32_bf16 v[156:159], v[212:215], v[68:71], v[156:159]
    v_mfma_f32_16x16x32_bf16 v[156:159], v[224:227], v[72:75], v[156:159]
    v_mfma_f32_16x16x32_bf16 v[160:163], a[220:223], v[40:43], v[136:139]
    s_add_u32 s30, s30, 13312
    v_mfma_f32_16x16x32_bf16 v[160:163], a[232:235], v[44:47], v[160:163]
    s_cmp_eq_u32 s30, 53248
    v_mfma_f32_16x16x32_bf16 v[160:163], a[244:247], v[48:51], v[160:163]
    s_cselect_b32 s30, 0, s30
    v_mfma_f32_16x16x32_bf16 v[160:163], v[168:171], v[52:55], v[160:163]
    v_add_u32 v9, s30, v6
    v_mfma_f32_16x16x32_bf16 v[160:163], v[180:183], v[56:59], v[160:163]
    v_add_u32 v10, s30, v7
    v_mfma_f32_16x16x32_bf16 v[160:163], v[192:195], v[60:63], v[160:163]
    v_add_u32 v11, s30, v8
    v_mfma_f32_16x16x32_bf16 v[160:163], v[204:207], v[64:67], v[160:163]
    v_mfma_f32_16x16x32_bf16 v[160:163], v[216:219], v[68:71], v[160:163]
    v_mfma_f32_16x16x32_bf16 v[160:163], v[228:231], v[72:75], v[160:163]
    v_cvt_pk_bf16_f32 v76, v156, v157
    v_mfma_f32_16x16x32_bf16 v[164:167], a[224:227], v[40:43], v[140:143]
    v_cvt_pk_bf16_f32 v77, v158, v159
    v_mfma_f32_16x16x32_bf16 v[164:167], a[236:239], v[44:47], v[164:167]
    ds_write_b64 v12, v[76:77] offset:3072
    v_mfma_f32_16x16x32_bf16 v[164:167], a[248:251], v[48:51], v[164:167]
    v_mfma_f32_16x16x32_bf16 v[164:167], v[172:175], v[52:55], v[164:167]
    v_mfma_f32_16x16x32_bf16 v[164:167], v[184:187], v[56:59], v[164:167]
    v_mfma_f32_16x16x32_bf16 v[164:167], v[196:199], v[60:63], v[164:167]
    v_mfma_f32_16x16x32_bf16 v[164:167], v[208:211], v[64:67], v[164:167]
    v_mfma_f32_16x16x32_bf16 v[164:167], v[220:223], v[68:71], v[164:167]
    v_mfma_f32_16x16x32_bf16 v[164:167], v[232:235], v[72:75], v[164:167]
    v_cvt_pk_bf16_f32 v78, v160, v161
    v_mfma_f32_16x16x32_bf16 v[132:135], a[108:111], v[40:43], v[108:111]
    v_cvt_pk_bf16_f32 v79, v162, v163
    v_mfma_f32_16x16x32_bf16 v[132:135], a[120:123], v[44:47], v[132:135]
    ds_write_b64 v13, v[78:79] offset:3072
    v_mfma_f32_16x16x32_bf16 v[132:135], a[132:135], v[48:51], v[132:135]
    v_mfma_f32_16x16x32_bf16 v[136:139], a[112:115], v[40:43], v[112:115]
    v_mfma_f32_16x16x32_bf16 v[136:139], a[124:127], v[44:47], v[136:139]
    v_mfma_f32_16x16x32_bf16 v[136:139], a[136:139], v[48:51], v[136:139]
    v_mfma_f32_16x16x32_bf16 v[140:143], a[116:119], v[40:43], v[116:119]
    v_mfma_f32_16x16x32_bf16 v[140:143], a[128:131], v[44:47], v[140:143]
    v_mfma_f32_16x16x32_bf16 v[140:143], a[140:143], v[48:51], v[140:143]
    v_cvt_pk_bf16_f32 v80, v164, v165
    v_mfma_f32_16x16x32_bf16 v[132:135], a[144:147], v[52:55], v[132:135]
    v_cvt_pk_bf16_f32 v81, v166, v167
    v_mfma_f32_16x16x32_bf16 v[132:135], a[156:159], v[56:59], v[132:135]
    ds_write_b64 v14, v[80:81] offset:3072
    v_mfma_f32_16x16x32_bf16 v[132:135], a[168:171], v[60:63], v[132:135]
    v_mfma_f32_16x16x32_bf16 v[136:139], a[148:151], v[52:55], v[136:139]
    s_waitcnt vmcnt(10) lgkmcnt(0)
    s_barrier
    v_mfma_f32_16x16x32_bf16 v[136:139], a[160:163], v[56:59], v[136:139]
    ds_read_b128 v[40:43], v9 offset:0
    v_mfma_f32_16x16x32_bf16 v[136:139], a[172:175], v[60:63], v[136:139]
    ds_read_b128 v[44:47], v9 offset:64
    v_mfma_f32_16x16x32_bf16 v[140:143], a[152:155], v[52:55], v[140:143]
    ds_read_b128 v[48:51], v9 offset:128
    v_mfma_f32_16x16x32_bf16 v[140:143], a[164:167], v[56:59], v[140:143]
    ds_read_b128 v[52:55], v10 offset:0
    v_mfma_f32_16x16x32_bf16 v[140:143], a[176:179], v[60:63], v[140:143]
    ds_read_b128 v[56:59], v10 offset:64
    v_mfma_f32_16x16x32_bf16 v[132:135], a[180:183], v[64:67], v[132:135]
    ds_read_b128 v[60:63], v10 offset:128
    v_mfma_f32_16x16x32_bf16 v[132:135], a[192:195], v[68:71], v[132:135]
    v_mfma_f32_16x16x32_bf16 v[132:135], a[204:207], v[72:75], v[132:135]
    v_mfma_f32_16x16x32_bf16 v[136:139], a[184:187], v[64:67], v[136:139]
    v_mfma_f32_16x16x32_bf16 v[136:139], a[196:199], v[68:71], v[136:139]
    v_mfma_f32_16x16x32_bf16 v[136:139], a[208:211], v[72:75], v[136:139]
    v_mfma_f32_16x16x32_bf16 v[140:143], a[188:191], v[64:67], v[140:143]
    ds_read_b128 v[64:67], v11 offset:0
    v_mfma_f32_16x16x32_bf16 v[140:143], a[200:203], v[68:71], v[140:143]
    ds_read_b128 v[68:71], v11 offset:64
    v_mfma_f32_16x16x32_bf16 v[140:143], a[212:215], v[72:75], v[140:143]
    ds_read_b128 v[72:75], v11 offset:128
    s_waitcnt lgkmcnt(6)
    v_mfma_f32_16x16x32_bf16 v[144:147], a[216:219], v[40:43], v[120:123]
    v_xor_b32 v12, 0x4000, v12
    v_mfma_f32_16x16x32_bf16 v[144:147], a[228:231], v[44:47], v[144:147]
    v_xor_b32 v13, 0x4000, v13
    v_mfma_f32_16x16x32_bf16 v[144:147], a[240:243], v[48:51], v[144:147]
    v_xor_b32 v14, 0x4000, v14
    s_waitcnt lgkmcnt(3)
    v_mfma_f32_16x16x32_bf16 v[144:147], a[252:255], v[52:55], v[144:147]
    v_mfma_f32_16x16x32_bf16 v[144:147], v[176:179], v[56:59], v[144:147]
    v_mfma_f32_16x16x32_bf16 v[144:147], v[188:191], v[60:63], v[144:147]
    s_waitcnt lgkmcnt(0)
    v_mfma_f32_16x16x32_bf16 v[144:147], v[200:203], v[64:67], v[144:147]
    ds_read_b128 v[84:87], v15
    v_mfma_f32_16x16x32_bf16 v[144:147], v[212:215], v[68:71], v[144:147]
    ds_read_b128 v[88:91], v16
    v_mfma_f32_16x16x32_bf16 v[144:147], v[224:227], v[72:75], v[144:147]
    ds_read_b128 v[92:95], v17
    v_mfma_f32_16x16x32_bf16 v[148:151], a[220:223], v[40:43], v[124:127]
    v_xor_b32 v15, 0x4000, v15
    v_mfma_f32_16x16x32_bf16 v[148:151], a[232:235], v[44:47], v[148:151]
    v_xor_b32 v16, 0x4000, v16
    v_mfma_f32_16x16x32_bf16 v[148:151], a[244:247], v[48:51], v[148:151]
    v_xor_b32 v17, 0x4000, v17
    v_mfma_f32_16x16x32_bf16 v[148:151], v[168:171], v[52:55], v[148:151]
    s_waitcnt lgkmcnt(2)
    buffer_store_dwordx4 v[84:87], v18, s[20:23], s35 offen offset:0 sc1
    v_mfma_f32_16x16x32_bf16 v[148:151], v[180:183], v[56:59], v[148:151]
    v_mfma_f32_16x16x32_bf16 v[148:151], v[192:195], v[60:63], v[148:151]
    v_mfma_f32_16x16x32_bf16 v[148:151], v[204:207], v[64:67], v[148:151]
    v_mfma_f32_16x16x32_bf16 v[148:151], v[216:219], v[68:71], v[148:151]
    v_mfma_f32_16x16x32_bf16 v[148:151], v[228:231], v[72:75], v[148:151]
    v_cvt_pk_bf16_f32 v76, v144, v145
    v_mfma_f32_16x16x32_bf16 v[152:155], a[224:227], v[40:43], v[128:131]
    ds_read_b128 v[40:43], v9 offset:3072
    v_cvt_pk_bf16_f32 v77, v146, v147
    v_mfma_f32_16x16x32_bf16 v[152:155], a[236:239], v[44:47], v[152:155]
    ds_read_b128 v[44:47], v9 offset:3136
    ds_write_b64 v12, v[76:77] offset:0
    v_mfma_f32_16x16x32_bf16 v[152:155], a[248:251], v[48:51], v[152:155]
    s_waitcnt lgkmcnt(4)
    buffer_store_dwordx4 v[88:91], v18, s[20:23], s35 offen offset:1024 sc1
    ds_read_b128 v[48:51], v9 offset:3200
    v_mfma_f32_16x16x32_bf16 v[152:155], v[172:175], v[52:55], v[152:155]
    ds_read_b128 v[52:55], v10 offset:3072
    v_mfma_f32_16x16x32_bf16 v[152:155], v[184:187], v[56:59], v[152:155]
    ds_read_b128 v[56:59], v10 offset:3136
    v_mfma_f32_16x16x32_bf16 v[152:155], v[196:199], v[60:63], v[152:155]
    ds_read_b128 v[60:63], v10 offset:3200
    v_mfma_f32_16x16x32_bf16 v[152:155], v[208:211], v[64:67], v[152:155]
    ds_read_b128 v[64:67], v11 offset:3072
    v_mfma_f32_16x16x32_bf16 v[152:155], v[220:223], v[68:71], v[152:155]
    ds_read_b128 v[68:71], v11 offset:3136
    v_mfma_f32_16x16x32_bf16 v[152:155], v[232:235], v[72:75], v[152:155]
    ds_read_b128 v[72:75], v11 offset:3200
    v_cvt_pk_bf16_f32 v78, v148, v149
    s_waitcnt lgkmcnt(6)
    v_mfma_f32_16x16x32_bf16 v[156:159], a[216:219], v[40:43], v[132:135]
    v_cvt_pk_bf16_f32 v79, v150, v151
    v_mfma_f32_16x16x32_bf16 v[156:159], a[228:231], v[44:47], v[156:159]
    buffer_store_dwordx4 v[92:95], v18, s[20:23], s35 offen offset:2048 sc1
    ds_write_b64 v13, v[78:79] offset:0
    v_mfma_f32_16x16x32_bf16 v[156:159], a[240:243], v[48:51], v[156:159]
    s_add_u32 s35, s35, 196608
    s_waitcnt lgkmcnt(4)
    v_mfma_f32_16x16x32_bf16 v[156:159], a[252:255], v[52:55], v[156:159]
    v_mfma_f32_16x16x32_bf16 v[156:159], v[176:179], v[56:59], v[156:159]
    v_mfma_f32_16x16x32_bf16 v[156:159], v[188:191], v[60:63], v[156:159]
    s_waitcnt lgkmcnt(1)
    v_mfma_f32_16x16x32_bf16 v[156:159], v[200:203], v[64:67], v[156:159]
    v_mfma_f32_16x16x32_bf16 v[156:159], v[212:215], v[68:71], v[156:159]
    v_mfma_f32_16x16x32_bf16 v[156:159], v[224:227], v[72:75], v[156:159]
    v_cvt_pk_bf16_f32 v80, v152, v153
    v_mfma_f32_16x16x32_bf16 v[160:163], a[220:223], v[40:43], v[136:139]
    v_cvt_pk_bf16_f32 v81, v154, v155
    v_mfma_f32_16x16x32_bf16 v[160:163], a[232:235], v[44:47], v[160:163]
    ds_write_b64 v14, v[80:81] offset:0
    v_mfma_f32_16x16x32_bf16 v[160:163], a[244:247], v[48:51], v[160:163]
    v_mfma_f32_16x16x32_bf16 v[160:163], v[168:171], v[52:55], v[160:163]
    v_mfma_f32_16x16x32_bf16 v[160:163], v[180:183], v[56:59], v[160:163]
    v_mfma_f32_16x16x32_bf16 v[160:163], v[192:195], v[60:63], v[160:163]
    v_mfma_f32_16x16x32_bf16 v[160:163], v[204:207], v[64:67], v[160:163]
    v_mfma_f32_16x16x32_bf16 v[160:163], v[216:219], v[68:71], v[160:163]
    v_mfma_f32_16x16x32_bf16 v[160:163], v[228:231], v[72:75], v[160:163]
    v_cvt_pk_bf16_f32 v76, v156, v157
    v_mfma_f32_16x16x32_bf16 v[164:167], a[224:227], v[40:43], v[140:143]
    v_cvt_pk_bf16_f32 v77, v158, v159
    v_mfma_f32_16x16x32_bf16 v[164:167], a[236:239], v[44:47], v[164:167]
    ds_write_b64 v12, v[76:77] offset:3072
    v_mfma_f32_16x16x32_bf16 v[164:167], a[248:251], v[48:51], v[164:167]
    v_mfma_f32_16x16x32_bf16 v[164:167], v[172:175], v[52:55], v[164:167]
    v_mfma_f32_16x16x32_bf16 v[164:167], v[184:187], v[56:59], v[164:167]
    v_mfma_f32_16x16x32_bf16 v[164:167], v[196:199], v[60:63], v[164:167]
    v_mfma_f32_16x16x32_bf16 v[164:167], v[208:211], v[64:67], v[164:167]
    v_mfma_f32_16x16x32_bf16 v[164:167], v[220:223], v[68:71], v[164:167]
    v_mfma_f32_16x16x32_bf16 v[164:167], v[232:235], v[72:75], v[164:167]
    v_cvt_pk_bf16_f32 v78, v160, v161
    s_nop 7
    v_cvt_pk_bf16_f32 v79, v162, v163
    ds_write_b64 v13, v[78:79] offset:3072
    v_cvt_pk_bf16_f32 v80, v164, v165
    v_cvt_pk_bf16_f32 v81, v166, v167
    ds_write_b64 v14, v[80:81] offset:3072
    s_waitcnt lgkmcnt(0)
    s_barrier
    ds_read_b128 v[84:87], v15
    ds_read_b128 v[88:91], v16
    ds_read_b128 v[92:95], v17
    s_waitcnt lgkmcnt(2)
    buffer_store_dwordx4 v[84:87], v18, s[20:23], s35 offen offset:0 sc1
    s_waitcnt lgkmcnt(1)
    buffer_store_dwordx4 v[88:91], v18, s[20:23], s35 offen offset:1024 sc1
    s_waitcnt lgkmcnt(0)
    buffer_store_dwordx4 v[92:95], v18, s[20:23], s35 offen offset:2048 sc1
L_end:
    s_endpgm
L_slow:
    s_mov_b32 s38, 0
L_slowx:
    ds_read_b128 v[236:239], v244
    s_waitcnt lgkmcnt(0)
    v_min3_u32 v245, v236, v237, v238
    v_min_u32 v245, v245, v239
    s_add_u32 s38, s38, 1
    v_readfirstlane_b32 s57, v245
    s_cmp_gt_u32 s38, 0x40000
    s_cbranch_scc1 L_back
    s_cmp_ge_u32 s57, s63
    s_cbranch_scc0 L_slowx
    s_branch L_back
L_slowP:
    s_mov_b32 s38, 0
L_slowxP:
    ds_read_b128 v[236:239], v244
    s_waitcnt lgkmcnt(0)
    v_min3_u32 v245, v236, v237, v238
    v_min_u32 v245, v245, v239
    s_add_u32 s38, s38, 1
    v_readfirstlane_b32 s57, v245
    s_cmp_gt_u32 s38, 0x40000
    s_cbranch_scc1 L_backP
    s_cmp_ge_u32 s57, s63
    s_cbranch_scc0 L_slowxP
    s_branch L_backP
.section .rodata,"a"
.p2align 6
.amdhsa_kernel standalone__dilated_atrous__vision_kernel
  .amdhsa_next_free_vgpr 512
  .amdhsa_next_free_sgpr 100
  .amdhsa_accum_offset 256
  .amdhsa_group_segment_fixed_size 0
  .amdhsa_kernarg_size 40
  .amdhsa_user_sgpr_count 2
  .amdhsa_user_sgpr_kernarg_segment_ptr 1
  .amdhsa_system_sgpr_workgroup_id_x 1
.end_amdhsa_kernel
```

```asm
; @launch grid=(256,1,1) block=(256,1,1) lds=163840
.amdgcn_target "amdgcn-amd-amdhsa--gfx950"
.text
.globl standalone__dilated_atrous__vision_kernel
.p2align 8
.type standalone__dilated_atrous__vision_kernel,@function
standalone__dilated_atrous__vision_kernel:
    s_cmp_ge_u32 s2, 256
    s_cbranch_scc1 L_end
    s_load_dwordx4 s[4:7], s[0:1], 0
    s_load_dwordx2 s[8:9], s[0:1], 16
    v_lshrrev_b32 v29, 6, v0
    s_and_b32 s37, s2, 7
    v_readfirstlane_b32 s24, v29
    s_lshr_b32 s38, s2, 3
    s_and_b32 s38, s38, 1
    s_lshr_b32 s39, s2, 4
    s_lshl_b32 s39, s39, 5
    s_add_u32 s25, s39, s38
    s_mul_i32 s40, s37, 12288
    s_sub_u32 s41, s40, 384
    v_mul_u32_u24 v31, 43691, v0
    v_lshlrev_b32 v32, 4, v0
    v_lshrrev_b32 v31, 19, v31
    v_and_b32 v33, 4, v31
    v_and_b32 v34, 8, v31
    v_lshlrev_b32 v33, 3, v33
    v_lshlrev_b32 v34, 2, v34
    v_xor_b32 v33, v33, v32
    v_xor_b32 v19, v34, v32
    v_add_u32 v2, s41, v33
    v_add_u32 v30, 256, v0
    v_mul_u32_u24 v31, 43691, v30
    v_lshlrev_b32 v32, 4, v30
    v_lshrrev_b32 v31, 19, v31
    v_and_b32 v33, 4, v31
    v_and_b32 v34, 8, v31
    v_lshlrev_b32 v33, 3, v33
    v_lshlrev_b32 v34, 2, v34
    v_xor_b32 v33, v33, v32
    v_xor_b32 v20, v34, v32
    v_add_u32 v3, s41, v33
    v_add_u32 v30, 512, v0
    v_mul_u32_u24 v31, 43691, v30
    v_lshlrev_b32 v32, 4, v30
    v_lshrrev_b32 v31, 19, v31
    v_and_b32 v33, 4, v31
    v_and_b32 v34, 8, v31
    v_lshlrev_b32 v33, 3, v33
    v_lshlrev_b32 v34, 2, v34
    v_xor_b32 v33, v33, v32
    v_xor_b32 v21, v34, v32
    v_add_u32 v4, s41, v33
    s_cmp_eq_u32 s37, 0
    s_cselect_b32 s42, 24, 0
    v_mov_b32 v35, 0x80000000
    v_cmp_gt_u32 vcc, s42, v0
    v_and_b32 v36, 63, v0
    s_lshl_b32 s26, s24, 10
    v_cndmask_b32 v2, v2, v35, vcc
    s_add_u32 s27, s26, 4096
    s_add_u32 s28, s26, 8192
    s_mov_b32 s29, 12288
    s_cmp_eq_u32 s37, 7
    s_cselect_b32 s45, 24, 48
    s_add_u32 s44, s41, 12288
    v_cmp_gt_u32 vcc, s45, v36
    v_lshlrev_b32 v29, 4, v36
    v_add_u32 v29, s44, v29
    v_cndmask_b32 v5, v35, v29, vcc
    s_lshl_b32 s47, s24, 9
    s_mul_i32 s43, s24, 192
    s_add_u32 s62, s43, 12288
    s_add_u32 s44, s41, s62
    s_lshl_b32 s45, s37, 2
    s_add_u32 s45, s45, s24
    s_cmp_ge_u32 s45, 30
    s_cselect_b32 s44, 0x80000000, s44
    v_lshlrev_b32 v29, 4, v36
    v_add_u32 v1, s44, v29
    s_lshr_b32 s45, s2, 3
    s_lshl_b32 s45, s45, 2
    s_add_u32 s45, s45, s24
    s_mul_i32 s45, s45, 1408
    v_lshl_add_u32 v39, v36, 7, s45
    s_mov_b32 s33, s25
    s_mul_i32 s32, s33, 98304
    s_add_u32 s34, s25, 33
    s_min_u32 s34, s34, 512
    s_mov_b32 s14, 50331648
    s_mov_b32 s15, 0x20000
    s_mov_b32 s18, 165888
    s_mov_b32 s19, 0x20000
    s_mov_b32 s30, 0
    s_mov_b32 s31, 0
    s_waitcnt lgkmcnt(0)
    s_mov_b32 s12, s4
    s_and_b32 s13, s5, 0xffff
    s_add_u32 m0, s31, s26
    s_nop 0
    buffer_load_dwordx4 v2, s[12:15], s32 offen nt lds
    s_add_u32 m0, s31, s27
    s_nop 0
    buffer_load_dwordx4 v3, s[12:15], s32 offen nt lds
    s_add_u32 m0, s31, s28
    s_nop 0
    buffer_load_dwordx4 v4, s[12:15], s32 offen nt lds
    s_add_u32 m0, s31, s62
    s_nop 0
    s_mov_b64 exec, 0xfff
    buffer_load_dwordx4 v1, s[12:15], s32 offen nt lds
    s_mov_b64 exec, -1
    s_mov_b32 s16, s6
    s_and_b32 s17, s7, 0xffff
    s_lshl_b32 s42, s24, 5
    s_add_u32 s42, s42, 3328
    v_add_u32 v30, s42, v36
    v_mul_u32_u24 v31, 43691, v30
    v_lshlrev_b32 v32, 4, v30
    v_lshrrev_b32 v31, 19, v31
    v_and_b32 v34, 8, v31
    v_lshlrev_b32 v34, 2, v34
    v_xor_b32 v22, v34, v32
    s_add_u32 m0, s26, 53248
    s_mov_b32 s46, 0
    buffer_load_dwordx4 v19, s[16:19], s46 offen lds
    s_add_u32 m0, s26, 57344
    s_nop 0
    buffer_load_dwordx4 v20, s[16:19], s46 offen lds
    s_add_u32 m0, s26, 61440
    s_nop 0
    buffer_load_dwordx4 v21, s[16:19], s46 offen lds
    s_add_u32 m0, s26, 65536
    s_mov_b32 s46, 12288
    buffer_load_dwordx4 v19, s[16:19], s46 offen lds
    s_add_u32 m0, s26, 69632
    s_nop 0
    buffer_load_dwordx4 v20, s[16:19], s46 offen lds
    s_mov_b32 s16, s6
    s_and_b32 s17, s7, 0xffff
    s_mov_b64 exec, 0x7ff
    buffer_load_dword v38, v39, s[16:19], 0 offen
    s_mov_b64 exec, -1
    v_and_b32 v29, 15, v36
    v_lshrrev_b32 v30, 4, v36
    s_lshr_b32 s42, s24, 1
    s_and_b32 s43, s24, 1
    s_lshl_b32 s42, s42, 5
    s_mul_i32 s43, s43, 96
    v_lshlrev_b32 v31, 4, v30
    v_add_u32 v32, s42, v29
    v_and_b32 v33, 4, v32
    v_mul_u32_u24 v34, 192, v32
    v_lshlrev_b32 v33, 3, v33
    v_xor_b32 v33, v33, v31
    v_add_u32 v6, v34, v33
    v_mov_b32 v9, v6
    v_add_u32 v32, s42, v29
    v_add_u32 v32, 2, v32
    v_and_b32 v33, 4, v32
    v_mul_u32_u24 v34, 192, v32
    v_lshlrev_b32 v33, 3, v33
    v_xor_b32 v33, v33, v31
    v_add_u32 v7, v34, v33
    v_mov_b32 v10, v7
    v_add_u32 v32, s42, v29
    v_add_u32 v32, 4, v32
    v_and_b32 v33, 4, v32
    v_mul_u32_u24 v34, 192, v32
    v_lshlrev_b32 v33, 3, v33
    v_xor_b32 v33, v33, v31
    v_add_u32 v8, v34, v33
    v_mov_b32 v11, v8
    v_lshrrev_b32 v32, 2, v29
    v_lshl_add_u32 v32, v30, 3, v32
    v_mul_u32_u24 v32, 192, v32
    v_and_b32 v33, 3, v29
    v_lshlrev_b32 v33, 3, v33
    v_and_b32 v34, 1, v30
    v_lshlrev_b32 v34, 5, v34
    v_add_u32 v33, s43, v33
    v_add_u32 v35, 0, v33
    v_xor_b32 v35, v35, v34
    v_add_u32 v35, v35, v32
    v_add_u32 v23, 53248, v35
    v_add_u32 v26, 108544, v35
    v_add_u32 v35, 32, v33
    v_xor_b32 v35, v35, v34
    v_add_u32 v35, v35, v32
    v_add_u32 v24, 53248, v35
    v_add_u32 v27, 108544, v35
    v_add_u32 v35, 64, v33
    v_xor_b32 v35, v35, v34
    v_add_u32 v35, v35, v32
    v_add_u32 v25, 53248, v35
    v_add_u32 v28, 108544, v35
    v_add_u32 v32, s42, v29
    v_mul_u32_u24 v32, 192, v32
    v_add_u32 v32, 65536, v32
    v_lshlrev_b32 v33, 3, v29
    v_and_b32 v33, 0x30, v33
    v_lshlrev_b32 v34, 3, v30
    v_add_u32 v34, s43, v34
    v_add_u32 v35, 0, v34
    v_xor_b32 v35, v35, v33
    v_add_u32 v12, v35, v32
    v_add_u32 v35, 32, v34
    v_xor_b32 v35, v35, v33
    v_add_u32 v13, v35, v32
    v_add_u32 v35, 64, v34
    v_xor_b32 v35, v35, v33
    v_add_u32 v14, v35, v32
    s_mul_i32 s44, s24, 192
    v_add_u32 v32, s44, v36
    v_mul_u32_u24 v33, 43691, v32
    v_lshlrev_b32 v34, 4, v32
    v_lshrrev_b32 v33, 16, v33
    v_and_b32 v33, 0x30, v33
    v_xor_b32 v34, v34, v33
    v_add_u32 v15, 65536, v34
    v_add_u32 v32, s44, v36
    v_add_u32 v32, 64, v32
    v_mul_u32_u24 v33, 43691, v32
    v_lshlrev_b32 v34, 4, v32
    v_lshrrev_b32 v33, 16, v33
    v_and_b32 v33, 0x30, v33
    v_xor_b32 v34, v34, v33
    v_add_u32 v16, 65536, v34
    v_add_u32 v32, s44, v36
    v_add_u32 v32, 128, v32
    v_mul_u32_u24 v33, 43691, v32
    v_lshlrev_b32 v34, 4, v32
    v_lshrrev_b32 v33, 16, v33
    v_and_b32 v33, 0x30, v33
    v_xor_b32 v34, v34, v33
    v_add_u32 v17, 65536, v34
    s_lshl_b32 s45, s24, 8
    v_lshlrev_b32 v32, 2, v36
    v_add_u32 v32, s45, v32
    v_add_u32 v242, 108608, v32
    s_lshl_b32 s45, s24, 2
    s_add_u32 s45, s45, 108544
    v_cmp_eq_u32 vcc, 0, v36
    v_mov_b32 v32, s45
    v_mov_b32 v244, 108544
    v_cndmask_b32 v242, v242, v32, vcc
    v_mov_b32 v243, 2
    s_mov_b32 s63, 2
    s_mul_i32 s45, s24, 3072
    s_add_u32 s45, s45, s40
    v_lshlrev_b32 v32, 4, v36
    v_add_u32 v18, s45, v32
    s_mov_b32 s20, s8
    s_and_b32 s21, s9, 0xffff
    s_mov_b32 s22, 50331648
    s_mov_b32 s23, 0x20000
    s_mul_i32 s35, s25, 98304
    s_add_u32 m0, s26, 73728
    s_nop 0
    buffer_load_dwordx4 v21, s[16:19], s46 offen lds
    s_add_u32 m0, s26, 77824
    s_mov_b32 s46, 24576
    buffer_load_dwordx4 v19, s[16:19], s46 offen lds
    s_add_u32 m0, s26, 81920
    s_nop 0
    buffer_load_dwordx4 v20, s[16:19], s46 offen lds
    s_add_u32 m0, s26, 86016
    s_nop 0
    buffer_load_dwordx4 v21, s[16:19], s46 offen lds
    s_waitcnt vmcnt(5)
    s_barrier
    ds_read_b128 v[40:43], v6 offset:0
    ds_read_b64_tr_b16 a[0:1], v23 offset:0
    ds_read_b64_tr_b16 a[2:3], v23 offset:768
    ds_read_b128 v[44:47], v6 offset:64
    ds_read_b64_tr_b16 a[12:13], v23 offset:6144
    ds_read_b64_tr_b16 a[14:15], v23 offset:6912
    ds_read_b128 v[48:51], v6 offset:128
    ds_read_b64_tr_b16 a[24:25], v23 offset:12288
    ds_read_b64_tr_b16 a[26:27], v23 offset:13056
    ds_read_b64_tr_b16 a[4:5], v24 offset:0
    ds_read_b64_tr_b16 a[6:7], v24 offset:768
    s_waitcnt lgkmcnt(2)
    v_mfma_f32_16x16x32_bf16 v[120:123], a[0:3], v[40:43], 0
    s_add_u32 m0, s26, 90112
    s_mov_b32 s46, 36864
    ds_read_b64_tr_b16 a[16:17], v24 offset:6144
    ds_read_b64_tr_b16 a[18:19], v24 offset:6912
    v_mfma_f32_16x16x32_bf16 v[120:123], a[12:15], v[44:47], v[120:123]
    ds_read_b128 v[84:87], v6 offset:3072
    buffer_load_dwordx4 v19, s[16:19], s46 offen lds
    s_add_u32 m0, s26, 94208
    ds_read_b64_tr_b16 a[28:29], v24 offset:12288
    ds_read_b64_tr_b16 a[30:31], v24 offset:13056
    v_mfma_f32_16x16x32_bf16 v[120:123], a[24:27], v[48:51], v[120:123]
    ds_read_b128 v[88:91], v6 offset:3136
    buffer_load_dwordx4 v20, s[16:19], s46 offen lds
    s_add_u32 m0, s26, 98304
    ds_read_b64_tr_b16 a[8:9], v25 offset:0
    ds_read_b64_tr_b16 a[10:11], v25 offset:768
    s_waitcnt lgkmcnt(3)
    v_mfma_f32_16x16x32_bf16 v[124:127], a[4:7], v[40:43], 0
    ds_read_b128 v[92:95], v6 offset:3200
    buffer_load_dwordx4 v21, s[16:19], s46 offen lds
    s_add_u32 m0, s26, 102400
    s_mov_b32 s46, 49152
    ds_read_b64_tr_b16 a[20:21], v25 offset:6144
    ds_read_b64_tr_b16 a[22:23], v25 offset:6912
    v_mfma_f32_16x16x32_bf16 v[124:127], a[16:19], v[44:47], v[124:127]
    buffer_load_dwordx4 v19, s[16:19], s46 offen lds
    s_add_u32 m0, s47, 106496
    s_mov_b32 s46, 0
    ds_read_b64_tr_b16 a[32:33], v25 offset:12288
    ds_read_b64_tr_b16 a[34:35], v25 offset:13056
    v_mfma_f32_16x16x32_bf16 v[124:127], a[28:31], v[48:51], v[124:127]
    s_mov_b32 exec_hi, 0
    buffer_load_dwordx4 v22, s[16:19], s46 offen lds
    s_mov_b64 exec, -1
    s_waitcnt lgkmcnt(0)
    v_mfma_f32_16x16x32_bf16 v[128:131], a[8:11], v[40:43], 0
    s_add_u32 m0, s26, 108544
    s_mov_b32 s46, 55296
    v_mfma_f32_16x16x32_bf16 v[128:131], a[20:23], v[44:47], v[128:131]
    s_waitcnt vmcnt(5)
    s_barrier
    ds_read_b64_tr_b16 a[36:37], v23 offset:18432
    v_mfma_f32_16x16x32_bf16 v[128:131], a[32:35], v[48:51], v[128:131]
    ds_read_b64_tr_b16 a[38:39], v23 offset:19200
    buffer_load_dwordx4 v19, s[16:19], s46 offen lds
    v_mfma_f32_16x16x32_bf16 v[132:135], a[0:3], v[84:87], 0
    ds_read_b64_tr_b16 a[48:49], v23 offset:24576
    ds_read_b64_tr_b16 a[50:51], v23 offset:25344
    ds_read_b128 v[52:55], v7 offset:0
    v_mfma_f32_16x16x32_bf16 v[132:135], a[12:15], v[88:91], v[132:135]
    ds_read_b64_tr_b16 a[60:61], v23 offset:30720
    ds_read_b64_tr_b16 a[62:63], v23 offset:31488
    ds_read_b128 v[56:59], v7 offset:64
    v_mfma_f32_16x16x32_bf16 v[132:135], a[24:27], v[92:95], v[132:135]
    s_add_u32 m0, s26, 112640
    ds_read_b64_tr_b16 a[40:41], v24 offset:18432
    ds_read_b64_tr_b16 a[42:43], v24 offset:19200
    v_mfma_f32_16x16x32_bf16 v[136:139], a[4:7], v[84:87], 0
    ds_read_b128 v[60:63], v7 offset:128
    buffer_load_dwordx4 v20, s[16:19], s46 offen lds
    ds_read_b64_tr_b16 a[52:53], v24 offset:24576
    v_mfma_f32_16x16x32_bf16 v[136:139], a[16:19], v[88:91], v[136:139]
    ds_read_b64_tr_b16 a[54:55], v24 offset:25344
    ds_read_b64_tr_b16 a[64:65], v24 offset:30720
    ds_read_b64_tr_b16 a[66:67], v24 offset:31488
    v_mfma_f32_16x16x32_bf16 v[136:139], a[28:31], v[92:95], v[136:139]
    ds_read_b128 v[96:99], v7 offset:3072
    s_add_u32 m0, s26, 116736
    ds_read_b64_tr_b16 a[44:45], v25 offset:18432
    v_mfma_f32_16x16x32_bf16 v[140:143], a[8:11], v[84:87], 0
    ds_read_b64_tr_b16 a[46:47], v25 offset:19200
    ds_read_b128 v[100:103], v7 offset:3136
    buffer_load_dwordx4 v21, s[16:19], s46 offen lds
    v_mfma_f32_16x16x32_bf16 v[140:143], a[20:23], v[88:91], v[140:143]
    ds_read_b64_tr_b16 a[56:57], v25 offset:24576
    ds_read_b64_tr_b16 a[58:59], v25 offset:25344
    ds_read_b128 v[104:107], v7 offset:3200
    v_mfma_f32_16x16x32_bf16 v[140:143], a[32:35], v[92:95], v[140:143]
    ds_read_b64_tr_b16 a[68:69], v25 offset:30720
    ds_read_b64_tr_b16 a[70:71], v25 offset:31488
    s_waitcnt lgkmcnt(13)
    v_mfma_f32_16x16x32_bf16 v[120:123], a[36:39], v[52:55], v[120:123]
    s_add_u32 m0, s26, 120832
    s_mov_b32 s46, 67584
    buffer_load_dwordx4 v19, s[16:19], s46 offen lds
    v_mfma_f32_16x16x32_bf16 v[120:123], a[48:51], v[56:59], v[120:123]
    s_add_u32 m0, s26, 124928
    v_mfma_f32_16x16x32_bf16 v[120:123], a[60:63], v[60:63], v[120:123]
    buffer_load_dwordx4 v20, s[16:19], s46 offen lds
    s_add_u32 m0, s26, 129024
    s_waitcnt lgkmcnt(9)
    v_mfma_f32_16x16x32_bf16 v[124:127], a[40:43], v[52:55], v[124:127]
    buffer_load_dwordx4 v21, s[16:19], s46 offen lds
    v_mfma_f32_16x16x32_bf16 v[124:127], a[52:55], v[56:59], v[124:127]
    s_add_u32 m0, s26, 133120
    s_mov_b32 s46, 79872
    v_mfma_f32_16x16x32_bf16 v[124:127], a[64:67], v[60:63], v[124:127]
    s_waitcnt vmcnt(6)
    s_barrier
    s_waitcnt lgkmcnt(0)
    v_mfma_f32_16x16x32_bf16 v[128:131], a[44:47], v[52:55], v[128:131]
    ds_read_b64_tr_b16 a[72:73], v23 offset:36864
    ds_read_b64_tr_b16 a[74:75], v23 offset:37632
    buffer_load_dwordx4 v19, s[16:19], s46 offen lds
    v_mfma_f32_16x16x32_bf16 v[128:131], a[56:59], v[56:59], v[128:131]
    ds_read_b64_tr_b16 a[84:85], v23 offset:43008
    ds_read_b64_tr_b16 a[86:87], v23 offset:43776
    ds_read_b128 v[64:67], v8 offset:0
    v_mfma_f32_16x16x32_bf16 v[128:131], a[68:71], v[60:63], v[128:131]
    ds_read_b64_tr_b16 a[96:97], v23 offset:49152
    ds_read_b64_tr_b16 a[98:99], v23 offset:49920
    v_mfma_f32_16x16x32_bf16 v[132:135], a[36:39], v[96:99], v[132:135]
    ds_read_b128 v[68:71], v8 offset:64
    s_add_u32 m0, s26, 137216
    ds_read_b64_tr_b16 a[76:77], v24 offset:36864
    v_mfma_f32_16x16x32_bf16 v[132:135], a[48:51], v[100:103], v[132:135]
    ds_read_b64_tr_b16 a[78:79], v24 offset:37632
    ds_read_b128 v[72:75], v8 offset:128
    buffer_load_dwordx4 v20, s[16:19], s46 offen lds
    v_mfma_f32_16x16x32_bf16 v[132:135], a[60:63], v[104:107], v[132:135]
    ds_read_b64_tr_b16 a[88:89], v24 offset:43008
    ds_read_b64_tr_b16 a[90:91], v24 offset:43776
    ds_read_b64_tr_b16 a[100:101], v24 offset:49152
    v_mfma_f32_16x16x32_bf16 v[136:139], a[40:43], v[96:99], v[136:139]
    ds_read_b64_tr_b16 a[102:103], v24 offset:49920
    ds_read_b128 v[108:111], v8 offset:3072
    s_add_u32 m0, s26, 141312
    v_mfma_f32_16x16x32_bf16 v[136:139], a[52:55], v[100:103], v[136:139]
    ds_read_b64_tr_b16 a[80:81], v25 offset:36864
    ds_read_b64_tr_b16 a[82:83], v25 offset:37632
    ds_read_b128 v[112:115], v8 offset:3136
    v_mfma_f32_16x16x32_bf16 v[136:139], a[64:67], v[104:107], v[136:139]
    buffer_load_dwordx4 v21, s[16:19], s46 offen lds
    ds_read_b64_tr_b16 a[92:93], v25 offset:43008
    ds_read_b64_tr_b16 a[94:95], v25 offset:43776
    v_mfma_f32_16x16x32_bf16 v[140:143], a[44:47], v[96:99], v[140:143]
    ds_read_b128 v[116:119], v8 offset:3200
    ds_read_b64_tr_b16 a[104:105], v25 offset:49152
    ds_read_b64_tr_b16 a[106:107], v25 offset:49920
    v_mfma_f32_16x16x32_bf16 v[140:143], a[56:59], v[100:103], v[140:143]
    s_add_u32 m0, s26, 145408
    s_mov_b32 s46, 92160
    buffer_load_dwordx4 v19, s[16:19], s46 offen lds
    v_mfma_f32_16x16x32_bf16 v[140:143], a[68:71], v[104:107], v[140:143]
    s_add_u32 m0, s26, 149504
    s_waitcnt lgkmcnt(13)
    v_mfma_f32_16x16x32_bf16 v[120:123], a[72:75], v[64:67], v[120:123]
    buffer_load_dwordx4 v20, s[16:19], s46 offen lds
    v_mfma_f32_16x16x32_bf16 v[120:123], a[84:87], v[68:71], v[120:123]
    s_add_u32 m0, s26, 153600
    v_mfma_f32_16x16x32_bf16 v[120:123], a[96:99], v[72:75], v[120:123]
    buffer_load_dwordx4 v21, s[16:19], s46 offen lds
    s_waitcnt lgkmcnt(9)
    v_mfma_f32_16x16x32_bf16 v[124:127], a[76:79], v[64:67], v[124:127]
    v_mfma_f32_16x16x32_bf16 v[124:127], a[88:91], v[68:71], v[124:127]
    s_add_u32 m0, s26, 157696
    s_mov_b32 s46, 104448
    v_mfma_f32_16x16x32_bf16 v[124:127], a[100:103], v[72:75], v[124:127]
    s_waitcnt vmcnt(7)
    s_barrier
    s_waitcnt lgkmcnt(0)
    v_mfma_f32_16x16x32_bf16 v[128:131], a[80:83], v[64:67], v[128:131]
    ds_read_b64_tr_b16 a[108:109], v26 offset:0
    ds_read_b64_tr_b16 a[110:111], v26 offset:768
    buffer_load_dwordx4 v19, s[16:19], s46 offen lds
    v_mfma_f32_16x16x32_bf16 v[128:131], a[92:95], v[68:71], v[128:131]
    ds_read_b64_tr_b16 a[120:121], v26 offset:6144
    ds_read_b64_tr_b16 a[122:123], v26 offset:6912
    ds_read_b64_tr_b16 a[132:133], v26 offset:12288
    v_mfma_f32_16x16x32_bf16 v[128:131], a[104:107], v[72:75], v[128:131]
    ds_read_b64_tr_b16 a[134:135], v26 offset:13056
    s_add_u32 m0, s47, 161792
    v_mfma_f32_16x16x32_bf16 v[132:135], a[72:75], v[108:111], v[132:135]
    s_mov_b32 s46, 55296
    ds_read_b64_tr_b16 a[112:113], v27 offset:0
    ds_read_b64_tr_b16 a[114:115], v27 offset:768
    v_mfma_f32_16x16x32_bf16 v[132:135], a[84:87], v[112:115], v[132:135]
    s_mov_b32 exec_hi, 0
    buffer_load_dwordx4 v22, s[16:19], s46 offen lds
    s_mov_b64 exec, -1
    v_mfma_f32_16x16x32_bf16 v[132:135], a[96:99], v[116:119], v[132:135]
    ds_read_b64_tr_b16 a[124:125], v27 offset:6144
    ds_read_b64_tr_b16 a[126:127], v27 offset:6912
    ds_read_b64_tr_b16 a[136:137], v27 offset:12288
    v_mfma_f32_16x16x32_bf16 v[136:139], a[76:79], v[108:111], v[136:139]
    ds_read_b64_tr_b16 a[138:139], v27 offset:13056
    s_add_u32 s32, s32, 196608
    s_add_u32 s33, s33, 2
    v_mfma_f32_16x16x32_bf16 v[136:139], a[88:91], v[112:115], v[136:139]
    s_cmp_lt_u32 s33, s34
    s_cselect_b32 s14, 50331648, 0
    s_add_u32 s31, s31, 13312
    v_mfma_f32_16x16x32_bf16 v[136:139], a[100:103], v[116:119], v[136:139]
    s_cmp_eq_u32 s31, 53248
    s_cselect_b32 s31, 0, s31
    ds_read_b64_tr_b16 a[116:117], v28 offset:0
    v_mfma_f32_16x16x32_bf16 v[140:143], a[80:83], v[108:111], v[140:143]
    ds_read_b64_tr_b16 a[118:119], v28 offset:768
    s_add_u32 m0, s31, s26
    ds_read_b64_tr_b16 a[128:129], v28 offset:6144
    v_mfma_f32_16x16x32_bf16 v[140:143], a[92:95], v[112:115], v[140:143]
    ds_read_b64_tr_b16 a[130:131], v28 offset:6912
    buffer_load_dwordx4 v2, s[12:15], s32 offen nt lds
    ds_read_b64_tr_b16 a[140:141], v28 offset:12288
    v_mfma_f32_16x16x32_bf16 v[140:143], a[104:107], v[116:119], v[140:143]
    ds_read_b64_tr_b16 a[142:143], v28 offset:13056
    s_add_u32 m0, s31, s27
    s_waitcnt lgkmcnt(12)
    v_mfma_f32_16x16x32_bf16 v[144:147], a[108:111], v[40:43], 0
    buffer_load_dwordx4 v3, s[12:15], s32 offen nt lds
    s_add_u32 m0, s31, s28
    v_mfma_f32_16x16x32_bf16 v[144:147], a[120:123], v[44:47], v[144:147]
    buffer_load_dwordx4 v4, s[12:15], s32 offen nt lds
    v_mfma_f32_16x16x32_bf16 v[144:147], a[132:135], v[48:51], v[144:147]
    s_add_u32 m0, s31, s29
    s_waitcnt lgkmcnt(6)
    v_mfma_f32_16x16x32_bf16 v[148:151], a[112:115], v[40:43], 0
    buffer_load_dwordx4 v5, s[12:15], s32 offen nt lds
    v_mfma_f32_16x16x32_bf16 v[148:151], a[124:127], v[44:47], v[148:151]
    v_mfma_f32_16x16x32_bf16 v[148:151], a[136:139], v[48:51], v[148:151]
    s_waitcnt vmcnt(9)
    s_barrier
    s_waitcnt lgkmcnt(0)
    v_mfma_f32_16x16x32_bf16 v[152:155], a[116:119], v[40:43], 0
    ds_read_b64_tr_b16 a[144:145], v26 offset:18432
    ds_read_b64_tr_b16 a[146:147], v26 offset:19200
    s_add_u32 m0, s26, 53248
    v_mfma_f32_16x16x32_bf16 v[152:155], a[128:131], v[44:47], v[152:155]
    s_mov_b32 s46, 110592
    ds_read_b64_tr_b16 a[156:157], v26 offset:24576
    ds_read_b64_tr_b16 a[158:159], v26 offset:25344
    v_mfma_f32_16x16x32_bf16 v[152:155], a[140:143], v[48:51], v[152:155]
    buffer_load_dwordx4 v19, s[16:19], s46 offen lds
    ds_read_b64_tr_b16 a[168:169], v26 offset:30720
    ds_read_b64_tr_b16 a[170:171], v26 offset:31488
    v_mfma_f32_16x16x32_bf16 v[156:159], a[108:111], v[84:87], 0
    ds_read_b64_tr_b16 a[148:149], v27 offset:18432
    ds_read_b64_tr_b16 a[150:151], v27 offset:19200
    s_add_u32 m0, s26, 57344
    v_mfma_f32_16x16x32_bf16 v[156:159], a[120:123], v[88:91], v[156:159]
    ds_read_b64_tr_b16 a[160:161], v27 offset:24576
    ds_read_b64_tr_b16 a[162:163], v27 offset:25344
    buffer_load_dwordx4 v20, s[16:19], s46 offen lds
    v_mfma_f32_16x16x32_bf16 v[156:159], a[132:135], v[92:95], v[156:159]
    ds_read_b64_tr_b16 a[172:173], v27 offset:30720
    ds_read_b64_tr_b16 a[174:175], v27 offset:31488
    ds_read_b64_tr_b16 a[152:153], v28 offset:18432
    v_mfma_f32_16x16x32_bf16 v[160:163], a[112:115], v[84:87], 0
    ds_read_b64_tr_b16 a[154:155], v28 offset:19200
    s_add_u32 m0, s26, 61440
    ds_read_b64_tr_b16 a[164:165], v28 offset:24576
    v_mfma_f32_16x16x32_bf16 v[160:163], a[124:127], v[88:91], v[160:163]
    ds_read_b64_tr_b16 a[166:167], v28 offset:25344
    buffer_load_dwordx4 v21, s[16:19], s46 offen lds
    ds_read_b64_tr_b16 a[176:177], v28 offset:30720
    v_mfma_f32_16x16x32_bf16 v[160:163], a[136:139], v[92:95], v[160:163]
    ds_read_b64_tr_b16 a[178:179], v28 offset:31488
    s_add_u32 m0, s26, 65536
    s_mov_b32 s46, 122880
    v_mfma_f32_16x16x32_bf16 v[164:167], a[116:119], v[84:87], 0
    buffer_load_dwordx4 v19, s[16:19], s46 offen lds
    v_mfma_f32_16x16x32_bf16 v[164:167], a[128:131], v[88:91], v[164:167]
    v_mfma_f32_16x16x32_bf16 v[164:167], a[140:143], v[92:95], v[164:167]
    s_add_u32 m0, s26, 69632
    s_waitcnt lgkmcnt(12)
    v_mfma_f32_16x16x32_bf16 v[144:147], a[144:147], v[52:55], v[144:147]
    buffer_load_dwordx4 v20, s[16:19], s46 offen lds
    v_mfma_f32_16x16x32_bf16 v[144:147], a[156:159], v[56:59], v[144:147]
    v_mfma_f32_16x16x32_bf16 v[144:147], a[168:171], v[60:63], v[144:147]
    s_add_u32 m0, s26, 73728
    s_waitcnt lgkmcnt(6)
    v_mfma_f32_16x16x32_bf16 v[148:151], a[148:151], v[52:55], v[148:151]
    buffer_load_dwordx4 v21, s[16:19], s46 offen lds
    v_mfma_f32_16x16x32_bf16 v[148:151], a[160:163], v[56:59], v[148:151]
    v_mfma_f32_16x16x32_bf16 v[148:151], a[172:175], v[60:63], v[148:151]
    s_waitcnt vmcnt(10)
    s_barrier
    s_waitcnt lgkmcnt(0)
    v_mfma_f32_16x16x32_bf16 v[152:155], a[152:155], v[52:55], v[152:155]
    ds_read_b64_tr_b16 a[180:181], v26 offset:36864
    ds_read_b64_tr_b16 a[182:183], v26 offset:37632
    s_add_u32 m0, s26, 77824
    v_mfma_f32_16x16x32_bf16 v[152:155], a[164:167], v[56:59], v[152:155]
    s_mov_b32 s46, 135168
    ds_read_b64_tr_b16 a[192:193], v26 offset:43008
    ds_read_b64_tr_b16 a[194:195], v26 offset:43776
    v_mfma_f32_16x16x32_bf16 v[152:155], a[176:179], v[60:63], v[152:155]
    buffer_load_dwordx4 v19, s[16:19], s46 offen lds
    ds_read_b64_tr_b16 a[204:205], v26 offset:49152
    ds_read_b64_tr_b16 a[206:207], v26 offset:49920
    v_mfma_f32_16x16x32_bf16 v[156:159], a[144:147], v[96:99], v[156:159]
    ds_read_b64_tr_b16 a[184:185], v27 offset:36864
    ds_read_b64_tr_b16 a[186:187], v27 offset:37632
    s_add_u32 m0, s26, 81920
    v_mfma_f32_16x16x32_bf16 v[156:159], a[156:159], v[100:103], v[156:159]
    ds_read_b64_tr_b16 a[196:197], v27 offset:43008
    ds_read_b64_tr_b16 a[198:199], v27 offset:43776
    buffer_load_dwordx4 v20, s[16:19], s46 offen lds
    v_mfma_f32_16x16x32_bf16 v[156:159], a[168:171], v[104:107], v[156:159]
    ds_read_b64_tr_b16 a[208:209], v27 offset:49152
    ds_read_b64_tr_b16 a[210:211], v27 offset:49920
    ds_read_b64_tr_b16 a[188:189], v28 offset:36864
    v_mfma_f32_16x16x32_bf16 v[160:163], a[148:151], v[96:99], v[160:163]
    ds_read_b64_tr_b16 a[190:191], v28 offset:37632
    s_add_u32 m0, s26, 86016
    s_add_u32 s30, s30, 13312
    v_mfma_f32_16x16x32_bf16 v[160:163], a[160:163], v[100:103], v[160:163]
    ds_read_b64_tr_b16 a[200:201], v28 offset:43008
    ds_read_b64_tr_b16 a[202:203], v28 offset:43776
    buffer_load_dwordx4 v21, s[16:19], s46 offen lds
    v_mfma_f32_16x16x32_bf16 v[160:163], a[172:175], v[104:107], v[160:163]
    s_cmp_eq_u32 s30, 53248
    s_cselect_b32 s30, 0, s30
    ds_read_b64_tr_b16 a[212:213], v28 offset:49152
    v_mfma_f32_16x16x32_bf16 v[164:167], a[152:155], v[96:99], v[164:167]
    ds_read_b64_tr_b16 a[214:215], v28 offset:49920
    v_add_u32 v9, s30, v6
    s_add_u32 m0, s26, 90112
    v_mfma_f32_16x16x32_bf16 v[164:167], a[164:167], v[100:103], v[164:167]
    s_mov_b32 s46, 147456
    v_add_u32 v10, s30, v7
    buffer_load_dwordx4 v19, s[16:19], s46 offen lds
    v_mfma_f32_16x16x32_bf16 v[164:167], a[176:179], v[104:107], v[164:167]
    v_add_u32 v11, s30, v8
    s_add_u32 m0, s26, 94208
    s_waitcnt lgkmcnt(12)
    v_mfma_f32_16x16x32_bf16 v[144:147], a[180:183], v[64:67], v[144:147]
    buffer_load_dwordx4 v20, s[16:19], s46 offen lds
    v_mfma_f32_16x16x32_bf16 v[144:147], a[192:195], v[68:71], v[144:147]
    v_mfma_f32_16x16x32_bf16 v[144:147], a[204:207], v[72:75], v[144:147]
    s_add_u32 m0, s26, 98304
    s_waitcnt lgkmcnt(6)
    v_mfma_f32_16x16x32_bf16 v[148:151], a[184:187], v[64:67], v[148:151]
    buffer_load_dwordx4 v21, s[16:19], s46 offen lds
    v_mfma_f32_16x16x32_bf16 v[148:151], a[196:199], v[68:71], v[148:151]
    v_mfma_f32_16x16x32_bf16 v[148:151], a[208:211], v[72:75], v[148:151]
    s_add_u32 m0, s26, 102400
    s_mov_b32 s46, 159744
    s_waitcnt lgkmcnt(0)
    v_mfma_f32_16x16x32_bf16 v[152:155], a[188:191], v[64:67], v[152:155]
    s_waitcnt vmcnt(12)
    s_barrier
    buffer_load_dwordx4 v19, s[16:19], s46 offen lds
    v_mfma_f32_16x16x32_bf16 v[152:155], a[200:203], v[68:71], v[152:155]
    ds_read_b128 v[40:43], v9 offset:0
    ds_read_b128 v[44:47], v9 offset:64
    v_mfma_f32_16x16x32_bf16 v[152:155], a[212:215], v[72:75], v[152:155]
    s_add_u32 m0, s47, 106496
    s_mov_b32 s46, 110592
    ds_read_b128 v[48:51], v9 offset:128
    v_mfma_f32_16x16x32_bf16 v[156:159], a[180:183], v[108:111], v[156:159]
    s_mov_b32 exec_hi, 0
    buffer_load_dwordx4 v22, s[16:19], s46 offen lds
    s_mov_b64 exec, -1
    v_mfma_f32_16x16x32_bf16 v[156:159], a[192:195], v[112:115], v[156:159]
    ds_read_b128 v[52:55], v10 offset:0
    ds_read_b128 v[56:59], v10 offset:64
    v_mfma_f32_16x16x32_bf16 v[156:159], a[204:207], v[116:119], v[156:159]
    ds_read_b128 v[60:63], v10 offset:128
    v_mfma_f32_16x16x32_bf16 v[160:163], a[184:187], v[108:111], v[160:163]
    ds_read_b128 v[64:67], v11 offset:0
    v_mfma_f32_16x16x32_bf16 v[160:163], a[196:199], v[112:115], v[160:163]
    ds_read_b128 v[68:71], v11 offset:64
    v_mfma_f32_16x16x32_bf16 v[160:163], a[208:211], v[116:119], v[160:163]
    ds_read_b128 v[72:75], v11 offset:128
    v_mfma_f32_16x16x32_bf16 v[164:167], a[188:191], v[108:111], v[164:167]
    v_mfma_f32_16x16x32_bf16 v[164:167], a[200:203], v[112:115], v[164:167]
    v_mfma_f32_16x16x32_bf16 v[164:167], a[212:215], v[116:119], v[164:167]
    s_waitcnt lgkmcnt(6)
    v_mfma_f32_16x16x32_bf16 v[96:99], a[0:3], v[40:43], 0
    v_mfma_f32_16x16x32_bf16 v[96:99], a[12:15], v[44:47], v[96:99]
    v_mfma_f32_16x16x32_bf16 v[96:99], a[24:27], v[48:51], v[96:99]
    v_mfma_f32_16x16x32_bf16 v[100:103], a[4:7], v[40:43], 0
    v_mfma_f32_16x16x32_bf16 v[100:103], a[16:19], v[44:47], v[100:103]
    v_mfma_f32_16x16x32_bf16 v[100:103], a[28:31], v[48:51], v[100:103]
    v_mfma_f32_16x16x32_bf16 v[104:107], a[8:11], v[40:43], 0
    v_mfma_f32_16x16x32_bf16 v[104:107], a[20:23], v[44:47], v[104:107]
    v_mfma_f32_16x16x32_bf16 v[104:107], a[32:35], v[48:51], v[104:107]
    s_waitcnt lgkmcnt(3)
    v_mfma_f32_16x16x32_bf16 v[96:99], a[36:39], v[52:55], v[96:99]
    v_mfma_f32_16x16x32_bf16 v[96:99], a[48:51], v[56:59], v[96:99]
    v_mfma_f32_16x16x32_bf16 v[96:99], a[60:63], v[60:63], v[96:99]
    s_sub_u32 s32, s32, 393216
    v_mfma_f32_16x16x32_bf16 v[100:103], a[40:43], v[52:55], v[100:103]
    s_sub_u32 s33, s33, 4
    v_mfma_f32_16x16x32_bf16 v[100:103], a[52:55], v[56:59], v[100:103]
    s_cmp_lt_u32 s33, s34
    s_cselect_b32 s14, 50331648, 0
    v_mfma_f32_16x16x32_bf16 v[100:103], a[64:67], v[60:63], v[100:103]
    s_add_u32 s31, s31, 13312
    v_mfma_f32_16x16x32_bf16 v[104:107], a[44:47], v[52:55], v[104:107]
    s_cmp_eq_u32 s31, 53248
    s_cselect_b32 s31, 0, s31
    v_mfma_f32_16x16x32_bf16 v[104:107], a[56:59], v[56:59], v[104:107]
    v_mfma_f32_16x16x32_bf16 v[104:107], a[68:71], v[60:63], v[104:107]
    s_waitcnt lgkmcnt(0)
    v_mfma_f32_16x16x32_bf16 v[96:99], a[72:75], v[64:67], v[96:99]
    s_add_u32 m0, s31, s26
    v_mfma_f32_16x16x32_bf16 v[96:99], a[84:87], v[68:71], v[96:99]
    buffer_load_dwordx4 v2, s[12:15], s32 offen nt lds
    v_mfma_f32_16x16x32_bf16 v[96:99], a[96:99], v[72:75], v[96:99]
    s_add_u32 m0, s31, s27
    v_mfma_f32_16x16x32_bf16 v[100:103], a[76:79], v[64:67], v[100:103]
    buffer_load_dwordx4 v3, s[12:15], s32 offen nt lds
    v_mfma_f32_16x16x32_bf16 v[100:103], a[88:91], v[68:71], v[100:103]
    s_add_u32 m0, s31, s28
    v_mfma_f32_16x16x32_bf16 v[100:103], a[100:103], v[72:75], v[100:103]
    buffer_load_dwordx4 v4, s[12:15], s32 offen nt lds
    v_mfma_f32_16x16x32_bf16 v[104:107], a[80:83], v[64:67], v[104:107]
    s_add_u32 m0, s31, s29
    v_mfma_f32_16x16x32_bf16 v[104:107], a[92:95], v[68:71], v[104:107]
    buffer_load_dwordx4 v5, s[12:15], s32 offen nt lds
    v_mfma_f32_16x16x32_bf16 v[104:107], a[104:107], v[72:75], v[104:107]
    v_mfma_f32_16x16x32_bf16 v[120:123], a[108:111], v[40:43], v[120:123]
    v_mfma_f32_16x16x32_bf16 v[120:123], a[120:123], v[44:47], v[120:123]
    v_mfma_f32_16x16x32_bf16 v[120:123], a[132:135], v[48:51], v[120:123]
    s_waitcnt vmcnt(4)
    s_barrier
    v_mfma_f32_16x16x32_bf16 v[120:123], a[144:147], v[52:55], v[120:123]
    ds_read_b64_tr_b16 a[216:217], v23 offset:0
    ds_read_b64_tr_b16 a[218:219], v23 offset:768
    v_mfma_f32_16x16x32_bf16 v[120:123], a[156:159], v[56:59], v[120:123]
    ds_read_b64_tr_b16 a[228:229], v23 offset:6144
    ds_read_b64_tr_b16 a[230:231], v23 offset:6912
    v_mfma_f32_16x16x32_bf16 v[120:123], a[168:171], v[60:63], v[120:123]
    ds_read_b64_tr_b16 a[240:241], v23 offset:12288
    v_mfma_f32_16x16x32_bf16 v[120:123], a[180:183], v[64:67], v[120:123]
    ds_read_b64_tr_b16 a[242:243], v23 offset:13056
    ds_read_b64_tr_b16 a[252:253], v23 offset:18432
    v_mfma_f32_16x16x32_bf16 v[120:123], a[192:195], v[68:71], v[120:123]
    ds_read_b64_tr_b16 a[254:255], v23 offset:19200
    ds_read_b64_tr_b16 v[176:177], v23 offset:24576
    v_mfma_f32_16x16x32_bf16 v[120:123], a[204:207], v[72:75], v[120:123]
    ds_read_b64_tr_b16 v[178:179], v23 offset:25344
    v_mfma_f32_16x16x32_bf16 v[124:127], a[112:115], v[40:43], v[124:127]
    ds_read_b64_tr_b16 v[188:189], v23 offset:30720
    ds_read_b64_tr_b16 v[190:191], v23 offset:31488
    v_mfma_f32_16x16x32_bf16 v[124:127], a[124:127], v[44:47], v[124:127]
    ds_read_b64_tr_b16 v[200:201], v23 offset:36864
    ds_read_b64_tr_b16 v[202:203], v23 offset:37632
    v_mfma_f32_16x16x32_bf16 v[124:127], a[136:139], v[48:51], v[124:127]
    ds_read_b64_tr_b16 v[212:213], v23 offset:43008
    s_waitcnt lgkmcnt(14)
    v_mfma_f32_16x16x32_bf16 v[124:127], a[148:151], v[52:55], v[124:127]
    ds_read_b64_tr_b16 v[214:215], v23 offset:43776
    ds_read_b64_tr_b16 v[224:225], v23 offset:49152
    v_mfma_f32_16x16x32_bf16 v[124:127], a[160:163], v[56:59], v[124:127]
    ds_read_b64_tr_b16 v[226:227], v23 offset:49920
    ds_read_b64_tr_b16 a[220:221], v24 offset:0
    v_mfma_f32_16x16x32_bf16 v[124:127], a[172:175], v[60:63], v[124:127]
    ds_read_b64_tr_b16 a[222:223], v24 offset:768
    s_waitcnt lgkmcnt(14)
    v_mfma_f32_16x16x32_bf16 v[124:127], a[184:187], v[64:67], v[124:127]
    ds_read_b64_tr_b16 a[232:233], v24 offset:6144
    ds_read_b64_tr_b16 a[234:235], v24 offset:6912
    v_mfma_f32_16x16x32_bf16 v[124:127], a[196:199], v[68:71], v[124:127]
    ds_read_b64_tr_b16 a[244:245], v24 offset:12288
    ds_read_b64_tr_b16 a[246:247], v24 offset:13056
    v_mfma_f32_16x16x32_bf16 v[124:127], a[208:211], v[72:75], v[124:127]
    ds_read_b64_tr_b16 v[168:169], v24 offset:18432
    s_waitcnt lgkmcnt(14)
    v_mfma_f32_16x16x32_bf16 v[128:131], a[116:119], v[40:43], v[128:131]
    ds_read_b64_tr_b16 v[170:171], v24 offset:19200
    ds_read_b64_tr_b16 v[180:181], v24 offset:24576
    v_mfma_f32_16x16x32_bf16 v[128:131], a[128:131], v[44:47], v[128:131]
    ds_read_b64_tr_b16 v[182:183], v24 offset:25344
    ds_read_b64_tr_b16 v[192:193], v24 offset:30720
    v_mfma_f32_16x16x32_bf16 v[128:131], a[140:143], v[48:51], v[128:131]
    ds_read_b64_tr_b16 v[194:195], v24 offset:31488
    s_waitcnt lgkmcnt(14)
    v_mfma_f32_16x16x32_bf16 v[128:131], a[152:155], v[52:55], v[128:131]
    ds_read_b64_tr_b16 v[204:205], v24 offset:36864
    ds_read_b64_tr_b16 v[206:207], v24 offset:37632
    v_mfma_f32_16x16x32_bf16 v[128:131], a[164:167], v[56:59], v[128:131]
    ds_read_b64_tr_b16 v[216:217], v24 offset:43008
    ds_read_b64_tr_b16 v[218:219], v24 offset:43776
    v_mfma_f32_16x16x32_bf16 v[128:131], a[176:179], v[60:63], v[128:131]
    ds_read_b64_tr_b16 v[228:229], v24 offset:49152
    s_waitcnt lgkmcnt(14)
    v_mfma_f32_16x16x32_bf16 v[128:131], a[188:191], v[64:67], v[128:131]
    ds_read_b64_tr_b16 v[230:231], v24 offset:49920
    ds_read_b64_tr_b16 a[224:225], v25 offset:0
    v_mfma_f32_16x16x32_bf16 v[128:131], a[200:203], v[68:71], v[128:131]
    ds_read_b64_tr_b16 a[226:227], v25 offset:768
    ds_read_b64_tr_b16 a[236:237], v25 offset:6144
    v_mfma_f32_16x16x32_bf16 v[128:131], a[212:215], v[72:75], v[128:131]
    ds_read_b64_tr_b16 a[238:239], v25 offset:6912
    s_waitcnt lgkmcnt(14)
    v_mfma_f32_16x16x32_bf16 v[144:147], a[216:219], v[40:43], v[144:147]
    ds_read_b64_tr_b16 a[248:249], v25 offset:12288
    ds_read_b64_tr_b16 a[250:251], v25 offset:13056
    v_mfma_f32_16x16x32_bf16 v[144:147], a[228:231], v[44:47], v[144:147]
    ds_read_b64_tr_b16 v[172:173], v25 offset:18432
    ds_read_b64_tr_b16 v[174:175], v25 offset:19200
    v_mfma_f32_16x16x32_bf16 v[144:147], a[240:243], v[48:51], v[144:147]
    ds_read_b64_tr_b16 v[184:185], v25 offset:24576
    s_waitcnt lgkmcnt(14)
    v_mfma_f32_16x16x32_bf16 v[144:147], a[252:255], v[52:55], v[144:147]
    ds_read_b64_tr_b16 v[186:187], v25 offset:25344
    ds_read_b64_tr_b16 v[196:197], v25 offset:30720
    v_mfma_f32_16x16x32_bf16 v[144:147], v[176:179], v[56:59], v[144:147]
    ds_read_b64_tr_b16 v[198:199], v25 offset:31488
    ds_read_b64_tr_b16 v[208:209], v25 offset:36864
    v_mfma_f32_16x16x32_bf16 v[144:147], v[188:191], v[60:63], v[144:147]
    ds_read_b64_tr_b16 v[210:211], v25 offset:37632
    s_waitcnt lgkmcnt(14)
    v_mfma_f32_16x16x32_bf16 v[144:147], v[200:203], v[64:67], v[144:147]
    ds_read_b64_tr_b16 v[220:221], v25 offset:43008
    ds_read_b64_tr_b16 v[222:223], v25 offset:43776
    v_mfma_f32_16x16x32_bf16 v[144:147], v[212:215], v[68:71], v[144:147]
    ds_read_b64_tr_b16 v[232:233], v25 offset:49152
    ds_read_b64_tr_b16 v[234:235], v25 offset:49920
    v_mfma_f32_16x16x32_bf16 v[144:147], v[224:227], v[72:75], v[144:147]
    s_waitcnt lgkmcnt(14)
    v_mfma_f32_16x16x32_bf16 v[148:151], a[220:223], v[40:43], v[148:151]
    v_mfma_f32_16x16x32_bf16 v[148:151], a[232:235], v[44:47], v[148:151]
    v_mfma_f32_16x16x32_bf16 v[148:151], a[244:247], v[48:51], v[148:151]
    v_mfma_f32_16x16x32_bf16 v[148:151], v[168:171], v[52:55], v[148:151]
    v_mfma_f32_16x16x32_bf16 v[148:151], v[180:183], v[56:59], v[148:151]
    v_mfma_f32_16x16x32_bf16 v[148:151], v[192:195], v[60:63], v[148:151]
    v_mfma_f32_16x16x32_bf16 v[148:151], v[204:207], v[64:67], v[148:151]
    v_mfma_f32_16x16x32_bf16 v[148:151], v[216:219], v[68:71], v[148:151]
    v_mfma_f32_16x16x32_bf16 v[148:151], v[228:231], v[72:75], v[148:151]
    s_waitcnt lgkmcnt(12)
    v_mfma_f32_16x16x32_bf16 v[152:155], a[224:227], v[40:43], v[152:155]
    ds_read_b128 v[40:43], v9 offset:3072
    v_mfma_f32_16x16x32_bf16 v[152:155], a[236:239], v[44:47], v[152:155]
    ds_read_b128 v[44:47], v9 offset:3136
    v_mfma_f32_16x16x32_bf16 v[152:155], a[248:251], v[48:51], v[152:155]
    ds_read_b128 v[48:51], v9 offset:3200
    s_waitcnt lgkmcnt(9)
    v_mfma_f32_16x16x32_bf16 v[152:155], v[172:175], v[52:55], v[152:155]
    ds_read_b128 v[52:55], v10 offset:3072
    v_mfma_f32_16x16x32_bf16 v[152:155], v[184:187], v[56:59], v[152:155]
    ds_read_b128 v[56:59], v10 offset:3136
    v_mfma_f32_16x16x32_bf16 v[152:155], v[196:199], v[60:63], v[152:155]
    ds_read_b128 v[60:63], v10 offset:3200
    s_waitcnt lgkmcnt(6)
    v_mfma_f32_16x16x32_bf16 v[152:155], v[208:211], v[64:67], v[152:155]
    ds_read_b128 v[64:67], v11 offset:3072
    v_mfma_f32_16x16x32_bf16 v[152:155], v[220:223], v[68:71], v[152:155]
    ds_read_b128 v[68:71], v11 offset:3136
    v_mfma_f32_16x16x32_bf16 v[152:155], v[232:235], v[72:75], v[152:155]
    ds_read_b128 v[72:75], v11 offset:3200
    s_waitcnt lgkmcnt(6)
    v_mfma_f32_16x16x32_bf16 v[108:111], a[0:3], v[40:43], 0
    s_add_u32 s32, s32, 589824
    v_mfma_f32_16x16x32_bf16 v[108:111], a[12:15], v[44:47], v[108:111]
    s_add_u32 s33, s33, 6
    v_mfma_f32_16x16x32_bf16 v[108:111], a[24:27], v[48:51], v[108:111]
    s_cmp_lt_u32 s33, s34
    s_cselect_b32 s14, 50331648, 0
    s_waitcnt lgkmcnt(3)
    v_mfma_f32_16x16x32_bf16 v[108:111], a[36:39], v[52:55], v[108:111]
    s_add_u32 s31, s31, 13312
    v_mfma_f32_16x16x32_bf16 v[108:111], a[48:51], v[56:59], v[108:111]
    s_cmp_eq_u32 s31, 53248
    s_cselect_b32 s31, 0, s31
    v_mfma_f32_16x16x32_bf16 v[108:111], a[60:63], v[60:63], v[108:111]
    s_waitcnt lgkmcnt(0)
    v_mfma_f32_16x16x32_bf16 v[108:111], a[72:75], v[64:67], v[108:111]
    v_mfma_f32_16x16x32_bf16 v[108:111], a[84:87], v[68:71], v[108:111]
    s_add_u32 m0, s31, s26
    v_mfma_f32_16x16x32_bf16 v[108:111], a[96:99], v[72:75], v[108:111]
    buffer_load_dwordx4 v2, s[12:15], s32 offen nt lds
    v_mfma_f32_16x16x32_bf16 v[112:115], a[4:7], v[40:43], 0
    v_mfma_f32_16x16x32_bf16 v[112:115], a[16:19], v[44:47], v[112:115]
    s_add_u32 m0, s31, s27
    v_mfma_f32_16x16x32_bf16 v[112:115], a[28:31], v[48:51], v[112:115]
    buffer_load_dwordx4 v3, s[12:15], s32 offen nt lds
    v_mfma_f32_16x16x32_bf16 v[112:115], a[40:43], v[52:55], v[112:115]
    v_mfma_f32_16x16x32_bf16 v[112:115], a[52:55], v[56:59], v[112:115]
    s_add_u32 m0, s31, s28
    v_mfma_f32_16x16x32_bf16 v[112:115], a[64:67], v[60:63], v[112:115]
    buffer_load_dwordx4 v4, s[12:15], s32 offen nt lds
    v_mfma_f32_16x16x32_bf16 v[112:115], a[76:79], v[64:67], v[112:115]
    v_mfma_f32_16x16x32_bf16 v[112:115], a[88:91], v[68:71], v[112:115]
    s_add_u32 m0, s31, s29
    v_mfma_f32_16x16x32_bf16 v[112:115], a[100:103], v[72:75], v[112:115]
    buffer_load_dwordx4 v5, s[12:15], s32 offen nt lds
    v_mfma_f32_16x16x32_bf16 v[116:119], a[8:11], v[40:43], 0
    v_mfma_f32_16x16x32_bf16 v[116:119], a[20:23], v[44:47], v[116:119]
    v_mfma_f32_16x16x32_bf16 v[116:119], a[32:35], v[48:51], v[116:119]
    s_add_u32 s32, s32, 196608
    v_mfma_f32_16x16x32_bf16 v[116:119], a[44:47], v[52:55], v[116:119]
    s_add_u32 s33, s33, 2
    v_mfma_f32_16x16x32_bf16 v[116:119], a[56:59], v[56:59], v[116:119]
    s_cmp_lt_u32 s33, s34
    s_cselect_b32 s14, 50331648, 0
    v_mfma_f32_16x16x32_bf16 v[116:119], a[68:71], v[60:63], v[116:119]
    s_add_u32 s31, s31, 13312
    v_mfma_f32_16x16x32_bf16 v[116:119], a[80:83], v[64:67], v[116:119]
    s_cmp_eq_u32 s31, 53248
    s_cselect_b32 s31, 0, s31
    v_mfma_f32_16x16x32_bf16 v[116:119], a[92:95], v[68:71], v[116:119]
    v_mfma_f32_16x16x32_bf16 v[116:119], a[104:107], v[72:75], v[116:119]
    v_mfma_f32_16x16x32_bf16 v[132:135], a[108:111], v[40:43], v[132:135]
    s_add_u32 m0, s31, s26
    v_mfma_f32_16x16x32_bf16 v[132:135], a[120:123], v[44:47], v[132:135]
    buffer_load_dwordx4 v2, s[12:15], s32 offen nt lds
    v_mfma_f32_16x16x32_bf16 v[132:135], a[132:135], v[48:51], v[132:135]
    v_mfma_f32_16x16x32_bf16 v[132:135], a[144:147], v[52:55], v[132:135]
    s_add_u32 m0, s31, s27
    v_mfma_f32_16x16x32_bf16 v[132:135], a[156:159], v[56:59], v[132:135]
    buffer_load_dwordx4 v3, s[12:15], s32 offen nt lds
    v_mfma_f32_16x16x32_bf16 v[132:135], a[168:171], v[60:63], v[132:135]
    v_mfma_f32_16x16x32_bf16 v[132:135], a[180:183], v[64:67], v[132:135]
    s_add_u32 m0, s31, s28
    v_mfma_f32_16x16x32_bf16 v[132:135], a[192:195], v[68:71], v[132:135]
    buffer_load_dwordx4 v4, s[12:15], s32 offen nt lds
    v_mfma_f32_16x16x32_bf16 v[132:135], a[204:207], v[72:75], v[132:135]
    v_mfma_f32_16x16x32_bf16 v[136:139], a[112:115], v[40:43], v[136:139]
    s_add_u32 m0, s31, s29
    v_mfma_f32_16x16x32_bf16 v[136:139], a[124:127], v[44:47], v[136:139]
    buffer_load_dwordx4 v5, s[12:15], s32 offen nt lds
    v_mfma_f32_16x16x32_bf16 v[136:139], a[136:139], v[48:51], v[136:139]
    v_mfma_f32_16x16x32_bf16 v[136:139], a[148:151], v[52:55], v[136:139]
    v_mfma_f32_16x16x32_bf16 v[136:139], a[160:163], v[56:59], v[136:139]
    s_add_u32 s30, s30, 13312
    v_mfma_f32_16x16x32_bf16 v[136:139], a[172:175], v[60:63], v[136:139]
    s_cmp_eq_u32 s30, 53248
    s_cselect_b32 s30, 0, s30
    v_mfma_f32_16x16x32_bf16 v[136:139], a[184:187], v[64:67], v[136:139]
    v_add_u32 v9, s30, v6
    v_mfma_f32_16x16x32_bf16 v[136:139], a[196:199], v[68:71], v[136:139]
    v_add_u32 v10, s30, v7
    v_mfma_f32_16x16x32_bf16 v[136:139], a[208:211], v[72:75], v[136:139]
    v_add_u32 v11, s30, v8
    v_mfma_f32_16x16x32_bf16 v[140:143], a[116:119], v[40:43], v[140:143]
    v_mfma_f32_16x16x32_bf16 v[140:143], a[128:131], v[44:47], v[140:143]
    v_mfma_f32_16x16x32_bf16 v[140:143], a[140:143], v[48:51], v[140:143]
    v_mfma_f32_16x16x32_bf16 v[140:143], a[152:155], v[52:55], v[140:143]
    ds_write_b32 v242, v243
    v_mfma_f32_16x16x32_bf16 v[140:143], a[164:167], v[56:59], v[140:143]
    v_mfma_f32_16x16x32_bf16 v[140:143], a[176:179], v[60:63], v[140:143]
    v_mfma_f32_16x16x32_bf16 v[140:143], a[188:191], v[64:67], v[140:143]
    v_mfma_f32_16x16x32_bf16 v[140:143], a[200:203], v[68:71], v[140:143]
    v_mfma_f32_16x16x32_bf16 v[140:143], a[212:215], v[72:75], v[140:143]
    v_mfma_f32_16x16x32_bf16 v[156:159], a[216:219], v[40:43], v[156:159]
    v_mfma_f32_16x16x32_bf16 v[156:159], a[228:231], v[44:47], v[156:159]
    v_mfma_f32_16x16x32_bf16 v[156:159], a[240:243], v[48:51], v[156:159]
    v_mfma_f32_16x16x32_bf16 v[160:163], a[220:223], v[40:43], v[160:163]
    v_mfma_f32_16x16x32_bf16 v[160:163], a[232:235], v[44:47], v[160:163]
    v_mfma_f32_16x16x32_bf16 v[160:163], a[244:247], v[48:51], v[160:163]
    s_waitcnt vmcnt(8)
    s_barrier
    v_mfma_f32_16x16x32_bf16 v[164:167], a[224:227], v[40:43], v[164:167]
    ds_read_b128 v[40:43], v9 offset:0
    v_mfma_f32_16x16x32_bf16 v[164:167], a[236:239], v[44:47], v[164:167]
    ds_read_b128 v[44:47], v9 offset:64
    v_mfma_f32_16x16x32_bf16 v[164:167], a[248:251], v[48:51], v[164:167]
    ds_read_b128 v[48:51], v9 offset:128
    v_mfma_f32_16x16x32_bf16 v[156:159], a[252:255], v[52:55], v[156:159]
    v_mfma_f32_16x16x32_bf16 v[156:159], v[176:179], v[56:59], v[156:159]
    v_mfma_f32_16x16x32_bf16 v[156:159], v[188:191], v[60:63], v[156:159]
    v_mfma_f32_16x16x32_bf16 v[160:163], v[168:171], v[52:55], v[160:163]
    v_mfma_f32_16x16x32_bf16 v[160:163], v[180:183], v[56:59], v[160:163]
    v_mfma_f32_16x16x32_bf16 v[160:163], v[192:195], v[60:63], v[160:163]
    v_mfma_f32_16x16x32_bf16 v[164:167], v[172:175], v[52:55], v[164:167]
    ds_read_b128 v[52:55], v10 offset:0
    v_mfma_f32_16x16x32_bf16 v[164:167], v[184:187], v[56:59], v[164:167]
    ds_read_b128 v[56:59], v10 offset:64
    v_mfma_f32_16x16x32_bf16 v[164:167], v[196:199], v[60:63], v[164:167]
    ds_read_b128 v[60:63], v10 offset:128
    v_mfma_f32_16x16x32_bf16 v[156:159], v[200:203], v[64:67], v[156:159]
    v_mfma_f32_16x16x32_bf16 v[156:159], v[212:215], v[68:71], v[156:159]
    v_mfma_f32_16x16x32_bf16 v[156:159], v[224:227], v[72:75], v[156:159]
    v_mfma_f32_16x16x32_bf16 v[160:163], v[204:207], v[64:67], v[160:163]
    v_mfma_f32_16x16x32_bf16 v[160:163], v[216:219], v[68:71], v[160:163]
    v_mfma_f32_16x16x32_bf16 v[160:163], v[228:231], v[72:75], v[160:163]
    v_mfma_f32_16x16x32_bf16 v[164:167], v[208:211], v[64:67], v[164:167]
    ds_read_b128 v[64:67], v11 offset:0
    v_mfma_f32_16x16x32_bf16 v[164:167], v[220:223], v[68:71], v[164:167]
    ds_read_b128 v[68:71], v11 offset:64
    v_mfma_f32_16x16x32_bf16 v[164:167], v[232:235], v[72:75], v[164:167]
    ds_read_b128 v[72:75], v11 offset:128
    s_waitcnt lgkmcnt(6)
    v_mfma_f32_16x16x32_bf16 v[144:147], a[0:3], v[40:43], v[144:147]
    s_add_u32 s32, s32, 196608
    v_mfma_f32_16x16x32_bf16 v[144:147], a[12:15], v[44:47], v[144:147]
    s_add_u32 s33, s33, 2
    v_mfma_f32_16x16x32_bf16 v[144:147], a[24:27], v[48:51], v[144:147]
    s_cmp_lt_u32 s33, s34
    s_cselect_b32 s14, 50331648, 0
    s_waitcnt lgkmcnt(3)
    v_mfma_f32_16x16x32_bf16 v[144:147], a[36:39], v[52:55], v[144:147]
    s_add_u32 s31, s31, 13312
    v_mfma_f32_16x16x32_bf16 v[144:147], a[48:51], v[56:59], v[144:147]
    s_cmp_eq_u32 s31, 53248
    s_cselect_b32 s31, 0, s31
    v_mfma_f32_16x16x32_bf16 v[144:147], a[60:63], v[60:63], v[144:147]
    s_waitcnt lgkmcnt(0)
    v_mfma_f32_16x16x32_bf16 v[144:147], a[72:75], v[64:67], v[144:147]
    v_mfma_f32_16x16x32_bf16 v[144:147], a[84:87], v[68:71], v[144:147]
    s_add_u32 m0, s31, s26
    v_mfma_f32_16x16x32_bf16 v[144:147], a[96:99], v[72:75], v[144:147]
    buffer_load_dwordx4 v2, s[12:15], s32 offen nt lds
    v_mfma_f32_16x16x32_bf16 v[148:151], a[4:7], v[40:43], v[148:151]
    s_add_u32 m0, s31, s27
    v_mfma_f32_16x16x32_bf16 v[148:151], a[16:19], v[44:47], v[148:151]
    buffer_load_dwordx4 v3, s[12:15], s32 offen nt lds
    v_mfma_f32_16x16x32_bf16 v[148:151], a[28:31], v[48:51], v[148:151]
    s_add_u32 m0, s31, s28
    v_mfma_f32_16x16x32_bf16 v[148:151], a[40:43], v[52:55], v[148:151]
    buffer_load_dwordx4 v4, s[12:15], s32 offen nt lds
    v_mfma_f32_16x16x32_bf16 v[148:151], a[52:55], v[56:59], v[148:151]
    s_add_u32 m0, s31, s29
    v_mfma_f32_16x16x32_bf16 v[148:151], a[64:67], v[60:63], v[148:151]
    buffer_load_dwordx4 v5, s[12:15], s32 offen nt lds
    v_mfma_f32_16x16x32_bf16 v[148:151], a[76:79], v[64:67], v[148:151]
    v_mfma_f32_16x16x32_bf16 v[148:151], a[88:91], v[68:71], v[148:151]
    v_mfma_f32_16x16x32_bf16 v[148:151], a[100:103], v[72:75], v[148:151]
    v_cvt_pk_bf16_f32 v76, v144, v145
    v_mfma_f32_16x16x32_bf16 v[152:155], a[8:11], v[40:43], v[152:155]
    ds_read_b128 v[40:43], v9 offset:3072
    v_cvt_pk_bf16_f32 v77, v146, v147
    v_mfma_f32_16x16x32_bf16 v[152:155], a[20:23], v[44:47], v[152:155]
    ds_read_b128 v[44:47], v9 offset:3136
    ds_write_b64 v12, v[76:77] offset:0
    v_mfma_f32_16x16x32_bf16 v[152:155], a[32:35], v[48:51], v[152:155]
    ds_read_b128 v[48:51], v9 offset:3200
    v_mfma_f32_16x16x32_bf16 v[152:155], a[44:47], v[52:55], v[152:155]
    ds_read_b128 v[52:55], v10 offset:3072
    v_mfma_f32_16x16x32_bf16 v[152:155], a[56:59], v[56:59], v[152:155]
    ds_read_b128 v[56:59], v10 offset:3136
    v_mfma_f32_16x16x32_bf16 v[152:155], a[68:71], v[60:63], v[152:155]
    ds_read_b128 v[60:63], v10 offset:3200
    v_mfma_f32_16x16x32_bf16 v[152:155], a[80:83], v[64:67], v[152:155]
    ds_read_b128 v[64:67], v11 offset:3072
    v_mfma_f32_16x16x32_bf16 v[152:155], a[92:95], v[68:71], v[152:155]
    ds_read_b128 v[68:71], v11 offset:3136
    v_mfma_f32_16x16x32_bf16 v[152:155], a[104:107], v[72:75], v[152:155]
    ds_read_b128 v[72:75], v11 offset:3200
    s_waitcnt lgkmcnt(6)
    v_mfma_f32_16x16x32_bf16 v[156:159], a[0:3], v[40:43], v[156:159]
    v_cvt_pk_bf16_f32 v78, v148, v149
    s_add_u32 s30, s30, 13312
    v_mfma_f32_16x16x32_bf16 v[156:159], a[12:15], v[44:47], v[156:159]
    v_cvt_pk_bf16_f32 v79, v150, v151
    v_mfma_f32_16x16x32_bf16 v[156:159], a[24:27], v[48:51], v[156:159]
    s_cmp_eq_u32 s30, 53248
    s_cselect_b32 s30, 0, s30
    v_mfma_f32_16x16x32_bf16 v[160:163], a[4:7], v[40:43], v[160:163]
    ds_write_b64 v13, v[78:79] offset:0
    v_add_u32 v9, s30, v6
    v_mfma_f32_16x16x32_bf16 v[160:163], a[16:19], v[44:47], v[160:163]
    v_add_u32 v10, s30, v7
    v_add_u32 v11, s30, v8
    v_mfma_f32_16x16x32_bf16 v[160:163], a[28:31], v[48:51], v[160:163]
    s_waitcnt vmcnt(8)
    s_barrier
    v_mfma_f32_16x16x32_bf16 v[164:167], a[8:11], v[40:43], v[164:167]
    ds_read_b128 v[40:43], v9 offset:0
    v_mfma_f32_16x16x32_bf16 v[164:167], a[20:23], v[44:47], v[164:167]
    ds_read_b128 v[44:47], v9 offset:64
    v_mfma_f32_16x16x32_bf16 v[164:167], a[32:35], v[48:51], v[164:167]
    v_cvt_pk_bf16_f32 v80, v152, v153
    s_waitcnt lgkmcnt(6)
    v_mfma_f32_16x16x32_bf16 v[156:159], a[36:39], v[52:55], v[156:159]
    ds_read_b128 v[48:51], v9 offset:128
    v_cvt_pk_bf16_f32 v81, v154, v155
    v_mfma_f32_16x16x32_bf16 v[156:159], a[48:51], v[56:59], v[156:159]
    ds_write_b64 v14, v[80:81] offset:0
    v_mfma_f32_16x16x32_bf16 v[156:159], a[60:63], v[60:63], v[156:159]
    v_mfma_f32_16x16x32_bf16 v[160:163], a[40:43], v[52:55], v[160:163]
    v_mfma_f32_16x16x32_bf16 v[160:163], a[52:55], v[56:59], v[160:163]
    v_mfma_f32_16x16x32_bf16 v[160:163], a[64:67], v[60:63], v[160:163]
    v_mfma_f32_16x16x32_bf16 v[164:167], a[44:47], v[52:55], v[164:167]
    ds_read_b128 v[52:55], v10 offset:0
    v_mfma_f32_16x16x32_bf16 v[164:167], a[56:59], v[56:59], v[164:167]
    ds_read_b128 v[56:59], v10 offset:64
    v_mfma_f32_16x16x32_bf16 v[164:167], a[68:71], v[60:63], v[164:167]
    ds_read_b128 v[60:63], v10 offset:128
    s_waitcnt lgkmcnt(8)
    v_mfma_f32_16x16x32_bf16 v[156:159], a[72:75], v[64:67], v[156:159]
    v_mfma_f32_16x16x32_bf16 v[156:159], a[84:87], v[68:71], v[156:159]
    v_mfma_f32_16x16x32_bf16 v[156:159], a[96:99], v[72:75], v[156:159]
    v_mfma_f32_16x16x32_bf16 v[160:163], a[76:79], v[64:67], v[160:163]
    v_mfma_f32_16x16x32_bf16 v[160:163], a[88:91], v[68:71], v[160:163]
    v_mfma_f32_16x16x32_bf16 v[160:163], a[100:103], v[72:75], v[160:163]
    v_mfma_f32_16x16x32_bf16 v[164:167], a[80:83], v[64:67], v[164:167]
    ds_read_b128 v[64:67], v11 offset:0
    v_mfma_f32_16x16x32_bf16 v[164:167], a[92:95], v[68:71], v[164:167]
    ds_read_b128 v[68:71], v11 offset:64
    v_mfma_f32_16x16x32_bf16 v[164:167], a[104:107], v[72:75], v[164:167]
    ds_read_b128 v[72:75], v11 offset:128
    s_waitcnt lgkmcnt(7)
    v_mfma_f32_16x16x32_bf16 v[144:147], a[216:219], v[40:43], v[120:123]
    v_mfma_f32_16x16x32_bf16 v[144:147], a[228:231], v[44:47], v[144:147]
    v_cvt_pk_bf16_f32 v76, v156, v157
    v_mfma_f32_16x16x32_bf16 v[144:147], a[240:243], v[48:51], v[144:147]
    v_cvt_pk_bf16_f32 v77, v158, v159
    s_waitcnt lgkmcnt(3)
    v_mfma_f32_16x16x32_bf16 v[144:147], a[252:255], v[52:55], v[144:147]
    ds_write_b64 v12, v[76:77] offset:3072
    v_mfma_f32_16x16x32_bf16 v[144:147], v[176:179], v[56:59], v[144:147]
    v_cvt_pk_bf16_f32 v78, v160, v161
    v_mfma_f32_16x16x32_bf16 v[144:147], v[188:191], v[60:63], v[144:147]
    v_cvt_pk_bf16_f32 v79, v162, v163
    s_waitcnt lgkmcnt(1)
    v_mfma_f32_16x16x32_bf16 v[144:147], v[200:203], v[64:67], v[144:147]
    ds_write_b64 v13, v[78:79] offset:3072
    v_mfma_f32_16x16x32_bf16 v[144:147], v[212:215], v[68:71], v[144:147]
    v_mfma_f32_16x16x32_bf16 v[144:147], v[224:227], v[72:75], v[144:147]
    v_cvt_pk_bf16_f32 v80, v164, v165
    v_mfma_f32_16x16x32_bf16 v[148:151], a[220:223], v[40:43], v[124:127]
    v_cvt_pk_bf16_f32 v81, v166, v167
    v_mfma_f32_16x16x32_bf16 v[148:151], a[232:235], v[44:47], v[148:151]
    ds_write_b64 v14, v[80:81] offset:3072
    v_mfma_f32_16x16x32_bf16 v[148:151], a[244:247], v[48:51], v[148:151]
    v_xor_b32 v12, 0x4000, v12
    v_mfma_f32_16x16x32_bf16 v[148:151], v[168:171], v[52:55], v[148:151]
    v_xor_b32 v13, 0x4000, v13
    v_mfma_f32_16x16x32_bf16 v[148:151], v[180:183], v[56:59], v[148:151]
    v_xor_b32 v14, 0x4000, v14
    v_mfma_f32_16x16x32_bf16 v[148:151], v[192:195], v[60:63], v[148:151]
    v_mfma_f32_16x16x32_bf16 v[148:151], v[204:207], v[64:67], v[148:151]
    s_waitcnt lgkmcnt(0)
    s_barrier
    v_mfma_f32_16x16x32_bf16 v[148:151], v[216:219], v[68:71], v[148:151]
    ds_read_b128 v[84:87], v15
    v_mfma_f32_16x16x32_bf16 v[148:151], v[228:231], v[72:75], v[148:151]
    ds_read_b128 v[88:91], v16
    v_cvt_pk_bf16_f32 v76, v144, v145
    v_mfma_f32_16x16x32_bf16 v[152:155], a[224:227], v[40:43], v[128:131]
    ds_read_b128 v[92:95], v17
    v_cvt_pk_bf16_f32 v77, v146, v147
    v_mfma_f32_16x16x32_bf16 v[152:155], a[236:239], v[44:47], v[152:155]
    v_xor_b32 v15, 0x4000, v15
    ds_write_b64 v12, v[76:77] offset:0
    v_mfma_f32_16x16x32_bf16 v[152:155], a[248:251], v[48:51], v[152:155]
    v_xor_b32 v16, 0x4000, v16
    v_mfma_f32_16x16x32_bf16 v[152:155], v[172:175], v[52:55], v[152:155]
    v_xor_b32 v17, 0x4000, v17
    v_mfma_f32_16x16x32_bf16 v[152:155], v[184:187], v[56:59], v[152:155]
    s_waitcnt lgkmcnt(3)
    buffer_store_dwordx4 v[84:87], v18, s[20:23], s35 offen offset:0 sc1
    v_mfma_f32_16x16x32_bf16 v[152:155], v[196:199], v[60:63], v[152:155]
    v_mfma_f32_16x16x32_bf16 v[152:155], v[208:211], v[64:67], v[152:155]
    v_mfma_f32_16x16x32_bf16 v[152:155], v[220:223], v[68:71], v[152:155]
    v_mfma_f32_16x16x32_bf16 v[152:155], v[232:235], v[72:75], v[152:155]
    v_cvt_pk_bf16_f32 v78, v148, v149
    v_mfma_f32_16x16x32_bf16 v[120:123], a[108:111], v[40:43], v[96:99]
    v_cvt_pk_bf16_f32 v79, v150, v151
    v_mfma_f32_16x16x32_bf16 v[120:123], a[120:123], v[44:47], v[120:123]
    ds_write_b64 v13, v[78:79] offset:0
    v_mfma_f32_16x16x32_bf16 v[120:123], a[132:135], v[48:51], v[120:123]
    v_mfma_f32_16x16x32_bf16 v[120:123], a[144:147], v[52:55], v[120:123]
    s_waitcnt lgkmcnt(3)
    buffer_store_dwordx4 v[88:91], v18, s[20:23], s35 offen offset:1024 sc1
    v_mfma_f32_16x16x32_bf16 v[120:123], a[156:159], v[56:59], v[120:123]
    v_mfma_f32_16x16x32_bf16 v[120:123], a[168:171], v[60:63], v[120:123]
    v_mfma_f32_16x16x32_bf16 v[120:123], a[180:183], v[64:67], v[120:123]
    v_mfma_f32_16x16x32_bf16 v[120:123], a[192:195], v[68:71], v[120:123]
    v_mfma_f32_16x16x32_bf16 v[120:123], a[204:207], v[72:75], v[120:123]
    v_cvt_pk_bf16_f32 v80, v152, v153
    v_mfma_f32_16x16x32_bf16 v[124:127], a[112:115], v[40:43], v[100:103]
    v_cvt_pk_bf16_f32 v81, v154, v155
    v_mfma_f32_16x16x32_bf16 v[124:127], a[124:127], v[44:47], v[124:127]
    ds_write_b64 v14, v[80:81] offset:0
    v_mfma_f32_16x16x32_bf16 v[124:127], a[136:139], v[48:51], v[124:127]
    s_waitcnt lgkmcnt(3)
    buffer_store_dwordx4 v[92:95], v18, s[20:23], s35 offen offset:2048 sc1
    s_add_u32 s32, s32, 196608
    v_mfma_f32_16x16x32_bf16 v[124:127], a[148:151], v[52:55], v[124:127]
    s_add_u32 s35, s35, 196608
    s_add_u32 s33, s33, 2
    v_mfma_f32_16x16x32_bf16 v[124:127], a[160:163], v[56:59], v[124:127]
    s_cmp_lt_u32 s33, s34
    v_mfma_f32_16x16x32_bf16 v[124:127], a[172:175], v[60:63], v[124:127]
    s_cselect_b32 s14, 50331648, 0
    v_mfma_f32_16x16x32_bf16 v[124:127], a[184:187], v[64:67], v[124:127]
    s_add_u32 s31, s31, 13312
    v_mfma_f32_16x16x32_bf16 v[124:127], a[196:199], v[68:71], v[124:127]
    s_cmp_eq_u32 s31, 53248
    v_mfma_f32_16x16x32_bf16 v[124:127], a[208:211], v[72:75], v[124:127]
    s_cselect_b32 s31, 0, s31
    v_mfma_f32_16x16x32_bf16 v[128:131], a[116:119], v[40:43], v[104:107]
    v_mfma_f32_16x16x32_bf16 v[128:131], a[128:131], v[44:47], v[128:131]
    s_add_u32 m0, s31, s26
    v_mfma_f32_16x16x32_bf16 v[128:131], a[140:143], v[48:51], v[128:131]
    buffer_load_dwordx4 v2, s[12:15], s32 offen nt lds
    v_mfma_f32_16x16x32_bf16 v[128:131], a[152:155], v[52:55], v[128:131]
    v_mfma_f32_16x16x32_bf16 v[128:131], a[164:167], v[56:59], v[128:131]
    v_mfma_f32_16x16x32_bf16 v[128:131], a[176:179], v[60:63], v[128:131]
    s_add_u32 m0, s31, s27
    v_mfma_f32_16x16x32_bf16 v[128:131], a[188:191], v[64:67], v[128:131]
    buffer_load_dwordx4 v3, s[12:15], s32 offen nt lds
    v_mfma_f32_16x16x32_bf16 v[128:131], a[200:203], v[68:71], v[128:131]
    v_mfma_f32_16x16x32_bf16 v[128:131], a[212:215], v[72:75], v[128:131]
    v_mfma_f32_16x16x32_bf16 v[96:99], a[0:3], v[40:43], 0
    s_add_u32 m0, s31, s28
    v_mfma_f32_16x16x32_bf16 v[96:99], a[12:15], v[44:47], v[96:99]
    buffer_load_dwordx4 v4, s[12:15], s32 offen nt lds
    v_mfma_f32_16x16x32_bf16 v[96:99], a[24:27], v[48:51], v[96:99]
    v_mfma_f32_16x16x32_bf16 v[100:103], a[4:7], v[40:43], 0
    v_mfma_f32_16x16x32_bf16 v[100:103], a[16:19], v[44:47], v[100:103]
    s_add_u32 m0, s31, s29
    v_mfma_f32_16x16x32_bf16 v[100:103], a[28:31], v[48:51], v[100:103]
    buffer_load_dwordx4 v5, s[12:15], s32 offen nt lds
    v_mfma_f32_16x16x32_bf16 v[104:107], a[8:11], v[40:43], 0
    ds_read_b128 v[40:43], v9 offset:3072
    v_mfma_f32_16x16x32_bf16 v[104:107], a[20:23], v[44:47], v[104:107]
    ds_read_b128 v[44:47], v9 offset:3136
    v_mfma_f32_16x16x32_bf16 v[104:107], a[32:35], v[48:51], v[104:107]
    ds_read_b128 v[48:51], v9 offset:3200
    v_mfma_f32_16x16x32_bf16 v[96:99], a[36:39], v[52:55], v[96:99]
    v_mfma_f32_16x16x32_bf16 v[96:99], a[48:51], v[56:59], v[96:99]
    v_mfma_f32_16x16x32_bf16 v[96:99], a[60:63], v[60:63], v[96:99]
    v_mfma_f32_16x16x32_bf16 v[100:103], a[40:43], v[52:55], v[100:103]
    v_mfma_f32_16x16x32_bf16 v[100:103], a[52:55], v[56:59], v[100:103]
    v_mfma_f32_16x16x32_bf16 v[100:103], a[64:67], v[60:63], v[100:103]
    v_mfma_f32_16x16x32_bf16 v[104:107], a[44:47], v[52:55], v[104:107]
    ds_read_b128 v[52:55], v10 offset:3072
    v_mfma_f32_16x16x32_bf16 v[104:107], a[56:59], v[56:59], v[104:107]
    ds_read_b128 v[56:59], v10 offset:3136
    v_mfma_f32_16x16x32_bf16 v[104:107], a[68:71], v[60:63], v[104:107]
    ds_read_b128 v[60:63], v10 offset:3200
    v_mfma_f32_16x16x32_bf16 v[96:99], a[72:75], v[64:67], v[96:99]
    v_mfma_f32_16x16x32_bf16 v[96:99], a[84:87], v[68:71], v[96:99]
    v_mfma_f32_16x16x32_bf16 v[96:99], a[96:99], v[72:75], v[96:99]
    v_mfma_f32_16x16x32_bf16 v[100:103], a[76:79], v[64:67], v[100:103]
    v_mfma_f32_16x16x32_bf16 v[100:103], a[88:91], v[68:71], v[100:103]
    v_mfma_f32_16x16x32_bf16 v[100:103], a[100:103], v[72:75], v[100:103]
    v_mfma_f32_16x16x32_bf16 v[104:107], a[80:83], v[64:67], v[104:107]
    ds_read_b128 v[64:67], v11 offset:3072
    v_mfma_f32_16x16x32_bf16 v[104:107], a[92:95], v[68:71], v[104:107]
    ds_read_b128 v[68:71], v11 offset:3136
    v_mfma_f32_16x16x32_bf16 v[104:107], a[104:107], v[72:75], v[104:107]
    ds_read_b128 v[72:75], v11 offset:3200
    s_waitcnt lgkmcnt(6)
    v_mfma_f32_16x16x32_bf16 v[156:159], a[216:219], v[40:43], v[132:135]
    v_mfma_f32_16x16x32_bf16 v[156:159], a[228:231], v[44:47], v[156:159]
    v_mfma_f32_16x16x32_bf16 v[156:159], a[240:243], v[48:51], v[156:159]
    s_waitcnt lgkmcnt(3)
    v_mfma_f32_16x16x32_bf16 v[156:159], a[252:255], v[52:55], v[156:159]
    v_mfma_f32_16x16x32_bf16 v[156:159], v[176:179], v[56:59], v[156:159]
    v_mfma_f32_16x16x32_bf16 v[156:159], v[188:191], v[60:63], v[156:159]
    s_waitcnt lgkmcnt(0)
    v_mfma_f32_16x16x32_bf16 v[156:159], v[200:203], v[64:67], v[156:159]
    v_mfma_f32_16x16x32_bf16 v[156:159], v[212:215], v[68:71], v[156:159]
    v_mfma_f32_16x16x32_bf16 v[156:159], v[224:227], v[72:75], v[156:159]
    v_mfma_f32_16x16x32_bf16 v[160:163], a[220:223], v[40:43], v[136:139]
    s_add_u32 s30, s30, 13312
    v_mfma_f32_16x16x32_bf16 v[160:163], a[232:235], v[44:47], v[160:163]
    s_cmp_eq_u32 s30, 53248
    v_mfma_f32_16x16x32_bf16 v[160:163], a[244:247], v[48:51], v[160:163]
    s_cselect_b32 s30, 0, s30
    v_mfma_f32_16x16x32_bf16 v[160:163], v[168:171], v[52:55], v[160:163]
    v_add_u32 v9, s30, v6
    v_mfma_f32_16x16x32_bf16 v[160:163], v[180:183], v[56:59], v[160:163]
    v_add_u32 v10, s30, v7
    v_mfma_f32_16x16x32_bf16 v[160:163], v[192:195], v[60:63], v[160:163]
    v_add_u32 v11, s30, v8
    v_mfma_f32_16x16x32_bf16 v[160:163], v[204:207], v[64:67], v[160:163]
    v_mfma_f32_16x16x32_bf16 v[160:163], v[216:219], v[68:71], v[160:163]
    v_mfma_f32_16x16x32_bf16 v[160:163], v[228:231], v[72:75], v[160:163]
    v_cvt_pk_bf16_f32 v76, v156, v157
    v_mfma_f32_16x16x32_bf16 v[164:167], a[224:227], v[40:43], v[140:143]
    v_cvt_pk_bf16_f32 v77, v158, v159
    v_mfma_f32_16x16x32_bf16 v[164:167], a[236:239], v[44:47], v[164:167]
    ds_write_b64 v12, v[76:77] offset:3072
    v_mfma_f32_16x16x32_bf16 v[164:167], a[248:251], v[48:51], v[164:167]
    v_mfma_f32_16x16x32_bf16 v[164:167], v[172:175], v[52:55], v[164:167]
    v_mfma_f32_16x16x32_bf16 v[164:167], v[184:187], v[56:59], v[164:167]
    v_mfma_f32_16x16x32_bf16 v[164:167], v[196:199], v[60:63], v[164:167]
    v_mfma_f32_16x16x32_bf16 v[164:167], v[208:211], v[64:67], v[164:167]
    v_mfma_f32_16x16x32_bf16 v[164:167], v[220:223], v[68:71], v[164:167]
    v_mfma_f32_16x16x32_bf16 v[164:167], v[232:235], v[72:75], v[164:167]
    v_cvt_pk_bf16_f32 v78, v160, v161
    v_mfma_f32_16x16x32_bf16 v[132:135], a[108:111], v[40:43], v[108:111]
    v_cvt_pk_bf16_f32 v79, v162, v163
    v_mfma_f32_16x16x32_bf16 v[132:135], a[120:123], v[44:47], v[132:135]
    ds_write_b64 v13, v[78:79] offset:3072
    v_mfma_f32_16x16x32_bf16 v[132:135], a[132:135], v[48:51], v[132:135]
    v_mfma_f32_16x16x32_bf16 v[132:135], a[144:147], v[52:55], v[132:135]
    v_mfma_f32_16x16x32_bf16 v[132:135], a[156:159], v[56:59], v[132:135]
    v_mfma_f32_16x16x32_bf16 v[132:135], a[168:171], v[60:63], v[132:135]
    v_mfma_f32_16x16x32_bf16 v[132:135], a[180:183], v[64:67], v[132:135]
    v_mfma_f32_16x16x32_bf16 v[132:135], a[192:195], v[68:71], v[132:135]
    v_mfma_f32_16x16x32_bf16 v[132:135], a[204:207], v[72:75], v[132:135]
    v_cvt_pk_bf16_f32 v80, v164, v165
    v_mfma_f32_16x16x32_bf16 v[136:139], a[112:115], v[40:43], v[112:115]
    v_cvt_pk_bf16_f32 v81, v166, v167
    v_mfma_f32_16x16x32_bf16 v[136:139], a[124:127], v[44:47], v[136:139]
    ds_write_b64 v14, v[80:81] offset:3072
    v_mfma_f32_16x16x32_bf16 v[136:139], a[136:139], v[48:51], v[136:139]
    v_mfma_f32_16x16x32_bf16 v[136:139], a[148:151], v[52:55], v[136:139]
    v_mfma_f32_16x16x32_bf16 v[136:139], a[160:163], v[56:59], v[136:139]
    v_add_u32 v243, 1, v243
    v_mfma_f32_16x16x32_bf16 v[136:139], a[172:175], v[60:63], v[136:139]
    s_add_u32 s63, s63, 1
    v_mfma_f32_16x16x32_bf16 v[136:139], a[184:187], v[64:67], v[136:139]
    s_waitcnt vmcnt(11)
    ds_write_b32 v242, v243
    v_mfma_f32_16x16x32_bf16 v[136:139], a[196:199], v[68:71], v[136:139]
    v_mfma_f32_16x16x32_bf16 v[136:139], a[208:211], v[72:75], v[136:139]
    v_mfma_f32_16x16x32_bf16 v[140:143], a[116:119], v[40:43], v[116:119]
    v_mfma_f32_16x16x32_bf16 v[140:143], a[128:131], v[44:47], v[140:143]
    v_mfma_f32_16x16x32_bf16 v[140:143], a[140:143], v[48:51], v[140:143]
    v_mfma_f32_16x16x32_bf16 v[140:143], a[152:155], v[52:55], v[140:143]
    v_mfma_f32_16x16x32_bf16 v[140:143], a[164:167], v[56:59], v[140:143]
    v_mfma_f32_16x16x32_bf16 v[140:143], a[176:179], v[60:63], v[140:143]
    v_mfma_f32_16x16x32_bf16 v[140:143], a[188:191], v[64:67], v[140:143]
    v_mfma_f32_16x16x32_bf16 v[140:143], a[200:203], v[68:71], v[140:143]
    v_mfma_f32_16x16x32_bf16 v[140:143], a[212:215], v[72:75], v[140:143]
    ds_read_b128 v[236:239], v244
    v_mfma_f32_16x16x32_bf16 v[108:111], a[0:3], v[40:43], 0
    v_mfma_f32_16x16x32_bf16 v[108:111], a[12:15], v[44:47], v[108:111]
    v_mfma_f32_16x16x32_bf16 v[108:111], a[24:27], v[48:51], v[108:111]
    v_mfma_f32_16x16x32_bf16 v[112:115], a[4:7], v[40:43], 0
    v_mfma_f32_16x16x32_bf16 v[112:115], a[16:19], v[44:47], v[112:115]
    v_mfma_f32_16x16x32_bf16 v[112:115], a[28:31], v[48:51], v[112:115]
    s_waitcnt lgkmcnt(0)
    v_min3_u32 v245, v236, v237, v238
    v_mfma_f32_16x16x32_bf16 v[116:119], a[8:11], v[40:43], 0
    v_min_u32 v245, v245, v239
    v_mfma_f32_16x16x32_bf16 v[116:119], a[20:23], v[44:47], v[116:119]
    v_mfma_f32_16x16x32_bf16 v[116:119], a[32:35], v[48:51], v[116:119]
    v_readfirstlane_b32 s57, v245
    v_mfma_f32_16x16x32_bf16 v[108:111], a[36:39], v[52:55], v[108:111]
    v_mfma_f32_16x16x32_bf16 v[108:111], a[48:51], v[56:59], v[108:111]
    v_mfma_f32_16x16x32_bf16 v[108:111], a[60:63], v[60:63], v[108:111]
    s_cmp_ge_u32 s57, s63
    s_cbranch_scc0 L_slowP
L_backP:
    v_mfma_f32_16x16x32_bf16 v[112:115], a[40:43], v[52:55], v[112:115]
    ds_read_b128 v[40:43], v9 offset:0
    v_mfma_f32_16x16x32_bf16 v[112:115], a[52:55], v[56:59], v[112:115]
    ds_read_b128 v[44:47], v9 offset:64
    v_mfma_f32_16x16x32_bf16 v[112:115], a[64:67], v[60:63], v[112:115]
    ds_read_b128 v[48:51], v9 offset:128
    v_mfma_f32_16x16x32_bf16 v[116:119], a[44:47], v[52:55], v[116:119]
    ds_read_b128 v[52:55], v10 offset:0
    v_mfma_f32_16x16x32_bf16 v[116:119], a[56:59], v[56:59], v[116:119]
    ds_read_b128 v[56:59], v10 offset:64
    v_mfma_f32_16x16x32_bf16 v[116:119], a[68:71], v[60:63], v[116:119]
    ds_read_b128 v[60:63], v10 offset:128
    v_mfma_f32_16x16x32_bf16 v[108:111], a[72:75], v[64:67], v[108:111]
    v_mfma_f32_16x16x32_bf16 v[108:111], a[84:87], v[68:71], v[108:111]
    v_mfma_f32_16x16x32_bf16 v[108:111], a[96:99], v[72:75], v[108:111]
    v_mfma_f32_16x16x32_bf16 v[112:115], a[76:79], v[64:67], v[112:115]
    v_mfma_f32_16x16x32_bf16 v[112:115], a[88:91], v[68:71], v[112:115]
    v_mfma_f32_16x16x32_bf16 v[112:115], a[100:103], v[72:75], v[112:115]
    v_mfma_f32_16x16x32_bf16 v[116:119], a[80:83], v[64:67], v[116:119]
    ds_read_b128 v[64:67], v11 offset:0
    v_mfma_f32_16x16x32_bf16 v[116:119], a[92:95], v[68:71], v[116:119]
    ds_read_b128 v[68:71], v11 offset:64
    v_mfma_f32_16x16x32_bf16 v[116:119], a[104:107], v[72:75], v[116:119]
    ds_read_b128 v[72:75], v11 offset:128
    s_mov_b32 s36, 12
L_loop:
    s_waitcnt lgkmcnt(6)
    v_mfma_f32_16x16x32_bf16 v[144:147], a[216:219], v[40:43], v[120:123]
    v_xor_b32 v12, 0x4000, v12
    v_mfma_f32_16x16x32_bf16 v[144:147], a[228:231], v[44:47], v[144:147]
    v_xor_b32 v13, 0x4000, v13
    v_mfma_f32_16x16x32_bf16 v[144:147], a[240:243], v[48:51], v[144:147]
    v_xor_b32 v14, 0x4000, v14
    s_waitcnt lgkmcnt(3)
    v_mfma_f32_16x16x32_bf16 v[144:147], a[252:255], v[52:55], v[144:147]
    v_mfma_f32_16x16x32_bf16 v[144:147], v[176:179], v[56:59], v[144:147]
    v_mfma_f32_16x16x32_bf16 v[144:147], v[188:191], v[60:63], v[144:147]
    s_waitcnt lgkmcnt(0)
    v_mfma_f32_16x16x32_bf16 v[144:147], v[200:203], v[64:67], v[144:147]
    ds_read_b128 v[84:87], v15
    v_mfma_f32_16x16x32_bf16 v[144:147], v[212:215], v[68:71], v[144:147]
    ds_read_b128 v[88:91], v16
    v_mfma_f32_16x16x32_bf16 v[144:147], v[224:227], v[72:75], v[144:147]
    ds_read_b128 v[92:95], v17
    v_mfma_f32_16x16x32_bf16 v[148:151], a[220:223], v[40:43], v[124:127]
    v_xor_b32 v15, 0x4000, v15
    v_mfma_f32_16x16x32_bf16 v[148:151], a[232:235], v[44:47], v[148:151]
    v_xor_b32 v16, 0x4000, v16
    v_mfma_f32_16x16x32_bf16 v[148:151], a[244:247], v[48:51], v[148:151]
    v_xor_b32 v17, 0x4000, v17
    v_mfma_f32_16x16x32_bf16 v[148:151], v[168:171], v[52:55], v[148:151]
    s_waitcnt lgkmcnt(2)
    buffer_store_dwordx4 v[84:87], v18, s[20:23], s35 offen offset:0 sc1
    v_mfma_f32_16x16x32_bf16 v[148:151], v[180:183], v[56:59], v[148:151]
    v_mfma_f32_16x16x32_bf16 v[148:151], v[192:195], v[60:63], v[148:151]
    v_mfma_f32_16x16x32_bf16 v[148:151], v[204:207], v[64:67], v[148:151]
    v_mfma_f32_16x16x32_bf16 v[148:151], v[216:219], v[68:71], v[148:151]
    v_mfma_f32_16x16x32_bf16 v[148:151], v[228:231], v[72:75], v[148:151]
    v_cvt_pk_bf16_f32 v76, v144, v145
    v_mfma_f32_16x16x32_bf16 v[152:155], a[224:227], v[40:43], v[128:131]
    v_cvt_pk_bf16_f32 v77, v146, v147
    v_mfma_f32_16x16x32_bf16 v[152:155], a[236:239], v[44:47], v[152:155]
    ds_write_b64 v12, v[76:77] offset:0
    v_mfma_f32_16x16x32_bf16 v[152:155], a[248:251], v[48:51], v[152:155]
    s_waitcnt lgkmcnt(2)
    buffer_store_dwordx4 v[88:91], v18, s[20:23], s35 offen offset:1024 sc1
    v_mfma_f32_16x16x32_bf16 v[152:155], v[172:175], v[52:55], v[152:155]
    v_mfma_f32_16x16x32_bf16 v[152:155], v[184:187], v[56:59], v[152:155]
    v_mfma_f32_16x16x32_bf16 v[152:155], v[196:199], v[60:63], v[152:155]
    v_mfma_f32_16x16x32_bf16 v[152:155], v[208:211], v[64:67], v[152:155]
    v_mfma_f32_16x16x32_bf16 v[152:155], v[220:223], v[68:71], v[152:155]
    v_mfma_f32_16x16x32_bf16 v[152:155], v[232:235], v[72:75], v[152:155]
    v_cvt_pk_bf16_f32 v78, v148, v149
    v_mfma_f32_16x16x32_bf16 v[120:123], a[108:111], v[40:43], v[96:99]
    v_cvt_pk_bf16_f32 v79, v150, v151
    v_mfma_f32_16x16x32_bf16 v[120:123], a[120:123], v[44:47], v[120:123]
    s_waitcnt lgkmcnt(1)
    buffer_store_dwordx4 v[92:95], v18, s[20:23], s35 offen offset:2048 sc1
    ds_write_b64 v13, v[78:79] offset:0
    v_mfma_f32_16x16x32_bf16 v[120:123], a[132:135], v[48:51], v[120:123]
    s_add_u32 s35, s35, 196608
    v_mfma_f32_16x16x32_bf16 v[120:123], a[144:147], v[52:55], v[120:123]
    v_mfma_f32_16x16x32_bf16 v[120:123], a[156:159], v[56:59], v[120:123]
    v_mfma_f32_16x16x32_bf16 v[120:123], a[168:171], v[60:63], v[120:123]
    v_mfma_f32_16x16x32_bf16 v[120:123], a[180:183], v[64:67], v[120:123]
    v_mfma_f32_16x16x32_bf16 v[120:123], a[192:195], v[68:71], v[120:123]
    v_mfma_f32_16x16x32_bf16 v[120:123], a[204:207], v[72:75], v[120:123]
    v_cvt_pk_bf16_f32 v80, v152, v153
    v_mfma_f32_16x16x32_bf16 v[124:127], a[112:115], v[40:43], v[100:103]
    v_cvt_pk_bf16_f32 v81, v154, v155
    v_mfma_f32_16x16x32_bf16 v[124:127], a[124:127], v[44:47], v[124:127]
    ds_write_b64 v14, v[80:81] offset:0
    v_mfma_f32_16x16x32_bf16 v[124:127], a[136:139], v[48:51], v[124:127]
    s_add_u32 s32, s32, 196608
    v_mfma_f32_16x16x32_bf16 v[124:127], a[148:151], v[52:55], v[124:127]
    s_add_u32 s33, s33, 2
    v_mfma_f32_16x16x32_bf16 v[124:127], a[160:163], v[56:59], v[124:127]
    s_cmp_lt_u32 s33, s34
    v_mfma_f32_16x16x32_bf16 v[124:127], a[172:175], v[60:63], v[124:127]
    s_cselect_b32 s14, 50331648, 0
    v_mfma_f32_16x16x32_bf16 v[124:127], a[184:187], v[64:67], v[124:127]
    s_add_u32 s31, s31, 13312
    v_mfma_f32_16x16x32_bf16 v[124:127], a[196:199], v[68:71], v[124:127]
    s_cmp_eq_u32 s31, 53248
    v_mfma_f32_16x16x32_bf16 v[124:127], a[208:211], v[72:75], v[124:127]
    s_cselect_b32 s31, 0, s31
    v_mfma_f32_16x16x32_bf16 v[128:131], a[116:119], v[40:43], v[104:107]
    v_mfma_f32_16x16x32_bf16 v[128:131], a[128:131], v[44:47], v[128:131]
    s_add_u32 m0, s31, s26
    v_mfma_f32_16x16x32_bf16 v[128:131], a[140:143], v[48:51], v[128:131]
    buffer_load_dwordx4 v2, s[12:15], s32 offen nt lds
    v_mfma_f32_16x16x32_bf16 v[128:131], a[152:155], v[52:55], v[128:131]
    v_mfma_f32_16x16x32_bf16 v[128:131], a[164:167], v[56:59], v[128:131]
    v_mfma_f32_16x16x32_bf16 v[128:131], a[176:179], v[60:63], v[128:131]
    s_add_u32 m0, s31, s27
    v_mfma_f32_16x16x32_bf16 v[128:131], a[188:191], v[64:67], v[128:131]
    buffer_load_dwordx4 v3, s[12:15], s32 offen nt lds
    v_mfma_f32_16x16x32_bf16 v[128:131], a[200:203], v[68:71], v[128:131]
    v_mfma_f32_16x16x32_bf16 v[128:131], a[212:215], v[72:75], v[128:131]
    v_mfma_f32_16x16x32_bf16 v[96:99], a[0:3], v[40:43], 0
    s_add_u32 m0, s31, s28
    v_mfma_f32_16x16x32_bf16 v[96:99], a[12:15], v[44:47], v[96:99]
    buffer_load_dwordx4 v4, s[12:15], s32 offen nt lds
    v_mfma_f32_16x16x32_bf16 v[96:99], a[24:27], v[48:51], v[96:99]
    v_mfma_f32_16x16x32_bf16 v[100:103], a[4:7], v[40:43], 0
    v_mfma_f32_16x16x32_bf16 v[100:103], a[16:19], v[44:47], v[100:103]
    s_add_u32 m0, s31, s29
    v_mfma_f32_16x16x32_bf16 v[100:103], a[28:31], v[48:51], v[100:103]
    buffer_load_dwordx4 v5, s[12:15], s32 offen nt lds
    v_mfma_f32_16x16x32_bf16 v[104:107], a[8:11], v[40:43], 0
    ds_read_b128 v[40:43], v9 offset:3072
    v_mfma_f32_16x16x32_bf16 v[104:107], a[20:23], v[44:47], v[104:107]
    ds_read_b128 v[44:47], v9 offset:3136
    v_mfma_f32_16x16x32_bf16 v[104:107], a[32:35], v[48:51], v[104:107]
    ds_read_b128 v[48:51], v9 offset:3200
    v_mfma_f32_16x16x32_bf16 v[96:99], a[36:39], v[52:55], v[96:99]
    v_mfma_f32_16x16x32_bf16 v[96:99], a[48:51], v[56:59], v[96:99]
    v_mfma_f32_16x16x32_bf16 v[96:99], a[60:63], v[60:63], v[96:99]
    v_mfma_f32_16x16x32_bf16 v[100:103], a[40:43], v[52:55], v[100:103]
    v_mfma_f32_16x16x32_bf16 v[100:103], a[52:55], v[56:59], v[100:103]
    v_mfma_f32_16x16x32_bf16 v[100:103], a[64:67], v[60:63], v[100:103]
    v_mfma_f32_16x16x32_bf16 v[104:107], a[44:47], v[52:55], v[104:107]
    ds_read_b128 v[52:55], v10 offset:3072
    v_mfma_f32_16x16x32_bf16 v[104:107], a[56:59], v[56:59], v[104:107]
    ds_read_b128 v[56:59], v10 offset:3136
    v_mfma_f32_16x16x32_bf16 v[104:107], a[68:71], v[60:63], v[104:107]
    ds_read_b128 v[60:63], v10 offset:3200
    v_mfma_f32_16x16x32_bf16 v[96:99], a[72:75], v[64:67], v[96:99]
    v_mfma_f32_16x16x32_bf16 v[96:99], a[84:87], v[68:71], v[96:99]
    v_mfma_f32_16x16x32_bf16 v[96:99], a[96:99], v[72:75], v[96:99]
    v_mfma_f32_16x16x32_bf16 v[100:103], a[76:79], v[64:67], v[100:103]
    v_mfma_f32_16x16x32_bf16 v[100:103], a[88:91], v[68:71], v[100:103]
    v_mfma_f32_16x16x32_bf16 v[100:103], a[100:103], v[72:75], v[100:103]
    v_mfma_f32_16x16x32_bf16 v[104:107], a[80:83], v[64:67], v[104:107]
    ds_read_b128 v[64:67], v11 offset:3072
    v_mfma_f32_16x16x32_bf16 v[104:107], a[92:95], v[68:71], v[104:107]
    ds_read_b128 v[68:71], v11 offset:3136
    v_mfma_f32_16x16x32_bf16 v[104:107], a[104:107], v[72:75], v[104:107]
    ds_read_b128 v[72:75], v11 offset:3200
    s_waitcnt lgkmcnt(6)
    v_mfma_f32_16x16x32_bf16 v[156:159], a[216:219], v[40:43], v[132:135]
    v_mfma_f32_16x16x32_bf16 v[156:159], a[228:231], v[44:47], v[156:159]
    v_mfma_f32_16x16x32_bf16 v[156:159], a[240:243], v[48:51], v[156:159]
    s_waitcnt lgkmcnt(3)
    v_mfma_f32_16x16x32_bf16 v[156:159], a[252:255], v[52:55], v[156:159]
    v_mfma_f32_16x16x32_bf16 v[156:159], v[176:179], v[56:59], v[156:159]
    v_mfma_f32_16x16x32_bf16 v[156:159], v[188:191], v[60:63], v[156:159]
    s_waitcnt lgkmcnt(0)
    v_mfma_f32_16x16x32_bf16 v[156:159], v[200:203], v[64:67], v[156:159]
    v_mfma_f32_16x16x32_bf16 v[156:159], v[212:215], v[68:71], v[156:159]
    v_mfma_f32_16x16x32_bf16 v[156:159], v[224:227], v[72:75], v[156:159]
    v_mfma_f32_16x16x32_bf16 v[160:163], a[220:223], v[40:43], v[136:139]
    s_add_u32 s30, s30, 13312
    v_mfma_f32_16x16x32_bf16 v[160:163], a[232:235], v[44:47], v[160:163]
    s_cmp_eq_u32 s30, 53248
    v_mfma_f32_16x16x32_bf16 v[160:163], a[244:247], v[48:51], v[160:163]
    s_cselect_b32 s30, 0, s30
    v_mfma_f32_16x16x32_bf16 v[160:163], v[168:171], v[52:55], v[160:163]
    v_add_u32 v9, s30, v6
    v_mfma_f32_16x16x32_bf16 v[160:163], v[180:183], v[56:59], v[160:163]
    v_add_u32 v10, s30, v7
    v_mfma_f32_16x16x32_bf16 v[160:163], v[192:195], v[60:63], v[160:163]
    v_add_u32 v11, s30, v8
    v_mfma_f32_16x16x32_bf16 v[160:163], v[204:207], v[64:67], v[160:163]
    v_mfma_f32_16x16x32_bf16 v[160:163], v[216:219], v[68:71], v[160:163]
    v_mfma_f32_16x16x32_bf16 v[160:163], v[228:231], v[72:75], v[160:163]
    v_cvt_pk_bf16_f32 v76, v156, v157
    v_mfma_f32_16x16x32_bf16 v[164:167], a[224:227], v[40:43], v[140:143]
    v_cvt_pk_bf16_f32 v77, v158, v159
    v_mfma_f32_16x16x32_bf16 v[164:167], a[236:239], v[44:47], v[164:167]
    ds_write_b64 v12, v[76:77] offset:3072
    v_mfma_f32_16x16x32_bf16 v[164:167], a[248:251], v[48:51], v[164:167]
    v_mfma_f32_16x16x32_bf16 v[164:167], v[172:175], v[52:55], v[164:167]
    v_mfma_f32_16x16x32_bf16 v[164:167], v[184:187], v[56:59], v[164:167]
    v_mfma_f32_16x16x32_bf16 v[164:167], v[196:199], v[60:63], v[164:167]
    v_mfma_f32_16x16x32_bf16 v[164:167], v[208:211], v[64:67], v[164:167]
    v_mfma_f32_16x16x32_bf16 v[164:167], v[220:223], v[68:71], v[164:167]
    v_mfma_f32_16x16x32_bf16 v[164:167], v[232:235], v[72:75], v[164:167]
    v_cvt_pk_bf16_f32 v78, v160, v161
    v_mfma_f32_16x16x32_bf16 v[132:135], a[108:111], v[40:43], v[108:111]
    v_cvt_pk_bf16_f32 v79, v162, v163
    v_mfma_f32_16x16x32_bf16 v[132:135], a[120:123], v[44:47], v[132:135]
    ds_write_b64 v13, v[78:79] offset:3072
    v_mfma_f32_16x16x32_bf16 v[132:135], a[132:135], v[48:51], v[132:135]
    v_mfma_f32_16x16x32_bf16 v[132:135], a[144:147], v[52:55], v[132:135]
    v_mfma_f32_16x16x32_bf16 v[132:135], a[156:159], v[56:59], v[132:135]
    v_mfma_f32_16x16x32_bf16 v[132:135], a[168:171], v[60:63], v[132:135]
    v_mfma_f32_16x16x32_bf16 v[132:135], a[180:183], v[64:67], v[132:135]
    v_mfma_f32_16x16x32_bf16 v[132:135], a[192:195], v[68:71], v[132:135]
    v_mfma_f32_16x16x32_bf16 v[132:135], a[204:207], v[72:75], v[132:135]
    v_cvt_pk_bf16_f32 v80, v164, v165
    v_mfma_f32_16x16x32_bf16 v[136:139], a[112:115], v[40:43], v[112:115]
    v_cvt_pk_bf16_f32 v81, v166, v167
    v_mfma_f32_16x16x32_bf16 v[136:139], a[124:127], v[44:47], v[136:139]
    ds_write_b64 v14, v[80:81] offset:3072
    v_mfma_f32_16x16x32_bf16 v[136:139], a[136:139], v[48:51], v[136:139]
    v_mfma_f32_16x16x32_bf16 v[136:139], a[148:151], v[52:55], v[136:139]
    v_mfma_f32_16x16x32_bf16 v[136:139], a[160:163], v[56:59], v[136:139]
    v_add_u32 v243, 1, v243
    v_mfma_f32_16x16x32_bf16 v[136:139], a[172:175], v[60:63], v[136:139]
    s_add_u32 s63, s63, 1
    v_mfma_f32_16x16x32_bf16 v[136:139], a[184:187], v[64:67], v[136:139]
    s_waitcnt vmcnt(14)
    ds_write_b32 v242, v243
    v_mfma_f32_16x16x32_bf16 v[136:139], a[196:199], v[68:71], v[136:139]
    v_mfma_f32_16x16x32_bf16 v[136:139], a[208:211], v[72:75], v[136:139]
    v_mfma_f32_16x16x32_bf16 v[140:143], a[116:119], v[40:43], v[116:119]
    v_mfma_f32_16x16x32_bf16 v[140:143], a[128:131], v[44:47], v[140:143]
    v_mfma_f32_16x16x32_bf16 v[140:143], a[140:143], v[48:51], v[140:143]
    v_mfma_f32_16x16x32_bf16 v[140:143], a[152:155], v[52:55], v[140:143]
    v_mfma_f32_16x16x32_bf16 v[140:143], a[164:167], v[56:59], v[140:143]
    v_mfma_f32_16x16x32_bf16 v[140:143], a[176:179], v[60:63], v[140:143]
    v_mfma_f32_16x16x32_bf16 v[140:143], a[188:191], v[64:67], v[140:143]
    v_mfma_f32_16x16x32_bf16 v[140:143], a[200:203], v[68:71], v[140:143]
    v_mfma_f32_16x16x32_bf16 v[140:143], a[212:215], v[72:75], v[140:143]
    ds_read_b128 v[236:239], v244
    v_mfma_f32_16x16x32_bf16 v[108:111], a[0:3], v[40:43], 0
    v_mfma_f32_16x16x32_bf16 v[108:111], a[12:15], v[44:47], v[108:111]
    v_mfma_f32_16x16x32_bf16 v[108:111], a[24:27], v[48:51], v[108:111]
    v_mfma_f32_16x16x32_bf16 v[112:115], a[4:7], v[40:43], 0
    v_mfma_f32_16x16x32_bf16 v[112:115], a[16:19], v[44:47], v[112:115]
    v_mfma_f32_16x16x32_bf16 v[112:115], a[28:31], v[48:51], v[112:115]
    s_waitcnt lgkmcnt(0)
    v_min3_u32 v245, v236, v237, v238
    v_mfma_f32_16x16x32_bf16 v[116:119], a[8:11], v[40:43], 0
    v_min_u32 v245, v245, v239
    v_mfma_f32_16x16x32_bf16 v[116:119], a[20:23], v[44:47], v[116:119]
    v_mfma_f32_16x16x32_bf16 v[116:119], a[32:35], v[48:51], v[116:119]
    v_readfirstlane_b32 s57, v245
    v_mfma_f32_16x16x32_bf16 v[108:111], a[36:39], v[52:55], v[108:111]
    v_mfma_f32_16x16x32_bf16 v[108:111], a[48:51], v[56:59], v[108:111]
    v_mfma_f32_16x16x32_bf16 v[108:111], a[60:63], v[60:63], v[108:111]
    s_cmp_ge_u32 s57, s63
    s_cbranch_scc0 L_slow
L_back:
    v_mfma_f32_16x16x32_bf16 v[112:115], a[40:43], v[52:55], v[112:115]
    ds_read_b128 v[40:43], v9 offset:0
    v_mfma_f32_16x16x32_bf16 v[112:115], a[52:55], v[56:59], v[112:115]
    ds_read_b128 v[44:47], v9 offset:64
    v_mfma_f32_16x16x32_bf16 v[112:115], a[64:67], v[60:63], v[112:115]
    ds_read_b128 v[48:51], v9 offset:128
    v_mfma_f32_16x16x32_bf16 v[116:119], a[44:47], v[52:55], v[116:119]
    ds_read_b128 v[52:55], v10 offset:0
    v_mfma_f32_16x16x32_bf16 v[116:119], a[56:59], v[56:59], v[116:119]
    ds_read_b128 v[56:59], v10 offset:64
    v_mfma_f32_16x16x32_bf16 v[116:119], a[68:71], v[60:63], v[116:119]
    ds_read_b128 v[60:63], v10 offset:128
    v_mfma_f32_16x16x32_bf16 v[108:111], a[72:75], v[64:67], v[108:111]
    v_mfma_f32_16x16x32_bf16 v[108:111], a[84:87], v[68:71], v[108:111]
    v_mfma_f32_16x16x32_bf16 v[108:111], a[96:99], v[72:75], v[108:111]
    s_sub_u32 s36, s36, 1
    v_mfma_f32_16x16x32_bf16 v[112:115], a[76:79], v[64:67], v[112:115]
    s_cmp_lg_u32 s36, 0
    v_mfma_f32_16x16x32_bf16 v[112:115], a[88:91], v[68:71], v[112:115]
    v_mfma_f32_16x16x32_bf16 v[112:115], a[100:103], v[72:75], v[112:115]
    v_mfma_f32_16x16x32_bf16 v[116:119], a[80:83], v[64:67], v[116:119]
    ds_read_b128 v[64:67], v11 offset:0
    v_mfma_f32_16x16x32_bf16 v[116:119], a[92:95], v[68:71], v[116:119]
    ds_read_b128 v[68:71], v11 offset:64
    v_mfma_f32_16x16x32_bf16 v[116:119], a[104:107], v[72:75], v[116:119]
    ds_read_b128 v[72:75], v11 offset:128
    s_cbranch_scc1 L_loop
    s_waitcnt lgkmcnt(6)
    v_mfma_f32_16x16x32_bf16 v[144:147], a[216:219], v[40:43], v[120:123]
    v_xor_b32 v12, 0x4000, v12
    v_mfma_f32_16x16x32_bf16 v[144:147], a[228:231], v[44:47], v[144:147]
    v_xor_b32 v13, 0x4000, v13
    v_mfma_f32_16x16x32_bf16 v[144:147], a[240:243], v[48:51], v[144:147]
    v_xor_b32 v14, 0x4000, v14
    s_waitcnt lgkmcnt(3)
    v_mfma_f32_16x16x32_bf16 v[144:147], a[252:255], v[52:55], v[144:147]
    v_mfma_f32_16x16x32_bf16 v[144:147], v[176:179], v[56:59], v[144:147]
    v_mfma_f32_16x16x32_bf16 v[144:147], v[188:191], v[60:63], v[144:147]
    s_waitcnt lgkmcnt(0)
    v_mfma_f32_16x16x32_bf16 v[144:147], v[200:203], v[64:67], v[144:147]
    ds_read_b128 v[84:87], v15
    v_mfma_f32_16x16x32_bf16 v[144:147], v[212:215], v[68:71], v[144:147]
    ds_read_b128 v[88:91], v16
    v_mfma_f32_16x16x32_bf16 v[144:147], v[224:227], v[72:75], v[144:147]
    ds_read_b128 v[92:95], v17
    v_mfma_f32_16x16x32_bf16 v[148:151], a[220:223], v[40:43], v[124:127]
    v_xor_b32 v15, 0x4000, v15
    v_mfma_f32_16x16x32_bf16 v[148:151], a[232:235], v[44:47], v[148:151]
    v_xor_b32 v16, 0x4000, v16
    v_mfma_f32_16x16x32_bf16 v[148:151], a[244:247], v[48:51], v[148:151]
    v_xor_b32 v17, 0x4000, v17
    v_mfma_f32_16x16x32_bf16 v[148:151], v[168:171], v[52:55], v[148:151]
    s_waitcnt lgkmcnt(2)
    buffer_store_dwordx4 v[84:87], v18, s[20:23], s35 offen offset:0 sc1
    v_mfma_f32_16x16x32_bf16 v[148:151], v[180:183], v[56:59], v[148:151]
    v_mfma_f32_16x16x32_bf16 v[148:151], v[192:195], v[60:63], v[148:151]
    v_mfma_f32_16x16x32_bf16 v[148:151], v[204:207], v[64:67], v[148:151]
    v_mfma_f32_16x16x32_bf16 v[148:151], v[216:219], v[68:71], v[148:151]
    v_mfma_f32_16x16x32_bf16 v[148:151], v[228:231], v[72:75], v[148:151]
    v_cvt_pk_bf16_f32 v76, v144, v145
    v_mfma_f32_16x16x32_bf16 v[152:155], a[224:227], v[40:43], v[128:131]
    v_cvt_pk_bf16_f32 v77, v146, v147
    v_mfma_f32_16x16x32_bf16 v[152:155], a[236:239], v[44:47], v[152:155]
    ds_write_b64 v12, v[76:77] offset:0
    v_mfma_f32_16x16x32_bf16 v[152:155], a[248:251], v[48:51], v[152:155]
    s_waitcnt lgkmcnt(2)
    buffer_store_dwordx4 v[88:91], v18, s[20:23], s35 offen offset:1024 sc1
    v_mfma_f32_16x16x32_bf16 v[152:155], v[172:175], v[52:55], v[152:155]
    v_mfma_f32_16x16x32_bf16 v[152:155], v[184:187], v[56:59], v[152:155]
    v_mfma_f32_16x16x32_bf16 v[152:155], v[196:199], v[60:63], v[152:155]
    v_mfma_f32_16x16x32_bf16 v[152:155], v[208:211], v[64:67], v[152:155]
    v_mfma_f32_16x16x32_bf16 v[152:155], v[220:223], v[68:71], v[152:155]
    v_mfma_f32_16x16x32_bf16 v[152:155], v[232:235], v[72:75], v[152:155]
    v_cvt_pk_bf16_f32 v78, v148, v149
    v_mfma_f32_16x16x32_bf16 v[120:123], a[108:111], v[40:43], v[96:99]
    v_cvt_pk_bf16_f32 v79, v150, v151
    v_mfma_f32_16x16x32_bf16 v[120:123], a[120:123], v[44:47], v[120:123]
    s_waitcnt lgkmcnt(1)
    buffer_store_dwordx4 v[92:95], v18, s[20:23], s35 offen offset:2048 sc1
    ds_write_b64 v13, v[78:79] offset:0
    v_mfma_f32_16x16x32_bf16 v[120:123], a[132:135], v[48:51], v[120:123]
    s_add_u32 s35, s35, 196608
    v_mfma_f32_16x16x32_bf16 v[124:127], a[112:115], v[40:43], v[100:103]
    v_mfma_f32_16x16x32_bf16 v[124:127], a[124:127], v[44:47], v[124:127]
    v_mfma_f32_16x16x32_bf16 v[124:127], a[136:139], v[48:51], v[124:127]
    v_mfma_f32_16x16x32_bf16 v[128:131], a[116:119], v[40:43], v[104:107]
    ds_read_b128 v[40:43], v9 offset:3072
    v_mfma_f32_16x16x32_bf16 v[128:131], a[128:131], v[44:47], v[128:131]
    ds_read_b128 v[44:47], v9 offset:3136
    v_mfma_f32_16x16x32_bf16 v[128:131], a[140:143], v[48:51], v[128:131]
    v_cvt_pk_bf16_f32 v80, v152, v153
    ds_read_b128 v[48:51], v9 offset:3200
    v_mfma_f32_16x16x32_bf16 v[120:123], a[144:147], v[52:55], v[120:123]
    v_cvt_pk_bf16_f32 v81, v154, v155
    v_mfma_f32_16x16x32_bf16 v[120:123], a[156:159], v[56:59], v[120:123]
    ds_write_b64 v14, v[80:81] offset:0
    v_mfma_f32_16x16x32_bf16 v[120:123], a[168:171], v[60:63], v[120:123]
    v_mfma_f32_16x16x32_bf16 v[124:127], a[148:151], v[52:55], v[124:127]
    v_mfma_f32_16x16x32_bf16 v[124:127], a[160:163], v[56:59], v[124:127]
    v_mfma_f32_16x16x32_bf16 v[124:127], a[172:175], v[60:63], v[124:127]
    v_mfma_f32_16x16x32_bf16 v[128:131], a[152:155], v[52:55], v[128:131]
    ds_read_b128 v[52:55], v10 offset:3072
    v_mfma_f32_16x16x32_bf16 v[128:131], a[164:167], v[56:59], v[128:131]
    ds_read_b128 v[56:59], v10 offset:3136
    v_mfma_f32_16x16x32_bf16 v[128:131], a[176:179], v[60:63], v[128:131]
    ds_read_b128 v[60:63], v10 offset:3200
    v_mfma_f32_16x16x32_bf16 v[120:123], a[180:183], v[64:67], v[120:123]
    v_mfma_f32_16x16x32_bf16 v[120:123], a[192:195], v[68:71], v[120:123]
    v_mfma_f32_16x16x32_bf16 v[120:123], a[204:207], v[72:75], v[120:123]
    v_mfma_f32_16x16x32_bf16 v[124:127], a[184:187], v[64:67], v[124:127]
    v_mfma_f32_16x16x32_bf16 v[124:127], a[196:199], v[68:71], v[124:127]
    v_mfma_f32_16x16x32_bf16 v[124:127], a[208:211], v[72:75], v[124:127]
    v_mfma_f32_16x16x32_bf16 v[128:131], a[188:191], v[64:67], v[128:131]
    ds_read_b128 v[64:67], v11 offset:3072
    v_mfma_f32_16x16x32_bf16 v[128:131], a[200:203], v[68:71], v[128:131]
    ds_read_b128 v[68:71], v11 offset:3136
    v_mfma_f32_16x16x32_bf16 v[128:131], a[212:215], v[72:75], v[128:131]
    ds_read_b128 v[72:75], v11 offset:3200
    s_waitcnt lgkmcnt(7)
    v_mfma_f32_16x16x32_bf16 v[156:159], a[216:219], v[40:43], v[132:135]
    v_mfma_f32_16x16x32_bf16 v[156:159], a[228:231], v[44:47], v[156:159]
    v_mfma_f32_16x16x32_bf16 v[156:159], a[240:243], v[48:51], v[156:159]
    s_waitcnt lgkmcnt(3)
    v_mfma_f32_16x16x32_bf16 v[156:159], a[252:255], v[52:55], v[156:159]
    v_mfma_f32_16x16x32_bf16 v[156:159], v[176:179], v[56:59], v[156:159]
    v_mfma_f32_16x16x32_bf16 v[156:159], v[188:191], v[60:63], v[156:159]
    s_waitcnt lgkmcnt(0)
    v_mfma_f32_16x16x32_bf16 v[156:159], v[200:203], v[64:67], v[156:159]
    v_mfma_f32_16x16x32_bf16 v[156:159], v[212:215], v[68:71], v[156:159]
    v_mfma_f32_16x16x32_bf16 v[156:159], v[224:227], v[72:75], v[156:159]
    v_mfma_f32_16x16x32_bf16 v[160:163], a[220:223], v[40:43], v[136:139]
    s_add_u32 s30, s30, 13312
    v_mfma_f32_16x16x32_bf16 v[160:163], a[232:235], v[44:47], v[160:163]
    s_cmp_eq_u32 s30, 53248
    v_mfma_f32_16x16x32_bf16 v[160:163], a[244:247], v[48:51], v[160:163]
    s_cselect_b32 s30, 0, s30
    v_mfma_f32_16x16x32_bf16 v[160:163], v[168:171], v[52:55], v[160:163]
    v_add_u32 v9, s30, v6
    v_mfma_f32_16x16x32_bf16 v[160:163], v[180:183], v[56:59], v[160:163]
    v_add_u32 v10, s30, v7
    v_mfma_f32_16x16x32_bf16 v[160:163], v[192:195], v[60:63], v[160:163]
    v_add_u32 v11, s30, v8
    v_mfma_f32_16x16x32_bf16 v[160:163], v[204:207], v[64:67], v[160:163]
    v_mfma_f32_16x16x32_bf16 v[160:163], v[216:219], v[68:71], v[160:163]
    v_mfma_f32_16x16x32_bf16 v[160:163], v[228:231], v[72:75], v[160:163]
    v_cvt_pk_bf16_f32 v76, v156, v157
    v_mfma_f32_16x16x32_bf16 v[164:167], a[224:227], v[40:43], v[140:143]
    v_cvt_pk_bf16_f32 v77, v158, v159
    v_mfma_f32_16x16x32_bf16 v[164:167], a[236:239], v[44:47], v[164:167]
    ds_write_b64 v12, v[76:77] offset:3072
    v_mfma_f32_16x16x32_bf16 v[164:167], a[248:251], v[48:51], v[164:167]
    v_mfma_f32_16x16x32_bf16 v[164:167], v[172:175], v[52:55], v[164:167]
    v_mfma_f32_16x16x32_bf16 v[164:167], v[184:187], v[56:59], v[164:167]
    v_mfma_f32_16x16x32_bf16 v[164:167], v[196:199], v[60:63], v[164:167]
    v_mfma_f32_16x16x32_bf16 v[164:167], v[208:211], v[64:67], v[164:167]
    v_mfma_f32_16x16x32_bf16 v[164:167], v[220:223], v[68:71], v[164:167]
    v_mfma_f32_16x16x32_bf16 v[164:167], v[232:235], v[72:75], v[164:167]
    v_cvt_pk_bf16_f32 v78, v160, v161
    v_mfma_f32_16x16x32_bf16 v[132:135], a[108:111], v[40:43], v[108:111]
    v_cvt_pk_bf16_f32 v79, v162, v163
    v_mfma_f32_16x16x32_bf16 v[132:135], a[120:123], v[44:47], v[132:135]
    ds_write_b64 v13, v[78:79] offset:3072
    v_mfma_f32_16x16x32_bf16 v[132:135], a[132:135], v[48:51], v[132:135]
    v_mfma_f32_16x16x32_bf16 v[136:139], a[112:115], v[40:43], v[112:115]
    v_mfma_f32_16x16x32_bf16 v[136:139], a[124:127], v[44:47], v[136:139]
    v_mfma_f32_16x16x32_bf16 v[136:139], a[136:139], v[48:51], v[136:139]
    v_mfma_f32_16x16x32_bf16 v[140:143], a[116:119], v[40:43], v[116:119]
    v_mfma_f32_16x16x32_bf16 v[140:143], a[128:131], v[44:47], v[140:143]
    v_mfma_f32_16x16x32_bf16 v[140:143], a[140:143], v[48:51], v[140:143]
    v_cvt_pk_bf16_f32 v80, v164, v165
    v_mfma_f32_16x16x32_bf16 v[132:135], a[144:147], v[52:55], v[132:135]
    v_cvt_pk_bf16_f32 v81, v166, v167
    v_mfma_f32_16x16x32_bf16 v[132:135], a[156:159], v[56:59], v[132:135]
    ds_write_b64 v14, v[80:81] offset:3072
    v_mfma_f32_16x16x32_bf16 v[132:135], a[168:171], v[60:63], v[132:135]
    v_mfma_f32_16x16x32_bf16 v[136:139], a[148:151], v[52:55], v[136:139]
    s_waitcnt vmcnt(10) lgkmcnt(0)
    s_barrier
    v_mfma_f32_16x16x32_bf16 v[136:139], a[160:163], v[56:59], v[136:139]
    ds_read_b128 v[40:43], v9 offset:0
    v_mfma_f32_16x16x32_bf16 v[136:139], a[172:175], v[60:63], v[136:139]
    ds_read_b128 v[44:47], v9 offset:64
    v_mfma_f32_16x16x32_bf16 v[140:143], a[152:155], v[52:55], v[140:143]
    ds_read_b128 v[48:51], v9 offset:128
    v_mfma_f32_16x16x32_bf16 v[140:143], a[164:167], v[56:59], v[140:143]
    ds_read_b128 v[52:55], v10 offset:0
    v_mfma_f32_16x16x32_bf16 v[140:143], a[176:179], v[60:63], v[140:143]
    ds_read_b128 v[56:59], v10 offset:64
    v_mfma_f32_16x16x32_bf16 v[132:135], a[180:183], v[64:67], v[132:135]
    ds_read_b128 v[60:63], v10 offset:128
    v_mfma_f32_16x16x32_bf16 v[132:135], a[192:195], v[68:71], v[132:135]
    v_mfma_f32_16x16x32_bf16 v[132:135], a[204:207], v[72:75], v[132:135]
    v_mfma_f32_16x16x32_bf16 v[136:139], a[184:187], v[64:67], v[136:139]
    v_mfma_f32_16x16x32_bf16 v[136:139], a[196:199], v[68:71], v[136:139]
    v_mfma_f32_16x16x32_bf16 v[136:139], a[208:211], v[72:75], v[136:139]
    v_mfma_f32_16x16x32_bf16 v[140:143], a[188:191], v[64:67], v[140:143]
    ds_read_b128 v[64:67], v11 offset:0
    v_mfma_f32_16x16x32_bf16 v[140:143], a[200:203], v[68:71], v[140:143]
    ds_read_b128 v[68:71], v11 offset:64
    v_mfma_f32_16x16x32_bf16 v[140:143], a[212:215], v[72:75], v[140:143]
    ds_read_b128 v[72:75], v11 offset:128
    s_waitcnt lgkmcnt(6)
    v_mfma_f32_16x16x32_bf16 v[144:147], a[216:219], v[40:43], v[120:123]
    v_xor_b32 v12, 0x4000, v12
    v_mfma_f32_16x16x32_bf16 v[144:147], a[228:231], v[44:47], v[144:147]
    v_xor_b32 v13, 0x4000, v13
    v_mfma_f32_16x16x32_bf16 v[144:147], a[240:243], v[48:51], v[144:147]
    v_xor_b32 v14, 0x4000, v14
    s_waitcnt lgkmcnt(3)
    v_mfma_f32_16x16x32_bf16 v[144:147], a[252:255], v[52:55], v[144:147]
    v_mfma_f32_16x16x32_bf16 v[144:147], v[176:179], v[56:59], v[144:147]
    v_mfma_f32_16x16x32_bf16 v[144:147], v[188:191], v[60:63], v[144:147]
    s_waitcnt lgkmcnt(0)
    v_mfma_f32_16x16x32_bf16 v[144:147], v[200:203], v[64:67], v[144:147]
    ds_read_b128 v[84:87], v15
    v_mfma_f32_16x16x32_bf16 v[144:147], v[212:215], v[68:71], v[144:147]
    ds_read_b128 v[88:91], v16
    v_mfma_f32_16x16x32_bf16 v[144:147], v[224:227], v[72:75], v[144:147]
    ds_read_b128 v[92:95], v17
    v_mfma_f32_16x16x32_bf16 v[148:151], a[220:223], v[40:43], v[124:127]
    v_xor_b32 v15, 0x4000, v15
    v_mfma_f32_16x16x32_bf16 v[148:151], a[232:235], v[44:47], v[148:151]
    v_xor_b32 v16, 0x4000, v16
    v_mfma_f32_16x16x32_bf16 v[148:151], a[244:247], v[48:51], v[148:151]
    v_xor_b32 v17, 0x4000, v17
    v_mfma_f32_16x16x32_bf16 v[148:151], v[168:171], v[52:55], v[148:151]
    s_waitcnt lgkmcnt(2)
    buffer_store_dwordx4 v[84:87], v18, s[20:23], s35 offen offset:0 sc1
    v_mfma_f32_16x16x32_bf16 v[148:151], v[180:183], v[56:59], v[148:151]
    v_mfma_f32_16x16x32_bf16 v[148:151], v[192:195], v[60:63], v[148:151]
    v_mfma_f32_16x16x32_bf16 v[148:151], v[204:207], v[64:67], v[148:151]
    v_mfma_f32_16x16x32_bf16 v[148:151], v[216:219], v[68:71], v[148:151]
    v_mfma_f32_16x16x32_bf16 v[148:151], v[228:231], v[72:75], v[148:151]
    v_cvt_pk_bf16_f32 v76, v144, v145
    v_mfma_f32_16x16x32_bf16 v[152:155], a[224:227], v[40:43], v[128:131]
    ds_read_b128 v[40:43], v9 offset:3072
    v_cvt_pk_bf16_f32 v77, v146, v147
    v_mfma_f32_16x16x32_bf16 v[152:155], a[236:239], v[44:47], v[152:155]
    ds_read_b128 v[44:47], v9 offset:3136
    ds_write_b64 v12, v[76:77] offset:0
    v_mfma_f32_16x16x32_bf16 v[152:155], a[248:251], v[48:51], v[152:155]
    s_waitcnt lgkmcnt(4)
    buffer_store_dwordx4 v[88:91], v18, s[20:23], s35 offen offset:1024 sc1
    ds_read_b128 v[48:51], v9 offset:3200
    v_mfma_f32_16x16x32_bf16 v[152:155], v[172:175], v[52:55], v[152:155]
    ds_read_b128 v[52:55], v10 offset:3072
    v_mfma_f32_16x16x32_bf16 v[152:155], v[184:187], v[56:59], v[152:155]
    ds_read_b128 v[56:59], v10 offset:3136
    v_mfma_f32_16x16x32_bf16 v[152:155], v[196:199], v[60:63], v[152:155]
    ds_read_b128 v[60:63], v10 offset:3200
    v_mfma_f32_16x16x32_bf16 v[152:155], v[208:211], v[64:67], v[152:155]
    ds_read_b128 v[64:67], v11 offset:3072
    v_mfma_f32_16x16x32_bf16 v[152:155], v[220:223], v[68:71], v[152:155]
    ds_read_b128 v[68:71], v11 offset:3136
    v_mfma_f32_16x16x32_bf16 v[152:155], v[232:235], v[72:75], v[152:155]
    ds_read_b128 v[72:75], v11 offset:3200
    v_cvt_pk_bf16_f32 v78, v148, v149
    s_waitcnt lgkmcnt(6)
    v_mfma_f32_16x16x32_bf16 v[156:159], a[216:219], v[40:43], v[132:135]
    v_cvt_pk_bf16_f32 v79, v150, v151
    v_mfma_f32_16x16x32_bf16 v[156:159], a[228:231], v[44:47], v[156:159]
    buffer_store_dwordx4 v[92:95], v18, s[20:23], s35 offen offset:2048 sc1
    ds_write_b64 v13, v[78:79] offset:0
    v_mfma_f32_16x16x32_bf16 v[156:159], a[240:243], v[48:51], v[156:159]
    s_add_u32 s35, s35, 196608
    s_waitcnt lgkmcnt(4)
    v_mfma_f32_16x16x32_bf16 v[156:159], a[252:255], v[52:55], v[156:159]
    v_mfma_f32_16x16x32_bf16 v[156:159], v[176:179], v[56:59], v[156:159]
    v_mfma_f32_16x16x32_bf16 v[156:159], v[188:191], v[60:63], v[156:159]
    s_waitcnt lgkmcnt(1)
    v_mfma_f32_16x16x32_bf16 v[156:159], v[200:203], v[64:67], v[156:159]
    v_mfma_f32_16x16x32_bf16 v[156:159], v[212:215], v[68:71], v[156:159]
    v_mfma_f32_16x16x32_bf16 v[156:159], v[224:227], v[72:75], v[156:159]
    v_cvt_pk_bf16_f32 v80, v152, v153
    v_mfma_f32_16x16x32_bf16 v[160:163], a[220:223], v[40:43], v[136:139]
    v_cvt_pk_bf16_f32 v81, v154, v155
    v_mfma_f32_16x16x32_bf16 v[160:163], a[232:235], v[44:47], v[160:163]
    ds_write_b64 v14, v[80:81] offset:0
    v_mfma_f32_16x16x32_bf16 v[160:163], a[244:247], v[48:51], v[160:163]
    v_mfma_f32_16x16x32_bf16 v[160:163], v[168:171], v[52:55], v[160:163]
    v_mfma_f32_16x16x32_bf16 v[160:163], v[180:183], v[56:59], v[160:163]
    v_mfma_f32_16x16x32_bf16 v[160:163], v[192:195], v[60:63], v[160:163]
    v_mfma_f32_16x16x32_bf16 v[160:163], v[204:207], v[64:67], v[160:163]
    v_mfma_f32_16x16x32_bf16 v[160:163], v[216:219], v[68:71], v[160:163]
    v_mfma_f32_16x16x32_bf16 v[160:163], v[228:231], v[72:75], v[160:163]
    v_cvt_pk_bf16_f32 v76, v156, v157
    v_mfma_f32_16x16x32_bf16 v[164:167], a[224:227], v[40:43], v[140:143]
    v_cvt_pk_bf16_f32 v77, v158, v159
    v_mfma_f32_16x16x32_bf16 v[164:167], a[236:239], v[44:47], v[164:167]
    ds_write_b64 v12, v[76:77] offset:3072
    v_mfma_f32_16x16x32_bf16 v[164:167], a[248:251], v[48:51], v[164:167]
    v_mfma_f32_16x16x32_bf16 v[164:167], v[172:175], v[52:55], v[164:167]
    v_mfma_f32_16x16x32_bf16 v[164:167], v[184:187], v[56:59], v[164:167]
    v_mfma_f32_16x16x32_bf16 v[164:167], v[196:199], v[60:63], v[164:167]
    v_mfma_f32_16x16x32_bf16 v[164:167], v[208:211], v[64:67], v[164:167]
    v_mfma_f32_16x16x32_bf16 v[164:167], v[220:223], v[68:71], v[164:167]
    v_mfma_f32_16x16x32_bf16 v[164:167], v[232:235], v[72:75], v[164:167]
    v_cvt_pk_bf16_f32 v78, v160, v161
    s_nop 7
    v_cvt_pk_bf16_f32 v79, v162, v163
    ds_write_b64 v13, v[78:79] offset:3072
    v_cvt_pk_bf16_f32 v80, v164, v165
    v_cvt_pk_bf16_f32 v81, v166, v167
    ds_write_b64 v14, v[80:81] offset:3072
    s_waitcnt lgkmcnt(0)
    s_barrier
    ds_read_b128 v[84:87], v15
    ds_read_b128 v[88:91], v16
    ds_read_b128 v[92:95], v17
    s_waitcnt lgkmcnt(2)
    buffer_store_dwordx4 v[84:87], v18, s[20:23], s35 offen offset:0 sc1
    s_waitcnt lgkmcnt(1)
    buffer_store_dwordx4 v[88:91], v18, s[20:23], s35 offen offset:1024 sc1
    s_waitcnt lgkmcnt(0)
    buffer_store_dwordx4 v[92:95], v18, s[20:23], s35 offen offset:2048 sc1
L_end:
    s_endpgm
L_slow:
    s_mov_b32 s38, 0
L_slowx:
    ds_read_b128 v[236:239], v244
    s_waitcnt lgkmcnt(0)
    v_min3_u32 v245, v236, v237, v238
    v_min_u32 v245, v245, v239
    s_add_u32 s38, s38, 1
    v_readfirstlane_b32 s57, v245
    s_cmp_gt_u32 s38, 0x40000
    s_cbranch_scc1 L_back
    s_cmp_ge_u32 s57, s63
    s_cbranch_scc0 L_slowx
    s_branch L_back
L_slowP:
    s_mov_b32 s38, 0
L_slowxP:
    ds_read_b128 v[236:239], v244
    s_waitcnt lgkmcnt(0)
    v_min3_u32 v245, v236, v237, v238
    v_min_u32 v245, v245, v239
    s_add_u32 s38, s38, 1
    v_readfirstlane_b32 s57, v245
    s_cmp_gt_u32 s38, 0x40000
    s_cbranch_scc1 L_backP
    s_cmp_ge_u32 s57, s63
    s_cbranch_scc0 L_slowxP
    s_branch L_backP
L_codeend:
.section .rodata,"a"
.p2align 6
.amdhsa_kernel standalone__dilated_atrous__vision_kernel
  .amdhsa_next_free_vgpr 512
  .amdhsa_next_free_sgpr 100
  .amdhsa_accum_offset 256
  .amdhsa_group_segment_fixed_size 0
  .amdhsa_kernarg_size 40
  .amdhsa_user_sgpr_count 2
  .amdhsa_user_sgpr_kernarg_segment_ptr 1
  .amdhsa_system_sgpr_workgroup_id_x 1
.end_amdhsa_kernel
```

```asm
; @launch grid=(256,1,1) block=(256,1,1) lds=163840
.amdgcn_target "amdgcn-amd-amdhsa--gfx950"
.text
.globl standalone__dilated_atrous__vision_kernel
.p2align 8
.type standalone__dilated_atrous__vision_kernel,@function
standalone__dilated_atrous__vision_kernel:
    s_cmp_ge_u32 s2, 256
    s_cbranch_scc1 L_end
    s_load_dwordx4 s[4:7], s[0:1], 0
    s_load_dwordx2 s[8:9], s[0:1], 16
    v_lshrrev_b32 v29, 6, v0
    s_and_b32 s37, s2, 7
    v_readfirstlane_b32 s24, v29
    s_lshr_b32 s38, s2, 3
    s_and_b32 s38, s38, 1
    s_lshr_b32 s39, s2, 4
    s_lshl_b32 s39, s39, 5
    s_add_u32 s25, s39, s38
    s_mul_i32 s40, s37, 12288
    s_sub_u32 s41, s40, 384
    v_mul_u32_u24 v31, 43691, v0
    v_lshlrev_b32 v32, 4, v0
    v_lshrrev_b32 v31, 19, v31
    v_and_b32 v33, 4, v31
    v_and_b32 v34, 8, v31
    v_lshlrev_b32 v33, 3, v33
    v_lshlrev_b32 v34, 2, v34
    v_xor_b32 v33, v33, v32
    v_xor_b32 v19, v34, v32
    v_add_u32 v2, s41, v33
    v_add_u32 v30, 256, v0
    v_mul_u32_u24 v31, 43691, v30
    v_lshlrev_b32 v32, 4, v30
    v_lshrrev_b32 v31, 19, v31
    v_and_b32 v33, 4, v31
    v_and_b32 v34, 8, v31
    v_lshlrev_b32 v33, 3, v33
    v_lshlrev_b32 v34, 2, v34
    v_xor_b32 v33, v33, v32
    v_xor_b32 v20, v34, v32
    v_add_u32 v3, s41, v33
    v_add_u32 v30, 512, v0
    v_mul_u32_u24 v31, 43691, v30
    v_lshlrev_b32 v32, 4, v30
    v_lshrrev_b32 v31, 19, v31
    v_and_b32 v33, 4, v31
    v_and_b32 v34, 8, v31
    v_lshlrev_b32 v33, 3, v33
    v_lshlrev_b32 v34, 2, v34
    v_xor_b32 v33, v33, v32
    v_xor_b32 v21, v34, v32
    v_add_u32 v4, s41, v33
    s_cmp_eq_u32 s37, 0
    s_cselect_b32 s42, 24, 0
    v_mov_b32 v35, 0x80000000
    v_cmp_gt_u32 vcc, s42, v0
    v_and_b32 v36, 63, v0
    s_lshl_b32 s26, s24, 10
    v_cndmask_b32 v2, v2, v35, vcc
    s_add_u32 s27, s26, 4096
    s_add_u32 s28, s26, 8192
    s_mov_b32 s29, 12288
    s_cmp_eq_u32 s37, 7
    s_cselect_b32 s45, 24, 48
    s_add_u32 s44, s41, 12288
    v_cmp_gt_u32 vcc, s45, v36
    v_lshlrev_b32 v29, 4, v36
    v_add_u32 v29, s44, v29
    v_cndmask_b32 v5, v35, v29, vcc
    s_lshl_b32 s47, s24, 9
    s_mul_i32 s43, s24, 192
    s_add_u32 s62, s43, 12288
    s_add_u32 s44, s41, s62
    s_lshl_b32 s45, s37, 2
    s_add_u32 s45, s45, s24
    s_cmp_ge_u32 s45, 30
    s_cselect_b32 s44, 0x80000000, s44
    v_lshlrev_b32 v29, 4, v36
    v_add_u32 v1, s44, v29
    s_lshr_b32 s45, s2, 3
    s_lshl_b32 s45, s45, 2
    s_add_u32 s45, s45, s24
    s_mul_i32 s45, s45, 1408
    v_lshl_add_u32 v39, v36, 7, s45
    s_mov_b32 s33, s25
    s_mul_i32 s32, s33, 98304
    s_add_u32 s34, s25, 33
    s_min_u32 s34, s34, 512
    s_mov_b32 s14, 50331648
    s_mov_b32 s15, 0x20000
    s_mov_b32 s18, 165888
    s_mov_b32 s19, 0x20000
    s_mov_b32 s30, 0
    s_mov_b32 s31, 0
    s_waitcnt lgkmcnt(0)
    s_mov_b32 s12, s4
    s_and_b32 s13, s5, 0xffff
    s_add_u32 m0, s31, s26
    s_nop 0
    buffer_load_dwordx4 v2, s[12:15], s32 offen nt lds
    s_add_u32 m0, s31, s27
    s_nop 0
    buffer_load_dwordx4 v3, s[12:15], s32 offen nt lds
    s_add_u32 m0, s31, s28
    s_nop 0
    buffer_load_dwordx4 v4, s[12:15], s32 offen nt lds
    s_add_u32 m0, s31, s62
    s_nop 0
    s_mov_b64 exec, 0xfff
    buffer_load_dwordx4 v1, s[12:15], s32 offen nt lds
    s_mov_b64 exec, -1
    s_mov_b32 s16, s6
    s_and_b32 s17, s7, 0xffff
    s_lshl_b32 s42, s24, 5
    s_add_u32 s42, s42, 3328
    v_add_u32 v30, s42, v36
    v_mul_u32_u24 v31, 43691, v30
    v_lshlrev_b32 v32, 4, v30
    v_lshrrev_b32 v31, 19, v31
    v_and_b32 v34, 8, v31
    v_lshlrev_b32 v34, 2, v34
    v_xor_b32 v22, v34, v32
    s_add_u32 m0, s26, 53248
    s_mov_b32 s46, 0
    buffer_load_dwordx4 v19, s[16:19], s46 offen lds
    s_add_u32 m0, s26, 57344
    s_nop 0
    buffer_load_dwordx4 v20, s[16:19], s46 offen lds
    s_add_u32 m0, s26, 61440
    s_nop 0
    buffer_load_dwordx4 v21, s[16:19], s46 offen lds
    s_add_u32 m0, s26, 65536
    s_mov_b32 s46, 12288
    buffer_load_dwordx4 v19, s[16:19], s46 offen lds
    s_add_u32 m0, s26, 69632
    s_nop 0
    buffer_load_dwordx4 v20, s[16:19], s46 offen lds
    s_mov_b32 s16, s6
    s_and_b32 s17, s7, 0xffff
    s_mov_b64 exec, 0x7ff
    buffer_load_dword v38, v39, s[16:19], 0 offen
    s_mov_b64 exec, -1
    v_and_b32 v29, 15, v36
    v_lshrrev_b32 v30, 4, v36
    s_lshr_b32 s42, s24, 1
    s_and_b32 s43, s24, 1
    s_lshl_b32 s42, s42, 5
    s_mul_i32 s43, s43, 96
    v_lshlrev_b32 v31, 4, v30
    v_add_u32 v32, s42, v29
    v_and_b32 v33, 4, v32
    v_mul_u32_u24 v34, 192, v32
    v_lshlrev_b32 v33, 3, v33
    v_xor_b32 v33, v33, v31
    v_add_u32 v6, v34, v33
    v_mov_b32 v9, v6
    v_add_u32 v32, s42, v29
    v_add_u32 v32, 2, v32
    v_and_b32 v33, 4, v32
    v_mul_u32_u24 v34, 192, v32
    v_lshlrev_b32 v33, 3, v33
    v_xor_b32 v33, v33, v31
    v_add_u32 v7, v34, v33
    v_mov_b32 v10, v7
    v_add_u32 v32, s42, v29
    v_add_u32 v32, 4, v32
    v_and_b32 v33, 4, v32
    v_mul_u32_u24 v34, 192, v32
    v_lshlrev_b32 v33, 3, v33
    v_xor_b32 v33, v33, v31
    v_add_u32 v8, v34, v33
    v_mov_b32 v11, v8
    v_lshrrev_b32 v32, 2, v29
    v_lshl_add_u32 v32, v30, 3, v32
    v_mul_u32_u24 v32, 192, v32
    v_and_b32 v33, 3, v29
    v_lshlrev_b32 v33, 3, v33
    v_and_b32 v34, 1, v30
    v_lshlrev_b32 v34, 5, v34
    v_add_u32 v33, s43, v33
    v_add_u32 v35, 0, v33
    v_xor_b32 v35, v35, v34
    v_add_u32 v35, v35, v32
    v_add_u32 v23, 53248, v35
    v_add_u32 v26, 108544, v35
    v_add_u32 v35, 32, v33
    v_xor_b32 v35, v35, v34
    v_add_u32 v35, v35, v32
    v_add_u32 v24, 53248, v35
    v_add_u32 v27, 108544, v35
    v_add_u32 v35, 64, v33
    v_xor_b32 v35, v35, v34
    v_add_u32 v35, v35, v32
    v_add_u32 v25, 53248, v35
    v_add_u32 v28, 108544, v35
    v_add_u32 v32, s42, v29
    v_mul_u32_u24 v32, 192, v32
    v_add_u32 v32, 65536, v32
    v_lshlrev_b32 v33, 3, v29
    v_and_b32 v33, 0x30, v33
    v_lshlrev_b32 v34, 3, v30
    v_add_u32 v34, s43, v34
    v_add_u32 v35, 0, v34
    v_xor_b32 v35, v35, v33
    v_add_u32 v12, v35, v32
    v_add_u32 v35, 32, v34
    v_xor_b32 v35, v35, v33
    v_add_u32 v13, v35, v32
    v_add_u32 v35, 64, v34
    v_xor_b32 v35, v35, v33
    v_add_u32 v14, v35, v32
    s_mul_i32 s44, s24, 192
    v_add_u32 v32, s44, v36
    v_mul_u32_u24 v33, 43691, v32
    v_lshlrev_b32 v34, 4, v32
    v_lshrrev_b32 v33, 16, v33
    v_and_b32 v33, 0x30, v33
    v_xor_b32 v34, v34, v33
    v_add_u32 v15, 65536, v34
    v_add_u32 v32, s44, v36
    v_add_u32 v32, 64, v32
    v_mul_u32_u24 v33, 43691, v32
    v_lshlrev_b32 v34, 4, v32
    v_lshrrev_b32 v33, 16, v33
    v_and_b32 v33, 0x30, v33
    v_xor_b32 v34, v34, v33
    v_add_u32 v16, 65536, v34
    v_add_u32 v32, s44, v36
    v_add_u32 v32, 128, v32
    v_mul_u32_u24 v33, 43691, v32
    v_lshlrev_b32 v34, 4, v32
    v_lshrrev_b32 v33, 16, v33
    v_and_b32 v33, 0x30, v33
    v_xor_b32 v34, v34, v33
    v_add_u32 v17, 65536, v34
    s_lshl_b32 s45, s24, 8
    v_lshlrev_b32 v32, 2, v36
    v_add_u32 v32, s45, v32
    v_add_u32 v242, 108608, v32
    s_lshl_b32 s45, s24, 2
    s_add_u32 s45, s45, 108544
    v_cmp_eq_u32 vcc, 0, v36
    v_mov_b32 v32, s45
    v_mov_b32 v244, 108544
    v_cndmask_b32 v242, v242, v32, vcc
    v_mov_b32 v243, 2
    s_mov_b32 s63, 2
    s_mul_i32 s45, s24, 3072
    s_add_u32 s45, s45, s40
    v_lshlrev_b32 v32, 4, v36
    v_add_u32 v18, s45, v32
    s_mov_b32 s20, s8
    s_and_b32 s21, s9, 0xffff
    s_mov_b32 s22, 50331648
    s_mov_b32 s23, 0x20000
    s_mul_i32 s35, s25, 98304
    s_add_u32 m0, s26, 73728
    s_nop 0
    buffer_load_dwordx4 v21, s[16:19], s46 offen lds
    s_add_u32 m0, s26, 77824
    s_mov_b32 s46, 24576
    buffer_load_dwordx4 v19, s[16:19], s46 offen lds
    s_add_u32 m0, s26, 81920
    s_nop 0
    buffer_load_dwordx4 v20, s[16:19], s46 offen lds
    s_add_u32 m0, s26, 86016
    s_nop 0
    buffer_load_dwordx4 v21, s[16:19], s46 offen lds
    s_waitcnt vmcnt(5)
    s_barrier
    ds_read_b128 v[40:43], v6 offset:0
    ds_read_b64_tr_b16 a[0:1], v23 offset:0
    ds_read_b64_tr_b16 a[2:3], v23 offset:768
    ds_read_b128 v[44:47], v6 offset:64
    ds_read_b64_tr_b16 a[12:13], v23 offset:6144
    ds_read_b64_tr_b16 a[14:15], v23 offset:6912
    ds_read_b128 v[48:51], v6 offset:128
    ds_read_b64_tr_b16 a[24:25], v23 offset:12288
    ds_read_b64_tr_b16 a[26:27], v23 offset:13056
    ds_read_b64_tr_b16 a[4:5], v24 offset:0
    ds_read_b64_tr_b16 a[6:7], v24 offset:768
    s_waitcnt lgkmcnt(2)
    v_mfma_f32_16x16x32_bf16 v[120:123], a[0:3], v[40:43], 0
    s_add_u32 m0, s26, 90112
    s_mov_b32 s46, 36864
    ds_read_b64_tr_b16 a[16:17], v24 offset:6144
    ds_read_b64_tr_b16 a[18:19], v24 offset:6912
    v_mfma_f32_16x16x32_bf16 v[120:123], a[12:15], v[44:47], v[120:123]
    ds_read_b128 v[84:87], v6 offset:3072
    buffer_load_dwordx4 v19, s[16:19], s46 offen lds
    s_add_u32 m0, s26, 94208
    ds_read_b64_tr_b16 a[28:29], v24 offset:12288
    ds_read_b64_tr_b16 a[30:31], v24 offset:13056
    v_mfma_f32_16x16x32_bf16 v[120:123], a[24:27], v[48:51], v[120:123]
    ds_read_b128 v[88:91], v6 offset:3136
    buffer_load_dwordx4 v20, s[16:19], s46 offen lds
    s_add_u32 m0, s26, 98304
    ds_read_b64_tr_b16 a[8:9], v25 offset:0
    ds_read_b64_tr_b16 a[10:11], v25 offset:768
    s_waitcnt lgkmcnt(3)
    v_mfma_f32_16x16x32_bf16 v[124:127], a[4:7], v[40:43], 0
    ds_read_b128 v[92:95], v6 offset:3200
    buffer_load_dwordx4 v21, s[16:19], s46 offen lds
    s_add_u32 m0, s26, 102400
    s_mov_b32 s46, 49152
    ds_read_b64_tr_b16 a[20:21], v25 offset:6144
    ds_read_b64_tr_b16 a[22:23], v25 offset:6912
    v_mfma_f32_16x16x32_bf16 v[124:127], a[16:19], v[44:47], v[124:127]
    buffer_load_dwordx4 v19, s[16:19], s46 offen lds
    s_add_u32 m0, s47, 106496
    s_mov_b32 s46, 0
    ds_read_b64_tr_b16 a[32:33], v25 offset:12288
    ds_read_b64_tr_b16 a[34:35], v25 offset:13056
    v_mfma_f32_16x16x32_bf16 v[124:127], a[28:31], v[48:51], v[124:127]
    s_mov_b32 exec_hi, 0
    buffer_load_dwordx4 v22, s[16:19], s46 offen lds
    s_mov_b64 exec, -1
    s_waitcnt lgkmcnt(0)
    v_mfma_f32_16x16x32_bf16 v[128:131], a[8:11], v[40:43], 0
    s_add_u32 m0, s26, 108544
    s_mov_b32 s46, 55296
    v_mfma_f32_16x16x32_bf16 v[128:131], a[20:23], v[44:47], v[128:131]
    s_waitcnt vmcnt(5)
    s_barrier
    ds_read_b64_tr_b16 a[36:37], v23 offset:18432
    v_mfma_f32_16x16x32_bf16 v[128:131], a[32:35], v[48:51], v[128:131]
    ds_read_b64_tr_b16 a[38:39], v23 offset:19200
    buffer_load_dwordx4 v19, s[16:19], s46 offen lds
    v_mfma_f32_16x16x32_bf16 v[132:135], a[0:3], v[84:87], 0
    ds_read_b64_tr_b16 a[48:49], v23 offset:24576
    ds_read_b64_tr_b16 a[50:51], v23 offset:25344
    ds_read_b128 v[52:55], v7 offset:0
    v_mfma_f32_16x16x32_bf16 v[132:135], a[12:15], v[88:91], v[132:135]
    ds_read_b64_tr_b16 a[60:61], v23 offset:30720
    ds_read_b64_tr_b16 a[62:63], v23 offset:31488
    ds_read_b128 v[56:59], v7 offset:64
    v_mfma_f32_16x16x32_bf16 v[132:135], a[24:27], v[92:95], v[132:135]
    s_add_u32 m0, s26, 112640
    ds_read_b64_tr_b16 a[40:41], v24 offset:18432
    ds_read_b64_tr_b16 a[42:43], v24 offset:19200
    v_mfma_f32_16x16x32_bf16 v[136:139], a[4:7], v[84:87], 0
    ds_read_b128 v[60:63], v7 offset:128
    buffer_load_dwordx4 v20, s[16:19], s46 offen lds
    ds_read_b64_tr_b16 a[52:53], v24 offset:24576
    v_mfma_f32_16x16x32_bf16 v[136:139], a[16:19], v[88:91], v[136:139]
    ds_read_b64_tr_b16 a[54:55], v24 offset:25344
    ds_read_b64_tr_b16 a[64:65], v24 offset:30720
    ds_read_b64_tr_b16 a[66:67], v24 offset:31488
    v_mfma_f32_16x16x32_bf16 v[136:139], a[28:31], v[92:95], v[136:139]
    ds_read_b128 v[96:99], v7 offset:3072
    s_add_u32 m0, s26, 116736
    ds_read_b64_tr_b16 a[44:45], v25 offset:18432
    v_mfma_f32_16x16x32_bf16 v[140:143], a[8:11], v[84:87], 0
    ds_read_b64_tr_b16 a[46:47], v25 offset:19200
    ds_read_b128 v[100:103], v7 offset:3136
    buffer_load_dwordx4 v21, s[16:19], s46 offen lds
    v_mfma_f32_16x16x32_bf16 v[140:143], a[20:23], v[88:91], v[140:143]
    ds_read_b64_tr_b16 a[56:57], v25 offset:24576
    ds_read_b64_tr_b16 a[58:59], v25 offset:25344
    ds_read_b128 v[104:107], v7 offset:3200
    v_mfma_f32_16x16x32_bf16 v[140:143], a[32:35], v[92:95], v[140:143]
    ds_read_b64_tr_b16 a[68:69], v25 offset:30720
    ds_read_b64_tr_b16 a[70:71], v25 offset:31488
    s_waitcnt lgkmcnt(13)
    v_mfma_f32_16x16x32_bf16 v[120:123], a[36:39], v[52:55], v[120:123]
    s_add_u32 m0, s26, 120832
    s_mov_b32 s46, 67584
    buffer_load_dwordx4 v19, s[16:19], s46 offen lds
    v_mfma_f32_16x16x32_bf16 v[120:123], a[48:51], v[56:59], v[120:123]
    s_add_u32 m0, s26, 124928
    v_mfma_f32_16x16x32_bf16 v[120:123], a[60:63], v[60:63], v[120:123]
    buffer_load_dwordx4 v20, s[16:19], s46 offen lds
    s_add_u32 m0, s26, 129024
    s_waitcnt lgkmcnt(9)
    v_mfma_f32_16x16x32_bf16 v[124:127], a[40:43], v[52:55], v[124:127]
    buffer_load_dwordx4 v21, s[16:19], s46 offen lds
    v_mfma_f32_16x16x32_bf16 v[124:127], a[52:55], v[56:59], v[124:127]
    s_add_u32 m0, s26, 133120
    s_mov_b32 s46, 79872
    v_mfma_f32_16x16x32_bf16 v[124:127], a[64:67], v[60:63], v[124:127]
    s_waitcnt vmcnt(6)
    s_barrier
    s_waitcnt lgkmcnt(0)
    v_mfma_f32_16x16x32_bf16 v[128:131], a[44:47], v[52:55], v[128:131]
    ds_read_b64_tr_b16 a[72:73], v23 offset:36864
    ds_read_b64_tr_b16 a[74:75], v23 offset:37632
    buffer_load_dwordx4 v19, s[16:19], s46 offen lds
    v_mfma_f32_16x16x32_bf16 v[128:131], a[56:59], v[56:59], v[128:131]
    ds_read_b64_tr_b16 a[84:85], v23 offset:43008
    ds_read_b64_tr_b16 a[86:87], v23 offset:43776
    ds_read_b128 v[64:67], v8 offset:0
    v_mfma_f32_16x16x32_bf16 v[128:131], a[68:71], v[60:63], v[128:131]
    ds_read_b64_tr_b16 a[96:97], v23 offset:49152
    ds_read_b64_tr_b16 a[98:99], v23 offset:49920
    v_mfma_f32_16x16x32_bf16 v[132:135], a[36:39], v[96:99], v[132:135]
    ds_read_b128 v[68:71], v8 offset:64
    s_add_u32 m0, s26, 137216
    ds_read_b64_tr_b16 a[76:77], v24 offset:36864
    v_mfma_f32_16x16x32_bf16 v[132:135], a[48:51], v[100:103], v[132:135]
    ds_read_b64_tr_b16 a[78:79], v24 offset:37632
    ds_read_b128 v[72:75], v8 offset:128
    buffer_load_dwordx4 v20, s[16:19], s46 offen lds
    v_mfma_f32_16x16x32_bf16 v[132:135], a[60:63], v[104:107], v[132:135]
    ds_read_b64_tr_b16 a[88:89], v24 offset:43008
    ds_read_b64_tr_b16 a[90:91], v24 offset:43776
    ds_read_b64_tr_b16 a[100:101], v24 offset:49152
    v_mfma_f32_16x16x32_bf16 v[136:139], a[40:43], v[96:99], v[136:139]
    ds_read_b64_tr_b16 a[102:103], v24 offset:49920
    ds_read_b128 v[108:111], v8 offset:3072
    s_add_u32 m0, s26, 141312
    v_mfma_f32_16x16x32_bf16 v[136:139], a[52:55], v[100:103], v[136:139]
    ds_read_b64_tr_b16 a[80:81], v25 offset:36864
    ds_read_b64_tr_b16 a[82:83], v25 offset:37632
    ds_read_b128 v[112:115], v8 offset:3136
    v_mfma_f32_16x16x32_bf16 v[136:139], a[64:67], v[104:107], v[136:139]
    buffer_load_dwordx4 v21, s[16:19], s46 offen lds
    ds_read_b64_tr_b16 a[92:93], v25 offset:43008
    ds_read_b64_tr_b16 a[94:95], v25 offset:43776
    v_mfma_f32_16x16x32_bf16 v[140:143], a[44:47], v[96:99], v[140:143]
    ds_read_b128 v[116:119], v8 offset:3200
    ds_read_b64_tr_b16 a[104:105], v25 offset:49152
    ds_read_b64_tr_b16 a[106:107], v25 offset:49920
    v_mfma_f32_16x16x32_bf16 v[140:143], a[56:59], v[100:103], v[140:143]
    s_add_u32 m0, s26, 145408
    s_mov_b32 s46, 92160
    buffer_load_dwordx4 v19, s[16:19], s46 offen lds
    v_mfma_f32_16x16x32_bf16 v[140:143], a[68:71], v[104:107], v[140:143]
    s_add_u32 m0, s26, 149504
    s_waitcnt lgkmcnt(13)
    v_mfma_f32_16x16x32_bf16 v[120:123], a[72:75], v[64:67], v[120:123]
    buffer_load_dwordx4 v20, s[16:19], s46 offen lds
    v_mfma_f32_16x16x32_bf16 v[120:123], a[84:87], v[68:71], v[120:123]
    s_add_u32 m0, s26, 153600
    v_mfma_f32_16x16x32_bf16 v[120:123], a[96:99], v[72:75], v[120:123]
    buffer_load_dwordx4 v21, s[16:19], s46 offen lds
    s_waitcnt lgkmcnt(9)
    v_mfma_f32_16x16x32_bf16 v[124:127], a[76:79], v[64:67], v[124:127]
    v_mfma_f32_16x16x32_bf16 v[124:127], a[88:91], v[68:71], v[124:127]
    s_add_u32 m0, s26, 157696
    s_mov_b32 s46, 104448
    v_mfma_f32_16x16x32_bf16 v[124:127], a[100:103], v[72:75], v[124:127]
    s_waitcnt vmcnt(7)
    s_barrier
    s_waitcnt lgkmcnt(0)
    v_mfma_f32_16x16x32_bf16 v[128:131], a[80:83], v[64:67], v[128:131]
    ds_read_b64_tr_b16 a[108:109], v26 offset:0
    ds_read_b64_tr_b16 a[110:111], v26 offset:768
    buffer_load_dwordx4 v19, s[16:19], s46 offen lds
    v_mfma_f32_16x16x32_bf16 v[128:131], a[92:95], v[68:71], v[128:131]
    ds_read_b64_tr_b16 a[120:121], v26 offset:6144
    ds_read_b64_tr_b16 a[122:123], v26 offset:6912
    ds_read_b64_tr_b16 a[132:133], v26 offset:12288
    v_mfma_f32_16x16x32_bf16 v[128:131], a[104:107], v[72:75], v[128:131]
    ds_read_b64_tr_b16 a[134:135], v26 offset:13056
    s_add_u32 m0, s47, 161792
    v_mfma_f32_16x16x32_bf16 v[132:135], a[72:75], v[108:111], v[132:135]
    s_mov_b32 s46, 55296
    ds_read_b64_tr_b16 a[112:113], v27 offset:0
    ds_read_b64_tr_b16 a[114:115], v27 offset:768
    v_mfma_f32_16x16x32_bf16 v[132:135], a[84:87], v[112:115], v[132:135]
    s_mov_b32 exec_hi, 0
    buffer_load_dwordx4 v22, s[16:19], s46 offen lds
    s_mov_b64 exec, -1
    v_mfma_f32_16x16x32_bf16 v[132:135], a[96:99], v[116:119], v[132:135]
    ds_read_b64_tr_b16 a[124:125], v27 offset:6144
    ds_read_b64_tr_b16 a[126:127], v27 offset:6912
    ds_read_b64_tr_b16 a[136:137], v27 offset:12288
    v_mfma_f32_16x16x32_bf16 v[136:139], a[76:79], v[108:111], v[136:139]
    ds_read_b64_tr_b16 a[138:139], v27 offset:13056
    s_add_u32 s32, s32, 196608
    s_add_u32 s33, s33, 2
    v_mfma_f32_16x16x32_bf16 v[136:139], a[88:91], v[112:115], v[136:139]
    s_cmp_lt_u32 s33, s34
    s_cselect_b32 s14, 50331648, 0
    s_add_u32 s31, s31, 13312
    v_mfma_f32_16x16x32_bf16 v[136:139], a[100:103], v[116:119], v[136:139]
    s_cmp_eq_u32 s31, 53248
    s_cselect_b32 s31, 0, s31
    ds_read_b64_tr_b16 a[116:117], v28 offset:0
    v_mfma_f32_16x16x32_bf16 v[140:143], a[80:83], v[108:111], v[140:143]
    ds_read_b64_tr_b16 a[118:119], v28 offset:768
    s_add_u32 m0, s31, s26
    ds_read_b64_tr_b16 a[128:129], v28 offset:6144
    v_mfma_f32_16x16x32_bf16 v[140:143], a[92:95], v[112:115], v[140:143]
    ds_read_b64_tr_b16 a[130:131], v28 offset:6912
    buffer_load_dwordx4 v2, s[12:15], s32 offen nt lds
    ds_read_b64_tr_b16 a[140:141], v28 offset:12288
    v_mfma_f32_16x16x32_bf16 v[140:143], a[104:107], v[116:119], v[140:143]
    ds_read_b64_tr_b16 a[142:143], v28 offset:13056
    s_add_u32 m0, s31, s27
    s_waitcnt lgkmcnt(12)
    v_mfma_f32_16x16x32_bf16 v[144:147], a[108:111], v[40:43], 0
    buffer_load_dwordx4 v3, s[12:15], s32 offen nt lds
    s_add_u32 m0, s31, s28
    v_mfma_f32_16x16x32_bf16 v[144:147], a[120:123], v[44:47], v[144:147]
    buffer_load_dwordx4 v4, s[12:15], s32 offen nt lds
    v_mfma_f32_16x16x32_bf16 v[144:147], a[132:135], v[48:51], v[144:147]
    s_add_u32 m0, s31, s29
    s_waitcnt lgkmcnt(6)
    v_mfma_f32_16x16x32_bf16 v[148:151], a[112:115], v[40:43], 0
    buffer_load_dwordx4 v5, s[12:15], s32 offen nt lds
    v_mfma_f32_16x16x32_bf16 v[148:151], a[124:127], v[44:47], v[148:151]
    v_mfma_f32_16x16x32_bf16 v[148:151], a[136:139], v[48:51], v[148:151]
    s_waitcnt vmcnt(9)
    s_barrier
    s_waitcnt lgkmcnt(0)
    v_mfma_f32_16x16x32_bf16 v[152:155], a[116:119], v[40:43], 0
    ds_read_b64_tr_b16 a[144:145], v26 offset:18432
    ds_read_b64_tr_b16 a[146:147], v26 offset:19200
    s_add_u32 m0, s26, 53248
    v_mfma_f32_16x16x32_bf16 v[152:155], a[128:131], v[44:47], v[152:155]
    s_mov_b32 s46, 110592
    ds_read_b64_tr_b16 a[156:157], v26 offset:24576
    ds_read_b64_tr_b16 a[158:159], v26 offset:25344
    v_mfma_f32_16x16x32_bf16 v[152:155], a[140:143], v[48:51], v[152:155]
    buffer_load_dwordx4 v19, s[16:19], s46 offen lds
    ds_read_b64_tr_b16 a[168:169], v26 offset:30720
    ds_read_b64_tr_b16 a[170:171], v26 offset:31488
    v_mfma_f32_16x16x32_bf16 v[156:159], a[108:111], v[84:87], 0
    ds_read_b64_tr_b16 a[148:149], v27 offset:18432
    ds_read_b64_tr_b16 a[150:151], v27 offset:19200
    s_add_u32 m0, s26, 57344
    v_mfma_f32_16x16x32_bf16 v[156:159], a[120:123], v[88:91], v[156:159]
    ds_read_b64_tr_b16 a[160:161], v27 offset:24576
    ds_read_b64_tr_b16 a[162:163], v27 offset:25344
    buffer_load_dwordx4 v20, s[16:19], s46 offen lds
    v_mfma_f32_16x16x32_bf16 v[156:159], a[132:135], v[92:95], v[156:159]
    ds_read_b64_tr_b16 a[172:173], v27 offset:30720
    ds_read_b64_tr_b16 a[174:175], v27 offset:31488
    ds_read_b64_tr_b16 a[152:153], v28 offset:18432
    v_mfma_f32_16x16x32_bf16 v[160:163], a[112:115], v[84:87], 0
    ds_read_b64_tr_b16 a[154:155], v28 offset:19200
    s_add_u32 m0, s26, 61440
    ds_read_b64_tr_b16 a[164:165], v28 offset:24576
    v_mfma_f32_16x16x32_bf16 v[160:163], a[124:127], v[88:91], v[160:163]
    ds_read_b64_tr_b16 a[166:167], v28 offset:25344
    buffer_load_dwordx4 v21, s[16:19], s46 offen lds
    ds_read_b64_tr_b16 a[176:177], v28 offset:30720
    v_mfma_f32_16x16x32_bf16 v[160:163], a[136:139], v[92:95], v[160:163]
    ds_read_b64_tr_b16 a[178:179], v28 offset:31488
    s_add_u32 m0, s26, 65536
    s_mov_b32 s46, 122880
    v_mfma_f32_16x16x32_bf16 v[164:167], a[116:119], v[84:87], 0
    buffer_load_dwordx4 v19, s[16:19], s46 offen lds
    v_mfma_f32_16x16x32_bf16 v[164:167], a[128:131], v[88:91], v[164:167]
    v_mfma_f32_16x16x32_bf16 v[164:167], a[140:143], v[92:95], v[164:167]
    s_add_u32 m0, s26, 69632
    s_waitcnt lgkmcnt(12)
    v_mfma_f32_16x16x32_bf16 v[144:147], a[144:147], v[52:55], v[144:147]
    buffer_load_dwordx4 v20, s[16:19], s46 offen lds
    v_mfma_f32_16x16x32_bf16 v[144:147], a[156:159], v[56:59], v[144:147]
    v_mfma_f32_16x16x32_bf16 v[144:147], a[168:171], v[60:63], v[144:147]
    s_add_u32 m0, s26, 73728
    s_waitcnt lgkmcnt(6)
    v_mfma_f32_16x16x32_bf16 v[148:151], a[148:151], v[52:55], v[148:151]
    buffer_load_dwordx4 v21, s[16:19], s46 offen lds
    v_mfma_f32_16x16x32_bf16 v[148:151], a[160:163], v[56:59], v[148:151]
    v_mfma_f32_16x16x32_bf16 v[148:151], a[172:175], v[60:63], v[148:151]
    s_waitcnt vmcnt(10)
    s_barrier
    s_waitcnt lgkmcnt(0)
    v_mfma_f32_16x16x32_bf16 v[152:155], a[152:155], v[52:55], v[152:155]
    ds_read_b64_tr_b16 a[180:181], v26 offset:36864
    ds_read_b64_tr_b16 a[182:183], v26 offset:37632
    s_add_u32 m0, s26, 77824
    v_mfma_f32_16x16x32_bf16 v[152:155], a[164:167], v[56:59], v[152:155]
    s_mov_b32 s46, 135168
    ds_read_b64_tr_b16 a[192:193], v26 offset:43008
    ds_read_b64_tr_b16 a[194:195], v26 offset:43776
    v_mfma_f32_16x16x32_bf16 v[152:155], a[176:179], v[60:63], v[152:155]
    buffer_load_dwordx4 v19, s[16:19], s46 offen lds
    ds_read_b64_tr_b16 a[204:205], v26 offset:49152
    ds_read_b64_tr_b16 a[206:207], v26 offset:49920
    v_mfma_f32_16x16x32_bf16 v[156:159], a[144:147], v[96:99], v[156:159]
    ds_read_b64_tr_b16 a[184:185], v27 offset:36864
    ds_read_b64_tr_b16 a[186:187], v27 offset:37632
    s_add_u32 m0, s26, 81920
    v_mfma_f32_16x16x32_bf16 v[156:159], a[156:159], v[100:103], v[156:159]
    ds_read_b64_tr_b16 a[196:197], v27 offset:43008
    ds_read_b64_tr_b16 a[198:199], v27 offset:43776
    buffer_load_dwordx4 v20, s[16:19], s46 offen lds
    v_mfma_f32_16x16x32_bf16 v[156:159], a[168:171], v[104:107], v[156:159]
    ds_read_b64_tr_b16 a[208:209], v27 offset:49152
    ds_read_b64_tr_b16 a[210:211], v27 offset:49920
    ds_read_b64_tr_b16 a[188:189], v28 offset:36864
    v_mfma_f32_16x16x32_bf16 v[160:163], a[148:151], v[96:99], v[160:163]
    ds_read_b64_tr_b16 a[190:191], v28 offset:37632
    s_add_u32 m0, s26, 86016
    s_add_u32 s30, s30, 13312
    v_mfma_f32_16x16x32_bf16 v[160:163], a[160:163], v[100:103], v[160:163]
    ds_read_b64_tr_b16 a[200:201], v28 offset:43008
    ds_read_b64_tr_b16 a[202:203], v28 offset:43776
    buffer_load_dwordx4 v21, s[16:19], s46 offen lds
    v_mfma_f32_16x16x32_bf16 v[160:163], a[172:175], v[104:107], v[160:163]
    s_cmp_eq_u32 s30, 53248
    s_cselect_b32 s30, 0, s30
    ds_read_b64_tr_b16 a[212:213], v28 offset:49152
    v_mfma_f32_16x16x32_bf16 v[164:167], a[152:155], v[96:99], v[164:167]
    ds_read_b64_tr_b16 a[214:215], v28 offset:49920
    v_add_u32 v9, s30, v6
    s_add_u32 m0, s26, 90112
    v_mfma_f32_16x16x32_bf16 v[164:167], a[164:167], v[100:103], v[164:167]
    s_mov_b32 s46, 147456
    v_add_u32 v10, s30, v7
    buffer_load_dwordx4 v19, s[16:19], s46 offen lds
    v_mfma_f32_16x16x32_bf16 v[164:167], a[176:179], v[104:107], v[164:167]
    v_add_u32 v11, s30, v8
    s_add_u32 m0, s26, 94208
    s_waitcnt lgkmcnt(12)
    v_mfma_f32_16x16x32_bf16 v[144:147], a[180:183], v[64:67], v[144:147]
    buffer_load_dwordx4 v20, s[16:19], s46 offen lds
    v_mfma_f32_16x16x32_bf16 v[144:147], a[192:195], v[68:71], v[144:147]
    v_mfma_f32_16x16x32_bf16 v[144:147], a[204:207], v[72:75], v[144:147]
    s_add_u32 m0, s26, 98304
    s_waitcnt lgkmcnt(6)
    v_mfma_f32_16x16x32_bf16 v[148:151], a[184:187], v[64:67], v[148:151]
    buffer_load_dwordx4 v21, s[16:19], s46 offen lds
    v_mfma_f32_16x16x32_bf16 v[148:151], a[196:199], v[68:71], v[148:151]
    v_mfma_f32_16x16x32_bf16 v[148:151], a[208:211], v[72:75], v[148:151]
    s_add_u32 m0, s26, 102400
    s_mov_b32 s46, 159744
    s_waitcnt lgkmcnt(0)
    v_mfma_f32_16x16x32_bf16 v[152:155], a[188:191], v[64:67], v[152:155]
    s_waitcnt vmcnt(12)
    s_barrier
    buffer_load_dwordx4 v19, s[16:19], s46 offen lds
    v_mfma_f32_16x16x32_bf16 v[152:155], a[200:203], v[68:71], v[152:155]
    ds_read_b128 v[40:43], v9 offset:0
    ds_read_b128 v[44:47], v9 offset:64
    v_mfma_f32_16x16x32_bf16 v[152:155], a[212:215], v[72:75], v[152:155]
    s_add_u32 m0, s47, 106496
    s_mov_b32 s46, 110592
    ds_read_b128 v[48:51], v9 offset:128
    v_mfma_f32_16x16x32_bf16 v[156:159], a[180:183], v[108:111], v[156:159]
    s_mov_b32 exec_hi, 0
    buffer_load_dwordx4 v22, s[16:19], s46 offen lds
    s_mov_b64 exec, -1
    v_mfma_f32_16x16x32_bf16 v[156:159], a[192:195], v[112:115], v[156:159]
    ds_read_b128 v[52:55], v10 offset:0
    ds_read_b128 v[56:59], v10 offset:64
    v_mfma_f32_16x16x32_bf16 v[156:159], a[204:207], v[116:119], v[156:159]
    ds_read_b128 v[60:63], v10 offset:128
    v_mfma_f32_16x16x32_bf16 v[160:163], a[184:187], v[108:111], v[160:163]
    ds_read_b128 v[64:67], v11 offset:0
    v_mfma_f32_16x16x32_bf16 v[160:163], a[196:199], v[112:115], v[160:163]
    ds_read_b128 v[68:71], v11 offset:64
    v_mfma_f32_16x16x32_bf16 v[160:163], a[208:211], v[116:119], v[160:163]
    ds_read_b128 v[72:75], v11 offset:128
    v_mfma_f32_16x16x32_bf16 v[164:167], a[188:191], v[108:111], v[164:167]
    v_mfma_f32_16x16x32_bf16 v[164:167], a[200:203], v[112:115], v[164:167]
    v_mfma_f32_16x16x32_bf16 v[164:167], a[212:215], v[116:119], v[164:167]
    s_waitcnt lgkmcnt(6)
    v_mfma_f32_16x16x32_bf16 v[96:99], a[0:3], v[40:43], 0
    v_mfma_f32_16x16x32_bf16 v[96:99], a[12:15], v[44:47], v[96:99]
    v_mfma_f32_16x16x32_bf16 v[96:99], a[24:27], v[48:51], v[96:99]
    v_mfma_f32_16x16x32_bf16 v[100:103], a[4:7], v[40:43], 0
    v_mfma_f32_16x16x32_bf16 v[100:103], a[16:19], v[44:47], v[100:103]
    v_mfma_f32_16x16x32_bf16 v[100:103], a[28:31], v[48:51], v[100:103]
    v_mfma_f32_16x16x32_bf16 v[104:107], a[8:11], v[40:43], 0
    v_mfma_f32_16x16x32_bf16 v[104:107], a[20:23], v[44:47], v[104:107]
    v_mfma_f32_16x16x32_bf16 v[104:107], a[32:35], v[48:51], v[104:107]
    s_waitcnt lgkmcnt(3)
    v_mfma_f32_16x16x32_bf16 v[96:99], a[36:39], v[52:55], v[96:99]
    v_mfma_f32_16x16x32_bf16 v[96:99], a[48:51], v[56:59], v[96:99]
    v_mfma_f32_16x16x32_bf16 v[96:99], a[60:63], v[60:63], v[96:99]
    s_sub_u32 s32, s32, 393216
    v_mfma_f32_16x16x32_bf16 v[100:103], a[40:43], v[52:55], v[100:103]
    s_sub_u32 s33, s33, 4
    v_mfma_f32_16x16x32_bf16 v[100:103], a[52:55], v[56:59], v[100:103]
    s_cmp_lt_u32 s33, s34
    s_cselect_b32 s14, 50331648, 0
    v_mfma_f32_16x16x32_bf16 v[100:103], a[64:67], v[60:63], v[100:103]
    s_add_u32 s31, s31, 13312
    v_mfma_f32_16x16x32_bf16 v[104:107], a[44:47], v[52:55], v[104:107]
    s_cmp_eq_u32 s31, 53248
    s_cselect_b32 s31, 0, s31
    v_mfma_f32_16x16x32_bf16 v[104:107], a[56:59], v[56:59], v[104:107]
    v_mfma_f32_16x16x32_bf16 v[104:107], a[68:71], v[60:63], v[104:107]
    s_waitcnt lgkmcnt(0)
    v_mfma_f32_16x16x32_bf16 v[96:99], a[72:75], v[64:67], v[96:99]
    s_add_u32 m0, s31, s26
    v_mfma_f32_16x16x32_bf16 v[96:99], a[84:87], v[68:71], v[96:99]
    buffer_load_dwordx4 v2, s[12:15], s32 offen nt lds
    v_mfma_f32_16x16x32_bf16 v[96:99], a[96:99], v[72:75], v[96:99]
    s_add_u32 m0, s31, s27
    v_mfma_f32_16x16x32_bf16 v[100:103], a[76:79], v[64:67], v[100:103]
    buffer_load_dwordx4 v3, s[12:15], s32 offen nt lds
    v_mfma_f32_16x16x32_bf16 v[100:103], a[88:91], v[68:71], v[100:103]
    s_add_u32 m0, s31, s28
    v_mfma_f32_16x16x32_bf16 v[100:103], a[100:103], v[72:75], v[100:103]
    buffer_load_dwordx4 v4, s[12:15], s32 offen nt lds
    v_mfma_f32_16x16x32_bf16 v[104:107], a[80:83], v[64:67], v[104:107]
    s_add_u32 m0, s31, s29
    v_mfma_f32_16x16x32_bf16 v[104:107], a[92:95], v[68:71], v[104:107]
    buffer_load_dwordx4 v5, s[12:15], s32 offen nt lds
    v_mfma_f32_16x16x32_bf16 v[104:107], a[104:107], v[72:75], v[104:107]
    v_mfma_f32_16x16x32_bf16 v[120:123], a[108:111], v[40:43], v[120:123]
    v_mfma_f32_16x16x32_bf16 v[120:123], a[120:123], v[44:47], v[120:123]
    v_mfma_f32_16x16x32_bf16 v[120:123], a[132:135], v[48:51], v[120:123]
    s_waitcnt vmcnt(4)
    s_barrier
    v_mfma_f32_16x16x32_bf16 v[120:123], a[144:147], v[52:55], v[120:123]
    ds_read_b64_tr_b16 a[216:217], v23 offset:0
    ds_read_b64_tr_b16 a[218:219], v23 offset:768
    v_mfma_f32_16x16x32_bf16 v[120:123], a[156:159], v[56:59], v[120:123]
    ds_read_b64_tr_b16 a[228:229], v23 offset:6144
    ds_read_b64_tr_b16 a[230:231], v23 offset:6912
    v_mfma_f32_16x16x32_bf16 v[120:123], a[168:171], v[60:63], v[120:123]
    ds_read_b64_tr_b16 a[240:241], v23 offset:12288
    v_mfma_f32_16x16x32_bf16 v[120:123], a[180:183], v[64:67], v[120:123]
    ds_read_b64_tr_b16 a[242:243], v23 offset:13056
    ds_read_b64_tr_b16 a[252:253], v23 offset:18432
    v_mfma_f32_16x16x32_bf16 v[120:123], a[192:195], v[68:71], v[120:123]
    ds_read_b64_tr_b16 a[254:255], v23 offset:19200
    ds_read_b64_tr_b16 v[176:177], v23 offset:24576
    v_mfma_f32_16x16x32_bf16 v[120:123], a[204:207], v[72:75], v[120:123]
    ds_read_b64_tr_b16 v[178:179], v23 offset:25344
    v_mfma_f32_16x16x32_bf16 v[124:127], a[112:115], v[40:43], v[124:127]
    ds_read_b64_tr_b16 v[188:189], v23 offset:30720
    ds_read_b64_tr_b16 v[190:191], v23 offset:31488
    v_mfma_f32_16x16x32_bf16 v[124:127], a[124:127], v[44:47], v[124:127]
    ds_read_b64_tr_b16 v[200:201], v23 offset:36864
    ds_read_b64_tr_b16 v[202:203], v23 offset:37632
    v_mfma_f32_16x16x32_bf16 v[124:127], a[136:139], v[48:51], v[124:127]
    ds_read_b64_tr_b16 v[212:213], v23 offset:43008
    s_waitcnt lgkmcnt(14)
    v_mfma_f32_16x16x32_bf16 v[124:127], a[148:151], v[52:55], v[124:127]
    ds_read_b64_tr_b16 v[214:215], v23 offset:43776
    ds_read_b64_tr_b16 v[224:225], v23 offset:49152
    v_mfma_f32_16x16x32_bf16 v[124:127], a[160:163], v[56:59], v[124:127]
    ds_read_b64_tr_b16 v[226:227], v23 offset:49920
    ds_read_b64_tr_b16 a[220:221], v24 offset:0
    v_mfma_f32_16x16x32_bf16 v[124:127], a[172:175], v[60:63], v[124:127]
    ds_read_b64_tr_b16 a[222:223], v24 offset:768
    s_waitcnt lgkmcnt(14)
    v_mfma_f32_16x16x32_bf16 v[124:127], a[184:187], v[64:67], v[124:127]
    ds_read_b64_tr_b16 a[232:233], v24 offset:6144
    ds_read_b64_tr_b16 a[234:235], v24 offset:6912
    v_mfma_f32_16x16x32_bf16 v[124:127], a[196:199], v[68:71], v[124:127]
    ds_read_b64_tr_b16 a[244:245], v24 offset:12288
    ds_read_b64_tr_b16 a[246:247], v24 offset:13056
    v_mfma_f32_16x16x32_bf16 v[124:127], a[208:211], v[72:75], v[124:127]
    ds_read_b64_tr_b16 v[168:169], v24 offset:18432
    s_waitcnt lgkmcnt(14)
    v_mfma_f32_16x16x32_bf16 v[128:131], a[116:119], v[40:43], v[128:131]
    ds_read_b64_tr_b16 v[170:171], v24 offset:19200
    ds_read_b64_tr_b16 v[180:181], v24 offset:24576
    v_mfma_f32_16x16x32_bf16 v[128:131], a[128:131], v[44:47], v[128:131]
    ds_read_b64_tr_b16 v[182:183], v24 offset:25344
    ds_read_b64_tr_b16 v[192:193], v24 offset:30720
    v_mfma_f32_16x16x32_bf16 v[128:131], a[140:143], v[48:51], v[128:131]
    ds_read_b64_tr_b16 v[194:195], v24 offset:31488
    s_waitcnt lgkmcnt(14)
    v_mfma_f32_16x16x32_bf16 v[128:131], a[152:155], v[52:55], v[128:131]
    ds_read_b64_tr_b16 v[204:205], v24 offset:36864
    ds_read_b64_tr_b16 v[206:207], v24 offset:37632
    v_mfma_f32_16x16x32_bf16 v[128:131], a[164:167], v[56:59], v[128:131]
    ds_read_b64_tr_b16 v[216:217], v24 offset:43008
    ds_read_b64_tr_b16 v[218:219], v24 offset:43776
    v_mfma_f32_16x16x32_bf16 v[128:131], a[176:179], v[60:63], v[128:131]
    ds_read_b64_tr_b16 v[228:229], v24 offset:49152
    s_waitcnt lgkmcnt(14)
    v_mfma_f32_16x16x32_bf16 v[128:131], a[188:191], v[64:67], v[128:131]
    ds_read_b64_tr_b16 v[230:231], v24 offset:49920
    ds_read_b64_tr_b16 a[224:225], v25 offset:0
    v_mfma_f32_16x16x32_bf16 v[128:131], a[200:203], v[68:71], v[128:131]
    ds_read_b64_tr_b16 a[226:227], v25 offset:768
    ds_read_b64_tr_b16 a[236:237], v25 offset:6144
    v_mfma_f32_16x16x32_bf16 v[128:131], a[212:215], v[72:75], v[128:131]
    ds_read_b64_tr_b16 a[238:239], v25 offset:6912
    s_waitcnt lgkmcnt(14)
    v_mfma_f32_16x16x32_bf16 v[144:147], a[216:219], v[40:43], v[144:147]
    ds_read_b64_tr_b16 a[248:249], v25 offset:12288
    ds_read_b64_tr_b16 a[250:251], v25 offset:13056
    v_mfma_f32_16x16x32_bf16 v[144:147], a[228:231], v[44:47], v[144:147]
    ds_read_b64_tr_b16 v[172:173], v25 offset:18432
    ds_read_b64_tr_b16 v[174:175], v25 offset:19200
    v_mfma_f32_16x16x32_bf16 v[144:147], a[240:243], v[48:51], v[144:147]
    ds_read_b64_tr_b16 v[184:185], v25 offset:24576
    s_waitcnt lgkmcnt(14)
    v_mfma_f32_16x16x32_bf16 v[144:147], a[252:255], v[52:55], v[144:147]
    ds_read_b64_tr_b16 v[186:187], v25 offset:25344
    ds_read_b64_tr_b16 v[196:197], v25 offset:30720
    v_mfma_f32_16x16x32_bf16 v[144:147], v[176:179], v[56:59], v[144:147]
    ds_read_b64_tr_b16 v[198:199], v25 offset:31488
    ds_read_b64_tr_b16 v[208:209], v25 offset:36864
    v_mfma_f32_16x16x32_bf16 v[144:147], v[188:191], v[60:63], v[144:147]
    ds_read_b64_tr_b16 v[210:211], v25 offset:37632
    s_waitcnt lgkmcnt(14)
    v_mfma_f32_16x16x32_bf16 v[144:147], v[200:203], v[64:67], v[144:147]
    ds_read_b64_tr_b16 v[220:221], v25 offset:43008
    ds_read_b64_tr_b16 v[222:223], v25 offset:43776
    v_mfma_f32_16x16x32_bf16 v[144:147], v[212:215], v[68:71], v[144:147]
    ds_read_b64_tr_b16 v[232:233], v25 offset:49152
    ds_read_b64_tr_b16 v[234:235], v25 offset:49920
    v_mfma_f32_16x16x32_bf16 v[144:147], v[224:227], v[72:75], v[144:147]
    s_waitcnt lgkmcnt(14)
    v_mfma_f32_16x16x32_bf16 v[148:151], a[220:223], v[40:43], v[148:151]
    v_mfma_f32_16x16x32_bf16 v[148:151], a[232:235], v[44:47], v[148:151]
    v_mfma_f32_16x16x32_bf16 v[148:151], a[244:247], v[48:51], v[148:151]
    v_mfma_f32_16x16x32_bf16 v[148:151], v[168:171], v[52:55], v[148:151]
    v_mfma_f32_16x16x32_bf16 v[148:151], v[180:183], v[56:59], v[148:151]
    v_mfma_f32_16x16x32_bf16 v[148:151], v[192:195], v[60:63], v[148:151]
    v_mfma_f32_16x16x32_bf16 v[148:151], v[204:207], v[64:67], v[148:151]
    v_mfma_f32_16x16x32_bf16 v[148:151], v[216:219], v[68:71], v[148:151]
    v_mfma_f32_16x16x32_bf16 v[148:151], v[228:231], v[72:75], v[148:151]
    s_waitcnt lgkmcnt(12)
    v_mfma_f32_16x16x32_bf16 v[152:155], a[224:227], v[40:43], v[152:155]
    ds_read_b128 v[40:43], v9 offset:3072
    v_mfma_f32_16x16x32_bf16 v[152:155], a[236:239], v[44:47], v[152:155]
    ds_read_b128 v[44:47], v9 offset:3136
    v_mfma_f32_16x16x32_bf16 v[152:155], a[248:251], v[48:51], v[152:155]
    ds_read_b128 v[48:51], v9 offset:3200
    s_waitcnt lgkmcnt(9)
    v_mfma_f32_16x16x32_bf16 v[152:155], v[172:175], v[52:55], v[152:155]
    ds_read_b128 v[52:55], v10 offset:3072
    v_mfma_f32_16x16x32_bf16 v[152:155], v[184:187], v[56:59], v[152:155]
    ds_read_b128 v[56:59], v10 offset:3136
    v_mfma_f32_16x16x32_bf16 v[152:155], v[196:199], v[60:63], v[152:155]
    ds_read_b128 v[60:63], v10 offset:3200
    s_waitcnt lgkmcnt(6)
    v_mfma_f32_16x16x32_bf16 v[152:155], v[208:211], v[64:67], v[152:155]
    ds_read_b128 v[64:67], v11 offset:3072
    v_mfma_f32_16x16x32_bf16 v[152:155], v[220:223], v[68:71], v[152:155]
    ds_read_b128 v[68:71], v11 offset:3136
    v_mfma_f32_16x16x32_bf16 v[152:155], v[232:235], v[72:75], v[152:155]
    ds_read_b128 v[72:75], v11 offset:3200
    s_waitcnt lgkmcnt(6)
    v_mfma_f32_16x16x32_bf16 v[108:111], a[0:3], v[40:43], 0
    s_add_u32 s32, s32, 589824
    v_mfma_f32_16x16x32_bf16 v[108:111], a[12:15], v[44:47], v[108:111]
    s_add_u32 s33, s33, 6
    v_mfma_f32_16x16x32_bf16 v[108:111], a[24:27], v[48:51], v[108:111]
    s_cmp_lt_u32 s33, s34
    s_cselect_b32 s14, 50331648, 0
    s_waitcnt lgkmcnt(3)
    v_mfma_f32_16x16x32_bf16 v[108:111], a[36:39], v[52:55], v[108:111]
    s_add_u32 s31, s31, 13312
    v_mfma_f32_16x16x32_bf16 v[108:111], a[48:51], v[56:59], v[108:111]
    s_cmp_eq_u32 s31, 53248
    s_cselect_b32 s31, 0, s31
    v_mfma_f32_16x16x32_bf16 v[108:111], a[60:63], v[60:63], v[108:111]
    s_waitcnt lgkmcnt(0)
    v_mfma_f32_16x16x32_bf16 v[108:111], a[72:75], v[64:67], v[108:111]
    v_mfma_f32_16x16x32_bf16 v[108:111], a[84:87], v[68:71], v[108:111]
    s_add_u32 m0, s31, s26
    v_mfma_f32_16x16x32_bf16 v[108:111], a[96:99], v[72:75], v[108:111]
    buffer_load_dwordx4 v2, s[12:15], s32 offen nt lds
    v_mfma_f32_16x16x32_bf16 v[112:115], a[4:7], v[40:43], 0
    v_mfma_f32_16x16x32_bf16 v[112:115], a[16:19], v[44:47], v[112:115]
    s_add_u32 m0, s31, s27
    v_mfma_f32_16x16x32_bf16 v[112:115], a[28:31], v[48:51], v[112:115]
    buffer_load_dwordx4 v3, s[12:15], s32 offen nt lds
    v_mfma_f32_16x16x32_bf16 v[112:115], a[40:43], v[52:55], v[112:115]
    v_mfma_f32_16x16x32_bf16 v[112:115], a[52:55], v[56:59], v[112:115]
    s_add_u32 m0, s31, s28
    v_mfma_f32_16x16x32_bf16 v[112:115], a[64:67], v[60:63], v[112:115]
    buffer_load_dwordx4 v4, s[12:15], s32 offen nt lds
    v_mfma_f32_16x16x32_bf16 v[112:115], a[76:79], v[64:67], v[112:115]
    v_mfma_f32_16x16x32_bf16 v[112:115], a[88:91], v[68:71], v[112:115]
    s_add_u32 m0, s31, s29
    v_mfma_f32_16x16x32_bf16 v[112:115], a[100:103], v[72:75], v[112:115]
    buffer_load_dwordx4 v5, s[12:15], s32 offen nt lds
    v_mfma_f32_16x16x32_bf16 v[116:119], a[8:11], v[40:43], 0
    v_mfma_f32_16x16x32_bf16 v[116:119], a[20:23], v[44:47], v[116:119]
    v_mfma_f32_16x16x32_bf16 v[116:119], a[32:35], v[48:51], v[116:119]
    s_add_u32 s32, s32, 196608
    v_mfma_f32_16x16x32_bf16 v[116:119], a[44:47], v[52:55], v[116:119]
    s_add_u32 s33, s33, 2
    v_mfma_f32_16x16x32_bf16 v[116:119], a[56:59], v[56:59], v[116:119]
    s_cmp_lt_u32 s33, s34
    s_cselect_b32 s14, 50331648, 0
    v_mfma_f32_16x16x32_bf16 v[116:119], a[68:71], v[60:63], v[116:119]
    s_add_u32 s31, s31, 13312
    v_mfma_f32_16x16x32_bf16 v[116:119], a[80:83], v[64:67], v[116:119]
    s_cmp_eq_u32 s31, 53248
    s_cselect_b32 s31, 0, s31
    v_mfma_f32_16x16x32_bf16 v[116:119], a[92:95], v[68:71], v[116:119]
    v_mfma_f32_16x16x32_bf16 v[116:119], a[104:107], v[72:75], v[116:119]
    v_mfma_f32_16x16x32_bf16 v[132:135], a[108:111], v[40:43], v[132:135]
    s_add_u32 m0, s31, s26
    v_mfma_f32_16x16x32_bf16 v[132:135], a[120:123], v[44:47], v[132:135]
    buffer_load_dwordx4 v2, s[12:15], s32 offen nt lds
    v_mfma_f32_16x16x32_bf16 v[132:135], a[132:135], v[48:51], v[132:135]
    v_mfma_f32_16x16x32_bf16 v[132:135], a[144:147], v[52:55], v[132:135]
    s_add_u32 m0, s31, s27
    v_mfma_f32_16x16x32_bf16 v[132:135], a[156:159], v[56:59], v[132:135]
    buffer_load_dwordx4 v3, s[12:15], s32 offen nt lds
    v_mfma_f32_16x16x32_bf16 v[132:135], a[168:171], v[60:63], v[132:135]
    v_mfma_f32_16x16x32_bf16 v[132:135], a[180:183], v[64:67], v[132:135]
    s_add_u32 m0, s31, s28
    v_mfma_f32_16x16x32_bf16 v[132:135], a[192:195], v[68:71], v[132:135]
    buffer_load_dwordx4 v4, s[12:15], s32 offen nt lds
    v_mfma_f32_16x16x32_bf16 v[132:135], a[204:207], v[72:75], v[132:135]
    v_mfma_f32_16x16x32_bf16 v[136:139], a[112:115], v[40:43], v[136:139]
    s_add_u32 m0, s31, s29
    v_mfma_f32_16x16x32_bf16 v[136:139], a[124:127], v[44:47], v[136:139]
    buffer_load_dwordx4 v5, s[12:15], s32 offen nt lds
    v_mfma_f32_16x16x32_bf16 v[136:139], a[136:139], v[48:51], v[136:139]
    v_mfma_f32_16x16x32_bf16 v[136:139], a[148:151], v[52:55], v[136:139]
    v_mfma_f32_16x16x32_bf16 v[136:139], a[160:163], v[56:59], v[136:139]
    s_add_u32 s30, s30, 13312
    v_mfma_f32_16x16x32_bf16 v[136:139], a[172:175], v[60:63], v[136:139]
    s_cmp_eq_u32 s30, 53248
    s_cselect_b32 s30, 0, s30
    v_mfma_f32_16x16x32_bf16 v[136:139], a[184:187], v[64:67], v[136:139]
    v_add_u32 v9, s30, v6
    v_mfma_f32_16x16x32_bf16 v[136:139], a[196:199], v[68:71], v[136:139]
    v_add_u32 v10, s30, v7
    v_mfma_f32_16x16x32_bf16 v[136:139], a[208:211], v[72:75], v[136:139]
    v_add_u32 v11, s30, v8
    v_mfma_f32_16x16x32_bf16 v[140:143], a[116:119], v[40:43], v[140:143]
    v_mfma_f32_16x16x32_bf16 v[140:143], a[128:131], v[44:47], v[140:143]
    v_mfma_f32_16x16x32_bf16 v[140:143], a[140:143], v[48:51], v[140:143]
    v_mfma_f32_16x16x32_bf16 v[140:143], a[152:155], v[52:55], v[140:143]
    ds_write_b32 v242, v243
    v_mfma_f32_16x16x32_bf16 v[140:143], a[164:167], v[56:59], v[140:143]
    v_mfma_f32_16x16x32_bf16 v[140:143], a[176:179], v[60:63], v[140:143]
    v_mfma_f32_16x16x32_bf16 v[140:143], a[188:191], v[64:67], v[140:143]
    v_mfma_f32_16x16x32_bf16 v[140:143], a[200:203], v[68:71], v[140:143]
    v_mfma_f32_16x16x32_bf16 v[140:143], a[212:215], v[72:75], v[140:143]
    v_mfma_f32_16x16x32_bf16 v[156:159], a[216:219], v[40:43], v[156:159]
    v_mfma_f32_16x16x32_bf16 v[156:159], a[228:231], v[44:47], v[156:159]
    v_mfma_f32_16x16x32_bf16 v[156:159], a[240:243], v[48:51], v[156:159]
    v_mfma_f32_16x16x32_bf16 v[160:163], a[220:223], v[40:43], v[160:163]
    v_mfma_f32_16x16x32_bf16 v[160:163], a[232:235], v[44:47], v[160:163]
    v_mfma_f32_16x16x32_bf16 v[160:163], a[244:247], v[48:51], v[160:163]
    s_waitcnt vmcnt(8)
    s_barrier
    v_mfma_f32_16x16x32_bf16 v[164:167], a[224:227], v[40:43], v[164:167]
    ds_read_b128 v[40:43], v9 offset:0
    v_mfma_f32_16x16x32_bf16 v[164:167], a[236:239], v[44:47], v[164:167]
    ds_read_b128 v[44:47], v9 offset:64
    v_mfma_f32_16x16x32_bf16 v[164:167], a[248:251], v[48:51], v[164:167]
    ds_read_b128 v[48:51], v9 offset:128
    v_mfma_f32_16x16x32_bf16 v[156:159], a[252:255], v[52:55], v[156:159]
    v_mfma_f32_16x16x32_bf16 v[156:159], v[176:179], v[56:59], v[156:159]
    v_mfma_f32_16x16x32_bf16 v[156:159], v[188:191], v[60:63], v[156:159]
    v_mfma_f32_16x16x32_bf16 v[160:163], v[168:171], v[52:55], v[160:163]
    v_mfma_f32_16x16x32_bf16 v[160:163], v[180:183], v[56:59], v[160:163]
    v_mfma_f32_16x16x32_bf16 v[160:163], v[192:195], v[60:63], v[160:163]
    v_mfma_f32_16x16x32_bf16 v[164:167], v[172:175], v[52:55], v[164:167]
    ds_read_b128 v[52:55], v10 offset:0
    v_mfma_f32_16x16x32_bf16 v[164:167], v[184:187], v[56:59], v[164:167]
    ds_read_b128 v[56:59], v10 offset:64
    v_mfma_f32_16x16x32_bf16 v[164:167], v[196:199], v[60:63], v[164:167]
    ds_read_b128 v[60:63], v10 offset:128
    v_mfma_f32_16x16x32_bf16 v[156:159], v[200:203], v[64:67], v[156:159]
    v_mfma_f32_16x16x32_bf16 v[156:159], v[212:215], v[68:71], v[156:159]
    v_mfma_f32_16x16x32_bf16 v[156:159], v[224:227], v[72:75], v[156:159]
    v_mfma_f32_16x16x32_bf16 v[160:163], v[204:207], v[64:67], v[160:163]
    v_mfma_f32_16x16x32_bf16 v[160:163], v[216:219], v[68:71], v[160:163]
    v_mfma_f32_16x16x32_bf16 v[160:163], v[228:231], v[72:75], v[160:163]
    v_mfma_f32_16x16x32_bf16 v[164:167], v[208:211], v[64:67], v[164:167]
    ds_read_b128 v[64:67], v11 offset:0
    v_mfma_f32_16x16x32_bf16 v[164:167], v[220:223], v[68:71], v[164:167]
    ds_read_b128 v[68:71], v11 offset:64
    v_mfma_f32_16x16x32_bf16 v[164:167], v[232:235], v[72:75], v[164:167]
    ds_read_b128 v[72:75], v11 offset:128
    s_waitcnt lgkmcnt(6)
    v_mfma_f32_16x16x32_bf16 v[144:147], a[0:3], v[40:43], v[144:147]
    s_add_u32 s32, s32, 196608
    v_mfma_f32_16x16x32_bf16 v[144:147], a[12:15], v[44:47], v[144:147]
    s_add_u32 s33, s33, 2
    v_mfma_f32_16x16x32_bf16 v[144:147], a[24:27], v[48:51], v[144:147]
    s_cmp_lt_u32 s33, s34
    s_cselect_b32 s14, 50331648, 0
    s_waitcnt lgkmcnt(3)
    v_mfma_f32_16x16x32_bf16 v[144:147], a[36:39], v[52:55], v[144:147]
    s_add_u32 s31, s31, 13312
    v_mfma_f32_16x16x32_bf16 v[144:147], a[48:51], v[56:59], v[144:147]
    s_cmp_eq_u32 s31, 53248
    s_cselect_b32 s31, 0, s31
    v_mfma_f32_16x16x32_bf16 v[144:147], a[60:63], v[60:63], v[144:147]
    s_waitcnt lgkmcnt(0)
    v_mfma_f32_16x16x32_bf16 v[144:147], a[72:75], v[64:67], v[144:147]
    v_mfma_f32_16x16x32_bf16 v[144:147], a[84:87], v[68:71], v[144:147]
    s_add_u32 m0, s31, s26
    v_mfma_f32_16x16x32_bf16 v[144:147], a[96:99], v[72:75], v[144:147]
    buffer_load_dwordx4 v2, s[12:15], s32 offen nt lds
    v_mfma_f32_16x16x32_bf16 v[148:151], a[4:7], v[40:43], v[148:151]
    s_add_u32 m0, s31, s27
    v_mfma_f32_16x16x32_bf16 v[148:151], a[16:19], v[44:47], v[148:151]
    buffer_load_dwordx4 v3, s[12:15], s32 offen nt lds
    v_mfma_f32_16x16x32_bf16 v[148:151], a[28:31], v[48:51], v[148:151]
    s_add_u32 m0, s31, s28
    v_mfma_f32_16x16x32_bf16 v[148:151], a[40:43], v[52:55], v[148:151]
    buffer_load_dwordx4 v4, s[12:15], s32 offen nt lds
    v_mfma_f32_16x16x32_bf16 v[148:151], a[52:55], v[56:59], v[148:151]
    s_add_u32 m0, s31, s29
    v_mfma_f32_16x16x32_bf16 v[148:151], a[64:67], v[60:63], v[148:151]
    buffer_load_dwordx4 v5, s[12:15], s32 offen nt lds
    v_mfma_f32_16x16x32_bf16 v[148:151], a[76:79], v[64:67], v[148:151]
    v_mfma_f32_16x16x32_bf16 v[148:151], a[88:91], v[68:71], v[148:151]
    v_mfma_f32_16x16x32_bf16 v[148:151], a[100:103], v[72:75], v[148:151]
    v_cvt_pk_bf16_f32 v76, v144, v145
    v_mfma_f32_16x16x32_bf16 v[152:155], a[8:11], v[40:43], v[152:155]
    ds_read_b128 v[40:43], v9 offset:3072
    v_cvt_pk_bf16_f32 v77, v146, v147
    v_mfma_f32_16x16x32_bf16 v[152:155], a[20:23], v[44:47], v[152:155]
    ds_read_b128 v[44:47], v9 offset:3136
    ds_write_b64 v12, v[76:77] offset:0
    v_mfma_f32_16x16x32_bf16 v[152:155], a[32:35], v[48:51], v[152:155]
    ds_read_b128 v[48:51], v9 offset:3200
    v_mfma_f32_16x16x32_bf16 v[152:155], a[44:47], v[52:55], v[152:155]
    ds_read_b128 v[52:55], v10 offset:3072
    v_mfma_f32_16x16x32_bf16 v[152:155], a[56:59], v[56:59], v[152:155]
    ds_read_b128 v[56:59], v10 offset:3136
    v_mfma_f32_16x16x32_bf16 v[152:155], a[68:71], v[60:63], v[152:155]
    ds_read_b128 v[60:63], v10 offset:3200
    v_mfma_f32_16x16x32_bf16 v[152:155], a[80:83], v[64:67], v[152:155]
    ds_read_b128 v[64:67], v11 offset:3072
    v_mfma_f32_16x16x32_bf16 v[152:155], a[92:95], v[68:71], v[152:155]
    ds_read_b128 v[68:71], v11 offset:3136
    v_mfma_f32_16x16x32_bf16 v[152:155], a[104:107], v[72:75], v[152:155]
    ds_read_b128 v[72:75], v11 offset:3200
    s_waitcnt lgkmcnt(6)
    v_mfma_f32_16x16x32_bf16 v[156:159], a[0:3], v[40:43], v[156:159]
    v_cvt_pk_bf16_f32 v78, v148, v149
    s_add_u32 s30, s30, 13312
    v_mfma_f32_16x16x32_bf16 v[156:159], a[12:15], v[44:47], v[156:159]
    v_cvt_pk_bf16_f32 v79, v150, v151
    v_mfma_f32_16x16x32_bf16 v[156:159], a[24:27], v[48:51], v[156:159]
    s_cmp_eq_u32 s30, 53248
    s_cselect_b32 s30, 0, s30
    v_mfma_f32_16x16x32_bf16 v[160:163], a[4:7], v[40:43], v[160:163]
    ds_write_b64 v13, v[78:79] offset:0
    v_add_u32 v9, s30, v6
    v_mfma_f32_16x16x32_bf16 v[160:163], a[16:19], v[44:47], v[160:163]
    v_add_u32 v10, s30, v7
    v_add_u32 v11, s30, v8
    v_mfma_f32_16x16x32_bf16 v[160:163], a[28:31], v[48:51], v[160:163]
    s_waitcnt vmcnt(8)
    s_barrier
    v_mfma_f32_16x16x32_bf16 v[164:167], a[8:11], v[40:43], v[164:167]
    ds_read_b128 v[40:43], v9 offset:0
    v_mfma_f32_16x16x32_bf16 v[164:167], a[20:23], v[44:47], v[164:167]
    ds_read_b128 v[44:47], v9 offset:64
    v_mfma_f32_16x16x32_bf16 v[164:167], a[32:35], v[48:51], v[164:167]
    v_cvt_pk_bf16_f32 v80, v152, v153
    s_waitcnt lgkmcnt(6)
    v_mfma_f32_16x16x32_bf16 v[156:159], a[36:39], v[52:55], v[156:159]
    ds_read_b128 v[48:51], v9 offset:128
    v_cvt_pk_bf16_f32 v81, v154, v155
    v_mfma_f32_16x16x32_bf16 v[156:159], a[48:51], v[56:59], v[156:159]
    ds_write_b64 v14, v[80:81] offset:0
    v_mfma_f32_16x16x32_bf16 v[156:159], a[60:63], v[60:63], v[156:159]
    v_mfma_f32_16x16x32_bf16 v[160:163], a[40:43], v[52:55], v[160:163]
    v_mfma_f32_16x16x32_bf16 v[160:163], a[52:55], v[56:59], v[160:163]
    v_mfma_f32_16x16x32_bf16 v[160:163], a[64:67], v[60:63], v[160:163]
    v_mfma_f32_16x16x32_bf16 v[164:167], a[44:47], v[52:55], v[164:167]
    ds_read_b128 v[52:55], v10 offset:0
    v_mfma_f32_16x16x32_bf16 v[164:167], a[56:59], v[56:59], v[164:167]
    ds_read_b128 v[56:59], v10 offset:64
    v_mfma_f32_16x16x32_bf16 v[164:167], a[68:71], v[60:63], v[164:167]
    ds_read_b128 v[60:63], v10 offset:128
    s_waitcnt lgkmcnt(8)
    v_mfma_f32_16x16x32_bf16 v[156:159], a[72:75], v[64:67], v[156:159]
    v_mfma_f32_16x16x32_bf16 v[156:159], a[84:87], v[68:71], v[156:159]
    v_mfma_f32_16x16x32_bf16 v[156:159], a[96:99], v[72:75], v[156:159]
    v_mfma_f32_16x16x32_bf16 v[160:163], a[76:79], v[64:67], v[160:163]
    v_mfma_f32_16x16x32_bf16 v[160:163], a[88:91], v[68:71], v[160:163]
    v_mfma_f32_16x16x32_bf16 v[160:163], a[100:103], v[72:75], v[160:163]
    v_mfma_f32_16x16x32_bf16 v[164:167], a[80:83], v[64:67], v[164:167]
    ds_read_b128 v[64:67], v11 offset:0
    v_mfma_f32_16x16x32_bf16 v[164:167], a[92:95], v[68:71], v[164:167]
    ds_read_b128 v[68:71], v11 offset:64
    v_mfma_f32_16x16x32_bf16 v[164:167], a[104:107], v[72:75], v[164:167]
    ds_read_b128 v[72:75], v11 offset:128
    s_nop 7
    v_cvt_pk_bf16_f32 v76, v156, v157
    v_cvt_pk_bf16_f32 v77, v158, v159
    ds_write_b64 v12, v[76:77] offset:3072
    v_cvt_pk_bf16_f32 v78, v160, v161
    v_cvt_pk_bf16_f32 v79, v162, v163
    ds_write_b64 v13, v[78:79] offset:3072
    v_cvt_pk_bf16_f32 v80, v164, v165
    v_cvt_pk_bf16_f32 v81, v166, v167
    ds_write_b64 v14, v[80:81] offset:3072
    s_waitcnt lgkmcnt(0)
    s_barrier
    s_mov_b32 s36, 13
L_loop:
    s_waitcnt lgkmcnt(6)
    v_mfma_f32_16x16x32_bf16 v[144:147], a[216:219], v[40:43], v[120:123]
    v_xor_b32 v12, 0x4000, v12
    v_mfma_f32_16x16x32_bf16 v[144:147], a[228:231], v[44:47], v[144:147]
    v_xor_b32 v13, 0x4000, v13
    v_mfma_f32_16x16x32_bf16 v[144:147], a[240:243], v[48:51], v[144:147]
    v_xor_b32 v14, 0x4000, v14
    s_waitcnt lgkmcnt(3)
    v_mfma_f32_16x16x32_bf16 v[144:147], a[252:255], v[52:55], v[144:147]
    v_mfma_f32_16x16x32_bf16 v[144:147], v[176:179], v[56:59], v[144:147]
    v_mfma_f32_16x16x32_bf16 v[144:147], v[188:191], v[60:63], v[144:147]
    s_waitcnt lgkmcnt(0)
    v_mfma_f32_16x16x32_bf16 v[144:147], v[200:203], v[64:67], v[144:147]
    ds_read_b128 v[84:87], v15
    v_mfma_f32_16x16x32_bf16 v[144:147], v[212:215], v[68:71], v[144:147]
    ds_read_b128 v[88:91], v16
    v_mfma_f32_16x16x32_bf16 v[144:147], v[224:227], v[72:75], v[144:147]
    ds_read_b128 v[92:95], v17
    v_mfma_f32_16x16x32_bf16 v[148:151], a[220:223], v[40:43], v[124:127]
    v_xor_b32 v15, 0x4000, v15
    v_mfma_f32_16x16x32_bf16 v[148:151], a[232:235], v[44:47], v[148:151]
    v_xor_b32 v16, 0x4000, v16
    v_mfma_f32_16x16x32_bf16 v[148:151], a[244:247], v[48:51], v[148:151]
    v_xor_b32 v17, 0x4000, v17
    v_mfma_f32_16x16x32_bf16 v[148:151], v[168:171], v[52:55], v[148:151]
    s_waitcnt lgkmcnt(2)
    buffer_store_dwordx4 v[84:87], v18, s[20:23], s35 offen offset:0 sc1
    v_mfma_f32_16x16x32_bf16 v[148:151], v[180:183], v[56:59], v[148:151]
    v_mfma_f32_16x16x32_bf16 v[148:151], v[192:195], v[60:63], v[148:151]
    v_mfma_f32_16x16x32_bf16 v[148:151], v[204:207], v[64:67], v[148:151]
    v_mfma_f32_16x16x32_bf16 v[148:151], v[216:219], v[68:71], v[148:151]
    v_mfma_f32_16x16x32_bf16 v[148:151], v[228:231], v[72:75], v[148:151]
    v_cvt_pk_bf16_f32 v76, v144, v145
    v_mfma_f32_16x16x32_bf16 v[152:155], a[224:227], v[40:43], v[128:131]
    v_cvt_pk_bf16_f32 v77, v146, v147
    v_mfma_f32_16x16x32_bf16 v[152:155], a[236:239], v[44:47], v[152:155]
    ds_write_b64 v12, v[76:77] offset:0
    v_mfma_f32_16x16x32_bf16 v[152:155], a[248:251], v[48:51], v[152:155]
    s_waitcnt lgkmcnt(2)
    buffer_store_dwordx4 v[88:91], v18, s[20:23], s35 offen offset:1024 sc1
    v_mfma_f32_16x16x32_bf16 v[152:155], v[172:175], v[52:55], v[152:155]
    v_mfma_f32_16x16x32_bf16 v[152:155], v[184:187], v[56:59], v[152:155]
    v_mfma_f32_16x16x32_bf16 v[152:155], v[196:199], v[60:63], v[152:155]
    v_mfma_f32_16x16x32_bf16 v[152:155], v[208:211], v[64:67], v[152:155]
    v_mfma_f32_16x16x32_bf16 v[152:155], v[220:223], v[68:71], v[152:155]
    v_mfma_f32_16x16x32_bf16 v[152:155], v[232:235], v[72:75], v[152:155]
    v_cvt_pk_bf16_f32 v78, v148, v149
    v_mfma_f32_16x16x32_bf16 v[120:123], a[108:111], v[40:43], v[96:99]
    v_cvt_pk_bf16_f32 v79, v150, v151
    v_mfma_f32_16x16x32_bf16 v[120:123], a[120:123], v[44:47], v[120:123]
    s_waitcnt lgkmcnt(1)
    buffer_store_dwordx4 v[92:95], v18, s[20:23], s35 offen offset:2048 sc1
    ds_write_b64 v13, v[78:79] offset:0
    v_mfma_f32_16x16x32_bf16 v[120:123], a[132:135], v[48:51], v[120:123]
    s_add_u32 s35, s35, 196608
    v_mfma_f32_16x16x32_bf16 v[120:123], a[144:147], v[52:55], v[120:123]
    v_mfma_f32_16x16x32_bf16 v[120:123], a[156:159], v[56:59], v[120:123]
    v_mfma_f32_16x16x32_bf16 v[120:123], a[168:171], v[60:63], v[120:123]
    v_mfma_f32_16x16x32_bf16 v[120:123], a[180:183], v[64:67], v[120:123]
    v_mfma_f32_16x16x32_bf16 v[120:123], a[192:195], v[68:71], v[120:123]
    v_mfma_f32_16x16x32_bf16 v[120:123], a[204:207], v[72:75], v[120:123]
    v_cvt_pk_bf16_f32 v80, v152, v153
    v_mfma_f32_16x16x32_bf16 v[124:127], a[112:115], v[40:43], v[100:103]
    v_cvt_pk_bf16_f32 v81, v154, v155
    v_mfma_f32_16x16x32_bf16 v[124:127], a[124:127], v[44:47], v[124:127]
    ds_write_b64 v14, v[80:81] offset:0
    v_mfma_f32_16x16x32_bf16 v[124:127], a[136:139], v[48:51], v[124:127]
    s_add_u32 s32, s32, 196608
    v_mfma_f32_16x16x32_bf16 v[124:127], a[148:151], v[52:55], v[124:127]
    s_add_u32 s33, s33, 2
    v_mfma_f32_16x16x32_bf16 v[124:127], a[160:163], v[56:59], v[124:127]
    s_cmp_lt_u32 s33, s34
    v_mfma_f32_16x16x32_bf16 v[124:127], a[172:175], v[60:63], v[124:127]
    s_cselect_b32 s14, 50331648, 0
    v_mfma_f32_16x16x32_bf16 v[124:127], a[184:187], v[64:67], v[124:127]
    s_add_u32 s31, s31, 13312
    v_mfma_f32_16x16x32_bf16 v[124:127], a[196:199], v[68:71], v[124:127]
    s_cmp_eq_u32 s31, 53248
    v_mfma_f32_16x16x32_bf16 v[124:127], a[208:211], v[72:75], v[124:127]
    s_cselect_b32 s31, 0, s31
    v_mfma_f32_16x16x32_bf16 v[128:131], a[116:119], v[40:43], v[104:107]
    v_mfma_f32_16x16x32_bf16 v[128:131], a[128:131], v[44:47], v[128:131]
    s_add_u32 m0, s31, s26
    v_mfma_f32_16x16x32_bf16 v[128:131], a[140:143], v[48:51], v[128:131]
    buffer_load_dwordx4 v2, s[12:15], s32 offen nt lds
    v_mfma_f32_16x16x32_bf16 v[128:131], a[152:155], v[52:55], v[128:131]
    v_mfma_f32_16x16x32_bf16 v[128:131], a[164:167], v[56:59], v[128:131]
    v_mfma_f32_16x16x32_bf16 v[128:131], a[176:179], v[60:63], v[128:131]
    s_add_u32 m0, s31, s27
    v_mfma_f32_16x16x32_bf16 v[128:131], a[188:191], v[64:67], v[128:131]
    buffer_load_dwordx4 v3, s[12:15], s32 offen nt lds
    v_mfma_f32_16x16x32_bf16 v[128:131], a[200:203], v[68:71], v[128:131]
    v_mfma_f32_16x16x32_bf16 v[128:131], a[212:215], v[72:75], v[128:131]
    v_mfma_f32_16x16x32_bf16 v[96:99], a[0:3], v[40:43], 0
    s_add_u32 m0, s31, s28
    v_mfma_f32_16x16x32_bf16 v[96:99], a[12:15], v[44:47], v[96:99]
    buffer_load_dwordx4 v4, s[12:15], s32 offen nt lds
    v_mfma_f32_16x16x32_bf16 v[96:99], a[24:27], v[48:51], v[96:99]
    v_mfma_f32_16x16x32_bf16 v[100:103], a[4:7], v[40:43], 0
    v_mfma_f32_16x16x32_bf16 v[100:103], a[16:19], v[44:47], v[100:103]
    s_add_u32 m0, s31, s29
    v_mfma_f32_16x16x32_bf16 v[100:103], a[28:31], v[48:51], v[100:103]
    buffer_load_dwordx4 v5, s[12:15], s32 offen nt lds
    v_mfma_f32_16x16x32_bf16 v[104:107], a[8:11], v[40:43], 0
    ds_read_b128 v[40:43], v9 offset:3072
    v_mfma_f32_16x16x32_bf16 v[104:107], a[20:23], v[44:47], v[104:107]
    ds_read_b128 v[44:47], v9 offset:3136
    v_mfma_f32_16x16x32_bf16 v[104:107], a[32:35], v[48:51], v[104:107]
    ds_read_b128 v[48:51], v9 offset:3200
    v_mfma_f32_16x16x32_bf16 v[96:99], a[36:39], v[52:55], v[96:99]
    v_mfma_f32_16x16x32_bf16 v[96:99], a[48:51], v[56:59], v[96:99]
    v_mfma_f32_16x16x32_bf16 v[96:99], a[60:63], v[60:63], v[96:99]
    v_mfma_f32_16x16x32_bf16 v[100:103], a[40:43], v[52:55], v[100:103]
    v_mfma_f32_16x16x32_bf16 v[100:103], a[52:55], v[56:59], v[100:103]
    v_mfma_f32_16x16x32_bf16 v[100:103], a[64:67], v[60:63], v[100:103]
    v_mfma_f32_16x16x32_bf16 v[104:107], a[44:47], v[52:55], v[104:107]
    ds_read_b128 v[52:55], v10 offset:3072
    v_mfma_f32_16x16x32_bf16 v[104:107], a[56:59], v[56:59], v[104:107]
    ds_read_b128 v[56:59], v10 offset:3136
    v_mfma_f32_16x16x32_bf16 v[104:107], a[68:71], v[60:63], v[104:107]
    ds_read_b128 v[60:63], v10 offset:3200
    v_mfma_f32_16x16x32_bf16 v[96:99], a[72:75], v[64:67], v[96:99]
    v_mfma_f32_16x16x32_bf16 v[96:99], a[84:87], v[68:71], v[96:99]
    v_mfma_f32_16x16x32_bf16 v[96:99], a[96:99], v[72:75], v[96:99]
    v_mfma_f32_16x16x32_bf16 v[100:103], a[76:79], v[64:67], v[100:103]
    v_mfma_f32_16x16x32_bf16 v[100:103], a[88:91], v[68:71], v[100:103]
    v_mfma_f32_16x16x32_bf16 v[100:103], a[100:103], v[72:75], v[100:103]
    v_mfma_f32_16x16x32_bf16 v[104:107], a[80:83], v[64:67], v[104:107]
    ds_read_b128 v[64:67], v11 offset:3072
    v_mfma_f32_16x16x32_bf16 v[104:107], a[92:95], v[68:71], v[104:107]
    ds_read_b128 v[68:71], v11 offset:3136
    v_mfma_f32_16x16x32_bf16 v[104:107], a[104:107], v[72:75], v[104:107]
    ds_read_b128 v[72:75], v11 offset:3200
    s_waitcnt lgkmcnt(6)
    v_mfma_f32_16x16x32_bf16 v[156:159], a[216:219], v[40:43], v[132:135]
    v_mfma_f32_16x16x32_bf16 v[156:159], a[228:231], v[44:47], v[156:159]
    v_mfma_f32_16x16x32_bf16 v[156:159], a[240:243], v[48:51], v[156:159]
    s_waitcnt lgkmcnt(3)
    v_mfma_f32_16x16x32_bf16 v[156:159], a[252:255], v[52:55], v[156:159]
    v_mfma_f32_16x16x32_bf16 v[156:159], v[176:179], v[56:59], v[156:159]
    v_mfma_f32_16x16x32_bf16 v[156:159], v[188:191], v[60:63], v[156:159]
    s_waitcnt lgkmcnt(0)
    v_mfma_f32_16x16x32_bf16 v[156:159], v[200:203], v[64:67], v[156:159]
    v_mfma_f32_16x16x32_bf16 v[156:159], v[212:215], v[68:71], v[156:159]
    v_mfma_f32_16x16x32_bf16 v[156:159], v[224:227], v[72:75], v[156:159]
    v_mfma_f32_16x16x32_bf16 v[160:163], a[220:223], v[40:43], v[136:139]
    s_add_u32 s30, s30, 13312
    v_mfma_f32_16x16x32_bf16 v[160:163], a[232:235], v[44:47], v[160:163]
    s_cmp_eq_u32 s30, 53248
    v_mfma_f32_16x16x32_bf16 v[160:163], a[244:247], v[48:51], v[160:163]
    s_cselect_b32 s30, 0, s30
    v_mfma_f32_16x16x32_bf16 v[160:163], v[168:171], v[52:55], v[160:163]
    v_add_u32 v9, s30, v6
    v_mfma_f32_16x16x32_bf16 v[160:163], v[180:183], v[56:59], v[160:163]
    v_add_u32 v10, s30, v7
    v_mfma_f32_16x16x32_bf16 v[160:163], v[192:195], v[60:63], v[160:163]
    v_add_u32 v11, s30, v8
    v_mfma_f32_16x16x32_bf16 v[160:163], v[204:207], v[64:67], v[160:163]
    v_mfma_f32_16x16x32_bf16 v[160:163], v[216:219], v[68:71], v[160:163]
    v_mfma_f32_16x16x32_bf16 v[160:163], v[228:231], v[72:75], v[160:163]
    v_cvt_pk_bf16_f32 v76, v156, v157
    v_mfma_f32_16x16x32_bf16 v[164:167], a[224:227], v[40:43], v[140:143]
    v_cvt_pk_bf16_f32 v77, v158, v159
    v_mfma_f32_16x16x32_bf16 v[164:167], a[236:239], v[44:47], v[164:167]
    ds_write_b64 v12, v[76:77] offset:3072
    v_mfma_f32_16x16x32_bf16 v[164:167], a[248:251], v[48:51], v[164:167]
    v_mfma_f32_16x16x32_bf16 v[164:167], v[172:175], v[52:55], v[164:167]
    v_mfma_f32_16x16x32_bf16 v[164:167], v[184:187], v[56:59], v[164:167]
    v_mfma_f32_16x16x32_bf16 v[164:167], v[196:199], v[60:63], v[164:167]
    v_mfma_f32_16x16x32_bf16 v[164:167], v[208:211], v[64:67], v[164:167]
    v_mfma_f32_16x16x32_bf16 v[164:167], v[220:223], v[68:71], v[164:167]
    v_mfma_f32_16x16x32_bf16 v[164:167], v[232:235], v[72:75], v[164:167]
    v_cvt_pk_bf16_f32 v78, v160, v161
    v_mfma_f32_16x16x32_bf16 v[132:135], a[108:111], v[40:43], v[108:111]
    v_cvt_pk_bf16_f32 v79, v162, v163
    v_mfma_f32_16x16x32_bf16 v[132:135], a[120:123], v[44:47], v[132:135]
    ds_write_b64 v13, v[78:79] offset:3072
    v_mfma_f32_16x16x32_bf16 v[132:135], a[132:135], v[48:51], v[132:135]
    v_mfma_f32_16x16x32_bf16 v[132:135], a[144:147], v[52:55], v[132:135]
    v_mfma_f32_16x16x32_bf16 v[132:135], a[156:159], v[56:59], v[132:135]
    v_mfma_f32_16x16x32_bf16 v[132:135], a[168:171], v[60:63], v[132:135]
    v_mfma_f32_16x16x32_bf16 v[132:135], a[180:183], v[64:67], v[132:135]
    v_mfma_f32_16x16x32_bf16 v[132:135], a[192:195], v[68:71], v[132:135]
    v_mfma_f32_16x16x32_bf16 v[132:135], a[204:207], v[72:75], v[132:135]
    v_cvt_pk_bf16_f32 v80, v164, v165
    v_mfma_f32_16x16x32_bf16 v[136:139], a[112:115], v[40:43], v[112:115]
    v_cvt_pk_bf16_f32 v81, v166, v167
    v_mfma_f32_16x16x32_bf16 v[136:139], a[124:127], v[44:47], v[136:139]
    ds_write_b64 v14, v[80:81] offset:3072
    v_mfma_f32_16x16x32_bf16 v[136:139], a[136:139], v[48:51], v[136:139]
    v_mfma_f32_16x16x32_bf16 v[136:139], a[148:151], v[52:55], v[136:139]
    v_mfma_f32_16x16x32_bf16 v[136:139], a[160:163], v[56:59], v[136:139]
    v_add_u32 v243, 1, v243
    v_mfma_f32_16x16x32_bf16 v[136:139], a[172:175], v[60:63], v[136:139]
    s_add_u32 s63, s63, 1
    v_mfma_f32_16x16x32_bf16 v[136:139], a[184:187], v[64:67], v[136:139]
    s_waitcnt vmcnt(11)
    ds_write_b32 v242, v243
    v_mfma_f32_16x16x32_bf16 v[136:139], a[196:199], v[68:71], v[136:139]
    v_mfma_f32_16x16x32_bf16 v[136:139], a[208:211], v[72:75], v[136:139]
    v_mfma_f32_16x16x32_bf16 v[140:143], a[116:119], v[40:43], v[116:119]
    v_mfma_f32_16x16x32_bf16 v[140:143], a[128:131], v[44:47], v[140:143]
    v_mfma_f32_16x16x32_bf16 v[140:143], a[140:143], v[48:51], v[140:143]
    v_mfma_f32_16x16x32_bf16 v[140:143], a[152:155], v[52:55], v[140:143]
    v_mfma_f32_16x16x32_bf16 v[140:143], a[164:167], v[56:59], v[140:143]
    v_mfma_f32_16x16x32_bf16 v[140:143], a[176:179], v[60:63], v[140:143]
    v_mfma_f32_16x16x32_bf16 v[140:143], a[188:191], v[64:67], v[140:143]
    v_mfma_f32_16x16x32_bf16 v[140:143], a[200:203], v[68:71], v[140:143]
    v_mfma_f32_16x16x32_bf16 v[140:143], a[212:215], v[72:75], v[140:143]
    ds_read_b128 v[236:239], v244
    v_mfma_f32_16x16x32_bf16 v[108:111], a[0:3], v[40:43], 0
    v_mfma_f32_16x16x32_bf16 v[108:111], a[12:15], v[44:47], v[108:111]
    v_mfma_f32_16x16x32_bf16 v[108:111], a[24:27], v[48:51], v[108:111]
    v_mfma_f32_16x16x32_bf16 v[112:115], a[4:7], v[40:43], 0
    v_mfma_f32_16x16x32_bf16 v[112:115], a[16:19], v[44:47], v[112:115]
    v_mfma_f32_16x16x32_bf16 v[112:115], a[28:31], v[48:51], v[112:115]
    s_waitcnt lgkmcnt(0)
    v_min3_u32 v245, v236, v237, v238
    v_mfma_f32_16x16x32_bf16 v[116:119], a[8:11], v[40:43], 0
    v_min_u32 v245, v245, v239
    v_mfma_f32_16x16x32_bf16 v[116:119], a[20:23], v[44:47], v[116:119]
    v_mfma_f32_16x16x32_bf16 v[116:119], a[32:35], v[48:51], v[116:119]
    v_readfirstlane_b32 s57, v245
    v_mfma_f32_16x16x32_bf16 v[108:111], a[36:39], v[52:55], v[108:111]
    v_mfma_f32_16x16x32_bf16 v[108:111], a[48:51], v[56:59], v[108:111]
    v_mfma_f32_16x16x32_bf16 v[108:111], a[60:63], v[60:63], v[108:111]
    s_cmp_ge_u32 s57, s63
    s_cbranch_scc0 L_slow
L_back:
    v_mfma_f32_16x16x32_bf16 v[112:115], a[40:43], v[52:55], v[112:115]
    ds_read_b128 v[40:43], v9 offset:0
    v_mfma_f32_16x16x32_bf16 v[112:115], a[52:55], v[56:59], v[112:115]
    ds_read_b128 v[44:47], v9 offset:64
    v_mfma_f32_16x16x32_bf16 v[112:115], a[64:67], v[60:63], v[112:115]
    ds_read_b128 v[48:51], v9 offset:128
    v_mfma_f32_16x16x32_bf16 v[116:119], a[44:47], v[52:55], v[116:119]
    ds_read_b128 v[52:55], v10 offset:0
    v_mfma_f32_16x16x32_bf16 v[116:119], a[56:59], v[56:59], v[116:119]
    ds_read_b128 v[56:59], v10 offset:64
    v_mfma_f32_16x16x32_bf16 v[116:119], a[68:71], v[60:63], v[116:119]
    ds_read_b128 v[60:63], v10 offset:128
    v_mfma_f32_16x16x32_bf16 v[108:111], a[72:75], v[64:67], v[108:111]
    v_mfma_f32_16x16x32_bf16 v[108:111], a[84:87], v[68:71], v[108:111]
    v_mfma_f32_16x16x32_bf16 v[108:111], a[96:99], v[72:75], v[108:111]
    s_sub_u32 s36, s36, 1
    v_mfma_f32_16x16x32_bf16 v[112:115], a[76:79], v[64:67], v[112:115]
    s_cmp_lg_u32 s36, 0
    v_mfma_f32_16x16x32_bf16 v[112:115], a[88:91], v[68:71], v[112:115]
    v_mfma_f32_16x16x32_bf16 v[112:115], a[100:103], v[72:75], v[112:115]
    v_mfma_f32_16x16x32_bf16 v[116:119], a[80:83], v[64:67], v[116:119]
    ds_read_b128 v[64:67], v11 offset:0
    v_mfma_f32_16x16x32_bf16 v[116:119], a[92:95], v[68:71], v[116:119]
    ds_read_b128 v[68:71], v11 offset:64
    v_mfma_f32_16x16x32_bf16 v[116:119], a[104:107], v[72:75], v[116:119]
    ds_read_b128 v[72:75], v11 offset:128
    s_cbranch_scc1 L_loop
    s_waitcnt lgkmcnt(6)
    v_mfma_f32_16x16x32_bf16 v[144:147], a[216:219], v[40:43], v[120:123]
    v_xor_b32 v12, 0x4000, v12
    v_mfma_f32_16x16x32_bf16 v[144:147], a[228:231], v[44:47], v[144:147]
    v_xor_b32 v13, 0x4000, v13
    v_mfma_f32_16x16x32_bf16 v[144:147], a[240:243], v[48:51], v[144:147]
    v_xor_b32 v14, 0x4000, v14
    s_waitcnt lgkmcnt(3)
    v_mfma_f32_16x16x32_bf16 v[144:147], a[252:255], v[52:55], v[144:147]
    v_mfma_f32_16x16x32_bf16 v[144:147], v[176:179], v[56:59], v[144:147]
    v_mfma_f32_16x16x32_bf16 v[144:147], v[188:191], v[60:63], v[144:147]
    s_waitcnt lgkmcnt(0)
    v_mfma_f32_16x16x32_bf16 v[144:147], v[200:203], v[64:67], v[144:147]
    ds_read_b128 v[84:87], v15
    v_mfma_f32_16x16x32_bf16 v[144:147], v[212:215], v[68:71], v[144:147]
    ds_read_b128 v[88:91], v16
    v_mfma_f32_16x16x32_bf16 v[144:147], v[224:227], v[72:75], v[144:147]
    ds_read_b128 v[92:95], v17
    v_mfma_f32_16x16x32_bf16 v[148:151], a[220:223], v[40:43], v[124:127]
    v_xor_b32 v15, 0x4000, v15
    v_mfma_f32_16x16x32_bf16 v[148:151], a[232:235], v[44:47], v[148:151]
    v_xor_b32 v16, 0x4000, v16
    v_mfma_f32_16x16x32_bf16 v[148:151], a[244:247], v[48:51], v[148:151]
    v_xor_b32 v17, 0x4000, v17
    v_mfma_f32_16x16x32_bf16 v[148:151], v[168:171], v[52:55], v[148:151]
    s_waitcnt lgkmcnt(2)
    buffer_store_dwordx4 v[84:87], v18, s[20:23], s35 offen offset:0 sc1
    v_mfma_f32_16x16x32_bf16 v[148:151], v[180:183], v[56:59], v[148:151]
    v_mfma_f32_16x16x32_bf16 v[148:151], v[192:195], v[60:63], v[148:151]
    v_mfma_f32_16x16x32_bf16 v[148:151], v[204:207], v[64:67], v[148:151]
    v_mfma_f32_16x16x32_bf16 v[148:151], v[216:219], v[68:71], v[148:151]
    v_mfma_f32_16x16x32_bf16 v[148:151], v[228:231], v[72:75], v[148:151]
    v_cvt_pk_bf16_f32 v76, v144, v145
    v_mfma_f32_16x16x32_bf16 v[152:155], a[224:227], v[40:43], v[128:131]
    v_cvt_pk_bf16_f32 v77, v146, v147
    v_mfma_f32_16x16x32_bf16 v[152:155], a[236:239], v[44:47], v[152:155]
    ds_write_b64 v12, v[76:77] offset:0
    v_mfma_f32_16x16x32_bf16 v[152:155], a[248:251], v[48:51], v[152:155]
    s_waitcnt lgkmcnt(2)
    buffer_store_dwordx4 v[88:91], v18, s[20:23], s35 offen offset:1024 sc1
    v_mfma_f32_16x16x32_bf16 v[152:155], v[172:175], v[52:55], v[152:155]
    v_mfma_f32_16x16x32_bf16 v[152:155], v[184:187], v[56:59], v[152:155]
    v_mfma_f32_16x16x32_bf16 v[152:155], v[196:199], v[60:63], v[152:155]
    v_mfma_f32_16x16x32_bf16 v[152:155], v[208:211], v[64:67], v[152:155]
    v_mfma_f32_16x16x32_bf16 v[152:155], v[220:223], v[68:71], v[152:155]
    v_mfma_f32_16x16x32_bf16 v[152:155], v[232:235], v[72:75], v[152:155]
    v_cvt_pk_bf16_f32 v78, v148, v149
    v_mfma_f32_16x16x32_bf16 v[120:123], a[108:111], v[40:43], v[96:99]
    v_cvt_pk_bf16_f32 v79, v150, v151
    v_mfma_f32_16x16x32_bf16 v[120:123], a[120:123], v[44:47], v[120:123]
    s_waitcnt lgkmcnt(1)
    buffer_store_dwordx4 v[92:95], v18, s[20:23], s35 offen offset:2048 sc1
    ds_write_b64 v13, v[78:79] offset:0
    v_mfma_f32_16x16x32_bf16 v[120:123], a[132:135], v[48:51], v[120:123]
    s_add_u32 s35, s35, 196608
    v_mfma_f32_16x16x32_bf16 v[124:127], a[112:115], v[40:43], v[100:103]
    v_mfma_f32_16x16x32_bf16 v[124:127], a[124:127], v[44:47], v[124:127]
    v_mfma_f32_16x16x32_bf16 v[124:127], a[136:139], v[48:51], v[124:127]
    v_mfma_f32_16x16x32_bf16 v[128:131], a[116:119], v[40:43], v[104:107]
    ds_read_b128 v[40:43], v9 offset:3072
    v_mfma_f32_16x16x32_bf16 v[128:131], a[128:131], v[44:47], v[128:131]
    ds_read_b128 v[44:47], v9 offset:3136
    v_mfma_f32_16x16x32_bf16 v[128:131], a[140:143], v[48:51], v[128:131]
    v_cvt_pk_bf16_f32 v80, v152, v153
    ds_read_b128 v[48:51], v9 offset:3200
    v_mfma_f32_16x16x32_bf16 v[120:123], a[144:147], v[52:55], v[120:123]
    v_cvt_pk_bf16_f32 v81, v154, v155
    v_mfma_f32_16x16x32_bf16 v[120:123], a[156:159], v[56:59], v[120:123]
    ds_write_b64 v14, v[80:81] offset:0
    v_mfma_f32_16x16x32_bf16 v[120:123], a[168:171], v[60:63], v[120:123]
    v_mfma_f32_16x16x32_bf16 v[124:127], a[148:151], v[52:55], v[124:127]
    v_mfma_f32_16x16x32_bf16 v[124:127], a[160:163], v[56:59], v[124:127]
    v_mfma_f32_16x16x32_bf16 v[124:127], a[172:175], v[60:63], v[124:127]
    v_mfma_f32_16x16x32_bf16 v[128:131], a[152:155], v[52:55], v[128:131]
    ds_read_b128 v[52:55], v10 offset:3072
    v_mfma_f32_16x16x32_bf16 v[128:131], a[164:167], v[56:59], v[128:131]
    ds_read_b128 v[56:59], v10 offset:3136
    v_mfma_f32_16x16x32_bf16 v[128:131], a[176:179], v[60:63], v[128:131]
    ds_read_b128 v[60:63], v10 offset:3200
    v_mfma_f32_16x16x32_bf16 v[120:123], a[180:183], v[64:67], v[120:123]
    v_mfma_f32_16x16x32_bf16 v[120:123], a[192:195], v[68:71], v[120:123]
    v_mfma_f32_16x16x32_bf16 v[120:123], a[204:207], v[72:75], v[120:123]
    v_mfma_f32_16x16x32_bf16 v[124:127], a[184:187], v[64:67], v[124:127]
    v_mfma_f32_16x16x32_bf16 v[124:127], a[196:199], v[68:71], v[124:127]
    v_mfma_f32_16x16x32_bf16 v[124:127], a[208:211], v[72:75], v[124:127]
    v_mfma_f32_16x16x32_bf16 v[128:131], a[188:191], v[64:67], v[128:131]
    ds_read_b128 v[64:67], v11 offset:3072
    v_mfma_f32_16x16x32_bf16 v[128:131], a[200:203], v[68:71], v[128:131]
    ds_read_b128 v[68:71], v11 offset:3136
    v_mfma_f32_16x16x32_bf16 v[128:131], a[212:215], v[72:75], v[128:131]
    ds_read_b128 v[72:75], v11 offset:3200
    s_waitcnt lgkmcnt(7)
    v_mfma_f32_16x16x32_bf16 v[156:159], a[216:219], v[40:43], v[132:135]
    v_mfma_f32_16x16x32_bf16 v[156:159], a[228:231], v[44:47], v[156:159]
    v_mfma_f32_16x16x32_bf16 v[156:159], a[240:243], v[48:51], v[156:159]
    s_waitcnt lgkmcnt(3)
    v_mfma_f32_16x16x32_bf16 v[156:159], a[252:255], v[52:55], v[156:159]
    v_mfma_f32_16x16x32_bf16 v[156:159], v[176:179], v[56:59], v[156:159]
    v_mfma_f32_16x16x32_bf16 v[156:159], v[188:191], v[60:63], v[156:159]
    s_waitcnt lgkmcnt(0)
    v_mfma_f32_16x16x32_bf16 v[156:159], v[200:203], v[64:67], v[156:159]
    v_mfma_f32_16x16x32_bf16 v[156:159], v[212:215], v[68:71], v[156:159]
    v_mfma_f32_16x16x32_bf16 v[156:159], v[224:227], v[72:75], v[156:159]
    v_mfma_f32_16x16x32_bf16 v[160:163], a[220:223], v[40:43], v[136:139]
    s_add_u32 s30, s30, 13312
    v_mfma_f32_16x16x32_bf16 v[160:163], a[232:235], v[44:47], v[160:163]
    s_cmp_eq_u32 s30, 53248
    v_mfma_f32_16x16x32_bf16 v[160:163], a[244:247], v[48:51], v[160:163]
    s_cselect_b32 s30, 0, s30
    v_mfma_f32_16x16x32_bf16 v[160:163], v[168:171], v[52:55], v[160:163]
    v_add_u32 v9, s30, v6
    v_mfma_f32_16x16x32_bf16 v[160:163], v[180:183], v[56:59], v[160:163]
    v_add_u32 v10, s30, v7
    v_mfma_f32_16x16x32_bf16 v[160:163], v[192:195], v[60:63], v[160:163]
    v_add_u32 v11, s30, v8
    v_mfma_f32_16x16x32_bf16 v[160:163], v[204:207], v[64:67], v[160:163]
    v_mfma_f32_16x16x32_bf16 v[160:163], v[216:219], v[68:71], v[160:163]
    v_mfma_f32_16x16x32_bf16 v[160:163], v[228:231], v[72:75], v[160:163]
    v_cvt_pk_bf16_f32 v76, v156, v157
    v_mfma_f32_16x16x32_bf16 v[164:167], a[224:227], v[40:43], v[140:143]
    v_cvt_pk_bf16_f32 v77, v158, v159
    v_mfma_f32_16x16x32_bf16 v[164:167], a[236:239], v[44:47], v[164:167]
    ds_write_b64 v12, v[76:77] offset:3072
    v_mfma_f32_16x16x32_bf16 v[164:167], a[248:251], v[48:51], v[164:167]
    v_mfma_f32_16x16x32_bf16 v[164:167], v[172:175], v[52:55], v[164:167]
    v_mfma_f32_16x16x32_bf16 v[164:167], v[184:187], v[56:59], v[164:167]
    v_mfma_f32_16x16x32_bf16 v[164:167], v[196:199], v[60:63], v[164:167]
    v_mfma_f32_16x16x32_bf16 v[164:167], v[208:211], v[64:67], v[164:167]
    v_mfma_f32_16x16x32_bf16 v[164:167], v[220:223], v[68:71], v[164:167]
    v_mfma_f32_16x16x32_bf16 v[164:167], v[232:235], v[72:75], v[164:167]
    v_cvt_pk_bf16_f32 v78, v160, v161
    v_mfma_f32_16x16x32_bf16 v[132:135], a[108:111], v[40:43], v[108:111]
    v_cvt_pk_bf16_f32 v79, v162, v163
    v_mfma_f32_16x16x32_bf16 v[132:135], a[120:123], v[44:47], v[132:135]
    ds_write_b64 v13, v[78:79] offset:3072
    v_mfma_f32_16x16x32_bf16 v[132:135], a[132:135], v[48:51], v[132:135]
    v_mfma_f32_16x16x32_bf16 v[136:139], a[112:115], v[40:43], v[112:115]
    v_mfma_f32_16x16x32_bf16 v[136:139], a[124:127], v[44:47], v[136:139]
    v_mfma_f32_16x16x32_bf16 v[136:139], a[136:139], v[48:51], v[136:139]
    v_mfma_f32_16x16x32_bf16 v[140:143], a[116:119], v[40:43], v[116:119]
    v_mfma_f32_16x16x32_bf16 v[140:143], a[128:131], v[44:47], v[140:143]
    v_mfma_f32_16x16x32_bf16 v[140:143], a[140:143], v[48:51], v[140:143]
    v_cvt_pk_bf16_f32 v80, v164, v165
    v_mfma_f32_16x16x32_bf16 v[132:135], a[144:147], v[52:55], v[132:135]
    v_cvt_pk_bf16_f32 v81, v166, v167
    v_mfma_f32_16x16x32_bf16 v[132:135], a[156:159], v[56:59], v[132:135]
    ds_write_b64 v14, v[80:81] offset:3072
    v_mfma_f32_16x16x32_bf16 v[132:135], a[168:171], v[60:63], v[132:135]
    v_mfma_f32_16x16x32_bf16 v[136:139], a[148:151], v[52:55], v[136:139]
    s_waitcnt vmcnt(10) lgkmcnt(0)
    s_barrier
    v_mfma_f32_16x16x32_bf16 v[136:139], a[160:163], v[56:59], v[136:139]
    ds_read_b128 v[40:43], v9 offset:0
    v_mfma_f32_16x16x32_bf16 v[136:139], a[172:175], v[60:63], v[136:139]
    ds_read_b128 v[44:47], v9 offset:64
    v_mfma_f32_16x16x32_bf16 v[140:143], a[152:155], v[52:55], v[140:143]
    ds_read_b128 v[48:51], v9 offset:128
    v_mfma_f32_16x16x32_bf16 v[140:143], a[164:167], v[56:59], v[140:143]
    ds_read_b128 v[52:55], v10 offset:0
    v_mfma_f32_16x16x32_bf16 v[140:143], a[176:179], v[60:63], v[140:143]
    ds_read_b128 v[56:59], v10 offset:64
    v_mfma_f32_16x16x32_bf16 v[132:135], a[180:183], v[64:67], v[132:135]
    ds_read_b128 v[60:63], v10 offset:128
    v_mfma_f32_16x16x32_bf16 v[132:135], a[192:195], v[68:71], v[132:135]
    v_mfma_f32_16x16x32_bf16 v[132:135], a[204:207], v[72:75], v[132:135]
    v_mfma_f32_16x16x32_bf16 v[136:139], a[184:187], v[64:67], v[136:139]
    v_mfma_f32_16x16x32_bf16 v[136:139], a[196:199], v[68:71], v[136:139]
    v_mfma_f32_16x16x32_bf16 v[136:139], a[208:211], v[72:75], v[136:139]
    v_mfma_f32_16x16x32_bf16 v[140:143], a[188:191], v[64:67], v[140:143]
    ds_read_b128 v[64:67], v11 offset:0
    v_mfma_f32_16x16x32_bf16 v[140:143], a[200:203], v[68:71], v[140:143]
    ds_read_b128 v[68:71], v11 offset:64
    v_mfma_f32_16x16x32_bf16 v[140:143], a[212:215], v[72:75], v[140:143]
    ds_read_b128 v[72:75], v11 offset:128
    s_waitcnt lgkmcnt(6)
    v_mfma_f32_16x16x32_bf16 v[144:147], a[216:219], v[40:43], v[120:123]
    v_xor_b32 v12, 0x4000, v12
    v_mfma_f32_16x16x32_bf16 v[144:147], a[228:231], v[44:47], v[144:147]
    v_xor_b32 v13, 0x4000, v13
    v_mfma_f32_16x16x32_bf16 v[144:147], a[240:243], v[48:51], v[144:147]
    v_xor_b32 v14, 0x4000, v14
    s_waitcnt lgkmcnt(3)
    v_mfma_f32_16x16x32_bf16 v[144:147], a[252:255], v[52:55], v[144:147]
    v_mfma_f32_16x16x32_bf16 v[144:147], v[176:179], v[56:59], v[144:147]
    v_mfma_f32_16x16x32_bf16 v[144:147], v[188:191], v[60:63], v[144:147]
    s_waitcnt lgkmcnt(0)
    v_mfma_f32_16x16x32_bf16 v[144:147], v[200:203], v[64:67], v[144:147]
    ds_read_b128 v[84:87], v15
    v_mfma_f32_16x16x32_bf16 v[144:147], v[212:215], v[68:71], v[144:147]
    ds_read_b128 v[88:91], v16
    v_mfma_f32_16x16x32_bf16 v[144:147], v[224:227], v[72:75], v[144:147]
    ds_read_b128 v[92:95], v17
    v_mfma_f32_16x16x32_bf16 v[148:151], a[220:223], v[40:43], v[124:127]
    v_xor_b32 v15, 0x4000, v15
    v_mfma_f32_16x16x32_bf16 v[148:151], a[232:235], v[44:47], v[148:151]
    v_xor_b32 v16, 0x4000, v16
    v_mfma_f32_16x16x32_bf16 v[148:151], a[244:247], v[48:51], v[148:151]
    v_xor_b32 v17, 0x4000, v17
    v_mfma_f32_16x16x32_bf16 v[148:151], v[168:171], v[52:55], v[148:151]
    s_waitcnt lgkmcnt(2)
    buffer_store_dwordx4 v[84:87], v18, s[20:23], s35 offen offset:0 sc1
    v_mfma_f32_16x16x32_bf16 v[148:151], v[180:183], v[56:59], v[148:151]
    v_mfma_f32_16x16x32_bf16 v[148:151], v[192:195], v[60:63], v[148:151]
    v_mfma_f32_16x16x32_bf16 v[148:151], v[204:207], v[64:67], v[148:151]
    v_mfma_f32_16x16x32_bf16 v[148:151], v[216:219], v[68:71], v[148:151]
    v_mfma_f32_16x16x32_bf16 v[148:151], v[228:231], v[72:75], v[148:151]
    v_cvt_pk_bf16_f32 v76, v144, v145
    v_mfma_f32_16x16x32_bf16 v[152:155], a[224:227], v[40:43], v[128:131]
    ds_read_b128 v[40:43], v9 offset:3072
    v_cvt_pk_bf16_f32 v77, v146, v147
    v_mfma_f32_16x16x32_bf16 v[152:155], a[236:239], v[44:47], v[152:155]
    ds_read_b128 v[44:47], v9 offset:3136
    ds_write_b64 v12, v[76:77] offset:0
    v_mfma_f32_16x16x32_bf16 v[152:155], a[248:251], v[48:51], v[152:155]
    s_waitcnt lgkmcnt(4)
    buffer_store_dwordx4 v[88:91], v18, s[20:23], s35 offen offset:1024 sc1
    ds_read_b128 v[48:51], v9 offset:3200
    v_mfma_f32_16x16x32_bf16 v[152:155], v[172:175], v[52:55], v[152:155]
    ds_read_b128 v[52:55], v10 offset:3072
    v_mfma_f32_16x16x32_bf16 v[152:155], v[184:187], v[56:59], v[152:155]
    ds_read_b128 v[56:59], v10 offset:3136
    v_mfma_f32_16x16x32_bf16 v[152:155], v[196:199], v[60:63], v[152:155]
    ds_read_b128 v[60:63], v10 offset:3200
    v_mfma_f32_16x16x32_bf16 v[152:155], v[208:211], v[64:67], v[152:155]
    ds_read_b128 v[64:67], v11 offset:3072
    v_mfma_f32_16x16x32_bf16 v[152:155], v[220:223], v[68:71], v[152:155]
    ds_read_b128 v[68:71], v11 offset:3136
    v_mfma_f32_16x16x32_bf16 v[152:155], v[232:235], v[72:75], v[152:155]
    ds_read_b128 v[72:75], v11 offset:3200
    v_cvt_pk_bf16_f32 v78, v148, v149
    s_waitcnt lgkmcnt(6)
    v_mfma_f32_16x16x32_bf16 v[156:159], a[216:219], v[40:43], v[132:135]
    v_cvt_pk_bf16_f32 v79, v150, v151
    v_mfma_f32_16x16x32_bf16 v[156:159], a[228:231], v[44:47], v[156:159]
    buffer_store_dwordx4 v[92:95], v18, s[20:23], s35 offen offset:2048 sc1
    ds_write_b64 v13, v[78:79] offset:0
    v_mfma_f32_16x16x32_bf16 v[156:159], a[240:243], v[48:51], v[156:159]
    s_add_u32 s35, s35, 196608
    s_waitcnt lgkmcnt(4)
    v_mfma_f32_16x16x32_bf16 v[156:159], a[252:255], v[52:55], v[156:159]
    v_mfma_f32_16x16x32_bf16 v[156:159], v[176:179], v[56:59], v[156:159]
    v_mfma_f32_16x16x32_bf16 v[156:159], v[188:191], v[60:63], v[156:159]
    s_waitcnt lgkmcnt(1)
    v_mfma_f32_16x16x32_bf16 v[156:159], v[200:203], v[64:67], v[156:159]
    v_mfma_f32_16x16x32_bf16 v[156:159], v[212:215], v[68:71], v[156:159]
    v_mfma_f32_16x16x32_bf16 v[156:159], v[224:227], v[72:75], v[156:159]
    v_cvt_pk_bf16_f32 v80, v152, v153
    v_mfma_f32_16x16x32_bf16 v[160:163], a[220:223], v[40:43], v[136:139]
    v_cvt_pk_bf16_f32 v81, v154, v155
    v_mfma_f32_16x16x32_bf16 v[160:163], a[232:235], v[44:47], v[160:163]
    ds_write_b64 v14, v[80:81] offset:0
    v_mfma_f32_16x16x32_bf16 v[160:163], a[244:247], v[48:51], v[160:163]
    v_mfma_f32_16x16x32_bf16 v[160:163], v[168:171], v[52:55], v[160:163]
    v_mfma_f32_16x16x32_bf16 v[160:163], v[180:183], v[56:59], v[160:163]
    v_mfma_f32_16x16x32_bf16 v[160:163], v[192:195], v[60:63], v[160:163]
    v_mfma_f32_16x16x32_bf16 v[160:163], v[204:207], v[64:67], v[160:163]
    v_mfma_f32_16x16x32_bf16 v[160:163], v[216:219], v[68:71], v[160:163]
    v_mfma_f32_16x16x32_bf16 v[160:163], v[228:231], v[72:75], v[160:163]
    v_cvt_pk_bf16_f32 v76, v156, v157
    v_mfma_f32_16x16x32_bf16 v[164:167], a[224:227], v[40:43], v[140:143]
    v_cvt_pk_bf16_f32 v77, v158, v159
    v_mfma_f32_16x16x32_bf16 v[164:167], a[236:239], v[44:47], v[164:167]
    ds_write_b64 v12, v[76:77] offset:3072
    v_mfma_f32_16x16x32_bf16 v[164:167], a[248:251], v[48:51], v[164:167]
    v_mfma_f32_16x16x32_bf16 v[164:167], v[172:175], v[52:55], v[164:167]
    v_mfma_f32_16x16x32_bf16 v[164:167], v[184:187], v[56:59], v[164:167]
    v_mfma_f32_16x16x32_bf16 v[164:167], v[196:199], v[60:63], v[164:167]
    v_mfma_f32_16x16x32_bf16 v[164:167], v[208:211], v[64:67], v[164:167]
    v_mfma_f32_16x16x32_bf16 v[164:167], v[220:223], v[68:71], v[164:167]
    v_mfma_f32_16x16x32_bf16 v[164:167], v[232:235], v[72:75], v[164:167]
    v_cvt_pk_bf16_f32 v78, v160, v161
    s_nop 7
    v_cvt_pk_bf16_f32 v79, v162, v163
    ds_write_b64 v13, v[78:79] offset:3072
    v_cvt_pk_bf16_f32 v80, v164, v165
    v_cvt_pk_bf16_f32 v81, v166, v167
    ds_write_b64 v14, v[80:81] offset:3072
    s_waitcnt lgkmcnt(0)
    s_barrier
    ds_read_b128 v[84:87], v15
    ds_read_b128 v[88:91], v16
    ds_read_b128 v[92:95], v17
    s_waitcnt lgkmcnt(2)
    buffer_store_dwordx4 v[84:87], v18, s[20:23], s35 offen offset:0 sc1
    s_waitcnt lgkmcnt(1)
    buffer_store_dwordx4 v[88:91], v18, s[20:23], s35 offen offset:1024 sc1
    s_waitcnt lgkmcnt(0)
    buffer_store_dwordx4 v[92:95], v18, s[20:23], s35 offen offset:2048 sc1
L_end:
    s_endpgm
L_slow:
    s_mov_b32 s38, 0
L_slowx:
    ds_read_b128 v[236:239], v244
    s_waitcnt lgkmcnt(0)
    v_min3_u32 v245, v236, v237, v238
    v_min_u32 v245, v245, v239
    s_add_u32 s38, s38, 1
    v_readfirstlane_b32 s57, v245
    s_cmp_gt_u32 s38, 0x40000
    s_cbranch_scc1 L_back
    s_cmp_ge_u32 s57, s63
    s_cbranch_scc0 L_slowx
    s_branch L_back
L_codeend:
.section .rodata,"a"
.p2align 6
.amdhsa_kernel standalone__dilated_atrous__vision_kernel
  .amdhsa_next_free_vgpr 512
  .amdhsa_next_free_sgpr 100
  .amdhsa_accum_offset 256
  .amdhsa_group_segment_fixed_size 0
  .amdhsa_kernarg_size 40
  .amdhsa_user_sgpr_count 2
  .amdhsa_user_sgpr_kernarg_segment_ptr 1
  .amdhsa_system_sgpr_workgroup_id_x 1
.end_amdhsa_kernel
```

```asm
; @launch grid=(256,1,1) block=(256,1,1) lds=163840
.amdgcn_target "amdgcn-amd-amdhsa--gfx950"
.text
.globl standalone__dilated_atrous__vision_kernel
.p2align 8
.type standalone__dilated_atrous__vision_kernel,@function
standalone__dilated_atrous__vision_kernel:
    s_cmp_ge_u32 s2, 256
    s_cbranch_scc1 L_end
    s_load_dwordx4 s[4:7], s[0:1], 0
    s_load_dwordx2 s[8:9], s[0:1], 16
    v_lshrrev_b32 v29, 6, v0
    s_and_b32 s37, s2, 7
    v_readfirstlane_b32 s24, v29
    s_lshr_b32 s38, s2, 3
    s_and_b32 s38, s38, 1
    s_lshr_b32 s39, s2, 4
    s_lshl_b32 s39, s39, 5
    s_add_u32 s25, s39, s38
    s_mul_i32 s40, s37, 12288
    s_sub_u32 s41, s40, 384
    v_mul_u32_u24 v31, 43691, v0
    v_lshlrev_b32 v32, 4, v0
    v_lshrrev_b32 v31, 19, v31
    v_and_b32 v33, 4, v31
    v_and_b32 v34, 8, v31
    v_lshlrev_b32 v33, 3, v33
    v_lshlrev_b32 v34, 2, v34
    v_xor_b32 v33, v33, v32
    v_xor_b32 v19, v34, v32
    v_add_u32 v2, s41, v33
    v_add_u32 v30, 256, v0
    v_mul_u32_u24 v31, 43691, v30
    v_lshlrev_b32 v32, 4, v30
    v_lshrrev_b32 v31, 19, v31
    v_and_b32 v33, 4, v31
    v_and_b32 v34, 8, v31
    v_lshlrev_b32 v33, 3, v33
    v_lshlrev_b32 v34, 2, v34
    v_xor_b32 v33, v33, v32
    v_xor_b32 v20, v34, v32
    v_add_u32 v3, s41, v33
    v_add_u32 v30, 512, v0
    v_mul_u32_u24 v31, 43691, v30
    v_lshlrev_b32 v32, 4, v30
    v_lshrrev_b32 v31, 19, v31
    v_and_b32 v33, 4, v31
    v_and_b32 v34, 8, v31
    v_lshlrev_b32 v33, 3, v33
    v_lshlrev_b32 v34, 2, v34
    v_xor_b32 v33, v33, v32
    v_xor_b32 v21, v34, v32
    v_add_u32 v4, s41, v33
    s_cmp_eq_u32 s37, 0
    s_cselect_b32 s42, 24, 0
    v_mov_b32 v35, 0x80000000
    v_cmp_gt_u32 vcc, s42, v0
    v_and_b32 v36, 63, v0
    s_lshl_b32 s26, s24, 10
    v_cndmask_b32 v2, v2, v35, vcc
    s_add_u32 s27, s26, 4096
    s_add_u32 s28, s26, 8192
    s_mov_b32 s29, 12288
    s_cmp_eq_u32 s37, 7
    s_cselect_b32 s45, 24, 48
    s_add_u32 s44, s41, 12288
    v_cmp_gt_u32 vcc, s45, v36
    v_lshlrev_b32 v29, 4, v36
    v_add_u32 v29, s44, v29
    v_cndmask_b32 v5, v35, v29, vcc
    s_lshl_b32 s47, s24, 9
    s_mul_i32 s43, s24, 192
    s_add_u32 s62, s43, 12288
    s_add_u32 s44, s41, s62
    s_lshl_b32 s45, s37, 2
    s_add_u32 s45, s45, s24
    s_cmp_ge_u32 s45, 30
    s_cselect_b32 s44, 0x80000000, s44
    v_lshlrev_b32 v29, 4, v36
    v_add_u32 v1, s44, v29
    s_lshr_b32 s45, s2, 3
    s_lshl_b32 s45, s45, 2
    s_add_u32 s45, s45, s24
    s_mul_i32 s45, s45, 1408
    v_lshl_add_u32 v39, v36, 7, s45
    s_mov_b32 s33, s25
    s_mul_i32 s32, s33, 98304
    s_add_u32 s34, s25, 33
    s_min_u32 s34, s34, 512
    s_mov_b32 s14, 50331648
    s_mov_b32 s15, 0x20000
    s_mov_b32 s18, 165888
    s_mov_b32 s19, 0x20000
    s_mov_b32 s30, 0
    s_mov_b32 s31, 0
    s_waitcnt lgkmcnt(0)
    s_mov_b32 s12, s4
    s_and_b32 s13, s5, 0xffff
    s_add_u32 m0, s31, s26
    s_nop 0
    buffer_load_dwordx4 v2, s[12:15], s32 offen nt lds
    s_add_u32 m0, s31, s27
    s_nop 0
    buffer_load_dwordx4 v3, s[12:15], s32 offen nt lds
    s_add_u32 m0, s31, s28
    s_nop 0
    buffer_load_dwordx4 v4, s[12:15], s32 offen nt lds
    s_add_u32 m0, s31, s62
    s_nop 0
    s_mov_b64 exec, 0xfff
    buffer_load_dwordx4 v1, s[12:15], s32 offen nt lds
    s_mov_b64 exec, -1
    s_mov_b32 s16, s6
    s_and_b32 s17, s7, 0xffff
    s_lshl_b32 s42, s24, 5
    s_add_u32 s42, s42, 3328
    v_add_u32 v30, s42, v36
    v_mul_u32_u24 v31, 43691, v30
    v_lshlrev_b32 v32, 4, v30
    v_lshrrev_b32 v31, 19, v31
    v_and_b32 v34, 8, v31
    v_lshlrev_b32 v34, 2, v34
    v_xor_b32 v22, v34, v32
    s_add_u32 m0, s26, 53248
    s_mov_b32 s46, 0
    buffer_load_dwordx4 v19, s[16:19], s46 offen lds
    s_add_u32 m0, s26, 57344
    s_nop 0
    buffer_load_dwordx4 v20, s[16:19], s46 offen lds
    s_add_u32 m0, s26, 61440
    s_nop 0
    buffer_load_dwordx4 v21, s[16:19], s46 offen lds
    s_add_u32 m0, s26, 65536
    s_mov_b32 s46, 12288
    buffer_load_dwordx4 v19, s[16:19], s46 offen lds
    s_add_u32 m0, s26, 69632
    s_nop 0
    buffer_load_dwordx4 v20, s[16:19], s46 offen lds
    s_mov_b32 s16, s6
    s_and_b32 s17, s7, 0xffff
    s_mov_b64 exec, 0x7ff
    buffer_load_dword v38, v39, s[16:19], 0 offen
    s_mov_b64 exec, -1
    v_and_b32 v29, 15, v36
    v_lshrrev_b32 v30, 4, v36
    s_lshr_b32 s42, s24, 1
    s_and_b32 s43, s24, 1
    s_lshl_b32 s42, s42, 5
    s_mul_i32 s43, s43, 96
    v_lshlrev_b32 v31, 4, v30
    v_add_u32 v32, s42, v29
    v_and_b32 v33, 4, v32
    v_mul_u32_u24 v34, 192, v32
    v_lshlrev_b32 v33, 3, v33
    v_xor_b32 v33, v33, v31
    v_add_u32 v6, v34, v33
    v_mov_b32 v9, v6
    v_add_u32 v32, s42, v29
    v_add_u32 v32, 2, v32
    v_and_b32 v33, 4, v32
    v_mul_u32_u24 v34, 192, v32
    v_lshlrev_b32 v33, 3, v33
    v_xor_b32 v33, v33, v31
    v_add_u32 v7, v34, v33
    v_mov_b32 v10, v7
    v_add_u32 v32, s42, v29
    v_add_u32 v32, 4, v32
    v_and_b32 v33, 4, v32
    v_mul_u32_u24 v34, 192, v32
    v_lshlrev_b32 v33, 3, v33
    v_xor_b32 v33, v33, v31
    v_add_u32 v8, v34, v33
    v_mov_b32 v11, v8
    v_lshrrev_b32 v32, 2, v29
    v_lshl_add_u32 v32, v30, 3, v32
    v_mul_u32_u24 v32, 192, v32
    v_and_b32 v33, 3, v29
    v_lshlrev_b32 v33, 3, v33
    v_and_b32 v34, 1, v30
    v_lshlrev_b32 v34, 5, v34
    v_add_u32 v33, s43, v33
    v_add_u32 v35, 0, v33
    v_xor_b32 v35, v35, v34
    v_add_u32 v35, v35, v32
    v_add_u32 v23, 53248, v35
    v_add_u32 v26, 108544, v35
    v_add_u32 v35, 32, v33
    v_xor_b32 v35, v35, v34
    v_add_u32 v35, v35, v32
    v_add_u32 v24, 53248, v35
    v_add_u32 v27, 108544, v35
    v_add_u32 v35, 64, v33
    v_xor_b32 v35, v35, v34
    v_add_u32 v35, v35, v32
    v_add_u32 v25, 53248, v35
    v_add_u32 v28, 108544, v35
    v_add_u32 v32, s42, v29
    v_mul_u32_u24 v32, 192, v32
    v_add_u32 v32, 65536, v32
    v_lshlrev_b32 v33, 3, v29
    v_and_b32 v33, 0x30, v33
    v_lshlrev_b32 v34, 3, v30
    v_add_u32 v34, s43, v34
    v_add_u32 v35, 0, v34
    v_xor_b32 v35, v35, v33
    v_add_u32 v12, v35, v32
    v_add_u32 v35, 32, v34
    v_xor_b32 v35, v35, v33
    v_add_u32 v13, v35, v32
    v_add_u32 v35, 64, v34
    v_xor_b32 v35, v35, v33
    v_add_u32 v14, v35, v32
    s_mul_i32 s44, s24, 192
    v_add_u32 v32, s44, v36
    v_mul_u32_u24 v33, 43691, v32
    v_lshlrev_b32 v34, 4, v32
    v_lshrrev_b32 v33, 16, v33
    v_and_b32 v33, 0x30, v33
    v_xor_b32 v34, v34, v33
    v_add_u32 v15, 65536, v34
    v_add_u32 v32, s44, v36
    v_add_u32 v32, 64, v32
    v_mul_u32_u24 v33, 43691, v32
    v_lshlrev_b32 v34, 4, v32
    v_lshrrev_b32 v33, 16, v33
    v_and_b32 v33, 0x30, v33
    v_xor_b32 v34, v34, v33
    v_add_u32 v16, 65536, v34
    v_add_u32 v32, s44, v36
    v_add_u32 v32, 128, v32
    v_mul_u32_u24 v33, 43691, v32
    v_lshlrev_b32 v34, 4, v32
    v_lshrrev_b32 v33, 16, v33
    v_and_b32 v33, 0x30, v33
    v_xor_b32 v34, v34, v33
    v_add_u32 v17, 65536, v34
    s_lshl_b32 s45, s24, 8
    v_lshlrev_b32 v32, 2, v36
    v_add_u32 v32, s45, v32
    v_add_u32 v242, 108608, v32
    s_lshl_b32 s45, s24, 2
    s_add_u32 s45, s45, 108544
    v_cmp_eq_u32 vcc, 0, v36
    v_mov_b32 v32, s45
    v_mov_b32 v244, 108544
    v_cndmask_b32 v242, v242, v32, vcc
    v_mov_b32 v243, 2
    s_mov_b32 s63, 2
    s_mul_i32 s45, s24, 3072
    s_add_u32 s45, s45, s40
    v_lshlrev_b32 v32, 4, v36
    v_add_u32 v18, s45, v32
    s_mov_b32 s20, s8
    s_and_b32 s21, s9, 0xffff
    s_mov_b32 s22, 50331648
    s_mov_b32 s23, 0x20000
    s_mul_i32 s35, s25, 98304
    s_add_u32 m0, s26, 73728
    s_nop 0
    buffer_load_dwordx4 v21, s[16:19], s46 offen lds
    s_add_u32 m0, s26, 77824
    s_mov_b32 s46, 24576
    buffer_load_dwordx4 v19, s[16:19], s46 offen lds
    s_add_u32 m0, s26, 81920
    s_nop 0
    buffer_load_dwordx4 v20, s[16:19], s46 offen lds
    s_add_u32 m0, s26, 86016
    s_nop 0
    buffer_load_dwordx4 v21, s[16:19], s46 offen lds
    s_add_u32 m0, s26, 90112
    s_mov_b32 s46, 36864
    buffer_load_dwordx4 v19, s[16:19], s46 offen lds
    s_add_u32 m0, s26, 94208
    s_nop 0
    buffer_load_dwordx4 v20, s[16:19], s46 offen lds
    s_add_u32 m0, s26, 98304
    s_nop 0
    buffer_load_dwordx4 v21, s[16:19], s46 offen lds
    s_add_u32 m0, s26, 102400
    s_mov_b32 s46, 49152
    buffer_load_dwordx4 v19, s[16:19], s46 offen lds
    s_waitcnt vmcnt(9)
    s_barrier
    ds_read_b128 v[40:43], v6 offset:0
    ds_read_b64_tr_b16 a[0:1], v23 offset:0
    ds_read_b64_tr_b16 a[2:3], v23 offset:768
    ds_read_b128 v[44:47], v6 offset:64
    ds_read_b64_tr_b16 a[12:13], v23 offset:6144
    ds_read_b64_tr_b16 a[14:15], v23 offset:6912
    ds_read_b128 v[48:51], v6 offset:128
    ds_read_b64_tr_b16 a[24:25], v23 offset:12288
    ds_read_b64_tr_b16 a[26:27], v23 offset:13056
    ds_read_b64_tr_b16 a[4:5], v24 offset:0
    ds_read_b64_tr_b16 a[6:7], v24 offset:768
    s_waitcnt lgkmcnt(2)
    v_mfma_f32_16x16x32_bf16 v[120:123], a[0:3], v[40:43], 0
    s_add_u32 m0, s47, 106496
    s_mov_b32 s46, 0
    ds_read_b64_tr_b16 a[16:17], v24 offset:6144
    ds_read_b64_tr_b16 a[18:19], v24 offset:6912
    v_mfma_f32_16x16x32_bf16 v[120:123], a[12:15], v[44:47], v[120:123]
    ds_read_b128 v[84:87], v6 offset:3072
    s_mov_b32 exec_hi, 0
    buffer_load_dwordx4 v22, s[16:19], s46 offen lds
    s_mov_b64 exec, -1
    s_add_u32 m0, s26, 108544
    s_mov_b32 s46, 55296
    ds_read_b64_tr_b16 a[28:29], v24 offset:12288
    ds_read_b64_tr_b16 a[30:31], v24 offset:13056
    v_mfma_f32_16x16x32_bf16 v[120:123], a[24:27], v[48:51], v[120:123]
    ds_read_b128 v[88:91], v6 offset:3136
    buffer_load_dwordx4 v19, s[16:19], s46 offen lds
    ds_read_b64_tr_b16 a[8:9], v25 offset:0
    ds_read_b64_tr_b16 a[10:11], v25 offset:768
    s_waitcnt lgkmcnt(3)
    v_mfma_f32_16x16x32_bf16 v[124:127], a[4:7], v[40:43], 0
    ds_read_b128 v[92:95], v6 offset:3200
    s_add_u32 m0, s26, 112640
    ds_read_b64_tr_b16 a[20:21], v25 offset:6144
    ds_read_b64_tr_b16 a[22:23], v25 offset:6912
    v_mfma_f32_16x16x32_bf16 v[124:127], a[16:19], v[44:47], v[124:127]
    buffer_load_dwordx4 v20, s[16:19], s46 offen lds
    ds_read_b64_tr_b16 a[32:33], v25 offset:12288
    ds_read_b64_tr_b16 a[34:35], v25 offset:13056
    v_mfma_f32_16x16x32_bf16 v[124:127], a[28:31], v[48:51], v[124:127]
    s_add_u32 m0, s26, 116736
    s_waitcnt lgkmcnt(0)
    v_mfma_f32_16x16x32_bf16 v[128:131], a[8:11], v[40:43], 0
    s_waitcnt vmcnt(7)
    s_barrier
    ds_read_b64_tr_b16 a[36:37], v23 offset:18432
    v_mfma_f32_16x16x32_bf16 v[128:131], a[20:23], v[44:47], v[128:131]
    ds_read_b64_tr_b16 a[38:39], v23 offset:19200
    buffer_load_dwordx4 v21, s[16:19], s46 offen lds
    ds_read_b64_tr_b16 a[48:49], v23 offset:24576
    v_mfma_f32_16x16x32_bf16 v[128:131], a[32:35], v[48:51], v[128:131]
    ds_read_b64_tr_b16 a[50:51], v23 offset:25344
    ds_read_b128 v[52:55], v7 offset:0
    v_mfma_f32_16x16x32_bf16 v[132:135], a[0:3], v[84:87], 0
    s_add_u32 m0, s26, 120832
    s_mov_b32 s46, 67584
    ds_read_b64_tr_b16 a[60:61], v23 offset:30720
    v_mfma_f32_16x16x32_bf16 v[132:135], a[12:15], v[88:91], v[132:135]
    ds_read_b64_tr_b16 a[62:63], v23 offset:31488
    ds_read_b128 v[56:59], v7 offset:64
    buffer_load_dwordx4 v19, s[16:19], s46 offen lds
    v_mfma_f32_16x16x32_bf16 v[132:135], a[24:27], v[92:95], v[132:135]
    ds_read_b64_tr_b16 a[40:41], v24 offset:18432
    ds_read_b64_tr_b16 a[42:43], v24 offset:19200
    ds_read_b128 v[60:63], v7 offset:128
    v_mfma_f32_16x16x32_bf16 v[136:139], a[4:7], v[84:87], 0
    s_add_u32 m0, s26, 124928
    ds_read_b64_tr_b16 a[52:53], v24 offset:24576
    ds_read_b64_tr_b16 a[54:55], v24 offset:25344
    v_mfma_f32_16x16x32_bf16 v[136:139], a[16:19], v[88:91], v[136:139]
    buffer_load_dwordx4 v20, s[16:19], s46 offen lds
    ds_read_b64_tr_b16 a[64:65], v24 offset:30720
    ds_read_b64_tr_b16 a[66:67], v24 offset:31488
    v_mfma_f32_16x16x32_bf16 v[136:139], a[28:31], v[92:95], v[136:139]
    ds_read_b128 v[96:99], v7 offset:3072
    s_add_u32 m0, s26, 129024
    ds_read_b64_tr_b16 a[44:45], v25 offset:18432
    v_mfma_f32_16x16x32_bf16 v[140:143], a[8:11], v[84:87], 0
    ds_read_b64_tr_b16 a[46:47], v25 offset:19200
    ds_read_b128 v[100:103], v7 offset:3136
    buffer_load_dwordx4 v21, s[16:19], s46 offen lds
    v_mfma_f32_16x16x32_bf16 v[140:143], a[20:23], v[88:91], v[140:143]
    ds_read_b64_tr_b16 a[56:57], v25 offset:24576
    ds_read_b64_tr_b16 a[58:59], v25 offset:25344
    ds_read_b128 v[104:107], v7 offset:3200
    v_mfma_f32_16x16x32_bf16 v[140:143], a[32:35], v[92:95], v[140:143]
    s_add_u32 m0, s26, 133120
    s_mov_b32 s46, 79872
    s_waitcnt lgkmcnt(11)
    v_mfma_f32_16x16x32_bf16 v[120:123], a[36:39], v[52:55], v[120:123]
    ds_read_b64_tr_b16 a[68:69], v25 offset:30720
    ds_read_b64_tr_b16 a[70:71], v25 offset:31488
    buffer_load_dwordx4 v19, s[16:19], s46 offen lds
    v_mfma_f32_16x16x32_bf16 v[120:123], a[48:51], v[56:59], v[120:123]
    s_add_u32 m0, s26, 137216
    v_mfma_f32_16x16x32_bf16 v[120:123], a[60:63], v[60:63], v[120:123]
    buffer_load_dwordx4 v20, s[16:19], s46 offen lds
    s_add_u32 m0, s26, 141312
    s_waitcnt lgkmcnt(9)
    v_mfma_f32_16x16x32_bf16 v[124:127], a[40:43], v[52:55], v[124:127]
    buffer_load_dwordx4 v21, s[16:19], s46 offen lds
    s_add_u32 m0, s26, 145408
    s_mov_b32 s46, 92160
    v_mfma_f32_16x16x32_bf16 v[124:127], a[52:55], v[56:59], v[124:127]
    buffer_load_dwordx4 v19, s[16:19], s46 offen lds
    s_add_u32 m0, s26, 149504
    v_mfma_f32_16x16x32_bf16 v[124:127], a[64:67], v[60:63], v[124:127]
    buffer_load_dwordx4 v20, s[16:19], s46 offen lds
    s_add_u32 m0, s26, 153600
    s_waitcnt lgkmcnt(0)
    v_mfma_f32_16x16x32_bf16 v[128:131], a[44:47], v[52:55], v[128:131]
    s_waitcnt vmcnt(11)
    s_barrier
    ds_read_b64_tr_b16 a[72:73], v23 offset:36864
    v_mfma_f32_16x16x32_bf16 v[128:131], a[56:59], v[56:59], v[128:131]
    ds_read_b64_tr_b16 a[74:75], v23 offset:37632
    buffer_load_dwordx4 v21, s[16:19], s46 offen lds
    ds_read_b64_tr_b16 a[84:85], v23 offset:43008
    v_mfma_f32_16x16x32_bf16 v[128:131], a[68:71], v[60:63], v[128:131]
    ds_read_b64_tr_b16 a[86:87], v23 offset:43776
    ds_read_b128 v[64:67], v8 offset:0
    v_mfma_f32_16x16x32_bf16 v[132:135], a[36:39], v[96:99], v[132:135]
    s_add_u32 m0, s26, 157696
    s_mov_b32 s46, 104448
    ds_read_b64_tr_b16 a[96:97], v23 offset:49152
    v_mfma_f32_16x16x32_bf16 v[132:135], a[48:51], v[100:103], v[132:135]
    ds_read_b64_tr_b16 a[98:99], v23 offset:49920
    ds_read_b128 v[68:71], v8 offset:64
    buffer_load_dwordx4 v19, s[16:19], s46 offen lds
    v_mfma_f32_16x16x32_bf16 v[132:135], a[60:63], v[104:107], v[132:135]
    ds_read_b64_tr_b16 a[76:77], v24 offset:36864
    ds_read_b64_tr_b16 a[78:79], v24 offset:37632
    ds_read_b128 v[72:75], v8 offset:128
    v_mfma_f32_16x16x32_bf16 v[136:139], a[40:43], v[96:99], v[136:139]
    s_add_u32 m0, s47, 161792
    s_mov_b32 s46, 55296
    ds_read_b64_tr_b16 a[88:89], v24 offset:43008
    v_mfma_f32_16x16x32_bf16 v[136:139], a[52:55], v[100:103], v[136:139]
    ds_read_b64_tr_b16 a[90:91], v24 offset:43776
    v_mfma_f32_16x16x32_bf16 v[136:139], a[64:67], v[104:107], v[136:139]
    s_mov_b32 exec_hi, 0
    buffer_load_dwordx4 v22, s[16:19], s46 offen lds
    s_mov_b64 exec, -1
    v_mfma_f32_16x16x32_bf16 v[140:143], a[44:47], v[96:99], v[140:143]
    ds_read_b64_tr_b16 a[100:101], v24 offset:49152
    ds_read_b64_tr_b16 a[102:103], v24 offset:49920
    ds_read_b128 v[108:111], v8 offset:3072
    v_mfma_f32_16x16x32_bf16 v[140:143], a[56:59], v[100:103], v[140:143]
    s_add_u32 s32, s32, 196608
    s_add_u32 s33, s33, 2
    v_mfma_f32_16x16x32_bf16 v[140:143], a[68:71], v[104:107], v[140:143]
    s_cmp_lt_u32 s33, s34
    s_cselect_b32 s14, 50331648, 0
    s_waitcnt lgkmcnt(5)
    v_mfma_f32_16x16x32_bf16 v[120:123], a[72:75], v[64:67], v[120:123]
    s_add_u32 s31, s31, 13312
    s_cmp_eq_u32 s31, 53248
    s_cselect_b32 s31, 0, s31
    ds_read_b64_tr_b16 a[80:81], v25 offset:36864
    ds_read_b64_tr_b16 a[82:83], v25 offset:37632
    ds_read_b128 v[112:115], v8 offset:3136
    s_add_u32 m0, s31, s26
    ds_read_b64_tr_b16 a[92:93], v25 offset:43008
    ds_read_b64_tr_b16 a[94:95], v25 offset:43776
    ds_read_b128 v[116:119], v8 offset:3200
    buffer_load_dwordx4 v2, s[12:15], s32 offen nt lds
    ds_read_b64_tr_b16 a[104:105], v25 offset:49152
    ds_read_b64_tr_b16 a[106:107], v25 offset:49920
    v_mfma_f32_16x16x32_bf16 v[120:123], a[84:87], v[68:71], v[120:123]
    s_add_u32 m0, s31, s27
    v_mfma_f32_16x16x32_bf16 v[120:123], a[96:99], v[72:75], v[120:123]
    buffer_load_dwordx4 v3, s[12:15], s32 offen nt lds
    s_add_u32 m0, s31, s28
    s_waitcnt lgkmcnt(9)
    v_mfma_f32_16x16x32_bf16 v[124:127], a[76:79], v[64:67], v[124:127]
    buffer_load_dwordx4 v4, s[12:15], s32 offen nt lds
    s_add_u32 m0, s31, s29
    v_mfma_f32_16x16x32_bf16 v[124:127], a[88:91], v[68:71], v[124:127]
    buffer_load_dwordx4 v5, s[12:15], s32 offen nt lds
    v_mfma_f32_16x16x32_bf16 v[124:127], a[100:103], v[72:75], v[124:127]
    s_waitcnt vmcnt(13) lgkmcnt(0)
    s_barrier
    v_mfma_f32_16x16x32_bf16 v[128:131], a[80:83], v[64:67], v[128:131]
    ds_read_b64_tr_b16 a[108:109], v26 offset:0
    ds_read_b64_tr_b16 a[110:111], v26 offset:768
    ds_read_b64_tr_b16 a[120:121], v26 offset:6144
    v_mfma_f32_16x16x32_bf16 v[128:131], a[92:95], v[68:71], v[128:131]
    ds_read_b64_tr_b16 a[122:123], v26 offset:6912
    s_add_u32 m0, s26, 53248
    s_mov_b32 s46, 110592
    v_mfma_f32_16x16x32_bf16 v[128:131], a[104:107], v[72:75], v[128:131]
    ds_read_b64_tr_b16 a[132:133], v26 offset:12288
    ds_read_b64_tr_b16 a[134:135], v26 offset:13056
    v_mfma_f32_16x16x32_bf16 v[132:135], a[72:75], v[108:111], v[132:135]
    buffer_load_dwordx4 v19, s[16:19], s46 offen lds
    ds_read_b64_tr_b16 a[112:113], v27 offset:0
    ds_read_b64_tr_b16 a[114:115], v27 offset:768
    v_mfma_f32_16x16x32_bf16 v[132:135], a[84:87], v[112:115], v[132:135]
    ds_read_b64_tr_b16 a[124:125], v27 offset:6144
    ds_read_b64_tr_b16 a[126:127], v27 offset:6912
    s_add_u32 m0, s26, 57344
    v_mfma_f32_16x16x32_bf16 v[132:135], a[96:99], v[116:119], v[132:135]
    ds_read_b64_tr_b16 a[136:137], v27 offset:12288
    ds_read_b64_tr_b16 a[138:139], v27 offset:13056
    buffer_load_dwordx4 v20, s[16:19], s46 offen lds
    v_mfma_f32_16x16x32_bf16 v[136:139], a[76:79], v[108:111], v[136:139]
    ds_read_b64_tr_b16 a[116:117], v28 offset:0
    ds_read_b64_tr_b16 a[118:119], v28 offset:768
    ds_read_b64_tr_b16 a[128:129], v28 offset:6144
    v_mfma_f32_16x16x32_bf16 v[136:139], a[88:91], v[112:115], v[136:139]
    ds_read_b64_tr_b16 a[130:131], v28 offset:6912
    s_add_u32 m0, s26, 61440
    ds_read_b64_tr_b16 a[140:141], v28 offset:12288
    v_mfma_f32_16x16x32_bf16 v[136:139], a[100:103], v[116:119], v[136:139]
    ds_read_b64_tr_b16 a[142:143], v28 offset:13056
    buffer_load_dwordx4 v21, s[16:19], s46 offen lds
    v_mfma_f32_16x16x32_bf16 v[140:143], a[80:83], v[108:111], v[140:143]
    s_add_u32 m0, s26, 65536
    s_mov_b32 s46, 122880
    v_mfma_f32_16x16x32_bf16 v[140:143], a[92:95], v[112:115], v[140:143]
    buffer_load_dwordx4 v19, s[16:19], s46 offen lds
    v_mfma_f32_16x16x32_bf16 v[140:143], a[104:107], v[116:119], v[140:143]
    s_waitcnt lgkmcnt(12)
    v_mfma_f32_16x16x32_bf16 v[144:147], a[108:111], v[40:43], 0
    s_add_u32 m0, s26, 69632
    v_mfma_f32_16x16x32_bf16 v[144:147], a[120:123], v[44:47], v[144:147]
    buffer_load_dwordx4 v20, s[16:19], s46 offen lds
    v_mfma_f32_16x16x32_bf16 v[144:147], a[132:135], v[48:51], v[144:147]
    s_waitcnt lgkmcnt(6)
    v_mfma_f32_16x16x32_bf16 v[148:151], a[112:115], v[40:43], 0
    s_add_u32 m0, s26, 73728
    v_mfma_f32_16x16x32_bf16 v[148:151], a[124:127], v[44:47], v[148:151]
    buffer_load_dwordx4 v21, s[16:19], s46 offen lds
    v_mfma_f32_16x16x32_bf16 v[148:151], a[136:139], v[48:51], v[148:151]
    s_waitcnt vmcnt(15)
    s_barrier
    s_waitcnt lgkmcnt(0)
    v_mfma_f32_16x16x32_bf16 v[152:155], a[116:119], v[40:43], 0
    ds_read_b64_tr_b16 a[144:145], v26 offset:18432
    ds_read_b64_tr_b16 a[146:147], v26 offset:19200
    ds_read_b64_tr_b16 a[156:157], v26 offset:24576
    v_mfma_f32_16x16x32_bf16 v[152:155], a[128:131], v[44:47], v[152:155]
    ds_read_b64_tr_b16 a[158:159], v26 offset:25344
    s_add_u32 m0, s26, 77824
    s_mov_b32 s46, 135168
    v_mfma_f32_16x16x32_bf16 v[152:155], a[140:143], v[48:51], v[152:155]
    ds_read_b64_tr_b16 a[168:169], v26 offset:30720
    ds_read_b64_tr_b16 a[170:171], v26 offset:31488
    buffer_load_dwordx4 v19, s[16:19], s46 offen lds
    v_mfma_f32_16x16x32_bf16 v[156:159], a[108:111], v[84:87], 0
    ds_read_b64_tr_b16 a[148:149], v27 offset:18432
    ds_read_b64_tr_b16 a[150:151], v27 offset:19200
    ds_read_b64_tr_b16 a[160:161], v27 offset:24576
    v_mfma_f32_16x16x32_bf16 v[156:159], a[120:123], v[88:91], v[156:159]
    ds_read_b64_tr_b16 a[162:163], v27 offset:25344
    ds_read_b64_tr_b16 a[172:173], v27 offset:30720
    ds_read_b64_tr_b16 a[174:175], v27 offset:31488
    v_mfma_f32_16x16x32_bf16 v[156:159], a[132:135], v[92:95], v[156:159]
    ds_read_b64_tr_b16 a[152:153], v28 offset:18432
    ds_read_b64_tr_b16 a[154:155], v28 offset:19200
    v_mfma_f32_16x16x32_bf16 v[160:163], a[112:115], v[84:87], 0
    ds_read_b64_tr_b16 a[164:165], v28 offset:24576
    ds_read_b64_tr_b16 a[166:167], v28 offset:25344
    v_mfma_f32_16x16x32_bf16 v[160:163], a[124:127], v[88:91], v[160:163]
    ds_read_b64_tr_b16 a[176:177], v28 offset:30720
    ds_read_b64_tr_b16 a[178:179], v28 offset:31488
    v_mfma_f32_16x16x32_bf16 v[160:163], a[136:139], v[92:95], v[160:163]
    v_mfma_f32_16x16x32_bf16 v[164:167], a[116:119], v[84:87], 0
    v_mfma_f32_16x16x32_bf16 v[164:167], a[128:131], v[88:91], v[164:167]
    v_mfma_f32_16x16x32_bf16 v[164:167], a[140:143], v[92:95], v[164:167]
    s_waitcnt lgkmcnt(12)
    v_mfma_f32_16x16x32_bf16 v[144:147], a[144:147], v[52:55], v[144:147]
    v_mfma_f32_16x16x32_bf16 v[144:147], a[156:159], v[56:59], v[144:147]
    v_mfma_f32_16x16x32_bf16 v[144:147], a[168:171], v[60:63], v[144:147]
    s_waitcnt lgkmcnt(6)
    v_mfma_f32_16x16x32_bf16 v[148:151], a[148:151], v[52:55], v[148:151]
    v_mfma_f32_16x16x32_bf16 v[148:151], a[160:163], v[56:59], v[148:151]
    v_mfma_f32_16x16x32_bf16 v[148:151], a[172:175], v[60:63], v[148:151]
    s_waitcnt vmcnt(11)
    s_barrier
    s_waitcnt lgkmcnt(0)
    v_mfma_f32_16x16x32_bf16 v[152:155], a[152:155], v[52:55], v[152:155]
    ds_read_b64_tr_b16 a[180:181], v26 offset:36864
    ds_read_b64_tr_b16 a[182:183], v26 offset:37632
    ds_read_b64_tr_b16 a[192:193], v26 offset:43008
    v_mfma_f32_16x16x32_bf16 v[152:155], a[164:167], v[56:59], v[152:155]
    ds_read_b64_tr_b16 a[194:195], v26 offset:43776
    ds_read_b64_tr_b16 a[204:205], v26 offset:49152
    ds_read_b64_tr_b16 a[206:207], v26 offset:49920
    v_mfma_f32_16x16x32_bf16 v[152:155], a[176:179], v[60:63], v[152:155]
    ds_read_b64_tr_b16 a[184:185], v27 offset:36864
    ds_read_b64_tr_b16 a[186:187], v27 offset:37632
    v_mfma_f32_16x16x32_bf16 v[156:159], a[144:147], v[96:99], v[156:159]
    ds_read_b64_tr_b16 a[196:197], v27 offset:43008
    ds_read_b64_tr_b16 a[198:199], v27 offset:43776
    v_mfma_f32_16x16x32_bf16 v[156:159], a[156:159], v[100:103], v[156:159]
    ds_read_b64_tr_b16 a[208:209], v27 offset:49152
    ds_read_b64_tr_b16 a[210:211], v27 offset:49920
    v_mfma_f32_16x16x32_bf16 v[156:159], a[168:171], v[104:107], v[156:159]
    ds_read_b64_tr_b16 a[188:189], v28 offset:36864
    ds_read_b64_tr_b16 a[190:191], v28 offset:37632
    s_add_u32 s30, s30, 13312
    v_mfma_f32_16x16x32_bf16 v[160:163], a[148:151], v[96:99], v[160:163]
    ds_read_b64_tr_b16 a[200:201], v28 offset:43008
    ds_read_b64_tr_b16 a[202:203], v28 offset:43776
    v_mfma_f32_16x16x32_bf16 v[160:163], a[160:163], v[100:103], v[160:163]
    s_cmp_eq_u32 s30, 53248
    s_cselect_b32 s30, 0, s30
    ds_read_b64_tr_b16 a[212:213], v28 offset:49152
    v_mfma_f32_16x16x32_bf16 v[160:163], a[172:175], v[104:107], v[160:163]
    ds_read_b64_tr_b16 a[214:215], v28 offset:49920
    v_add_u32 v9, s30, v6
    v_add_u32 v10, s30, v7
    v_mfma_f32_16x16x32_bf16 v[164:167], a[152:155], v[96:99], v[164:167]
    v_add_u32 v11, s30, v8
    v_mfma_f32_16x16x32_bf16 v[164:167], a[164:167], v[100:103], v[164:167]
    v_mfma_f32_16x16x32_bf16 v[164:167], a[176:179], v[104:107], v[164:167]
    s_waitcnt lgkmcnt(12)
    v_mfma_f32_16x16x32_bf16 v[144:147], a[180:183], v[64:67], v[144:147]
    v_mfma_f32_16x16x32_bf16 v[144:147], a[192:195], v[68:71], v[144:147]
    v_mfma_f32_16x16x32_bf16 v[144:147], a[204:207], v[72:75], v[144:147]
    s_waitcnt lgkmcnt(6)
    v_mfma_f32_16x16x32_bf16 v[148:151], a[184:187], v[64:67], v[148:151]
    v_mfma_f32_16x16x32_bf16 v[148:151], a[196:199], v[68:71], v[148:151]
    v_mfma_f32_16x16x32_bf16 v[148:151], a[208:211], v[72:75], v[148:151]
    s_waitcnt vmcnt(7)
    s_barrier
    s_waitcnt lgkmcnt(0)
    v_mfma_f32_16x16x32_bf16 v[152:155], a[188:191], v[64:67], v[152:155]
    ds_read_b128 v[40:43], v9 offset:0
    v_mfma_f32_16x16x32_bf16 v[152:155], a[200:203], v[68:71], v[152:155]
    ds_read_b128 v[44:47], v9 offset:64
    v_mfma_f32_16x16x32_bf16 v[152:155], a[212:215], v[72:75], v[152:155]
    ds_read_b128 v[48:51], v9 offset:128
    v_mfma_f32_16x16x32_bf16 v[156:159], a[180:183], v[108:111], v[156:159]
    ds_read_b128 v[52:55], v10 offset:0
    v_mfma_f32_16x16x32_bf16 v[156:159], a[192:195], v[112:115], v[156:159]
    ds_read_b128 v[56:59], v10 offset:64
    v_mfma_f32_16x16x32_bf16 v[156:159], a[204:207], v[116:119], v[156:159]
    ds_read_b128 v[60:63], v10 offset:128
    v_mfma_f32_16x16x32_bf16 v[160:163], a[184:187], v[108:111], v[160:163]
    ds_read_b128 v[64:67], v11 offset:0
    v_mfma_f32_16x16x32_bf16 v[160:163], a[196:199], v[112:115], v[160:163]
    ds_read_b128 v[68:71], v11 offset:64
    v_mfma_f32_16x16x32_bf16 v[160:163], a[208:211], v[116:119], v[160:163]
    ds_read_b128 v[72:75], v11 offset:128
    v_mfma_f32_16x16x32_bf16 v[164:167], a[188:191], v[108:111], v[164:167]
    v_mfma_f32_16x16x32_bf16 v[164:167], a[200:203], v[112:115], v[164:167]
    v_mfma_f32_16x16x32_bf16 v[164:167], a[212:215], v[116:119], v[164:167]
    s_add_u32 m0, s26, 81920
    s_waitcnt lgkmcnt(6)
    v_mfma_f32_16x16x32_bf16 v[96:99], a[0:3], v[40:43], 0
    buffer_load_dwordx4 v20, s[16:19], s46 offen lds
    v_mfma_f32_16x16x32_bf16 v[96:99], a[12:15], v[44:47], v[96:99]
    v_mfma_f32_16x16x32_bf16 v[96:99], a[24:27], v[48:51], v[96:99]
    s_add_u32 m0, s26, 86016
    v_mfma_f32_16x16x32_bf16 v[100:103], a[4:7], v[40:43], 0
    buffer_load_dwordx4 v21, s[16:19], s46 offen lds
    v_mfma_f32_16x16x32_bf16 v[100:103], a[16:19], v[44:47], v[100:103]
    v_mfma_f32_16x16x32_bf16 v[100:103], a[28:31], v[48:51], v[100:103]
    s_add_u32 m0, s26, 90112
    v_mfma_f32_16x16x32_bf16 v[104:107], a[8:11], v[40:43], 0
    s_mov_b32 s46, 147456
    buffer_load_dwordx4 v19, s[16:19], s46 offen lds
    v_mfma_f32_16x16x32_bf16 v[104:107], a[20:23], v[44:47], v[104:107]
    v_mfma_f32_16x16x32_bf16 v[104:107], a[32:35], v[48:51], v[104:107]
    s_add_u32 m0, s26, 94208
    s_waitcnt lgkmcnt(3)
    v_mfma_f32_16x16x32_bf16 v[96:99], a[36:39], v[52:55], v[96:99]
    buffer_load_dwordx4 v20, s[16:19], s46 offen lds
    v_mfma_f32_16x16x32_bf16 v[96:99], a[48:51], v[56:59], v[96:99]
    v_mfma_f32_16x16x32_bf16 v[96:99], a[60:63], v[60:63], v[96:99]
    s_add_u32 m0, s26, 98304
    v_mfma_f32_16x16x32_bf16 v[100:103], a[40:43], v[52:55], v[100:103]
    buffer_load_dwordx4 v21, s[16:19], s46 offen lds
    v_mfma_f32_16x16x32_bf16 v[100:103], a[52:55], v[56:59], v[100:103]
    v_mfma_f32_16x16x32_bf16 v[100:103], a[64:67], v[60:63], v[100:103]
    s_add_u32 m0, s26, 102400
    v_mfma_f32_16x16x32_bf16 v[104:107], a[44:47], v[52:55], v[104:107]
    s_mov_b32 s46, 159744
    buffer_load_dwordx4 v19, s[16:19], s46 offen lds
    v_mfma_f32_16x16x32_bf16 v[104:107], a[56:59], v[56:59], v[104:107]
    v_mfma_f32_16x16x32_bf16 v[104:107], a[68:71], v[60:63], v[104:107]
    s_add_u32 m0, s47, 106496
    s_waitcnt lgkmcnt(0)
    v_mfma_f32_16x16x32_bf16 v[96:99], a[72:75], v[64:67], v[96:99]
    s_mov_b32 s46, 110592
    v_mfma_f32_16x16x32_bf16 v[96:99], a[84:87], v[68:71], v[96:99]
    s_mov_b32 exec_hi, 0
    buffer_load_dwordx4 v22, s[16:19], s46 offen lds
    s_mov_b64 exec, -1
    v_mfma_f32_16x16x32_bf16 v[96:99], a[96:99], v[72:75], v[96:99]
    s_sub_u32 s32, s32, 393216
    v_mfma_f32_16x16x32_bf16 v[100:103], a[76:79], v[64:67], v[100:103]
    s_sub_u32 s33, s33, 4
    v_mfma_f32_16x16x32_bf16 v[100:103], a[88:91], v[68:71], v[100:103]
    s_cmp_lt_u32 s33, s34
    s_cselect_b32 s14, 50331648, 0
    v_mfma_f32_16x16x32_bf16 v[100:103], a[100:103], v[72:75], v[100:103]
    s_add_u32 s31, s31, 13312
    v_mfma_f32_16x16x32_bf16 v[104:107], a[80:83], v[64:67], v[104:107]
    s_cmp_eq_u32 s31, 53248
    s_cselect_b32 s31, 0, s31
    v_mfma_f32_16x16x32_bf16 v[104:107], a[92:95], v[68:71], v[104:107]
    v_mfma_f32_16x16x32_bf16 v[104:107], a[104:107], v[72:75], v[104:107]
    v_mfma_f32_16x16x32_bf16 v[120:123], a[108:111], v[40:43], v[120:123]
    s_add_u32 m0, s31, s26
    v_mfma_f32_16x16x32_bf16 v[120:123], a[120:123], v[44:47], v[120:123]
    buffer_load_dwordx4 v2, s[12:15], s32 offen nt lds
    v_mfma_f32_16x16x32_bf16 v[120:123], a[132:135], v[48:51], v[120:123]
    s_add_u32 m0, s31, s27
    v_mfma_f32_16x16x32_bf16 v[120:123], a[144:147], v[52:55], v[120:123]
    buffer_load_dwordx4 v3, s[12:15], s32 offen nt lds
    v_mfma_f32_16x16x32_bf16 v[120:123], a[156:159], v[56:59], v[120:123]
    s_add_u32 m0, s31, s28
    v_mfma_f32_16x16x32_bf16 v[120:123], a[168:171], v[60:63], v[120:123]
    buffer_load_dwordx4 v4, s[12:15], s32 offen nt lds
    v_mfma_f32_16x16x32_bf16 v[120:123], a[180:183], v[64:67], v[120:123]
    s_add_u32 m0, s31, s29
    v_mfma_f32_16x16x32_bf16 v[120:123], a[192:195], v[68:71], v[120:123]
    buffer_load_dwordx4 v5, s[12:15], s32 offen nt lds
    v_mfma_f32_16x16x32_bf16 v[120:123], a[204:207], v[72:75], v[120:123]
    v_mfma_f32_16x16x32_bf16 v[124:127], a[112:115], v[40:43], v[124:127]
    v_mfma_f32_16x16x32_bf16 v[124:127], a[124:127], v[44:47], v[124:127]
    v_mfma_f32_16x16x32_bf16 v[124:127], a[136:139], v[48:51], v[124:127]
    v_mfma_f32_16x16x32_bf16 v[124:127], a[148:151], v[52:55], v[124:127]
    v_mfma_f32_16x16x32_bf16 v[124:127], a[160:163], v[56:59], v[124:127]
    v_mfma_f32_16x16x32_bf16 v[124:127], a[172:175], v[60:63], v[124:127]
    v_mfma_f32_16x16x32_bf16 v[124:127], a[184:187], v[64:67], v[124:127]
    v_mfma_f32_16x16x32_bf16 v[124:127], a[196:199], v[68:71], v[124:127]
    s_waitcnt vmcnt(4)
    s_barrier
    v_mfma_f32_16x16x32_bf16 v[124:127], a[208:211], v[72:75], v[124:127]
    ds_read_b64_tr_b16 a[216:217], v23 offset:0
    v_mfma_f32_16x16x32_bf16 v[128:131], a[116:119], v[40:43], v[128:131]
    ds_read_b64_tr_b16 a[218:219], v23 offset:768
    ds_read_b64_tr_b16 a[228:229], v23 offset:6144
    v_mfma_f32_16x16x32_bf16 v[128:131], a[128:131], v[44:47], v[128:131]
    ds_read_b64_tr_b16 a[230:231], v23 offset:6912
    ds_read_b64_tr_b16 a[240:241], v23 offset:12288
    v_mfma_f32_16x16x32_bf16 v[128:131], a[140:143], v[48:51], v[128:131]
    ds_read_b64_tr_b16 a[242:243], v23 offset:13056
    v_mfma_f32_16x16x32_bf16 v[128:131], a[152:155], v[52:55], v[128:131]
    ds_read_b64_tr_b16 a[252:253], v23 offset:18432
    ds_read_b64_tr_b16 a[254:255], v23 offset:19200
    v_mfma_f32_16x16x32_bf16 v[128:131], a[164:167], v[56:59], v[128:131]
    ds_read_b64_tr_b16 v[176:177], v23 offset:24576
    ds_read_b64_tr_b16 v[178:179], v23 offset:25344
    v_mfma_f32_16x16x32_bf16 v[128:131], a[176:179], v[60:63], v[128:131]
    ds_read_b64_tr_b16 v[188:189], v23 offset:30720
    v_mfma_f32_16x16x32_bf16 v[128:131], a[188:191], v[64:67], v[128:131]
    ds_read_b64_tr_b16 v[190:191], v23 offset:31488
    ds_read_b64_tr_b16 v[200:201], v23 offset:36864
    v_mfma_f32_16x16x32_bf16 v[128:131], a[200:203], v[68:71], v[128:131]
    ds_read_b64_tr_b16 v[202:203], v23 offset:37632
    ds_read_b64_tr_b16 v[212:213], v23 offset:43008
    v_mfma_f32_16x16x32_bf16 v[128:131], a[212:215], v[72:75], v[128:131]
    ds_read_b64_tr_b16 v[214:215], v23 offset:43776
    s_waitcnt lgkmcnt(10)
    v_mfma_f32_16x16x32_bf16 v[144:147], a[216:219], v[40:43], v[144:147]
    ds_read_b64_tr_b16 v[224:225], v23 offset:49152
    ds_read_b64_tr_b16 v[226:227], v23 offset:49920
    v_mfma_f32_16x16x32_bf16 v[144:147], a[228:231], v[44:47], v[144:147]
    ds_read_b64_tr_b16 a[220:221], v24 offset:0
    ds_read_b64_tr_b16 a[222:223], v24 offset:768
    v_mfma_f32_16x16x32_bf16 v[144:147], a[240:243], v[48:51], v[144:147]
    ds_read_b64_tr_b16 a[232:233], v24 offset:6144
    s_waitcnt lgkmcnt(9)
    v_mfma_f32_16x16x32_bf16 v[144:147], a[252:255], v[52:55], v[144:147]
    ds_read_b64_tr_b16 a[234:235], v24 offset:6912
    ds_read_b64_tr_b16 a[244:245], v24 offset:12288
    ds_read_b64_tr_b16 a[246:247], v24 offset:13056
    v_mfma_f32_16x16x32_bf16 v[144:147], v[176:179], v[56:59], v[144:147]
    ds_read_b64_tr_b16 v[168:169], v24 offset:18432
    ds_read_b64_tr_b16 v[170:171], v24 offset:19200
    v_mfma_f32_16x16x32_bf16 v[144:147], v[188:191], v[60:63], v[144:147]
    ds_read_b64_tr_b16 v[180:181], v24 offset:24576
    s_waitcnt lgkmcnt(9)
    v_mfma_f32_16x16x32_bf16 v[144:147], v[200:203], v[64:67], v[144:147]
    ds_read_b64_tr_b16 v[182:183], v24 offset:25344
    ds_read_b64_tr_b16 v[192:193], v24 offset:30720
    ds_read_b64_tr_b16 v[194:195], v24 offset:31488
    v_mfma_f32_16x16x32_bf16 v[144:147], v[212:215], v[68:71], v[144:147]
    ds_read_b64_tr_b16 v[204:205], v24 offset:36864
    ds_read_b64_tr_b16 v[206:207], v24 offset:37632
    v_mfma_f32_16x16x32_bf16 v[144:147], v[224:227], v[72:75], v[144:147]
    ds_read_b64_tr_b16 v[216:217], v24 offset:43008
    s_waitcnt lgkmcnt(9)
    v_mfma_f32_16x16x32_bf16 v[148:151], a[220:223], v[40:43], v[148:151]
    ds_read_b64_tr_b16 v[218:219], v24 offset:43776
    ds_read_b64_tr_b16 v[228:229], v24 offset:49152
    ds_read_b64_tr_b16 v[230:231], v24 offset:49920
    v_mfma_f32_16x16x32_bf16 v[148:151], a[232:235], v[44:47], v[148:151]
    ds_read_b64_tr_b16 a[224:225], v25 offset:0
    ds_read_b64_tr_b16 a[226:227], v25 offset:768
    v_mfma_f32_16x16x32_bf16 v[148:151], a[244:247], v[48:51], v[148:151]
    ds_read_b64_tr_b16 a[236:237], v25 offset:6144
    s_waitcnt lgkmcnt(9)
    v_mfma_f32_16x16x32_bf16 v[148:151], v[168:171], v[52:55], v[148:151]
    ds_read_b64_tr_b16 a[238:239], v25 offset:6912
    ds_read_b64_tr_b16 a[248:249], v25 offset:12288
    ds_read_b64_tr_b16 a[250:251], v25 offset:13056
    v_mfma_f32_16x16x32_bf16 v[148:151], v[180:183], v[56:59], v[148:151]
    ds_read_b64_tr_b16 v[172:173], v25 offset:18432
    ds_read_b64_tr_b16 v[174:175], v25 offset:19200
    v_mfma_f32_16x16x32_bf16 v[148:151], v[192:195], v[60:63], v[148:151]
    ds_read_b64_tr_b16 v[184:185], v25 offset:24576
    s_waitcnt lgkmcnt(9)
    v_mfma_f32_16x16x32_bf16 v[148:151], v[204:207], v[64:67], v[148:151]
    ds_read_b64_tr_b16 v[186:187], v25 offset:25344
    ds_read_b64_tr_b16 v[196:197], v25 offset:30720
    ds_read_b64_tr_b16 v[198:199], v25 offset:31488
    v_mfma_f32_16x16x32_bf16 v[148:151], v[216:219], v[68:71], v[148:151]
    ds_read_b64_tr_b16 v[208:209], v25 offset:36864
    ds_read_b64_tr_b16 v[210:211], v25 offset:37632
    v_mfma_f32_16x16x32_bf16 v[148:151], v[228:231], v[72:75], v[148:151]
    ds_read_b64_tr_b16 v[220:221], v25 offset:43008
    s_waitcnt lgkmcnt(9)
    v_mfma_f32_16x16x32_bf16 v[152:155], a[224:227], v[40:43], v[152:155]
    ds_read_b64_tr_b16 v[222:223], v25 offset:43776
    ds_read_b64_tr_b16 v[232:233], v25 offset:49152
    ds_read_b64_tr_b16 v[234:235], v25 offset:49920
    v_mfma_f32_16x16x32_bf16 v[152:155], a[236:239], v[44:47], v[152:155]
    ds_read_b128 v[40:43], v9 offset:3072
    ds_read_b128 v[44:47], v9 offset:3136
    v_mfma_f32_16x16x32_bf16 v[152:155], a[248:251], v[48:51], v[152:155]
    ds_read_b128 v[48:51], v9 offset:3200
    s_waitcnt lgkmcnt(9)
    v_mfma_f32_16x16x32_bf16 v[152:155], v[172:175], v[52:55], v[152:155]
    ds_read_b128 v[52:55], v10 offset:3072
    v_mfma_f32_16x16x32_bf16 v[152:155], v[184:187], v[56:59], v[152:155]
    ds_read_b128 v[56:59], v10 offset:3136
    v_mfma_f32_16x16x32_bf16 v[152:155], v[196:199], v[60:63], v[152:155]
    ds_read_b128 v[60:63], v10 offset:3200
    s_waitcnt lgkmcnt(6)
    v_mfma_f32_16x16x32_bf16 v[152:155], v[208:211], v[64:67], v[152:155]
    ds_read_b128 v[64:67], v11 offset:3072
    v_mfma_f32_16x16x32_bf16 v[152:155], v[220:223], v[68:71], v[152:155]
    ds_read_b128 v[68:71], v11 offset:3136
    v_mfma_f32_16x16x32_bf16 v[152:155], v[232:235], v[72:75], v[152:155]
    ds_read_b128 v[72:75], v11 offset:3200
    s_waitcnt lgkmcnt(6)
    v_mfma_f32_16x16x32_bf16 v[108:111], a[0:3], v[40:43], 0
    s_add_u32 s32, s32, 589824
    v_mfma_f32_16x16x32_bf16 v[108:111], a[12:15], v[44:47], v[108:111]
    s_add_u32 s33, s33, 6
    v_mfma_f32_16x16x32_bf16 v[108:111], a[24:27], v[48:51], v[108:111]
    s_cmp_lt_u32 s33, s34
    s_cselect_b32 s14, 50331648, 0
    s_waitcnt lgkmcnt(3)
    v_mfma_f32_16x16x32_bf16 v[108:111], a[36:39], v[52:55], v[108:111]
    s_add_u32 s31, s31, 13312
    v_mfma_f32_16x16x32_bf16 v[108:111], a[48:51], v[56:59], v[108:111]
    s_cmp_eq_u32 s31, 53248
    s_cselect_b32 s31, 0, s31
    v_mfma_f32_16x16x32_bf16 v[108:111], a[60:63], v[60:63], v[108:111]
    s_waitcnt lgkmcnt(0)
    v_mfma_f32_16x16x32_bf16 v[108:111], a[72:75], v[64:67], v[108:111]
    v_mfma_f32_16x16x32_bf16 v[108:111], a[84:87], v[68:71], v[108:111]
    s_add_u32 m0, s31, s26
    v_mfma_f32_16x16x32_bf16 v[108:111], a[96:99], v[72:75], v[108:111]
    buffer_load_dwordx4 v2, s[12:15], s32 offen nt lds
    v_mfma_f32_16x16x32_bf16 v[112:115], a[4:7], v[40:43], 0
    v_mfma_f32_16x16x32_bf16 v[112:115], a[16:19], v[44:47], v[112:115]
    s_add_u32 m0, s31, s27
    v_mfma_f32_16x16x32_bf16 v[112:115], a[28:31], v[48:51], v[112:115]
    buffer_load_dwordx4 v3, s[12:15], s32 offen nt lds
    v_mfma_f32_16x16x32_bf16 v[112:115], a[40:43], v[52:55], v[112:115]
    v_mfma_f32_16x16x32_bf16 v[112:115], a[52:55], v[56:59], v[112:115]
    s_add_u32 m0, s31, s28
    v_mfma_f32_16x16x32_bf16 v[112:115], a[64:67], v[60:63], v[112:115]
    buffer_load_dwordx4 v4, s[12:15], s32 offen nt lds
    v_mfma_f32_16x16x32_bf16 v[112:115], a[76:79], v[64:67], v[112:115]
    v_mfma_f32_16x16x32_bf16 v[112:115], a[88:91], v[68:71], v[112:115]
    s_add_u32 m0, s31, s29
    v_mfma_f32_16x16x32_bf16 v[112:115], a[100:103], v[72:75], v[112:115]
    buffer_load_dwordx4 v5, s[12:15], s32 offen nt lds
    v_mfma_f32_16x16x32_bf16 v[116:119], a[8:11], v[40:43], 0
    v_mfma_f32_16x16x32_bf16 v[116:119], a[20:23], v[44:47], v[116:119]
    v_mfma_f32_16x16x32_bf16 v[116:119], a[32:35], v[48:51], v[116:119]
    s_add_u32 s32, s32, 196608
    v_mfma_f32_16x16x32_bf16 v[116:119], a[44:47], v[52:55], v[116:119]
    s_add_u32 s33, s33, 2
    v_mfma_f32_16x16x32_bf16 v[116:119], a[56:59], v[56:59], v[116:119]
    s_cmp_lt_u32 s33, s34
    s_cselect_b32 s14, 50331648, 0
    v_mfma_f32_16x16x32_bf16 v[116:119], a[68:71], v[60:63], v[116:119]
    s_add_u32 s31, s31, 13312
    v_mfma_f32_16x16x32_bf16 v[116:119], a[80:83], v[64:67], v[116:119]
    s_cmp_eq_u32 s31, 53248
    s_cselect_b32 s31, 0, s31
    v_mfma_f32_16x16x32_bf16 v[116:119], a[92:95], v[68:71], v[116:119]
    v_mfma_f32_16x16x32_bf16 v[116:119], a[104:107], v[72:75], v[116:119]
    v_mfma_f32_16x16x32_bf16 v[132:135], a[108:111], v[40:43], v[132:135]
    s_add_u32 m0, s31, s26
    v_mfma_f32_16x16x32_bf16 v[132:135], a[120:123], v[44:47], v[132:135]
    buffer_load_dwordx4 v2, s[12:15], s32 offen nt lds
    v_mfma_f32_16x16x32_bf16 v[132:135], a[132:135], v[48:51], v[132:135]
    v_mfma_f32_16x16x32_bf16 v[132:135], a[144:147], v[52:55], v[132:135]
    s_add_u32 m0, s31, s27
    v_mfma_f32_16x16x32_bf16 v[132:135], a[156:159], v[56:59], v[132:135]
    buffer_load_dwordx4 v3, s[12:15], s32 offen nt lds
    v_mfma_f32_16x16x32_bf16 v[132:135], a[168:171], v[60:63], v[132:135]
    v_mfma_f32_16x16x32_bf16 v[132:135], a[180:183], v[64:67], v[132:135]
    s_add_u32 m0, s31, s28
    v_mfma_f32_16x16x32_bf16 v[132:135], a[192:195], v[68:71], v[132:135]
    buffer_load_dwordx4 v4, s[12:15], s32 offen nt lds
    v_mfma_f32_16x16x32_bf16 v[132:135], a[204:207], v[72:75], v[132:135]
    v_mfma_f32_16x16x32_bf16 v[136:139], a[112:115], v[40:43], v[136:139]
    s_add_u32 m0, s31, s29
    v_mfma_f32_16x16x32_bf16 v[136:139], a[124:127], v[44:47], v[136:139]
    buffer_load_dwordx4 v5, s[12:15], s32 offen nt lds
    v_mfma_f32_16x16x32_bf16 v[136:139], a[136:139], v[48:51], v[136:139]
    v_mfma_f32_16x16x32_bf16 v[136:139], a[148:151], v[52:55], v[136:139]
    v_mfma_f32_16x16x32_bf16 v[136:139], a[160:163], v[56:59], v[136:139]
    s_add_u32 s30, s30, 13312
    v_mfma_f32_16x16x32_bf16 v[136:139], a[172:175], v[60:63], v[136:139]
    s_cmp_eq_u32 s30, 53248
    s_cselect_b32 s30, 0, s30
    v_mfma_f32_16x16x32_bf16 v[136:139], a[184:187], v[64:67], v[136:139]
    v_add_u32 v9, s30, v6
    v_mfma_f32_16x16x32_bf16 v[136:139], a[196:199], v[68:71], v[136:139]
    v_add_u32 v10, s30, v7
    v_mfma_f32_16x16x32_bf16 v[136:139], a[208:211], v[72:75], v[136:139]
    v_add_u32 v11, s30, v8
    v_mfma_f32_16x16x32_bf16 v[140:143], a[116:119], v[40:43], v[140:143]
    v_mfma_f32_16x16x32_bf16 v[140:143], a[128:131], v[44:47], v[140:143]
    v_mfma_f32_16x16x32_bf16 v[140:143], a[140:143], v[48:51], v[140:143]
    v_mfma_f32_16x16x32_bf16 v[140:143], a[152:155], v[52:55], v[140:143]
    ds_write_b32 v242, v243
    v_mfma_f32_16x16x32_bf16 v[140:143], a[164:167], v[56:59], v[140:143]
    v_mfma_f32_16x16x32_bf16 v[140:143], a[176:179], v[60:63], v[140:143]
    v_mfma_f32_16x16x32_bf16 v[140:143], a[188:191], v[64:67], v[140:143]
    v_mfma_f32_16x16x32_bf16 v[140:143], a[200:203], v[68:71], v[140:143]
    v_mfma_f32_16x16x32_bf16 v[140:143], a[212:215], v[72:75], v[140:143]
    v_mfma_f32_16x16x32_bf16 v[156:159], a[216:219], v[40:43], v[156:159]
    v_mfma_f32_16x16x32_bf16 v[156:159], a[228:231], v[44:47], v[156:159]
    v_mfma_f32_16x16x32_bf16 v[156:159], a[240:243], v[48:51], v[156:159]
    v_mfma_f32_16x16x32_bf16 v[160:163], a[220:223], v[40:43], v[160:163]
    v_mfma_f32_16x16x32_bf16 v[160:163], a[232:235], v[44:47], v[160:163]
    v_mfma_f32_16x16x32_bf16 v[160:163], a[244:247], v[48:51], v[160:163]
    s_waitcnt vmcnt(8)
    s_barrier
    v_mfma_f32_16x16x32_bf16 v[164:167], a[224:227], v[40:43], v[164:167]
    ds_read_b128 v[40:43], v9 offset:0
    v_mfma_f32_16x16x32_bf16 v[164:167], a[236:239], v[44:47], v[164:167]
    ds_read_b128 v[44:47], v9 offset:64
    v_mfma_f32_16x16x32_bf16 v[164:167], a[248:251], v[48:51], v[164:167]
    ds_read_b128 v[48:51], v9 offset:128
    v_mfma_f32_16x16x32_bf16 v[156:159], a[252:255], v[52:55], v[156:159]
    v_mfma_f32_16x16x32_bf16 v[156:159], v[176:179], v[56:59], v[156:159]
    v_mfma_f32_16x16x32_bf16 v[156:159], v[188:191], v[60:63], v[156:159]
    v_mfma_f32_16x16x32_bf16 v[160:163], v[168:171], v[52:55], v[160:163]
    v_mfma_f32_16x16x32_bf16 v[160:163], v[180:183], v[56:59], v[160:163]
    v_mfma_f32_16x16x32_bf16 v[160:163], v[192:195], v[60:63], v[160:163]
    v_mfma_f32_16x16x32_bf16 v[164:167], v[172:175], v[52:55], v[164:167]
    ds_read_b128 v[52:55], v10 offset:0
    v_mfma_f32_16x16x32_bf16 v[164:167], v[184:187], v[56:59], v[164:167]
    ds_read_b128 v[56:59], v10 offset:64
    v_mfma_f32_16x16x32_bf16 v[164:167], v[196:199], v[60:63], v[164:167]
    ds_read_b128 v[60:63], v10 offset:128
    v_mfma_f32_16x16x32_bf16 v[156:159], v[200:203], v[64:67], v[156:159]
    v_mfma_f32_16x16x32_bf16 v[156:159], v[212:215], v[68:71], v[156:159]
    v_mfma_f32_16x16x32_bf16 v[156:159], v[224:227], v[72:75], v[156:159]
    v_mfma_f32_16x16x32_bf16 v[160:163], v[204:207], v[64:67], v[160:163]
    v_mfma_f32_16x16x32_bf16 v[160:163], v[216:219], v[68:71], v[160:163]
    v_mfma_f32_16x16x32_bf16 v[160:163], v[228:231], v[72:75], v[160:163]
    v_mfma_f32_16x16x32_bf16 v[164:167], v[208:211], v[64:67], v[164:167]
    ds_read_b128 v[64:67], v11 offset:0
    v_mfma_f32_16x16x32_bf16 v[164:167], v[220:223], v[68:71], v[164:167]
    ds_read_b128 v[68:71], v11 offset:64
    v_mfma_f32_16x16x32_bf16 v[164:167], v[232:235], v[72:75], v[164:167]
    ds_read_b128 v[72:75], v11 offset:128
    s_waitcnt lgkmcnt(6)
    v_mfma_f32_16x16x32_bf16 v[144:147], a[0:3], v[40:43], v[144:147]
    s_add_u32 s32, s32, 196608
    v_mfma_f32_16x16x32_bf16 v[144:147], a[12:15], v[44:47], v[144:147]
    s_add_u32 s33, s33, 2
    v_mfma_f32_16x16x32_bf16 v[144:147], a[24:27], v[48:51], v[144:147]
    s_cmp_lt_u32 s33, s34
    s_cselect_b32 s14, 50331648, 0
    s_waitcnt lgkmcnt(3)
    v_mfma_f32_16x16x32_bf16 v[144:147], a[36:39], v[52:55], v[144:147]
    s_add_u32 s31, s31, 13312
    v_mfma_f32_16x16x32_bf16 v[144:147], a[48:51], v[56:59], v[144:147]
    s_cmp_eq_u32 s31, 53248
    s_cselect_b32 s31, 0, s31
    v_mfma_f32_16x16x32_bf16 v[144:147], a[60:63], v[60:63], v[144:147]
    s_waitcnt lgkmcnt(0)
    v_mfma_f32_16x16x32_bf16 v[144:147], a[72:75], v[64:67], v[144:147]
    v_mfma_f32_16x16x32_bf16 v[144:147], a[84:87], v[68:71], v[144:147]
    s_add_u32 m0, s31, s26
    v_mfma_f32_16x16x32_bf16 v[144:147], a[96:99], v[72:75], v[144:147]
    buffer_load_dwordx4 v2, s[12:15], s32 offen nt lds
    v_mfma_f32_16x16x32_bf16 v[148:151], a[4:7], v[40:43], v[148:151]
    s_add_u32 m0, s31, s27
    v_mfma_f32_16x16x32_bf16 v[148:151], a[16:19], v[44:47], v[148:151]
    buffer_load_dwordx4 v3, s[12:15], s32 offen nt lds
    v_mfma_f32_16x16x32_bf16 v[148:151], a[28:31], v[48:51], v[148:151]
    s_add_u32 m0, s31, s28
    v_mfma_f32_16x16x32_bf16 v[148:151], a[40:43], v[52:55], v[148:151]
    buffer_load_dwordx4 v4, s[12:15], s32 offen nt lds
    v_mfma_f32_16x16x32_bf16 v[148:151], a[52:55], v[56:59], v[148:151]
    s_add_u32 m0, s31, s29
    v_mfma_f32_16x16x32_bf16 v[148:151], a[64:67], v[60:63], v[148:151]
    buffer_load_dwordx4 v5, s[12:15], s32 offen nt lds
    v_mfma_f32_16x16x32_bf16 v[148:151], a[76:79], v[64:67], v[148:151]
    v_mfma_f32_16x16x32_bf16 v[148:151], a[88:91], v[68:71], v[148:151]
    v_mfma_f32_16x16x32_bf16 v[148:151], a[100:103], v[72:75], v[148:151]
    v_cvt_pk_bf16_f32 v76, v144, v145
    v_mfma_f32_16x16x32_bf16 v[152:155], a[8:11], v[40:43], v[152:155]
    ds_read_b128 v[40:43], v9 offset:3072
    v_cvt_pk_bf16_f32 v77, v146, v147
    v_mfma_f32_16x16x32_bf16 v[152:155], a[20:23], v[44:47], v[152:155]
    ds_read_b128 v[44:47], v9 offset:3136
    ds_write_b64 v12, v[76:77] offset:0
    v_mfma_f32_16x16x32_bf16 v[152:155], a[32:35], v[48:51], v[152:155]
    ds_read_b128 v[48:51], v9 offset:3200
    v_mfma_f32_16x16x32_bf16 v[152:155], a[44:47], v[52:55], v[152:155]
    ds_read_b128 v[52:55], v10 offset:3072
    v_mfma_f32_16x16x32_bf16 v[152:155], a[56:59], v[56:59], v[152:155]
    ds_read_b128 v[56:59], v10 offset:3136
    v_mfma_f32_16x16x32_bf16 v[152:155], a[68:71], v[60:63], v[152:155]
    ds_read_b128 v[60:63], v10 offset:3200
    v_mfma_f32_16x16x32_bf16 v[152:155], a[80:83], v[64:67], v[152:155]
    ds_read_b128 v[64:67], v11 offset:3072
    v_mfma_f32_16x16x32_bf16 v[152:155], a[92:95], v[68:71], v[152:155]
    ds_read_b128 v[68:71], v11 offset:3136
    v_mfma_f32_16x16x32_bf16 v[152:155], a[104:107], v[72:75], v[152:155]
    ds_read_b128 v[72:75], v11 offset:3200
    s_waitcnt lgkmcnt(6)
    v_mfma_f32_16x16x32_bf16 v[156:159], a[0:3], v[40:43], v[156:159]
    v_cvt_pk_bf16_f32 v78, v148, v149
    s_add_u32 s30, s30, 13312
    v_mfma_f32_16x16x32_bf16 v[156:159], a[12:15], v[44:47], v[156:159]
    v_cvt_pk_bf16_f32 v79, v150, v151
    v_mfma_f32_16x16x32_bf16 v[156:159], a[24:27], v[48:51], v[156:159]
    s_cmp_eq_u32 s30, 53248
    s_cselect_b32 s30, 0, s30
    v_mfma_f32_16x16x32_bf16 v[160:163], a[4:7], v[40:43], v[160:163]
    ds_write_b64 v13, v[78:79] offset:0
    v_add_u32 v9, s30, v6
    v_mfma_f32_16x16x32_bf16 v[160:163], a[16:19], v[44:47], v[160:163]
    v_add_u32 v10, s30, v7
    v_add_u32 v11, s30, v8
    v_mfma_f32_16x16x32_bf16 v[160:163], a[28:31], v[48:51], v[160:163]
    s_waitcnt vmcnt(8)
    s_barrier
    v_mfma_f32_16x16x32_bf16 v[164:167], a[8:11], v[40:43], v[164:167]
    ds_read_b128 v[40:43], v9 offset:0
    v_mfma_f32_16x16x32_bf16 v[164:167], a[20:23], v[44:47], v[164:167]
    ds_read_b128 v[44:47], v9 offset:64
    v_mfma_f32_16x16x32_bf16 v[164:167], a[32:35], v[48:51], v[164:167]
    v_cvt_pk_bf16_f32 v80, v152, v153
    s_waitcnt lgkmcnt(6)
    v_mfma_f32_16x16x32_bf16 v[156:159], a[36:39], v[52:55], v[156:159]
    ds_read_b128 v[48:51], v9 offset:128
    v_cvt_pk_bf16_f32 v81, v154, v155
    v_mfma_f32_16x16x32_bf16 v[156:159], a[48:51], v[56:59], v[156:159]
    ds_write_b64 v14, v[80:81] offset:0
    v_mfma_f32_16x16x32_bf16 v[156:159], a[60:63], v[60:63], v[156:159]
    v_mfma_f32_16x16x32_bf16 v[160:163], a[40:43], v[52:55], v[160:163]
    v_mfma_f32_16x16x32_bf16 v[160:163], a[52:55], v[56:59], v[160:163]
    v_mfma_f32_16x16x32_bf16 v[160:163], a[64:67], v[60:63], v[160:163]
    v_mfma_f32_16x16x32_bf16 v[164:167], a[44:47], v[52:55], v[164:167]
    ds_read_b128 v[52:55], v10 offset:0
    v_mfma_f32_16x16x32_bf16 v[164:167], a[56:59], v[56:59], v[164:167]
    ds_read_b128 v[56:59], v10 offset:64
    v_mfma_f32_16x16x32_bf16 v[164:167], a[68:71], v[60:63], v[164:167]
    ds_read_b128 v[60:63], v10 offset:128
    s_waitcnt lgkmcnt(8)
    v_mfma_f32_16x16x32_bf16 v[156:159], a[72:75], v[64:67], v[156:159]
    v_mfma_f32_16x16x32_bf16 v[156:159], a[84:87], v[68:71], v[156:159]
    v_mfma_f32_16x16x32_bf16 v[156:159], a[96:99], v[72:75], v[156:159]
    v_mfma_f32_16x16x32_bf16 v[160:163], a[76:79], v[64:67], v[160:163]
    v_mfma_f32_16x16x32_bf16 v[160:163], a[88:91], v[68:71], v[160:163]
    v_mfma_f32_16x16x32_bf16 v[160:163], a[100:103], v[72:75], v[160:163]
    v_mfma_f32_16x16x32_bf16 v[164:167], a[80:83], v[64:67], v[164:167]
    ds_read_b128 v[64:67], v11 offset:0
    v_mfma_f32_16x16x32_bf16 v[164:167], a[92:95], v[68:71], v[164:167]
    ds_read_b128 v[68:71], v11 offset:64
    v_mfma_f32_16x16x32_bf16 v[164:167], a[104:107], v[72:75], v[164:167]
    ds_read_b128 v[72:75], v11 offset:128
    s_nop 7
    v_cvt_pk_bf16_f32 v76, v156, v157
    v_cvt_pk_bf16_f32 v77, v158, v159
    ds_write_b64 v12, v[76:77] offset:3072
    v_cvt_pk_bf16_f32 v78, v160, v161
    v_cvt_pk_bf16_f32 v79, v162, v163
    ds_write_b64 v13, v[78:79] offset:3072
    v_cvt_pk_bf16_f32 v80, v164, v165
    v_cvt_pk_bf16_f32 v81, v166, v167
    ds_write_b64 v14, v[80:81] offset:3072
    s_waitcnt lgkmcnt(0)
    s_barrier
    s_mov_b32 s36, 13
L_loop:
    s_waitcnt lgkmcnt(6)
    v_mfma_f32_16x16x32_bf16 v[144:147], a[216:219], v[40:43], v[120:123]
    v_xor_b32 v12, 0x4000, v12
    v_mfma_f32_16x16x32_bf16 v[144:147], a[228:231], v[44:47], v[144:147]
    v_xor_b32 v13, 0x4000, v13
    v_mfma_f32_16x16x32_bf16 v[144:147], a[240:243], v[48:51], v[144:147]
    v_xor_b32 v14, 0x4000, v14
    s_waitcnt lgkmcnt(3)
    v_mfma_f32_16x16x32_bf16 v[144:147], a[252:255], v[52:55], v[144:147]
    v_mfma_f32_16x16x32_bf16 v[144:147], v[176:179], v[56:59], v[144:147]
    v_mfma_f32_16x16x32_bf16 v[144:147], v[188:191], v[60:63], v[144:147]
    s_waitcnt lgkmcnt(0)
    v_mfma_f32_16x16x32_bf16 v[144:147], v[200:203], v[64:67], v[144:147]
    ds_read_b128 v[84:87], v15
    v_mfma_f32_16x16x32_bf16 v[144:147], v[212:215], v[68:71], v[144:147]
    ds_read_b128 v[88:91], v16
    v_mfma_f32_16x16x32_bf16 v[144:147], v[224:227], v[72:75], v[144:147]
    ds_read_b128 v[92:95], v17
    v_mfma_f32_16x16x32_bf16 v[148:151], a[220:223], v[40:43], v[124:127]
    v_xor_b32 v15, 0x4000, v15
    v_mfma_f32_16x16x32_bf16 v[148:151], a[232:235], v[44:47], v[148:151]
    v_xor_b32 v16, 0x4000, v16
    v_mfma_f32_16x16x32_bf16 v[148:151], a[244:247], v[48:51], v[148:151]
    v_xor_b32 v17, 0x4000, v17
    v_mfma_f32_16x16x32_bf16 v[148:151], v[168:171], v[52:55], v[148:151]
    s_waitcnt lgkmcnt(2)
    buffer_store_dwordx4 v[84:87], v18, s[20:23], s35 offen offset:0 sc1
    v_mfma_f32_16x16x32_bf16 v[148:151], v[180:183], v[56:59], v[148:151]
    v_mfma_f32_16x16x32_bf16 v[148:151], v[192:195], v[60:63], v[148:151]
    v_mfma_f32_16x16x32_bf16 v[148:151], v[204:207], v[64:67], v[148:151]
    v_mfma_f32_16x16x32_bf16 v[148:151], v[216:219], v[68:71], v[148:151]
    v_mfma_f32_16x16x32_bf16 v[148:151], v[228:231], v[72:75], v[148:151]
    v_cvt_pk_bf16_f32 v76, v144, v145
    v_mfma_f32_16x16x32_bf16 v[152:155], a[224:227], v[40:43], v[128:131]
    v_cvt_pk_bf16_f32 v77, v146, v147
    v_mfma_f32_16x16x32_bf16 v[152:155], a[236:239], v[44:47], v[152:155]
    ds_write_b64 v12, v[76:77] offset:0
    v_mfma_f32_16x16x32_bf16 v[152:155], a[248:251], v[48:51], v[152:155]
    s_waitcnt lgkmcnt(2)
    buffer_store_dwordx4 v[88:91], v18, s[20:23], s35 offen offset:1024 sc1
    v_mfma_f32_16x16x32_bf16 v[152:155], v[172:175], v[52:55], v[152:155]
    v_mfma_f32_16x16x32_bf16 v[152:155], v[184:187], v[56:59], v[152:155]
    v_mfma_f32_16x16x32_bf16 v[152:155], v[196:199], v[60:63], v[152:155]
    v_mfma_f32_16x16x32_bf16 v[152:155], v[208:211], v[64:67], v[152:155]
    v_mfma_f32_16x16x32_bf16 v[152:155], v[220:223], v[68:71], v[152:155]
    v_mfma_f32_16x16x32_bf16 v[152:155], v[232:235], v[72:75], v[152:155]
    v_cvt_pk_bf16_f32 v78, v148, v149
    v_mfma_f32_16x16x32_bf16 v[120:123], a[108:111], v[40:43], v[96:99]
    v_cvt_pk_bf16_f32 v79, v150, v151
    v_mfma_f32_16x16x32_bf16 v[120:123], a[120:123], v[44:47], v[120:123]
    s_waitcnt lgkmcnt(1)
    buffer_store_dwordx4 v[92:95], v18, s[20:23], s35 offen offset:2048 sc1
    ds_write_b64 v13, v[78:79] offset:0
    v_mfma_f32_16x16x32_bf16 v[120:123], a[132:135], v[48:51], v[120:123]
    s_add_u32 s35, s35, 196608
    v_mfma_f32_16x16x32_bf16 v[120:123], a[144:147], v[52:55], v[120:123]
    v_mfma_f32_16x16x32_bf16 v[120:123], a[156:159], v[56:59], v[120:123]
    v_mfma_f32_16x16x32_bf16 v[120:123], a[168:171], v[60:63], v[120:123]
    v_mfma_f32_16x16x32_bf16 v[120:123], a[180:183], v[64:67], v[120:123]
    v_mfma_f32_16x16x32_bf16 v[120:123], a[192:195], v[68:71], v[120:123]
    v_mfma_f32_16x16x32_bf16 v[120:123], a[204:207], v[72:75], v[120:123]
    v_cvt_pk_bf16_f32 v80, v152, v153
    v_mfma_f32_16x16x32_bf16 v[124:127], a[112:115], v[40:43], v[100:103]
    v_cvt_pk_bf16_f32 v81, v154, v155
    v_mfma_f32_16x16x32_bf16 v[124:127], a[124:127], v[44:47], v[124:127]
    ds_write_b64 v14, v[80:81] offset:0
    v_mfma_f32_16x16x32_bf16 v[124:127], a[136:139], v[48:51], v[124:127]
    s_add_u32 s32, s32, 196608
    v_mfma_f32_16x16x32_bf16 v[124:127], a[148:151], v[52:55], v[124:127]
    s_add_u32 s33, s33, 2
    v_mfma_f32_16x16x32_bf16 v[124:127], a[160:163], v[56:59], v[124:127]
    s_cmp_lt_u32 s33, s34
    v_mfma_f32_16x16x32_bf16 v[124:127], a[172:175], v[60:63], v[124:127]
    s_cselect_b32 s14, 50331648, 0
    v_mfma_f32_16x16x32_bf16 v[124:127], a[184:187], v[64:67], v[124:127]
    s_add_u32 s31, s31, 13312
    v_mfma_f32_16x16x32_bf16 v[124:127], a[196:199], v[68:71], v[124:127]
    s_cmp_eq_u32 s31, 53248
    v_mfma_f32_16x16x32_bf16 v[124:127], a[208:211], v[72:75], v[124:127]
    s_cselect_b32 s31, 0, s31
    v_mfma_f32_16x16x32_bf16 v[128:131], a[116:119], v[40:43], v[104:107]
    v_mfma_f32_16x16x32_bf16 v[128:131], a[128:131], v[44:47], v[128:131]
    s_add_u32 m0, s31, s26
    v_mfma_f32_16x16x32_bf16 v[128:131], a[140:143], v[48:51], v[128:131]
    buffer_load_dwordx4 v2, s[12:15], s32 offen nt lds
    v_mfma_f32_16x16x32_bf16 v[128:131], a[152:155], v[52:55], v[128:131]
    v_mfma_f32_16x16x32_bf16 v[128:131], a[164:167], v[56:59], v[128:131]
    v_mfma_f32_16x16x32_bf16 v[128:131], a[176:179], v[60:63], v[128:131]
    s_add_u32 m0, s31, s27
    v_mfma_f32_16x16x32_bf16 v[128:131], a[188:191], v[64:67], v[128:131]
    buffer_load_dwordx4 v3, s[12:15], s32 offen nt lds
    v_mfma_f32_16x16x32_bf16 v[128:131], a[200:203], v[68:71], v[128:131]
    v_mfma_f32_16x16x32_bf16 v[128:131], a[212:215], v[72:75], v[128:131]
    v_mfma_f32_16x16x32_bf16 v[96:99], a[0:3], v[40:43], 0
    s_add_u32 m0, s31, s28
    v_mfma_f32_16x16x32_bf16 v[96:99], a[12:15], v[44:47], v[96:99]
    buffer_load_dwordx4 v4, s[12:15], s32 offen nt lds
    v_mfma_f32_16x16x32_bf16 v[96:99], a[24:27], v[48:51], v[96:99]
    v_mfma_f32_16x16x32_bf16 v[100:103], a[4:7], v[40:43], 0
    v_mfma_f32_16x16x32_bf16 v[100:103], a[16:19], v[44:47], v[100:103]
    s_add_u32 m0, s31, s29
    v_mfma_f32_16x16x32_bf16 v[100:103], a[28:31], v[48:51], v[100:103]
    buffer_load_dwordx4 v5, s[12:15], s32 offen nt lds
    v_mfma_f32_16x16x32_bf16 v[104:107], a[8:11], v[40:43], 0
    ds_read_b128 v[40:43], v9 offset:3072
    v_mfma_f32_16x16x32_bf16 v[104:107], a[20:23], v[44:47], v[104:107]
    ds_read_b128 v[44:47], v9 offset:3136
    v_mfma_f32_16x16x32_bf16 v[104:107], a[32:35], v[48:51], v[104:107]
    ds_read_b128 v[48:51], v9 offset:3200
    v_mfma_f32_16x16x32_bf16 v[96:99], a[36:39], v[52:55], v[96:99]
    v_mfma_f32_16x16x32_bf16 v[96:99], a[48:51], v[56:59], v[96:99]
    v_mfma_f32_16x16x32_bf16 v[96:99], a[60:63], v[60:63], v[96:99]
    v_mfma_f32_16x16x32_bf16 v[100:103], a[40:43], v[52:55], v[100:103]
    v_mfma_f32_16x16x32_bf16 v[100:103], a[52:55], v[56:59], v[100:103]
    v_mfma_f32_16x16x32_bf16 v[100:103], a[64:67], v[60:63], v[100:103]
    v_mfma_f32_16x16x32_bf16 v[104:107], a[44:47], v[52:55], v[104:107]
    ds_read_b128 v[52:55], v10 offset:3072
    v_mfma_f32_16x16x32_bf16 v[104:107], a[56:59], v[56:59], v[104:107]
    ds_read_b128 v[56:59], v10 offset:3136
    v_mfma_f32_16x16x32_bf16 v[104:107], a[68:71], v[60:63], v[104:107]
    ds_read_b128 v[60:63], v10 offset:3200
    v_mfma_f32_16x16x32_bf16 v[96:99], a[72:75], v[64:67], v[96:99]
    v_mfma_f32_16x16x32_bf16 v[96:99], a[84:87], v[68:71], v[96:99]
    v_mfma_f32_16x16x32_bf16 v[96:99], a[96:99], v[72:75], v[96:99]
    v_mfma_f32_16x16x32_bf16 v[100:103], a[76:79], v[64:67], v[100:103]
    v_mfma_f32_16x16x32_bf16 v[100:103], a[88:91], v[68:71], v[100:103]
    v_mfma_f32_16x16x32_bf16 v[100:103], a[100:103], v[72:75], v[100:103]
    v_mfma_f32_16x16x32_bf16 v[104:107], a[80:83], v[64:67], v[104:107]
    ds_read_b128 v[64:67], v11 offset:3072
    v_mfma_f32_16x16x32_bf16 v[104:107], a[92:95], v[68:71], v[104:107]
    ds_read_b128 v[68:71], v11 offset:3136
    v_mfma_f32_16x16x32_bf16 v[104:107], a[104:107], v[72:75], v[104:107]
    ds_read_b128 v[72:75], v11 offset:3200
    s_waitcnt lgkmcnt(6)
    v_mfma_f32_16x16x32_bf16 v[156:159], a[216:219], v[40:43], v[132:135]
    v_mfma_f32_16x16x32_bf16 v[156:159], a[228:231], v[44:47], v[156:159]
    v_mfma_f32_16x16x32_bf16 v[156:159], a[240:243], v[48:51], v[156:159]
    s_waitcnt lgkmcnt(3)
    v_mfma_f32_16x16x32_bf16 v[156:159], a[252:255], v[52:55], v[156:159]
    v_mfma_f32_16x16x32_bf16 v[156:159], v[176:179], v[56:59], v[156:159]
    v_mfma_f32_16x16x32_bf16 v[156:159], v[188:191], v[60:63], v[156:159]
    s_waitcnt lgkmcnt(0)
    v_mfma_f32_16x16x32_bf16 v[156:159], v[200:203], v[64:67], v[156:159]
    v_mfma_f32_16x16x32_bf16 v[156:159], v[212:215], v[68:71], v[156:159]
    v_mfma_f32_16x16x32_bf16 v[156:159], v[224:227], v[72:75], v[156:159]
    v_mfma_f32_16x16x32_bf16 v[160:163], a[220:223], v[40:43], v[136:139]
    s_add_u32 s30, s30, 13312
    v_mfma_f32_16x16x32_bf16 v[160:163], a[232:235], v[44:47], v[160:163]
    s_cmp_eq_u32 s30, 53248
    v_mfma_f32_16x16x32_bf16 v[160:163], a[244:247], v[48:51], v[160:163]
    s_cselect_b32 s30, 0, s30
    v_mfma_f32_16x16x32_bf16 v[160:163], v[168:171], v[52:55], v[160:163]
    v_add_u32 v9, s30, v6
    v_mfma_f32_16x16x32_bf16 v[160:163], v[180:183], v[56:59], v[160:163]
    v_add_u32 v10, s30, v7
    v_mfma_f32_16x16x32_bf16 v[160:163], v[192:195], v[60:63], v[160:163]
    v_add_u32 v11, s30, v8
    v_mfma_f32_16x16x32_bf16 v[160:163], v[204:207], v[64:67], v[160:163]
    v_mfma_f32_16x16x32_bf16 v[160:163], v[216:219], v[68:71], v[160:163]
    v_mfma_f32_16x16x32_bf16 v[160:163], v[228:231], v[72:75], v[160:163]
    v_cvt_pk_bf16_f32 v76, v156, v157
    v_mfma_f32_16x16x32_bf16 v[164:167], a[224:227], v[40:43], v[140:143]
    v_cvt_pk_bf16_f32 v77, v158, v159
    v_mfma_f32_16x16x32_bf16 v[164:167], a[236:239], v[44:47], v[164:167]
    ds_write_b64 v12, v[76:77] offset:3072
    v_mfma_f32_16x16x32_bf16 v[164:167], a[248:251], v[48:51], v[164:167]
    v_mfma_f32_16x16x32_bf16 v[164:167], v[172:175], v[52:55], v[164:167]
    v_mfma_f32_16x16x32_bf16 v[164:167], v[184:187], v[56:59], v[164:167]
    v_mfma_f32_16x16x32_bf16 v[164:167], v[196:199], v[60:63], v[164:167]
    v_mfma_f32_16x16x32_bf16 v[164:167], v[208:211], v[64:67], v[164:167]
    v_mfma_f32_16x16x32_bf16 v[164:167], v[220:223], v[68:71], v[164:167]
    v_mfma_f32_16x16x32_bf16 v[164:167], v[232:235], v[72:75], v[164:167]
    v_cvt_pk_bf16_f32 v78, v160, v161
    v_mfma_f32_16x16x32_bf16 v[132:135], a[108:111], v[40:43], v[108:111]
    v_cvt_pk_bf16_f32 v79, v162, v163
    v_mfma_f32_16x16x32_bf16 v[132:135], a[120:123], v[44:47], v[132:135]
    ds_write_b64 v13, v[78:79] offset:3072
    v_mfma_f32_16x16x32_bf16 v[132:135], a[132:135], v[48:51], v[132:135]
    v_mfma_f32_16x16x32_bf16 v[132:135], a[144:147], v[52:55], v[132:135]
    v_mfma_f32_16x16x32_bf16 v[132:135], a[156:159], v[56:59], v[132:135]
    v_mfma_f32_16x16x32_bf16 v[132:135], a[168:171], v[60:63], v[132:135]
    v_mfma_f32_16x16x32_bf16 v[132:135], a[180:183], v[64:67], v[132:135]
    v_mfma_f32_16x16x32_bf16 v[132:135], a[192:195], v[68:71], v[132:135]
    v_mfma_f32_16x16x32_bf16 v[132:135], a[204:207], v[72:75], v[132:135]
    v_cvt_pk_bf16_f32 v80, v164, v165
    v_mfma_f32_16x16x32_bf16 v[136:139], a[112:115], v[40:43], v[112:115]
    v_cvt_pk_bf16_f32 v81, v166, v167
    v_mfma_f32_16x16x32_bf16 v[136:139], a[124:127], v[44:47], v[136:139]
    ds_write_b64 v14, v[80:81] offset:3072
    v_mfma_f32_16x16x32_bf16 v[136:139], a[136:139], v[48:51], v[136:139]
    v_mfma_f32_16x16x32_bf16 v[136:139], a[148:151], v[52:55], v[136:139]
    v_mfma_f32_16x16x32_bf16 v[136:139], a[160:163], v[56:59], v[136:139]
    v_add_u32 v243, 1, v243
    v_mfma_f32_16x16x32_bf16 v[136:139], a[172:175], v[60:63], v[136:139]
    s_add_u32 s63, s63, 1
    v_mfma_f32_16x16x32_bf16 v[136:139], a[184:187], v[64:67], v[136:139]
    s_waitcnt vmcnt(11)
    ds_write_b32 v242, v243
    v_mfma_f32_16x16x32_bf16 v[136:139], a[196:199], v[68:71], v[136:139]
    v_mfma_f32_16x16x32_bf16 v[136:139], a[208:211], v[72:75], v[136:139]
    v_mfma_f32_16x16x32_bf16 v[140:143], a[116:119], v[40:43], v[116:119]
    v_mfma_f32_16x16x32_bf16 v[140:143], a[128:131], v[44:47], v[140:143]
    v_mfma_f32_16x16x32_bf16 v[140:143], a[140:143], v[48:51], v[140:143]
    v_mfma_f32_16x16x32_bf16 v[140:143], a[152:155], v[52:55], v[140:143]
    v_mfma_f32_16x16x32_bf16 v[140:143], a[164:167], v[56:59], v[140:143]
    v_mfma_f32_16x16x32_bf16 v[140:143], a[176:179], v[60:63], v[140:143]
    v_mfma_f32_16x16x32_bf16 v[140:143], a[188:191], v[64:67], v[140:143]
    v_mfma_f32_16x16x32_bf16 v[140:143], a[200:203], v[68:71], v[140:143]
    v_mfma_f32_16x16x32_bf16 v[140:143], a[212:215], v[72:75], v[140:143]
    ds_read_b128 v[236:239], v244
    v_mfma_f32_16x16x32_bf16 v[108:111], a[0:3], v[40:43], 0
    v_mfma_f32_16x16x32_bf16 v[108:111], a[12:15], v[44:47], v[108:111]
    v_mfma_f32_16x16x32_bf16 v[108:111], a[24:27], v[48:51], v[108:111]
    v_mfma_f32_16x16x32_bf16 v[112:115], a[4:7], v[40:43], 0
    v_mfma_f32_16x16x32_bf16 v[112:115], a[16:19], v[44:47], v[112:115]
    v_mfma_f32_16x16x32_bf16 v[112:115], a[28:31], v[48:51], v[112:115]
    s_waitcnt lgkmcnt(0)
    v_min3_u32 v245, v236, v237, v238
    v_mfma_f32_16x16x32_bf16 v[116:119], a[8:11], v[40:43], 0
    v_min_u32 v245, v245, v239
    v_mfma_f32_16x16x32_bf16 v[116:119], a[20:23], v[44:47], v[116:119]
    v_mfma_f32_16x16x32_bf16 v[116:119], a[32:35], v[48:51], v[116:119]
    v_readfirstlane_b32 s57, v245
    v_mfma_f32_16x16x32_bf16 v[108:111], a[36:39], v[52:55], v[108:111]
    v_mfma_f32_16x16x32_bf16 v[108:111], a[48:51], v[56:59], v[108:111]
    v_mfma_f32_16x16x32_bf16 v[108:111], a[60:63], v[60:63], v[108:111]
    s_cmp_ge_u32 s57, s63
    s_cbranch_scc0 L_slow
L_back:
    v_mfma_f32_16x16x32_bf16 v[112:115], a[40:43], v[52:55], v[112:115]
    ds_read_b128 v[40:43], v9 offset:0
    v_mfma_f32_16x16x32_bf16 v[112:115], a[52:55], v[56:59], v[112:115]
    ds_read_b128 v[44:47], v9 offset:64
    v_mfma_f32_16x16x32_bf16 v[112:115], a[64:67], v[60:63], v[112:115]
    ds_read_b128 v[48:51], v9 offset:128
    v_mfma_f32_16x16x32_bf16 v[116:119], a[44:47], v[52:55], v[116:119]
    ds_read_b128 v[52:55], v10 offset:0
    v_mfma_f32_16x16x32_bf16 v[116:119], a[56:59], v[56:59], v[116:119]
    ds_read_b128 v[56:59], v10 offset:64
    v_mfma_f32_16x16x32_bf16 v[116:119], a[68:71], v[60:63], v[116:119]
    ds_read_b128 v[60:63], v10 offset:128
    v_mfma_f32_16x16x32_bf16 v[108:111], a[72:75], v[64:67], v[108:111]
    v_mfma_f32_16x16x32_bf16 v[108:111], a[84:87], v[68:71], v[108:111]
    v_mfma_f32_16x16x32_bf16 v[108:111], a[96:99], v[72:75], v[108:111]
    s_sub_u32 s36, s36, 1
    v_mfma_f32_16x16x32_bf16 v[112:115], a[76:79], v[64:67], v[112:115]
    s_cmp_lg_u32 s36, 0
    v_mfma_f32_16x16x32_bf16 v[112:115], a[88:91], v[68:71], v[112:115]
    v_mfma_f32_16x16x32_bf16 v[112:115], a[100:103], v[72:75], v[112:115]
    v_mfma_f32_16x16x32_bf16 v[116:119], a[80:83], v[64:67], v[116:119]
    ds_read_b128 v[64:67], v11 offset:0
    v_mfma_f32_16x16x32_bf16 v[116:119], a[92:95], v[68:71], v[116:119]
    ds_read_b128 v[68:71], v11 offset:64
    v_mfma_f32_16x16x32_bf16 v[116:119], a[104:107], v[72:75], v[116:119]
    ds_read_b128 v[72:75], v11 offset:128
    s_cbranch_scc1 L_loop
    s_waitcnt lgkmcnt(6)
    v_mfma_f32_16x16x32_bf16 v[144:147], a[216:219], v[40:43], v[120:123]
    v_xor_b32 v12, 0x4000, v12
    v_mfma_f32_16x16x32_bf16 v[144:147], a[228:231], v[44:47], v[144:147]
    v_xor_b32 v13, 0x4000, v13
    v_mfma_f32_16x16x32_bf16 v[144:147], a[240:243], v[48:51], v[144:147]
    v_xor_b32 v14, 0x4000, v14
    s_waitcnt lgkmcnt(3)
    v_mfma_f32_16x16x32_bf16 v[144:147], a[252:255], v[52:55], v[144:147]
    v_mfma_f32_16x16x32_bf16 v[144:147], v[176:179], v[56:59], v[144:147]
    v_mfma_f32_16x16x32_bf16 v[144:147], v[188:191], v[60:63], v[144:147]
    s_waitcnt lgkmcnt(0)
    v_mfma_f32_16x16x32_bf16 v[144:147], v[200:203], v[64:67], v[144:147]
    ds_read_b128 v[84:87], v15
    v_mfma_f32_16x16x32_bf16 v[144:147], v[212:215], v[68:71], v[144:147]
    ds_read_b128 v[88:91], v16
    v_mfma_f32_16x16x32_bf16 v[144:147], v[224:227], v[72:75], v[144:147]
    ds_read_b128 v[92:95], v17
    v_mfma_f32_16x16x32_bf16 v[148:151], a[220:223], v[40:43], v[124:127]
    v_xor_b32 v15, 0x4000, v15
    v_mfma_f32_16x16x32_bf16 v[148:151], a[232:235], v[44:47], v[148:151]
    v_xor_b32 v16, 0x4000, v16
    v_mfma_f32_16x16x32_bf16 v[148:151], a[244:247], v[48:51], v[148:151]
    v_xor_b32 v17, 0x4000, v17
    v_mfma_f32_16x16x32_bf16 v[148:151], v[168:171], v[52:55], v[148:151]
    s_waitcnt lgkmcnt(2)
    buffer_store_dwordx4 v[84:87], v18, s[20:23], s35 offen offset:0 sc1
    v_mfma_f32_16x16x32_bf16 v[148:151], v[180:183], v[56:59], v[148:151]
    v_mfma_f32_16x16x32_bf16 v[148:151], v[192:195], v[60:63], v[148:151]
    v_mfma_f32_16x16x32_bf16 v[148:151], v[204:207], v[64:67], v[148:151]
    v_mfma_f32_16x16x32_bf16 v[148:151], v[216:219], v[68:71], v[148:151]
    v_mfma_f32_16x16x32_bf16 v[148:151], v[228:231], v[72:75], v[148:151]
    v_cvt_pk_bf16_f32 v76, v144, v145
    v_mfma_f32_16x16x32_bf16 v[152:155], a[224:227], v[40:43], v[128:131]
    v_cvt_pk_bf16_f32 v77, v146, v147
    v_mfma_f32_16x16x32_bf16 v[152:155], a[236:239], v[44:47], v[152:155]
    ds_write_b64 v12, v[76:77] offset:0
    v_mfma_f32_16x16x32_bf16 v[152:155], a[248:251], v[48:51], v[152:155]
    s_waitcnt lgkmcnt(2)
    buffer_store_dwordx4 v[88:91], v18, s[20:23], s35 offen offset:1024 sc1
    v_mfma_f32_16x16x32_bf16 v[152:155], v[172:175], v[52:55], v[152:155]
    v_mfma_f32_16x16x32_bf16 v[152:155], v[184:187], v[56:59], v[152:155]
    v_mfma_f32_16x16x32_bf16 v[152:155], v[196:199], v[60:63], v[152:155]
    v_mfma_f32_16x16x32_bf16 v[152:155], v[208:211], v[64:67], v[152:155]
    v_mfma_f32_16x16x32_bf16 v[152:155], v[220:223], v[68:71], v[152:155]
    v_mfma_f32_16x16x32_bf16 v[152:155], v[232:235], v[72:75], v[152:155]
    v_cvt_pk_bf16_f32 v78, v148, v149
    v_mfma_f32_16x16x32_bf16 v[120:123], a[108:111], v[40:43], v[96:99]
    v_cvt_pk_bf16_f32 v79, v150, v151
    v_mfma_f32_16x16x32_bf16 v[120:123], a[120:123], v[44:47], v[120:123]
    s_waitcnt lgkmcnt(1)
    buffer_store_dwordx4 v[92:95], v18, s[20:23], s35 offen offset:2048 sc1
    ds_write_b64 v13, v[78:79] offset:0
    v_mfma_f32_16x16x32_bf16 v[120:123], a[132:135], v[48:51], v[120:123]
    s_add_u32 s35, s35, 196608
    v_mfma_f32_16x16x32_bf16 v[124:127], a[112:115], v[40:43], v[100:103]
    v_mfma_f32_16x16x32_bf16 v[124:127], a[124:127], v[44:47], v[124:127]
    v_mfma_f32_16x16x32_bf16 v[124:127], a[136:139], v[48:51], v[124:127]
    v_mfma_f32_16x16x32_bf16 v[128:131], a[116:119], v[40:43], v[104:107]
    ds_read_b128 v[40:43], v9 offset:3072
    v_mfma_f32_16x16x32_bf16 v[128:131], a[128:131], v[44:47], v[128:131]
    ds_read_b128 v[44:47], v9 offset:3136
    v_mfma_f32_16x16x32_bf16 v[128:131], a[140:143], v[48:51], v[128:131]
    v_cvt_pk_bf16_f32 v80, v152, v153
    ds_read_b128 v[48:51], v9 offset:3200
    v_mfma_f32_16x16x32_bf16 v[120:123], a[144:147], v[52:55], v[120:123]
    v_cvt_pk_bf16_f32 v81, v154, v155
    v_mfma_f32_16x16x32_bf16 v[120:123], a[156:159], v[56:59], v[120:123]
    ds_write_b64 v14, v[80:81] offset:0
    v_mfma_f32_16x16x32_bf16 v[120:123], a[168:171], v[60:63], v[120:123]
    v_mfma_f32_16x16x32_bf16 v[124:127], a[148:151], v[52:55], v[124:127]
    v_mfma_f32_16x16x32_bf16 v[124:127], a[160:163], v[56:59], v[124:127]
    v_mfma_f32_16x16x32_bf16 v[124:127], a[172:175], v[60:63], v[124:127]
    v_mfma_f32_16x16x32_bf16 v[128:131], a[152:155], v[52:55], v[128:131]
    ds_read_b128 v[52:55], v10 offset:3072
    v_mfma_f32_16x16x32_bf16 v[128:131], a[164:167], v[56:59], v[128:131]
    ds_read_b128 v[56:59], v10 offset:3136
    v_mfma_f32_16x16x32_bf16 v[128:131], a[176:179], v[60:63], v[128:131]
    ds_read_b128 v[60:63], v10 offset:3200
    v_mfma_f32_16x16x32_bf16 v[120:123], a[180:183], v[64:67], v[120:123]
    v_mfma_f32_16x16x32_bf16 v[120:123], a[192:195], v[68:71], v[120:123]
    v_mfma_f32_16x16x32_bf16 v[120:123], a[204:207], v[72:75], v[120:123]
    v_mfma_f32_16x16x32_bf16 v[124:127], a[184:187], v[64:67], v[124:127]
    v_mfma_f32_16x16x32_bf16 v[124:127], a[196:199], v[68:71], v[124:127]
    v_mfma_f32_16x16x32_bf16 v[124:127], a[208:211], v[72:75], v[124:127]
    v_mfma_f32_16x16x32_bf16 v[128:131], a[188:191], v[64:67], v[128:131]
    ds_read_b128 v[64:67], v11 offset:3072
    v_mfma_f32_16x16x32_bf16 v[128:131], a[200:203], v[68:71], v[128:131]
    ds_read_b128 v[68:71], v11 offset:3136
    v_mfma_f32_16x16x32_bf16 v[128:131], a[212:215], v[72:75], v[128:131]
    ds_read_b128 v[72:75], v11 offset:3200
    s_waitcnt lgkmcnt(7)
    v_mfma_f32_16x16x32_bf16 v[156:159], a[216:219], v[40:43], v[132:135]
    v_mfma_f32_16x16x32_bf16 v[156:159], a[228:231], v[44:47], v[156:159]
    v_mfma_f32_16x16x32_bf16 v[156:159], a[240:243], v[48:51], v[156:159]
    s_waitcnt lgkmcnt(3)
    v_mfma_f32_16x16x32_bf16 v[156:159], a[252:255], v[52:55], v[156:159]
    v_mfma_f32_16x16x32_bf16 v[156:159], v[176:179], v[56:59], v[156:159]
    v_mfma_f32_16x16x32_bf16 v[156:159], v[188:191], v[60:63], v[156:159]
    s_waitcnt lgkmcnt(0)
    v_mfma_f32_16x16x32_bf16 v[156:159], v[200:203], v[64:67], v[156:159]
    v_mfma_f32_16x16x32_bf16 v[156:159], v[212:215], v[68:71], v[156:159]
    v_mfma_f32_16x16x32_bf16 v[156:159], v[224:227], v[72:75], v[156:159]
    v_mfma_f32_16x16x32_bf16 v[160:163], a[220:223], v[40:43], v[136:139]
    s_add_u32 s30, s30, 13312
    v_mfma_f32_16x16x32_bf16 v[160:163], a[232:235], v[44:47], v[160:163]
    s_cmp_eq_u32 s30, 53248
    v_mfma_f32_16x16x32_bf16 v[160:163], a[244:247], v[48:51], v[160:163]
    s_cselect_b32 s30, 0, s30
    v_mfma_f32_16x16x32_bf16 v[160:163], v[168:171], v[52:55], v[160:163]
    v_add_u32 v9, s30, v6
    v_mfma_f32_16x16x32_bf16 v[160:163], v[180:183], v[56:59], v[160:163]
    v_add_u32 v10, s30, v7
    v_mfma_f32_16x16x32_bf16 v[160:163], v[192:195], v[60:63], v[160:163]
    v_add_u32 v11, s30, v8
    v_mfma_f32_16x16x32_bf16 v[160:163], v[204:207], v[64:67], v[160:163]
    v_mfma_f32_16x16x32_bf16 v[160:163], v[216:219], v[68:71], v[160:163]
    v_mfma_f32_16x16x32_bf16 v[160:163], v[228:231], v[72:75], v[160:163]
    v_cvt_pk_bf16_f32 v76, v156, v157
    v_mfma_f32_16x16x32_bf16 v[164:167], a[224:227], v[40:43], v[140:143]
    v_cvt_pk_bf16_f32 v77, v158, v159
    v_mfma_f32_16x16x32_bf16 v[164:167], a[236:239], v[44:47], v[164:167]
    ds_write_b64 v12, v[76:77] offset:3072
    v_mfma_f32_16x16x32_bf16 v[164:167], a[248:251], v[48:51], v[164:167]
    v_mfma_f32_16x16x32_bf16 v[164:167], v[172:175], v[52:55], v[164:167]
    v_mfma_f32_16x16x32_bf16 v[164:167], v[184:187], v[56:59], v[164:167]
    v_mfma_f32_16x16x32_bf16 v[164:167], v[196:199], v[60:63], v[164:167]
    v_mfma_f32_16x16x32_bf16 v[164:167], v[208:211], v[64:67], v[164:167]
    v_mfma_f32_16x16x32_bf16 v[164:167], v[220:223], v[68:71], v[164:167]
    v_mfma_f32_16x16x32_bf16 v[164:167], v[232:235], v[72:75], v[164:167]
    v_cvt_pk_bf16_f32 v78, v160, v161
    v_mfma_f32_16x16x32_bf16 v[132:135], a[108:111], v[40:43], v[108:111]
    v_cvt_pk_bf16_f32 v79, v162, v163
    v_mfma_f32_16x16x32_bf16 v[132:135], a[120:123], v[44:47], v[132:135]
    ds_write_b64 v13, v[78:79] offset:3072
    v_mfma_f32_16x16x32_bf16 v[132:135], a[132:135], v[48:51], v[132:135]
    v_mfma_f32_16x16x32_bf16 v[136:139], a[112:115], v[40:43], v[112:115]
    v_mfma_f32_16x16x32_bf16 v[136:139], a[124:127], v[44:47], v[136:139]
    v_mfma_f32_16x16x32_bf16 v[136:139], a[136:139], v[48:51], v[136:139]
    v_mfma_f32_16x16x32_bf16 v[140:143], a[116:119], v[40:43], v[116:119]
    v_mfma_f32_16x16x32_bf16 v[140:143], a[128:131], v[44:47], v[140:143]
    v_mfma_f32_16x16x32_bf16 v[140:143], a[140:143], v[48:51], v[140:143]
    v_cvt_pk_bf16_f32 v80, v164, v165
    v_mfma_f32_16x16x32_bf16 v[132:135], a[144:147], v[52:55], v[132:135]
    v_cvt_pk_bf16_f32 v81, v166, v167
    v_mfma_f32_16x16x32_bf16 v[132:135], a[156:159], v[56:59], v[132:135]
    ds_write_b64 v14, v[80:81] offset:3072
    v_mfma_f32_16x16x32_bf16 v[132:135], a[168:171], v[60:63], v[132:135]
    v_mfma_f32_16x16x32_bf16 v[136:139], a[148:151], v[52:55], v[136:139]
    s_waitcnt vmcnt(10) lgkmcnt(0)
    s_barrier
    v_mfma_f32_16x16x32_bf16 v[136:139], a[160:163], v[56:59], v[136:139]
    ds_read_b128 v[40:43], v9 offset:0
    v_mfma_f32_16x16x32_bf16 v[136:139], a[172:175], v[60:63], v[136:139]
    ds_read_b128 v[44:47], v9 offset:64
    v_mfma_f32_16x16x32_bf16 v[140:143], a[152:155], v[52:55], v[140:143]
    ds_read_b128 v[48:51], v9 offset:128
    v_mfma_f32_16x16x32_bf16 v[140:143], a[164:167], v[56:59], v[140:143]
    ds_read_b128 v[52:55], v10 offset:0
    v_mfma_f32_16x16x32_bf16 v[140:143], a[176:179], v[60:63], v[140:143]
    ds_read_b128 v[56:59], v10 offset:64
    v_mfma_f32_16x16x32_bf16 v[132:135], a[180:183], v[64:67], v[132:135]
    ds_read_b128 v[60:63], v10 offset:128
    v_mfma_f32_16x16x32_bf16 v[132:135], a[192:195], v[68:71], v[132:135]
    v_mfma_f32_16x16x32_bf16 v[132:135], a[204:207], v[72:75], v[132:135]
    v_mfma_f32_16x16x32_bf16 v[136:139], a[184:187], v[64:67], v[136:139]
    v_mfma_f32_16x16x32_bf16 v[136:139], a[196:199], v[68:71], v[136:139]
    v_mfma_f32_16x16x32_bf16 v[136:139], a[208:211], v[72:75], v[136:139]
    v_mfma_f32_16x16x32_bf16 v[140:143], a[188:191], v[64:67], v[140:143]
    ds_read_b128 v[64:67], v11 offset:0
    v_mfma_f32_16x16x32_bf16 v[140:143], a[200:203], v[68:71], v[140:143]
    ds_read_b128 v[68:71], v11 offset:64
    v_mfma_f32_16x16x32_bf16 v[140:143], a[212:215], v[72:75], v[140:143]
    ds_read_b128 v[72:75], v11 offset:128
    s_waitcnt lgkmcnt(6)
    v_mfma_f32_16x16x32_bf16 v[144:147], a[216:219], v[40:43], v[120:123]
    v_xor_b32 v12, 0x4000, v12
    v_mfma_f32_16x16x32_bf16 v[144:147], a[228:231], v[44:47], v[144:147]
    v_xor_b32 v13, 0x4000, v13
    v_mfma_f32_16x16x32_bf16 v[144:147], a[240:243], v[48:51], v[144:147]
    v_xor_b32 v14, 0x4000, v14
    s_waitcnt lgkmcnt(3)
    v_mfma_f32_16x16x32_bf16 v[144:147], a[252:255], v[52:55], v[144:147]
    v_mfma_f32_16x16x32_bf16 v[144:147], v[176:179], v[56:59], v[144:147]
    v_mfma_f32_16x16x32_bf16 v[144:147], v[188:191], v[60:63], v[144:147]
    s_waitcnt lgkmcnt(0)
    v_mfma_f32_16x16x32_bf16 v[144:147], v[200:203], v[64:67], v[144:147]
    ds_read_b128 v[84:87], v15
    v_mfma_f32_16x16x32_bf16 v[144:147], v[212:215], v[68:71], v[144:147]
    ds_read_b128 v[88:91], v16
    v_mfma_f32_16x16x32_bf16 v[144:147], v[224:227], v[72:75], v[144:147]
    ds_read_b128 v[92:95], v17
    v_mfma_f32_16x16x32_bf16 v[148:151], a[220:223], v[40:43], v[124:127]
    v_xor_b32 v15, 0x4000, v15
    v_mfma_f32_16x16x32_bf16 v[148:151], a[232:235], v[44:47], v[148:151]
    v_xor_b32 v16, 0x4000, v16
    v_mfma_f32_16x16x32_bf16 v[148:151], a[244:247], v[48:51], v[148:151]
    v_xor_b32 v17, 0x4000, v17
    v_mfma_f32_16x16x32_bf16 v[148:151], v[168:171], v[52:55], v[148:151]
    s_waitcnt lgkmcnt(2)
    buffer_store_dwordx4 v[84:87], v18, s[20:23], s35 offen offset:0 sc1
    v_mfma_f32_16x16x32_bf16 v[148:151], v[180:183], v[56:59], v[148:151]
    v_mfma_f32_16x16x32_bf16 v[148:151], v[192:195], v[60:63], v[148:151]
    v_mfma_f32_16x16x32_bf16 v[148:151], v[204:207], v[64:67], v[148:151]
    v_mfma_f32_16x16x32_bf16 v[148:151], v[216:219], v[68:71], v[148:151]
    v_mfma_f32_16x16x32_bf16 v[148:151], v[228:231], v[72:75], v[148:151]
    v_cvt_pk_bf16_f32 v76, v144, v145
    v_mfma_f32_16x16x32_bf16 v[152:155], a[224:227], v[40:43], v[128:131]
    ds_read_b128 v[40:43], v9 offset:3072
    v_cvt_pk_bf16_f32 v77, v146, v147
    v_mfma_f32_16x16x32_bf16 v[152:155], a[236:239], v[44:47], v[152:155]
    ds_read_b128 v[44:47], v9 offset:3136
    ds_write_b64 v12, v[76:77] offset:0
    v_mfma_f32_16x16x32_bf16 v[152:155], a[248:251], v[48:51], v[152:155]
    s_waitcnt lgkmcnt(4)
    buffer_store_dwordx4 v[88:91], v18, s[20:23], s35 offen offset:1024 sc1
    ds_read_b128 v[48:51], v9 offset:3200
    v_mfma_f32_16x16x32_bf16 v[152:155], v[172:175], v[52:55], v[152:155]
    ds_read_b128 v[52:55], v10 offset:3072
    v_mfma_f32_16x16x32_bf16 v[152:155], v[184:187], v[56:59], v[152:155]
    ds_read_b128 v[56:59], v10 offset:3136
    v_mfma_f32_16x16x32_bf16 v[152:155], v[196:199], v[60:63], v[152:155]
    ds_read_b128 v[60:63], v10 offset:3200
    v_mfma_f32_16x16x32_bf16 v[152:155], v[208:211], v[64:67], v[152:155]
    ds_read_b128 v[64:67], v11 offset:3072
    v_mfma_f32_16x16x32_bf16 v[152:155], v[220:223], v[68:71], v[152:155]
    ds_read_b128 v[68:71], v11 offset:3136
    v_mfma_f32_16x16x32_bf16 v[152:155], v[232:235], v[72:75], v[152:155]
    ds_read_b128 v[72:75], v11 offset:3200
    v_cvt_pk_bf16_f32 v78, v148, v149
    s_waitcnt lgkmcnt(6)
    v_mfma_f32_16x16x32_bf16 v[156:159], a[216:219], v[40:43], v[132:135]
    v_cvt_pk_bf16_f32 v79, v150, v151
    v_mfma_f32_16x16x32_bf16 v[156:159], a[228:231], v[44:47], v[156:159]
    buffer_store_dwordx4 v[92:95], v18, s[20:23], s35 offen offset:2048 sc1
    ds_write_b64 v13, v[78:79] offset:0
    v_mfma_f32_16x16x32_bf16 v[156:159], a[240:243], v[48:51], v[156:159]
    s_add_u32 s35, s35, 196608
    s_waitcnt lgkmcnt(4)
    v_mfma_f32_16x16x32_bf16 v[156:159], a[252:255], v[52:55], v[156:159]
    v_mfma_f32_16x16x32_bf16 v[156:159], v[176:179], v[56:59], v[156:159]
    v_mfma_f32_16x16x32_bf16 v[156:159], v[188:191], v[60:63], v[156:159]
    s_waitcnt lgkmcnt(1)
    v_mfma_f32_16x16x32_bf16 v[156:159], v[200:203], v[64:67], v[156:159]
    v_mfma_f32_16x16x32_bf16 v[156:159], v[212:215], v[68:71], v[156:159]
    v_mfma_f32_16x16x32_bf16 v[156:159], v[224:227], v[72:75], v[156:159]
    v_cvt_pk_bf16_f32 v80, v152, v153
    v_mfma_f32_16x16x32_bf16 v[160:163], a[220:223], v[40:43], v[136:139]
    v_cvt_pk_bf16_f32 v81, v154, v155
    v_mfma_f32_16x16x32_bf16 v[160:163], a[232:235], v[44:47], v[160:163]
    ds_write_b64 v14, v[80:81] offset:0
    v_mfma_f32_16x16x32_bf16 v[160:163], a[244:247], v[48:51], v[160:163]
    v_mfma_f32_16x16x32_bf16 v[160:163], v[168:171], v[52:55], v[160:163]
    v_mfma_f32_16x16x32_bf16 v[160:163], v[180:183], v[56:59], v[160:163]
    v_mfma_f32_16x16x32_bf16 v[160:163], v[192:195], v[60:63], v[160:163]
    v_mfma_f32_16x16x32_bf16 v[160:163], v[204:207], v[64:67], v[160:163]
    v_mfma_f32_16x16x32_bf16 v[160:163], v[216:219], v[68:71], v[160:163]
    v_mfma_f32_16x16x32_bf16 v[160:163], v[228:231], v[72:75], v[160:163]
    v_cvt_pk_bf16_f32 v76, v156, v157
    v_mfma_f32_16x16x32_bf16 v[164:167], a[224:227], v[40:43], v[140:143]
    v_cvt_pk_bf16_f32 v77, v158, v159
    v_mfma_f32_16x16x32_bf16 v[164:167], a[236:239], v[44:47], v[164:167]
    ds_write_b64 v12, v[76:77] offset:3072
    v_mfma_f32_16x16x32_bf16 v[164:167], a[248:251], v[48:51], v[164:167]
    v_mfma_f32_16x16x32_bf16 v[164:167], v[172:175], v[52:55], v[164:167]
    v_mfma_f32_16x16x32_bf16 v[164:167], v[184:187], v[56:59], v[164:167]
    v_mfma_f32_16x16x32_bf16 v[164:167], v[196:199], v[60:63], v[164:167]
    v_mfma_f32_16x16x32_bf16 v[164:167], v[208:211], v[64:67], v[164:167]
    v_mfma_f32_16x16x32_bf16 v[164:167], v[220:223], v[68:71], v[164:167]
    v_mfma_f32_16x16x32_bf16 v[164:167], v[232:235], v[72:75], v[164:167]
    v_cvt_pk_bf16_f32 v78, v160, v161
    s_nop 7
    v_cvt_pk_bf16_f32 v79, v162, v163
    ds_write_b64 v13, v[78:79] offset:3072
    v_cvt_pk_bf16_f32 v80, v164, v165
    v_cvt_pk_bf16_f32 v81, v166, v167
    ds_write_b64 v14, v[80:81] offset:3072
    s_waitcnt lgkmcnt(0)
    s_barrier
    ds_read_b128 v[84:87], v15
    ds_read_b128 v[88:91], v16
    ds_read_b128 v[92:95], v17
    s_waitcnt lgkmcnt(2)
    buffer_store_dwordx4 v[84:87], v18, s[20:23], s35 offen offset:0 sc1
    s_waitcnt lgkmcnt(1)
    buffer_store_dwordx4 v[88:91], v18, s[20:23], s35 offen offset:1024 sc1
    s_waitcnt lgkmcnt(0)
    buffer_store_dwordx4 v[92:95], v18, s[20:23], s35 offen offset:2048 sc1
L_end:
    s_endpgm
L_slow:
    s_mov_b32 s38, 0
L_slowx:
    ds_read_b128 v[236:239], v244
    s_waitcnt lgkmcnt(0)
    v_min3_u32 v245, v236, v237, v238
    v_min_u32 v245, v245, v239
    s_add_u32 s38, s38, 1
    v_readfirstlane_b32 s57, v245
    s_cmp_gt_u32 s38, 0x40000
    s_cbranch_scc1 L_back
    s_cmp_ge_u32 s57, s63
    s_cbranch_scc0 L_slowx
    s_branch L_back
L_codeend:
.section .rodata,"a"
.p2align 6
.amdhsa_kernel standalone__dilated_atrous__vision_kernel
  .amdhsa_next_free_vgpr 512
  .amdhsa_next_free_sgpr 100
  .amdhsa_accum_offset 256
  .amdhsa_group_segment_fixed_size 0
  .amdhsa_kernarg_size 40
  .amdhsa_user_sgpr_count 2
  .amdhsa_user_sgpr_kernarg_segment_ptr 1
  .amdhsa_system_sgpr_workgroup_id_x 1
.end_amdhsa_kernel
```

```asm
; @launch grid=(256,1,1) block=(256,1,1) lds=163840
.amdgcn_target "amdgcn-amd-amdhsa--gfx950"
.text
.globl standalone__dilated_atrous__vision_kernel
.p2align 8
.type standalone__dilated_atrous__vision_kernel,@function
standalone__dilated_atrous__vision_kernel:
    s_cmp_ge_u32 s2, 256
    s_cbranch_scc1 L_end
    s_load_dwordx4 s[4:7], s[0:1], 0
    s_load_dwordx2 s[8:9], s[0:1], 16
    v_lshrrev_b32 v29, 6, v0
    s_and_b32 s37, s2, 7
    v_readfirstlane_b32 s24, v29
    s_lshr_b32 s38, s2, 3
    s_and_b32 s38, s38, 1
    s_lshr_b32 s39, s2, 4
    s_lshl_b32 s39, s39, 5
    s_add_u32 s25, s39, s38
    s_mul_i32 s40, s37, 12288
    s_sub_u32 s41, s40, 384
    v_mul_u32_u24 v31, 43691, v0
    v_lshlrev_b32 v32, 4, v0
    v_lshrrev_b32 v31, 19, v31
    v_and_b32 v33, 4, v31
    v_and_b32 v34, 8, v31
    v_lshlrev_b32 v33, 3, v33
    v_lshlrev_b32 v34, 2, v34
    v_xor_b32 v33, v33, v32
    v_xor_b32 v19, v34, v32
    v_add_u32 v2, s41, v33
    v_add_u32 v30, 256, v0
    v_mul_u32_u24 v31, 43691, v30
    v_lshlrev_b32 v32, 4, v30
    v_lshrrev_b32 v31, 19, v31
    v_and_b32 v33, 4, v31
    v_and_b32 v34, 8, v31
    v_lshlrev_b32 v33, 3, v33
    v_lshlrev_b32 v34, 2, v34
    v_xor_b32 v33, v33, v32
    v_xor_b32 v20, v34, v32
    v_add_u32 v3, s41, v33
    v_add_u32 v30, 512, v0
    v_mul_u32_u24 v31, 43691, v30
    v_lshlrev_b32 v32, 4, v30
    v_lshrrev_b32 v31, 19, v31
    v_and_b32 v33, 4, v31
    v_and_b32 v34, 8, v31
    v_lshlrev_b32 v33, 3, v33
    v_lshlrev_b32 v34, 2, v34
    v_xor_b32 v33, v33, v32
    v_xor_b32 v21, v34, v32
    v_add_u32 v4, s41, v33
    s_cmp_eq_u32 s37, 0
    s_cselect_b32 s42, 24, 0
    v_mov_b32 v35, 0x80000000
    v_cmp_gt_u32 vcc, s42, v0
    v_and_b32 v36, 63, v0
    s_lshl_b32 s26, s24, 10
    v_cndmask_b32 v2, v2, v35, vcc
    s_add_u32 s27, s26, 4096
    s_add_u32 s28, s26, 8192
    s_mov_b32 s29, 12288
    s_cmp_eq_u32 s37, 7
    s_cselect_b32 s45, 24, 48
    s_add_u32 s44, s41, 12288
    v_cmp_gt_u32 vcc, s45, v36
    v_lshlrev_b32 v29, 4, v36
    v_add_u32 v29, s44, v29
    v_cndmask_b32 v5, v35, v29, vcc
    s_lshl_b32 s47, s24, 9
    s_mul_i32 s43, s24, 192
    s_add_u32 s62, s43, 12288
    s_add_u32 s44, s41, s62
    s_lshl_b32 s45, s37, 2
    s_add_u32 s45, s45, s24
    s_cmp_ge_u32 s45, 30
    s_cselect_b32 s44, 0x80000000, s44
    v_lshlrev_b32 v29, 4, v36
    v_add_u32 v246, s44, v29
    s_lshr_b32 s45, s2, 3
    s_lshl_b32 s45, s45, 2
    s_add_u32 s45, s45, s24
    s_mul_i32 s45, s45, 1408
    v_lshl_add_u32 v39, v36, 7, s45
    s_mov_b32 s33, s25
    s_mul_i32 s32, s33, 98304
    s_add_u32 s34, s25, 33
    s_min_u32 s34, s34, 512
    s_mov_b32 s14, 50331648
    s_mov_b32 s15, 0x20000
    s_mov_b32 s18, 165888
    s_mov_b32 s19, 0x20000
    s_mov_b32 s30, 0
    s_mov_b32 s31, 0
    s_waitcnt lgkmcnt(0)
    s_mov_b32 s12, s4
    s_and_b32 s13, s5, 0xffff
    s_add_u32 m0, s31, s26
    s_nop 0
    buffer_load_dwordx4 v2, s[12:15], s32 offen nt lds
    s_add_u32 m0, s31, s27
    s_nop 0
    buffer_load_dwordx4 v3, s[12:15], s32 offen nt lds
    s_add_u32 m0, s31, s28
    s_nop 0
    buffer_load_dwordx4 v4, s[12:15], s32 offen nt lds
    s_add_u32 m0, s31, s62
    s_nop 0
    s_mov_b64 exec, 0xfff
    buffer_load_dwordx4 v246, s[12:15], s32 offen nt lds
    s_mov_b64 exec, -1
    s_mov_b32 s16, s6
    s_and_b32 s17, s7, 0xffff
    s_lshl_b32 s42, s24, 5
    s_add_u32 s42, s42, 3328
    v_add_u32 v30, s42, v36
    v_mul_u32_u24 v31, 43691, v30
    v_lshlrev_b32 v32, 4, v30
    v_lshrrev_b32 v31, 19, v31
    v_and_b32 v34, 8, v31
    v_lshlrev_b32 v34, 2, v34
    v_xor_b32 v22, v34, v32
    s_add_u32 m0, s26, 53248
    s_mov_b32 s46, 0
    buffer_load_dwordx4 v19, s[16:19], s46 offen lds
    s_add_u32 m0, s26, 57344
    s_nop 0
    buffer_load_dwordx4 v20, s[16:19], s46 offen lds
    s_add_u32 m0, s26, 61440
    s_nop 0
    buffer_load_dwordx4 v21, s[16:19], s46 offen lds
    s_add_u32 m0, s26, 65536
    s_mov_b32 s46, 12288
    buffer_load_dwordx4 v19, s[16:19], s46 offen lds
    s_add_u32 m0, s26, 69632
    s_nop 0
    buffer_load_dwordx4 v20, s[16:19], s46 offen lds
    s_mov_b32 s16, s6
    s_and_b32 s17, s7, 0xffff
    s_mov_b64 exec, 0x7ff
    buffer_load_dword v38, v39, s[16:19], 0 offen
    s_mov_b64 exec, -1
    v_and_b32 v29, 15, v36
    v_lshrrev_b32 v30, 4, v36
    s_lshr_b32 s42, s24, 1
    s_and_b32 s43, s24, 1
    s_lshl_b32 s42, s42, 5
    s_mul_i32 s43, s43, 96
    v_lshlrev_b32 v31, 4, v30
    v_add_u32 v32, s42, v29
    v_and_b32 v33, 4, v32
    v_mul_u32_u24 v34, 192, v32
    v_lshlrev_b32 v33, 3, v33
    v_xor_b32 v33, v33, v31
    v_add_u32 v6, v34, v33
    v_mov_b32 v9, v6
    v_add_u32 v32, s42, v29
    v_add_u32 v32, 2, v32
    v_and_b32 v33, 4, v32
    v_mul_u32_u24 v34, 192, v32
    v_lshlrev_b32 v33, 3, v33
    v_xor_b32 v33, v33, v31
    v_add_u32 v7, v34, v33
    v_mov_b32 v10, v7
    v_add_u32 v32, s42, v29
    v_add_u32 v32, 4, v32
    v_and_b32 v33, 4, v32
    v_mul_u32_u24 v34, 192, v32
    v_lshlrev_b32 v33, 3, v33
    v_xor_b32 v33, v33, v31
    v_add_u32 v8, v34, v33
    v_mov_b32 v11, v8
    v_lshrrev_b32 v32, 2, v29
    v_lshl_add_u32 v32, v30, 3, v32
    v_mul_u32_u24 v32, 192, v32
    v_and_b32 v33, 3, v29
    v_lshlrev_b32 v33, 3, v33
    v_and_b32 v34, 1, v30
    v_lshlrev_b32 v34, 5, v34
    v_add_u32 v33, s43, v33
    v_add_u32 v35, 0, v33
    v_xor_b32 v35, v35, v34
    v_add_u32 v35, v35, v32
    v_add_u32 v23, 53248, v35
    v_add_u32 v26, 108544, v35
    v_add_u32 v35, 32, v33
    v_xor_b32 v35, v35, v34
    v_add_u32 v35, v35, v32
    v_add_u32 v24, 53248, v35
    v_add_u32 v27, 108544, v35
    v_add_u32 v35, 64, v33
    v_xor_b32 v35, v35, v34
    v_add_u32 v35, v35, v32
    v_add_u32 v25, 53248, v35
    v_add_u32 v28, 108544, v35
    v_add_u32 v32, s42, v29
    v_mul_u32_u24 v32, 192, v32
    v_add_u32 v32, 65536, v32
    v_lshlrev_b32 v33, 3, v29
    v_and_b32 v33, 0x30, v33
    v_lshlrev_b32 v34, 3, v30
    v_add_u32 v34, s43, v34
    v_add_u32 v35, 0, v34
    v_xor_b32 v35, v35, v33
    v_add_u32 v12, v35, v32
    v_add_u32 v35, 32, v34
    v_xor_b32 v35, v35, v33
    v_add_u32 v13, v35, v32
    v_add_u32 v35, 64, v34
    v_xor_b32 v35, v35, v33
    v_add_u32 v14, v35, v32
    s_mul_i32 s44, s24, 192
    v_add_u32 v32, s44, v36
    v_mul_u32_u24 v33, 43691, v32
    v_lshlrev_b32 v34, 4, v32
    v_lshrrev_b32 v33, 16, v33
    v_and_b32 v33, 0x30, v33
    v_xor_b32 v34, v34, v33
    v_add_u32 v15, 65536, v34
    v_add_u32 v32, s44, v36
    v_add_u32 v32, 64, v32
    v_mul_u32_u24 v33, 43691, v32
    v_lshlrev_b32 v34, 4, v32
    v_lshrrev_b32 v33, 16, v33
    v_and_b32 v33, 0x30, v33
    v_xor_b32 v34, v34, v33
    v_add_u32 v16, 65536, v34
    v_add_u32 v32, s44, v36
    v_add_u32 v32, 128, v32
    v_mul_u32_u24 v33, 43691, v32
    v_lshlrev_b32 v34, 4, v32
    v_lshrrev_b32 v33, 16, v33
    v_and_b32 v33, 0x30, v33
    v_xor_b32 v34, v34, v33
    v_add_u32 v17, 65536, v34
    s_lshl_b32 s45, s24, 8
    v_lshlrev_b32 v32, 2, v36
    v_add_u32 v32, s45, v32
    v_add_u32 v82, 108608, v32
    s_lshl_b32 s45, s24, 2
    s_add_u32 s45, s45, 108544
    v_cmp_eq_u32 vcc, 0, v36
    v_mov_b32 v32, s45
    v_mov_b32 v83, 2
    v_cndmask_b32 v82, v82, v32, vcc
    s_mov_b32 s63, 2
    s_mul_i32 s45, s24, 3072
    s_add_u32 s45, s45, s40
    v_lshlrev_b32 v32, 4, v36
    v_add_u32 v18, s45, v32
    s_mov_b32 s20, s8
    s_and_b32 s21, s9, 0xffff
    s_mov_b32 s22, 50331648
    s_mov_b32 s23, 0x20000
    s_mul_i32 s35, s25, 98304
    v_mov_b32 v0, 108544
    s_add_u32 m0, s26, 73728
    s_nop 0
    buffer_load_dwordx4 v21, s[16:19], s46 offen lds
    s_add_u32 m0, s26, 77824
    s_mov_b32 s46, 24576
    buffer_load_dwordx4 v19, s[16:19], s46 offen lds
    s_add_u32 m0, s26, 81920
    s_nop 0
    buffer_load_dwordx4 v20, s[16:19], s46 offen lds
    s_add_u32 m0, s26, 86016
    s_nop 0
    buffer_load_dwordx4 v21, s[16:19], s46 offen lds
    s_add_u32 m0, s26, 90112
    s_mov_b32 s46, 36864
    buffer_load_dwordx4 v19, s[16:19], s46 offen lds
    s_add_u32 m0, s26, 94208
    s_nop 0
    buffer_load_dwordx4 v20, s[16:19], s46 offen lds
    s_add_u32 m0, s26, 98304
    s_nop 0
    buffer_load_dwordx4 v21, s[16:19], s46 offen lds
    s_add_u32 m0, s26, 102400
    s_mov_b32 s46, 49152
    buffer_load_dwordx4 v19, s[16:19], s46 offen lds
    s_waitcnt vmcnt(9)
    s_barrier
    ds_read_b128 v[40:43], v6 offset:0
    ds_read_b64_tr_b16 a[0:1], v23 offset:0
    ds_read_b64_tr_b16 a[2:3], v23 offset:768
    ds_read_b128 v[44:47], v6 offset:64
    ds_read_b64_tr_b16 a[12:13], v23 offset:6144
    ds_read_b64_tr_b16 a[14:15], v23 offset:6912
    ds_read_b128 v[48:51], v6 offset:128
    ds_read_b64_tr_b16 a[24:25], v23 offset:12288
    ds_read_b64_tr_b16 a[26:27], v23 offset:13056
    ds_read_b64_tr_b16 a[4:5], v24 offset:0
    ds_read_b64_tr_b16 a[6:7], v24 offset:768
    s_waitcnt lgkmcnt(2)
    v_mfma_f32_16x16x32_bf16 v[120:123], a[0:3], v[40:43], 0
    s_add_u32 m0, s47, 106496
    s_mov_b32 s46, 0
    ds_read_b64_tr_b16 a[16:17], v24 offset:6144
    ds_read_b64_tr_b16 a[18:19], v24 offset:6912
    v_mfma_f32_16x16x32_bf16 v[120:123], a[12:15], v[44:47], v[120:123]
    ds_read_b128 v[84:87], v6 offset:3072
    s_mov_b32 exec_hi, 0
    buffer_load_dwordx4 v22, s[16:19], s46 offen lds
    s_mov_b64 exec, -1
    s_add_u32 m0, s26, 108544
    s_mov_b32 s46, 55296
    ds_read_b64_tr_b16 a[28:29], v24 offset:12288
    ds_read_b64_tr_b16 a[30:31], v24 offset:13056
    v_mfma_f32_16x16x32_bf16 v[120:123], a[24:27], v[48:51], v[120:123]
    ds_read_b128 v[88:91], v6 offset:3136
    buffer_load_dwordx4 v19, s[16:19], s46 offen lds
    ds_read_b64_tr_b16 a[8:9], v25 offset:0
    ds_read_b64_tr_b16 a[10:11], v25 offset:768
    s_waitcnt lgkmcnt(3)
    v_mfma_f32_16x16x32_bf16 v[124:127], a[4:7], v[40:43], 0
    ds_read_b128 v[92:95], v6 offset:3200
    s_add_u32 m0, s26, 112640
    ds_read_b64_tr_b16 a[20:21], v25 offset:6144
    ds_read_b64_tr_b16 a[22:23], v25 offset:6912
    v_mfma_f32_16x16x32_bf16 v[124:127], a[16:19], v[44:47], v[124:127]
    buffer_load_dwordx4 v20, s[16:19], s46 offen lds
    ds_read_b64_tr_b16 a[32:33], v25 offset:12288
    ds_read_b64_tr_b16 a[34:35], v25 offset:13056
    v_mfma_f32_16x16x32_bf16 v[124:127], a[28:31], v[48:51], v[124:127]
    s_add_u32 m0, s26, 116736
    s_waitcnt lgkmcnt(0)
    v_mfma_f32_16x16x32_bf16 v[128:131], a[8:11], v[40:43], 0
    s_waitcnt vmcnt(7)
    s_barrier
    ds_read_b64_tr_b16 a[36:37], v23 offset:18432
    v_mfma_f32_16x16x32_bf16 v[128:131], a[20:23], v[44:47], v[128:131]
    ds_read_b64_tr_b16 a[38:39], v23 offset:19200
    buffer_load_dwordx4 v21, s[16:19], s46 offen lds
    ds_read_b64_tr_b16 a[48:49], v23 offset:24576
    v_mfma_f32_16x16x32_bf16 v[128:131], a[32:35], v[48:51], v[128:131]
    ds_read_b64_tr_b16 a[50:51], v23 offset:25344
    ds_read_b128 v[52:55], v7 offset:0
    v_mfma_f32_16x16x32_bf16 v[132:135], a[0:3], v[84:87], 0
    s_add_u32 m0, s26, 120832
    s_mov_b32 s46, 67584
    ds_read_b64_tr_b16 a[60:61], v23 offset:30720
    v_mfma_f32_16x16x32_bf16 v[132:135], a[12:15], v[88:91], v[132:135]
    ds_read_b64_tr_b16 a[62:63], v23 offset:31488
    ds_read_b128 v[56:59], v7 offset:64
    buffer_load_dwordx4 v19, s[16:19], s46 offen lds
    v_mfma_f32_16x16x32_bf16 v[132:135], a[24:27], v[92:95], v[132:135]
    ds_read_b64_tr_b16 a[40:41], v24 offset:18432
    ds_read_b64_tr_b16 a[42:43], v24 offset:19200
    ds_read_b128 v[60:63], v7 offset:128
    v_mfma_f32_16x16x32_bf16 v[136:139], a[4:7], v[84:87], 0
    s_add_u32 m0, s26, 124928
    ds_read_b64_tr_b16 a[52:53], v24 offset:24576
    ds_read_b64_tr_b16 a[54:55], v24 offset:25344
    v_mfma_f32_16x16x32_bf16 v[136:139], a[16:19], v[88:91], v[136:139]
    buffer_load_dwordx4 v20, s[16:19], s46 offen lds
    ds_read_b64_tr_b16 a[64:65], v24 offset:30720
    ds_read_b64_tr_b16 a[66:67], v24 offset:31488
    v_mfma_f32_16x16x32_bf16 v[136:139], a[28:31], v[92:95], v[136:139]
    ds_read_b128 v[96:99], v7 offset:3072
    s_add_u32 m0, s26, 129024
    ds_read_b64_tr_b16 a[44:45], v25 offset:18432
    v_mfma_f32_16x16x32_bf16 v[140:143], a[8:11], v[84:87], 0
    ds_read_b64_tr_b16 a[46:47], v25 offset:19200
    ds_read_b128 v[100:103], v7 offset:3136
    buffer_load_dwordx4 v21, s[16:19], s46 offen lds
    v_mfma_f32_16x16x32_bf16 v[140:143], a[20:23], v[88:91], v[140:143]
    ds_read_b64_tr_b16 a[56:57], v25 offset:24576
    ds_read_b64_tr_b16 a[58:59], v25 offset:25344
    ds_read_b128 v[104:107], v7 offset:3200
    v_mfma_f32_16x16x32_bf16 v[140:143], a[32:35], v[92:95], v[140:143]
    s_add_u32 m0, s26, 133120
    s_mov_b32 s46, 79872
    s_waitcnt lgkmcnt(11)
    v_mfma_f32_16x16x32_bf16 v[120:123], a[36:39], v[52:55], v[120:123]
    ds_read_b64_tr_b16 a[68:69], v25 offset:30720
    ds_read_b64_tr_b16 a[70:71], v25 offset:31488
    buffer_load_dwordx4 v19, s[16:19], s46 offen lds
    v_mfma_f32_16x16x32_bf16 v[120:123], a[48:51], v[56:59], v[120:123]
    s_add_u32 m0, s26, 137216
    v_mfma_f32_16x16x32_bf16 v[120:123], a[60:63], v[60:63], v[120:123]
    buffer_load_dwordx4 v20, s[16:19], s46 offen lds
    s_add_u32 m0, s26, 141312
    s_waitcnt lgkmcnt(9)
    v_mfma_f32_16x16x32_bf16 v[124:127], a[40:43], v[52:55], v[124:127]
    buffer_load_dwordx4 v21, s[16:19], s46 offen lds
    s_add_u32 m0, s26, 145408
    s_mov_b32 s46, 92160
    v_mfma_f32_16x16x32_bf16 v[124:127], a[52:55], v[56:59], v[124:127]
    buffer_load_dwordx4 v19, s[16:19], s46 offen lds
    s_add_u32 m0, s26, 149504
    v_mfma_f32_16x16x32_bf16 v[124:127], a[64:67], v[60:63], v[124:127]
    buffer_load_dwordx4 v20, s[16:19], s46 offen lds
    s_add_u32 m0, s26, 153600
    s_waitcnt lgkmcnt(0)
    v_mfma_f32_16x16x32_bf16 v[128:131], a[44:47], v[52:55], v[128:131]
    s_waitcnt vmcnt(11)
    s_barrier
    ds_read_b64_tr_b16 a[72:73], v23 offset:36864
    v_mfma_f32_16x16x32_bf16 v[128:131], a[56:59], v[56:59], v[128:131]
    ds_read_b64_tr_b16 a[74:75], v23 offset:37632
    buffer_load_dwordx4 v21, s[16:19], s46 offen lds
    ds_read_b64_tr_b16 a[84:85], v23 offset:43008
    v_mfma_f32_16x16x32_bf16 v[128:131], a[68:71], v[60:63], v[128:131]
    ds_read_b64_tr_b16 a[86:87], v23 offset:43776
    ds_read_b128 v[64:67], v8 offset:0
    v_mfma_f32_16x16x32_bf16 v[132:135], a[36:39], v[96:99], v[132:135]
    s_add_u32 m0, s26, 157696
    s_mov_b32 s46, 104448
    ds_read_b64_tr_b16 a[96:97], v23 offset:49152
    v_mfma_f32_16x16x32_bf16 v[132:135], a[48:51], v[100:103], v[132:135]
    ds_read_b64_tr_b16 a[98:99], v23 offset:49920
    ds_read_b128 v[68:71], v8 offset:64
    buffer_load_dwordx4 v19, s[16:19], s46 offen lds
    v_mfma_f32_16x16x32_bf16 v[132:135], a[60:63], v[104:107], v[132:135]
    ds_read_b64_tr_b16 a[76:77], v24 offset:36864
    ds_read_b64_tr_b16 a[78:79], v24 offset:37632
    ds_read_b128 v[72:75], v8 offset:128
    v_mfma_f32_16x16x32_bf16 v[136:139], a[40:43], v[96:99], v[136:139]
    s_add_u32 m0, s47, 161792
    s_mov_b32 s46, 55296
    ds_read_b64_tr_b16 a[88:89], v24 offset:43008
    v_mfma_f32_16x16x32_bf16 v[136:139], a[52:55], v[100:103], v[136:139]
    ds_read_b64_tr_b16 a[90:91], v24 offset:43776
    v_mfma_f32_16x16x32_bf16 v[136:139], a[64:67], v[104:107], v[136:139]
    s_mov_b32 exec_hi, 0
    buffer_load_dwordx4 v22, s[16:19], s46 offen lds
    s_mov_b64 exec, -1
    v_mfma_f32_16x16x32_bf16 v[140:143], a[44:47], v[96:99], v[140:143]
    ds_read_b64_tr_b16 a[100:101], v24 offset:49152
    ds_read_b64_tr_b16 a[102:103], v24 offset:49920
    ds_read_b128 v[108:111], v8 offset:3072
    v_mfma_f32_16x16x32_bf16 v[140:143], a[56:59], v[100:103], v[140:143]
    s_add_u32 s32, s32, 196608
    s_add_u32 s33, s33, 2
    v_mfma_f32_16x16x32_bf16 v[140:143], a[68:71], v[104:107], v[140:143]
    s_cmp_lt_u32 s33, s34
    s_cselect_b32 s14, 50331648, 0
    s_waitcnt lgkmcnt(5)
    v_mfma_f32_16x16x32_bf16 v[120:123], a[72:75], v[64:67], v[120:123]
    s_add_u32 s31, s31, 13312
    s_cmp_eq_u32 s31, 53248
    s_cselect_b32 s31, 0, s31
    ds_read_b64_tr_b16 a[80:81], v25 offset:36864
    ds_read_b64_tr_b16 a[82:83], v25 offset:37632
    ds_read_b128 v[112:115], v8 offset:3136
    s_add_u32 m0, s31, s26
    ds_read_b64_tr_b16 a[92:93], v25 offset:43008
    ds_read_b64_tr_b16 a[94:95], v25 offset:43776
    ds_read_b128 v[116:119], v8 offset:3200
    buffer_load_dwordx4 v2, s[12:15], s32 offen nt lds
    ds_read_b64_tr_b16 a[104:105], v25 offset:49152
    ds_read_b64_tr_b16 a[106:107], v25 offset:49920
    v_mfma_f32_16x16x32_bf16 v[120:123], a[84:87], v[68:71], v[120:123]
    s_add_u32 m0, s31, s27
    v_mfma_f32_16x16x32_bf16 v[120:123], a[96:99], v[72:75], v[120:123]
    buffer_load_dwordx4 v3, s[12:15], s32 offen nt lds
    s_add_u32 m0, s31, s28
    s_waitcnt lgkmcnt(9)
    v_mfma_f32_16x16x32_bf16 v[124:127], a[76:79], v[64:67], v[124:127]
    buffer_load_dwordx4 v4, s[12:15], s32 offen nt lds
    s_add_u32 m0, s31, s29
    v_mfma_f32_16x16x32_bf16 v[124:127], a[88:91], v[68:71], v[124:127]
    buffer_load_dwordx4 v5, s[12:15], s32 offen nt lds
    v_mfma_f32_16x16x32_bf16 v[124:127], a[100:103], v[72:75], v[124:127]
    s_waitcnt vmcnt(13) lgkmcnt(0)
    s_barrier
    v_mfma_f32_16x16x32_bf16 v[128:131], a[80:83], v[64:67], v[128:131]
    ds_read_b64_tr_b16 a[108:109], v26 offset:0
    ds_read_b64_tr_b16 a[110:111], v26 offset:768
    ds_read_b64_tr_b16 a[120:121], v26 offset:6144
    v_mfma_f32_16x16x32_bf16 v[128:131], a[92:95], v[68:71], v[128:131]
    ds_read_b64_tr_b16 a[122:123], v26 offset:6912
    s_add_u32 m0, s26, 53248
    s_mov_b32 s46, 110592
    v_mfma_f32_16x16x32_bf16 v[128:131], a[104:107], v[72:75], v[128:131]
    ds_read_b64_tr_b16 a[132:133], v26 offset:12288
    ds_read_b64_tr_b16 a[134:135], v26 offset:13056
    v_mfma_f32_16x16x32_bf16 v[132:135], a[72:75], v[108:111], v[132:135]
    buffer_load_dwordx4 v19, s[16:19], s46 offen lds
    ds_read_b64_tr_b16 a[112:113], v27 offset:0
    ds_read_b64_tr_b16 a[114:115], v27 offset:768
    v_mfma_f32_16x16x32_bf16 v[132:135], a[84:87], v[112:115], v[132:135]
    ds_read_b64_tr_b16 a[124:125], v27 offset:6144
    ds_read_b64_tr_b16 a[126:127], v27 offset:6912
    s_add_u32 m0, s26, 57344
    v_mfma_f32_16x16x32_bf16 v[132:135], a[96:99], v[116:119], v[132:135]
    ds_read_b64_tr_b16 a[136:137], v27 offset:12288
    ds_read_b64_tr_b16 a[138:139], v27 offset:13056
    buffer_load_dwordx4 v20, s[16:19], s46 offen lds
    v_mfma_f32_16x16x32_bf16 v[136:139], a[76:79], v[108:111], v[136:139]
    ds_read_b64_tr_b16 a[116:117], v28 offset:0
    ds_read_b64_tr_b16 a[118:119], v28 offset:768
    ds_read_b64_tr_b16 a[128:129], v28 offset:6144
    v_mfma_f32_16x16x32_bf16 v[136:139], a[88:91], v[112:115], v[136:139]
    ds_read_b64_tr_b16 a[130:131], v28 offset:6912
    s_add_u32 m0, s26, 61440
    ds_read_b64_tr_b16 a[140:141], v28 offset:12288
    v_mfma_f32_16x16x32_bf16 v[136:139], a[100:103], v[116:119], v[136:139]
    ds_read_b64_tr_b16 a[142:143], v28 offset:13056
    buffer_load_dwordx4 v21, s[16:19], s46 offen lds
    v_mfma_f32_16x16x32_bf16 v[140:143], a[80:83], v[108:111], v[140:143]
    s_add_u32 m0, s26, 65536
    s_mov_b32 s46, 122880
    v_mfma_f32_16x16x32_bf16 v[140:143], a[92:95], v[112:115], v[140:143]
    buffer_load_dwordx4 v19, s[16:19], s46 offen lds
    v_mfma_f32_16x16x32_bf16 v[140:143], a[104:107], v[116:119], v[140:143]
    s_waitcnt lgkmcnt(12)
    v_mfma_f32_16x16x32_bf16 v[144:147], a[108:111], v[40:43], 0
    s_add_u32 m0, s26, 69632
    v_mfma_f32_16x16x32_bf16 v[144:147], a[120:123], v[44:47], v[144:147]
    buffer_load_dwordx4 v20, s[16:19], s46 offen lds
    v_mfma_f32_16x16x32_bf16 v[144:147], a[132:135], v[48:51], v[144:147]
    s_waitcnt lgkmcnt(6)
    v_mfma_f32_16x16x32_bf16 v[148:151], a[112:115], v[40:43], 0
    s_add_u32 m0, s26, 73728
    v_mfma_f32_16x16x32_bf16 v[148:151], a[124:127], v[44:47], v[148:151]
    buffer_load_dwordx4 v21, s[16:19], s46 offen lds
    v_mfma_f32_16x16x32_bf16 v[148:151], a[136:139], v[48:51], v[148:151]
    s_waitcnt vmcnt(15)
    s_barrier
    s_waitcnt lgkmcnt(0)
    v_mfma_f32_16x16x32_bf16 v[152:155], a[116:119], v[40:43], 0
    ds_read_b64_tr_b16 a[144:145], v26 offset:18432
    ds_read_b64_tr_b16 a[146:147], v26 offset:19200
    ds_read_b64_tr_b16 a[156:157], v26 offset:24576
    v_mfma_f32_16x16x32_bf16 v[152:155], a[128:131], v[44:47], v[152:155]
    ds_read_b64_tr_b16 a[158:159], v26 offset:25344
    s_add_u32 m0, s26, 77824
    s_mov_b32 s46, 135168
    v_mfma_f32_16x16x32_bf16 v[152:155], a[140:143], v[48:51], v[152:155]
    ds_read_b64_tr_b16 a[168:169], v26 offset:30720
    ds_read_b64_tr_b16 a[170:171], v26 offset:31488
    buffer_load_dwordx4 v19, s[16:19], s46 offen lds
    v_mfma_f32_16x16x32_bf16 v[156:159], a[108:111], v[84:87], 0
    ds_read_b64_tr_b16 a[148:149], v27 offset:18432
    ds_read_b64_tr_b16 a[150:151], v27 offset:19200
    ds_read_b64_tr_b16 a[160:161], v27 offset:24576
    v_mfma_f32_16x16x32_bf16 v[156:159], a[120:123], v[88:91], v[156:159]
    ds_read_b64_tr_b16 a[162:163], v27 offset:25344
    ds_read_b64_tr_b16 a[172:173], v27 offset:30720
    ds_read_b64_tr_b16 a[174:175], v27 offset:31488
    v_mfma_f32_16x16x32_bf16 v[156:159], a[132:135], v[92:95], v[156:159]
    ds_read_b64_tr_b16 a[152:153], v28 offset:18432
    ds_read_b64_tr_b16 a[154:155], v28 offset:19200
    v_mfma_f32_16x16x32_bf16 v[160:163], a[112:115], v[84:87], 0
    ds_read_b64_tr_b16 a[164:165], v28 offset:24576
    ds_read_b64_tr_b16 a[166:167], v28 offset:25344
    v_mfma_f32_16x16x32_bf16 v[160:163], a[124:127], v[88:91], v[160:163]
    ds_read_b64_tr_b16 a[176:177], v28 offset:30720
    ds_read_b64_tr_b16 a[178:179], v28 offset:31488
    v_mfma_f32_16x16x32_bf16 v[160:163], a[136:139], v[92:95], v[160:163]
    v_mfma_f32_16x16x32_bf16 v[164:167], a[116:119], v[84:87], 0
    v_mfma_f32_16x16x32_bf16 v[164:167], a[128:131], v[88:91], v[164:167]
    v_mfma_f32_16x16x32_bf16 v[164:167], a[140:143], v[92:95], v[164:167]
    s_waitcnt lgkmcnt(12)
    v_mfma_f32_16x16x32_bf16 v[144:147], a[144:147], v[52:55], v[144:147]
    v_mfma_f32_16x16x32_bf16 v[144:147], a[156:159], v[56:59], v[144:147]
    v_mfma_f32_16x16x32_bf16 v[144:147], a[168:171], v[60:63], v[144:147]
    s_waitcnt lgkmcnt(6)
    v_mfma_f32_16x16x32_bf16 v[148:151], a[148:151], v[52:55], v[148:151]
    v_mfma_f32_16x16x32_bf16 v[148:151], a[160:163], v[56:59], v[148:151]
    v_mfma_f32_16x16x32_bf16 v[148:151], a[172:175], v[60:63], v[148:151]
    s_waitcnt vmcnt(11)
    s_barrier
    s_waitcnt lgkmcnt(0)
    v_mfma_f32_16x16x32_bf16 v[152:155], a[152:155], v[52:55], v[152:155]
    ds_read_b64_tr_b16 a[180:181], v26 offset:36864
    ds_read_b64_tr_b16 a[182:183], v26 offset:37632
    ds_read_b64_tr_b16 a[192:193], v26 offset:43008
    v_mfma_f32_16x16x32_bf16 v[152:155], a[164:167], v[56:59], v[152:155]
    ds_read_b64_tr_b16 a[194:195], v26 offset:43776
    ds_read_b64_tr_b16 a[204:205], v26 offset:49152
    ds_read_b64_tr_b16 a[206:207], v26 offset:49920
    v_mfma_f32_16x16x32_bf16 v[152:155], a[176:179], v[60:63], v[152:155]
    ds_read_b64_tr_b16 a[184:185], v27 offset:36864
    ds_read_b64_tr_b16 a[186:187], v27 offset:37632
    v_mfma_f32_16x16x32_bf16 v[156:159], a[144:147], v[96:99], v[156:159]
    ds_read_b64_tr_b16 a[196:197], v27 offset:43008
    ds_read_b64_tr_b16 a[198:199], v27 offset:43776
    v_mfma_f32_16x16x32_bf16 v[156:159], a[156:159], v[100:103], v[156:159]
    ds_read_b64_tr_b16 a[208:209], v27 offset:49152
    ds_read_b64_tr_b16 a[210:211], v27 offset:49920
    v_mfma_f32_16x16x32_bf16 v[156:159], a[168:171], v[104:107], v[156:159]
    ds_read_b64_tr_b16 a[188:189], v28 offset:36864
    ds_read_b64_tr_b16 a[190:191], v28 offset:37632
    s_add_u32 s30, s30, 13312
    v_mfma_f32_16x16x32_bf16 v[160:163], a[148:151], v[96:99], v[160:163]
    ds_read_b64_tr_b16 a[200:201], v28 offset:43008
    ds_read_b64_tr_b16 a[202:203], v28 offset:43776
    v_mfma_f32_16x16x32_bf16 v[160:163], a[160:163], v[100:103], v[160:163]
    s_cmp_eq_u32 s30, 53248
    s_cselect_b32 s30, 0, s30
    ds_read_b64_tr_b16 a[212:213], v28 offset:49152
    v_mfma_f32_16x16x32_bf16 v[160:163], a[172:175], v[104:107], v[160:163]
    ds_read_b64_tr_b16 a[214:215], v28 offset:49920
    v_add_u32 v9, s30, v6
    v_add_u32 v10, s30, v7
    v_mfma_f32_16x16x32_bf16 v[164:167], a[152:155], v[96:99], v[164:167]
    v_add_u32 v11, s30, v8
    v_mfma_f32_16x16x32_bf16 v[164:167], a[164:167], v[100:103], v[164:167]
    v_mfma_f32_16x16x32_bf16 v[164:167], a[176:179], v[104:107], v[164:167]
    s_waitcnt lgkmcnt(12)
    v_mfma_f32_16x16x32_bf16 v[144:147], a[180:183], v[64:67], v[144:147]
    v_mfma_f32_16x16x32_bf16 v[144:147], a[192:195], v[68:71], v[144:147]
    v_mfma_f32_16x16x32_bf16 v[144:147], a[204:207], v[72:75], v[144:147]
    s_waitcnt lgkmcnt(6)
    v_mfma_f32_16x16x32_bf16 v[148:151], a[184:187], v[64:67], v[148:151]
    v_mfma_f32_16x16x32_bf16 v[148:151], a[196:199], v[68:71], v[148:151]
    v_mfma_f32_16x16x32_bf16 v[148:151], a[208:211], v[72:75], v[148:151]
    s_waitcnt vmcnt(7)
    s_barrier
    s_waitcnt lgkmcnt(0)
    v_mfma_f32_16x16x32_bf16 v[152:155], a[188:191], v[64:67], v[152:155]
    ds_read_b128 v[40:43], v9 offset:0
    v_mfma_f32_16x16x32_bf16 v[152:155], a[200:203], v[68:71], v[152:155]
    ds_read_b128 v[44:47], v9 offset:64
    v_mfma_f32_16x16x32_bf16 v[152:155], a[212:215], v[72:75], v[152:155]
    ds_read_b128 v[48:51], v9 offset:128
    v_mfma_f32_16x16x32_bf16 v[156:159], a[180:183], v[108:111], v[156:159]
    ds_read_b128 v[52:55], v10 offset:0
    v_mfma_f32_16x16x32_bf16 v[156:159], a[192:195], v[112:115], v[156:159]
    ds_read_b128 v[56:59], v10 offset:64
    v_mfma_f32_16x16x32_bf16 v[156:159], a[204:207], v[116:119], v[156:159]
    ds_read_b128 v[60:63], v10 offset:128
    v_mfma_f32_16x16x32_bf16 v[160:163], a[184:187], v[108:111], v[160:163]
    ds_read_b128 v[64:67], v11 offset:0
    v_mfma_f32_16x16x32_bf16 v[160:163], a[196:199], v[112:115], v[160:163]
    ds_read_b128 v[68:71], v11 offset:64
    v_mfma_f32_16x16x32_bf16 v[160:163], a[208:211], v[116:119], v[160:163]
    ds_read_b128 v[72:75], v11 offset:128
    v_mfma_f32_16x16x32_bf16 v[164:167], a[188:191], v[108:111], v[164:167]
    v_mfma_f32_16x16x32_bf16 v[164:167], a[200:203], v[112:115], v[164:167]
    v_mfma_f32_16x16x32_bf16 v[164:167], a[212:215], v[116:119], v[164:167]
    s_add_u32 m0, s26, 81920
    s_waitcnt lgkmcnt(6)
    v_mfma_f32_16x16x32_bf16 v[96:99], a[0:3], v[40:43], 0
    buffer_load_dwordx4 v20, s[16:19], s46 offen lds
    v_mfma_f32_16x16x32_bf16 v[96:99], a[12:15], v[44:47], v[96:99]
    v_mfma_f32_16x16x32_bf16 v[96:99], a[24:27], v[48:51], v[96:99]
    s_add_u32 m0, s26, 86016
    v_mfma_f32_16x16x32_bf16 v[100:103], a[4:7], v[40:43], 0
    buffer_load_dwordx4 v21, s[16:19], s46 offen lds
    v_mfma_f32_16x16x32_bf16 v[100:103], a[16:19], v[44:47], v[100:103]
    v_mfma_f32_16x16x32_bf16 v[100:103], a[28:31], v[48:51], v[100:103]
    s_add_u32 m0, s26, 90112
    v_mfma_f32_16x16x32_bf16 v[104:107], a[8:11], v[40:43], 0
    s_mov_b32 s46, 147456
    buffer_load_dwordx4 v19, s[16:19], s46 offen lds
    v_mfma_f32_16x16x32_bf16 v[104:107], a[20:23], v[44:47], v[104:107]
    v_mfma_f32_16x16x32_bf16 v[104:107], a[32:35], v[48:51], v[104:107]
    s_add_u32 m0, s26, 94208
    s_waitcnt lgkmcnt(3)
    v_mfma_f32_16x16x32_bf16 v[96:99], a[36:39], v[52:55], v[96:99]
    buffer_load_dwordx4 v20, s[16:19], s46 offen lds
    v_mfma_f32_16x16x32_bf16 v[96:99], a[48:51], v[56:59], v[96:99]
    v_mfma_f32_16x16x32_bf16 v[96:99], a[60:63], v[60:63], v[96:99]
    s_add_u32 m0, s26, 98304
    v_mfma_f32_16x16x32_bf16 v[100:103], a[40:43], v[52:55], v[100:103]
    buffer_load_dwordx4 v21, s[16:19], s46 offen lds
    v_mfma_f32_16x16x32_bf16 v[100:103], a[52:55], v[56:59], v[100:103]
    v_mfma_f32_16x16x32_bf16 v[100:103], a[64:67], v[60:63], v[100:103]
    s_add_u32 m0, s26, 102400
    v_mfma_f32_16x16x32_bf16 v[104:107], a[44:47], v[52:55], v[104:107]
    s_mov_b32 s46, 159744
    buffer_load_dwordx4 v19, s[16:19], s46 offen lds
    v_mfma_f32_16x16x32_bf16 v[104:107], a[56:59], v[56:59], v[104:107]
    v_mfma_f32_16x16x32_bf16 v[104:107], a[68:71], v[60:63], v[104:107]
    s_add_u32 m0, s47, 106496
    s_waitcnt lgkmcnt(0)
    v_mfma_f32_16x16x32_bf16 v[96:99], a[72:75], v[64:67], v[96:99]
    s_mov_b32 s46, 110592
    v_mfma_f32_16x16x32_bf16 v[96:99], a[84:87], v[68:71], v[96:99]
    s_mov_b32 exec_hi, 0
    buffer_load_dwordx4 v22, s[16:19], s46 offen lds
    s_mov_b64 exec, -1
    v_mfma_f32_16x16x32_bf16 v[96:99], a[96:99], v[72:75], v[96:99]
    s_sub_u32 s32, s32, 393216
    v_mfma_f32_16x16x32_bf16 v[100:103], a[76:79], v[64:67], v[100:103]
    s_sub_u32 s33, s33, 4
    v_mfma_f32_16x16x32_bf16 v[100:103], a[88:91], v[68:71], v[100:103]
    s_cmp_lt_u32 s33, s34
    s_cselect_b32 s14, 50331648, 0
    v_mfma_f32_16x16x32_bf16 v[100:103], a[100:103], v[72:75], v[100:103]
    s_add_u32 s31, s31, 13312
    v_mfma_f32_16x16x32_bf16 v[104:107], a[80:83], v[64:67], v[104:107]
    s_cmp_eq_u32 s31, 53248
    s_cselect_b32 s31, 0, s31
    v_mfma_f32_16x16x32_bf16 v[104:107], a[92:95], v[68:71], v[104:107]
    v_mfma_f32_16x16x32_bf16 v[104:107], a[104:107], v[72:75], v[104:107]
    v_mfma_f32_16x16x32_bf16 v[120:123], a[108:111], v[40:43], v[120:123]
    s_add_u32 m0, s31, s26
    v_mfma_f32_16x16x32_bf16 v[120:123], a[120:123], v[44:47], v[120:123]
    buffer_load_dwordx4 v2, s[12:15], s32 offen nt lds
    v_mfma_f32_16x16x32_bf16 v[120:123], a[132:135], v[48:51], v[120:123]
    s_add_u32 m0, s31, s27
    v_mfma_f32_16x16x32_bf16 v[120:123], a[144:147], v[52:55], v[120:123]
    buffer_load_dwordx4 v3, s[12:15], s32 offen nt lds
    v_mfma_f32_16x16x32_bf16 v[120:123], a[156:159], v[56:59], v[120:123]
    s_add_u32 m0, s31, s28
    v_mfma_f32_16x16x32_bf16 v[120:123], a[168:171], v[60:63], v[120:123]
    buffer_load_dwordx4 v4, s[12:15], s32 offen nt lds
    v_mfma_f32_16x16x32_bf16 v[120:123], a[180:183], v[64:67], v[120:123]
    s_add_u32 m0, s31, s29
    v_mfma_f32_16x16x32_bf16 v[120:123], a[192:195], v[68:71], v[120:123]
    buffer_load_dwordx4 v5, s[12:15], s32 offen nt lds
    v_mfma_f32_16x16x32_bf16 v[120:123], a[204:207], v[72:75], v[120:123]
    v_mfma_f32_16x16x32_bf16 v[124:127], a[112:115], v[40:43], v[124:127]
    v_mfma_f32_16x16x32_bf16 v[124:127], a[124:127], v[44:47], v[124:127]
    v_mfma_f32_16x16x32_bf16 v[124:127], a[136:139], v[48:51], v[124:127]
    v_mfma_f32_16x16x32_bf16 v[124:127], a[148:151], v[52:55], v[124:127]
    v_mfma_f32_16x16x32_bf16 v[124:127], a[160:163], v[56:59], v[124:127]
    v_mfma_f32_16x16x32_bf16 v[124:127], a[172:175], v[60:63], v[124:127]
    v_mfma_f32_16x16x32_bf16 v[124:127], a[184:187], v[64:67], v[124:127]
    v_mfma_f32_16x16x32_bf16 v[124:127], a[196:199], v[68:71], v[124:127]
    s_waitcnt vmcnt(4)
    s_barrier
    v_mfma_f32_16x16x32_bf16 v[124:127], a[208:211], v[72:75], v[124:127]
    ds_read_b64_tr_b16 a[216:217], v23 offset:0
    v_mfma_f32_16x16x32_bf16 v[128:131], a[116:119], v[40:43], v[128:131]
    ds_read_b64_tr_b16 a[218:219], v23 offset:768
    ds_read_b64_tr_b16 a[228:229], v23 offset:6144
    v_mfma_f32_16x16x32_bf16 v[128:131], a[128:131], v[44:47], v[128:131]
    ds_read_b64_tr_b16 a[230:231], v23 offset:6912
    ds_read_b64_tr_b16 a[240:241], v23 offset:12288
    v_mfma_f32_16x16x32_bf16 v[128:131], a[140:143], v[48:51], v[128:131]
    ds_read_b64_tr_b16 a[242:243], v23 offset:13056
    v_mfma_f32_16x16x32_bf16 v[128:131], a[152:155], v[52:55], v[128:131]
    ds_read_b64_tr_b16 a[252:253], v23 offset:18432
    ds_read_b64_tr_b16 a[254:255], v23 offset:19200
    v_mfma_f32_16x16x32_bf16 v[128:131], a[164:167], v[56:59], v[128:131]
    ds_read_b64_tr_b16 v[176:177], v23 offset:24576
    ds_read_b64_tr_b16 v[178:179], v23 offset:25344
    v_mfma_f32_16x16x32_bf16 v[128:131], a[176:179], v[60:63], v[128:131]
    ds_read_b64_tr_b16 v[188:189], v23 offset:30720
    v_mfma_f32_16x16x32_bf16 v[128:131], a[188:191], v[64:67], v[128:131]
    ds_read_b64_tr_b16 v[190:191], v23 offset:31488
    ds_read_b64_tr_b16 v[200:201], v23 offset:36864
    v_mfma_f32_16x16x32_bf16 v[128:131], a[200:203], v[68:71], v[128:131]
    ds_read_b64_tr_b16 v[202:203], v23 offset:37632
    ds_read_b64_tr_b16 v[212:213], v23 offset:43008
    v_mfma_f32_16x16x32_bf16 v[128:131], a[212:215], v[72:75], v[128:131]
    ds_read_b64_tr_b16 v[214:215], v23 offset:43776
    s_waitcnt lgkmcnt(10)
    v_mfma_f32_16x16x32_bf16 v[144:147], a[216:219], v[40:43], v[144:147]
    ds_read_b64_tr_b16 v[224:225], v23 offset:49152
    ds_read_b64_tr_b16 v[226:227], v23 offset:49920
    v_mfma_f32_16x16x32_bf16 v[144:147], a[228:231], v[44:47], v[144:147]
    ds_read_b64_tr_b16 a[220:221], v24 offset:0
    ds_read_b64_tr_b16 a[222:223], v24 offset:768
    v_mfma_f32_16x16x32_bf16 v[144:147], a[240:243], v[48:51], v[144:147]
    ds_read_b64_tr_b16 a[232:233], v24 offset:6144
    s_waitcnt lgkmcnt(9)
    v_mfma_f32_16x16x32_bf16 v[144:147], a[252:255], v[52:55], v[144:147]
    ds_read_b64_tr_b16 a[234:235], v24 offset:6912
    ds_read_b64_tr_b16 a[244:245], v24 offset:12288
    ds_read_b64_tr_b16 a[246:247], v24 offset:13056
    v_mfma_f32_16x16x32_bf16 v[144:147], v[176:179], v[56:59], v[144:147]
    ds_read_b64_tr_b16 v[168:169], v24 offset:18432
    ds_read_b64_tr_b16 v[170:171], v24 offset:19200
    v_mfma_f32_16x16x32_bf16 v[144:147], v[188:191], v[60:63], v[144:147]
    ds_read_b64_tr_b16 v[180:181], v24 offset:24576
    s_waitcnt lgkmcnt(9)
    v_mfma_f32_16x16x32_bf16 v[144:147], v[200:203], v[64:67], v[144:147]
    ds_read_b64_tr_b16 v[182:183], v24 offset:25344
    ds_read_b64_tr_b16 v[192:193], v24 offset:30720
    ds_read_b64_tr_b16 v[194:195], v24 offset:31488
    v_mfma_f32_16x16x32_bf16 v[144:147], v[212:215], v[68:71], v[144:147]
    ds_read_b64_tr_b16 v[204:205], v24 offset:36864
    ds_read_b64_tr_b16 v[206:207], v24 offset:37632
    v_mfma_f32_16x16x32_bf16 v[144:147], v[224:227], v[72:75], v[144:147]
    ds_read_b64_tr_b16 v[216:217], v24 offset:43008
    s_waitcnt lgkmcnt(9)
    v_mfma_f32_16x16x32_bf16 v[148:151], a[220:223], v[40:43], v[148:151]
    ds_read_b64_tr_b16 v[218:219], v24 offset:43776
    ds_read_b64_tr_b16 v[228:229], v24 offset:49152
    ds_read_b64_tr_b16 v[230:231], v24 offset:49920
    v_mfma_f32_16x16x32_bf16 v[148:151], a[232:235], v[44:47], v[148:151]
    ds_read_b64_tr_b16 a[224:225], v25 offset:0
    ds_read_b64_tr_b16 a[226:227], v25 offset:768
    v_mfma_f32_16x16x32_bf16 v[148:151], a[244:247], v[48:51], v[148:151]
    ds_read_b64_tr_b16 a[236:237], v25 offset:6144
    s_waitcnt lgkmcnt(9)
    v_mfma_f32_16x16x32_bf16 v[148:151], v[168:171], v[52:55], v[148:151]
    ds_read_b64_tr_b16 a[238:239], v25 offset:6912
    ds_read_b64_tr_b16 a[248:249], v25 offset:12288
    ds_read_b64_tr_b16 a[250:251], v25 offset:13056
    v_mfma_f32_16x16x32_bf16 v[148:151], v[180:183], v[56:59], v[148:151]
    ds_read_b64_tr_b16 v[172:173], v25 offset:18432
    ds_read_b64_tr_b16 v[174:175], v25 offset:19200
    v_mfma_f32_16x16x32_bf16 v[148:151], v[192:195], v[60:63], v[148:151]
    ds_read_b64_tr_b16 v[184:185], v25 offset:24576
    s_waitcnt lgkmcnt(9)
    v_mfma_f32_16x16x32_bf16 v[148:151], v[204:207], v[64:67], v[148:151]
    ds_read_b64_tr_b16 v[186:187], v25 offset:25344
    ds_read_b64_tr_b16 v[196:197], v25 offset:30720
    ds_read_b64_tr_b16 v[198:199], v25 offset:31488
    v_mfma_f32_16x16x32_bf16 v[148:151], v[216:219], v[68:71], v[148:151]
    ds_read_b64_tr_b16 v[208:209], v25 offset:36864
    ds_read_b64_tr_b16 v[210:211], v25 offset:37632
    v_mfma_f32_16x16x32_bf16 v[148:151], v[228:231], v[72:75], v[148:151]
    ds_read_b64_tr_b16 v[220:221], v25 offset:43008
    s_waitcnt lgkmcnt(9)
    v_mfma_f32_16x16x32_bf16 v[152:155], a[224:227], v[40:43], v[152:155]
    ds_read_b64_tr_b16 v[222:223], v25 offset:43776
    ds_read_b64_tr_b16 v[232:233], v25 offset:49152
    ds_read_b64_tr_b16 v[234:235], v25 offset:49920
    v_mfma_f32_16x16x32_bf16 v[152:155], a[236:239], v[44:47], v[152:155]
    ds_read_b128 v[40:43], v9 offset:3072
    ds_read_b128 v[44:47], v9 offset:3136
    v_mfma_f32_16x16x32_bf16 v[152:155], a[248:251], v[48:51], v[152:155]
    ds_read_b128 v[48:51], v9 offset:3200
    s_waitcnt lgkmcnt(9)
    v_mfma_f32_16x16x32_bf16 v[152:155], v[172:175], v[52:55], v[152:155]
    ds_read_b128 v[52:55], v10 offset:3072
    v_mfma_f32_16x16x32_bf16 v[152:155], v[184:187], v[56:59], v[152:155]
    ds_read_b128 v[56:59], v10 offset:3136
    v_mfma_f32_16x16x32_bf16 v[152:155], v[196:199], v[60:63], v[152:155]
    ds_read_b128 v[60:63], v10 offset:3200
    s_waitcnt lgkmcnt(6)
    v_mfma_f32_16x16x32_bf16 v[152:155], v[208:211], v[64:67], v[152:155]
    ds_read_b128 v[64:67], v11 offset:3072
    v_mfma_f32_16x16x32_bf16 v[152:155], v[220:223], v[68:71], v[152:155]
    ds_read_b128 v[68:71], v11 offset:3136
    v_mfma_f32_16x16x32_bf16 v[152:155], v[232:235], v[72:75], v[152:155]
    ds_read_b128 v[72:75], v11 offset:3200
    s_waitcnt lgkmcnt(6)
    v_mfma_f32_16x16x32_bf16 v[108:111], a[0:3], v[40:43], 0
    s_add_u32 s32, s32, 589824
    v_mfma_f32_16x16x32_bf16 v[108:111], a[12:15], v[44:47], v[108:111]
    s_add_u32 s33, s33, 6
    v_mfma_f32_16x16x32_bf16 v[108:111], a[24:27], v[48:51], v[108:111]
    s_cmp_lt_u32 s33, s34
    s_cselect_b32 s14, 50331648, 0
    s_waitcnt lgkmcnt(3)
    v_mfma_f32_16x16x32_bf16 v[108:111], a[36:39], v[52:55], v[108:111]
    s_add_u32 s31, s31, 13312
    v_mfma_f32_16x16x32_bf16 v[108:111], a[48:51], v[56:59], v[108:111]
    s_cmp_eq_u32 s31, 53248
    s_cselect_b32 s31, 0, s31
    v_mfma_f32_16x16x32_bf16 v[108:111], a[60:63], v[60:63], v[108:111]
    s_waitcnt lgkmcnt(0)
    v_mfma_f32_16x16x32_bf16 v[108:111], a[72:75], v[64:67], v[108:111]
    v_mfma_f32_16x16x32_bf16 v[108:111], a[84:87], v[68:71], v[108:111]
    s_add_u32 m0, s31, s26
    v_mfma_f32_16x16x32_bf16 v[108:111], a[96:99], v[72:75], v[108:111]
    buffer_load_dwordx4 v2, s[12:15], s32 offen nt lds
    v_mfma_f32_16x16x32_bf16 v[112:115], a[4:7], v[40:43], 0
    v_mfma_f32_16x16x32_bf16 v[112:115], a[16:19], v[44:47], v[112:115]
    s_add_u32 m0, s31, s27
    v_mfma_f32_16x16x32_bf16 v[112:115], a[28:31], v[48:51], v[112:115]
    buffer_load_dwordx4 v3, s[12:15], s32 offen nt lds
    v_mfma_f32_16x16x32_bf16 v[112:115], a[40:43], v[52:55], v[112:115]
    v_mfma_f32_16x16x32_bf16 v[112:115], a[52:55], v[56:59], v[112:115]
    s_add_u32 m0, s31, s28
    v_mfma_f32_16x16x32_bf16 v[112:115], a[64:67], v[60:63], v[112:115]
    buffer_load_dwordx4 v4, s[12:15], s32 offen nt lds
    v_mfma_f32_16x16x32_bf16 v[112:115], a[76:79], v[64:67], v[112:115]
    v_mfma_f32_16x16x32_bf16 v[112:115], a[88:91], v[68:71], v[112:115]
    s_add_u32 m0, s31, s29
    v_mfma_f32_16x16x32_bf16 v[112:115], a[100:103], v[72:75], v[112:115]
    buffer_load_dwordx4 v5, s[12:15], s32 offen nt lds
    v_mfma_f32_16x16x32_bf16 v[116:119], a[8:11], v[40:43], 0
    v_mfma_f32_16x16x32_bf16 v[116:119], a[20:23], v[44:47], v[116:119]
    v_mfma_f32_16x16x32_bf16 v[116:119], a[32:35], v[48:51], v[116:119]
    s_add_u32 s32, s32, 196608
    v_mfma_f32_16x16x32_bf16 v[116:119], a[44:47], v[52:55], v[116:119]
    s_add_u32 s33, s33, 2
    v_mfma_f32_16x16x32_bf16 v[116:119], a[56:59], v[56:59], v[116:119]
    s_cmp_lt_u32 s33, s34
    s_cselect_b32 s14, 50331648, 0
    v_mfma_f32_16x16x32_bf16 v[116:119], a[68:71], v[60:63], v[116:119]
    s_add_u32 s31, s31, 13312
    v_mfma_f32_16x16x32_bf16 v[116:119], a[80:83], v[64:67], v[116:119]
    s_cmp_eq_u32 s31, 53248
    s_cselect_b32 s31, 0, s31
    v_mfma_f32_16x16x32_bf16 v[116:119], a[92:95], v[68:71], v[116:119]
    v_mfma_f32_16x16x32_bf16 v[116:119], a[104:107], v[72:75], v[116:119]
    v_mfma_f32_16x16x32_bf16 v[132:135], a[108:111], v[40:43], v[132:135]
    s_add_u32 m0, s31, s26
    v_mfma_f32_16x16x32_bf16 v[132:135], a[120:123], v[44:47], v[132:135]
    buffer_load_dwordx4 v2, s[12:15], s32 offen nt lds
    v_mfma_f32_16x16x32_bf16 v[132:135], a[132:135], v[48:51], v[132:135]
    v_mfma_f32_16x16x32_bf16 v[132:135], a[144:147], v[52:55], v[132:135]
    s_add_u32 m0, s31, s27
    v_mfma_f32_16x16x32_bf16 v[132:135], a[156:159], v[56:59], v[132:135]
    buffer_load_dwordx4 v3, s[12:15], s32 offen nt lds
    v_mfma_f32_16x16x32_bf16 v[132:135], a[168:171], v[60:63], v[132:135]
    v_mfma_f32_16x16x32_bf16 v[132:135], a[180:183], v[64:67], v[132:135]
    s_add_u32 m0, s31, s28
    v_mfma_f32_16x16x32_bf16 v[132:135], a[192:195], v[68:71], v[132:135]
    buffer_load_dwordx4 v4, s[12:15], s32 offen nt lds
    v_mfma_f32_16x16x32_bf16 v[132:135], a[204:207], v[72:75], v[132:135]
    v_mfma_f32_16x16x32_bf16 v[136:139], a[112:115], v[40:43], v[136:139]
    s_add_u32 m0, s31, s29
    v_mfma_f32_16x16x32_bf16 v[136:139], a[124:127], v[44:47], v[136:139]
    buffer_load_dwordx4 v5, s[12:15], s32 offen nt lds
    v_mfma_f32_16x16x32_bf16 v[136:139], a[136:139], v[48:51], v[136:139]
    v_mfma_f32_16x16x32_bf16 v[136:139], a[148:151], v[52:55], v[136:139]
    v_mfma_f32_16x16x32_bf16 v[136:139], a[160:163], v[56:59], v[136:139]
    s_add_u32 s30, s30, 13312
    v_mfma_f32_16x16x32_bf16 v[136:139], a[172:175], v[60:63], v[136:139]
    s_cmp_eq_u32 s30, 53248
    s_cselect_b32 s30, 0, s30
    v_mfma_f32_16x16x32_bf16 v[136:139], a[184:187], v[64:67], v[136:139]
    v_add_u32 v9, s30, v6
    v_mfma_f32_16x16x32_bf16 v[136:139], a[196:199], v[68:71], v[136:139]
    v_add_u32 v10, s30, v7
    v_mfma_f32_16x16x32_bf16 v[136:139], a[208:211], v[72:75], v[136:139]
    v_add_u32 v11, s30, v8
    v_mfma_f32_16x16x32_bf16 v[140:143], a[116:119], v[40:43], v[140:143]
    v_mfma_f32_16x16x32_bf16 v[140:143], a[128:131], v[44:47], v[140:143]
    v_mfma_f32_16x16x32_bf16 v[140:143], a[140:143], v[48:51], v[140:143]
    v_mfma_f32_16x16x32_bf16 v[140:143], a[152:155], v[52:55], v[140:143]
    ds_write_b32 v82, v83
    v_mfma_f32_16x16x32_bf16 v[140:143], a[164:167], v[56:59], v[140:143]
    v_mfma_f32_16x16x32_bf16 v[140:143], a[176:179], v[60:63], v[140:143]
    v_mfma_f32_16x16x32_bf16 v[140:143], a[188:191], v[64:67], v[140:143]
    v_mfma_f32_16x16x32_bf16 v[140:143], a[200:203], v[68:71], v[140:143]
    v_mfma_f32_16x16x32_bf16 v[140:143], a[212:215], v[72:75], v[140:143]
    v_mfma_f32_16x16x32_bf16 v[156:159], a[216:219], v[40:43], v[156:159]
    v_mfma_f32_16x16x32_bf16 v[156:159], a[228:231], v[44:47], v[156:159]
    v_mfma_f32_16x16x32_bf16 v[156:159], a[240:243], v[48:51], v[156:159]
    v_mfma_f32_16x16x32_bf16 v[160:163], a[220:223], v[40:43], v[160:163]
    v_mfma_f32_16x16x32_bf16 v[160:163], a[232:235], v[44:47], v[160:163]
    v_mfma_f32_16x16x32_bf16 v[160:163], a[244:247], v[48:51], v[160:163]
    s_waitcnt vmcnt(8)
    s_barrier
    v_mfma_f32_16x16x32_bf16 v[164:167], a[224:227], v[40:43], v[164:167]
    ds_read_b128 v[40:43], v9 offset:0
    v_mfma_f32_16x16x32_bf16 v[164:167], a[236:239], v[44:47], v[164:167]
    ds_read_b128 v[44:47], v9 offset:64
    v_mfma_f32_16x16x32_bf16 v[164:167], a[248:251], v[48:51], v[164:167]
    ds_read_b128 v[48:51], v9 offset:128
    v_mfma_f32_16x16x32_bf16 v[156:159], a[252:255], v[52:55], v[156:159]
    v_mfma_f32_16x16x32_bf16 v[156:159], v[176:179], v[56:59], v[156:159]
    v_mfma_f32_16x16x32_bf16 v[156:159], v[188:191], v[60:63], v[156:159]
    v_mfma_f32_16x16x32_bf16 v[160:163], v[168:171], v[52:55], v[160:163]
    v_mfma_f32_16x16x32_bf16 v[160:163], v[180:183], v[56:59], v[160:163]
    v_mfma_f32_16x16x32_bf16 v[160:163], v[192:195], v[60:63], v[160:163]
    v_mfma_f32_16x16x32_bf16 v[164:167], v[172:175], v[52:55], v[164:167]
    ds_read_b128 v[52:55], v10 offset:0
    v_mfma_f32_16x16x32_bf16 v[164:167], v[184:187], v[56:59], v[164:167]
    ds_read_b128 v[56:59], v10 offset:64
    v_mfma_f32_16x16x32_bf16 v[164:167], v[196:199], v[60:63], v[164:167]
    ds_read_b128 v[60:63], v10 offset:128
    v_mfma_f32_16x16x32_bf16 v[156:159], v[200:203], v[64:67], v[156:159]
    v_mfma_f32_16x16x32_bf16 v[156:159], v[212:215], v[68:71], v[156:159]
    v_mfma_f32_16x16x32_bf16 v[156:159], v[224:227], v[72:75], v[156:159]
    v_mfma_f32_16x16x32_bf16 v[160:163], v[204:207], v[64:67], v[160:163]
    v_mfma_f32_16x16x32_bf16 v[160:163], v[216:219], v[68:71], v[160:163]
    v_mfma_f32_16x16x32_bf16 v[160:163], v[228:231], v[72:75], v[160:163]
    v_mfma_f32_16x16x32_bf16 v[164:167], v[208:211], v[64:67], v[164:167]
    ds_read_b128 v[64:67], v11 offset:0
    v_mfma_f32_16x16x32_bf16 v[164:167], v[220:223], v[68:71], v[164:167]
    ds_read_b128 v[68:71], v11 offset:64
    v_mfma_f32_16x16x32_bf16 v[164:167], v[232:235], v[72:75], v[164:167]
    ds_read_b128 v[72:75], v11 offset:128
    s_waitcnt lgkmcnt(6)
    v_mfma_f32_16x16x32_bf16 v[144:147], a[0:3], v[40:43], v[144:147]
    s_add_u32 s32, s32, 196608
    v_mfma_f32_16x16x32_bf16 v[144:147], a[12:15], v[44:47], v[144:147]
    s_add_u32 s33, s33, 2
    v_mfma_f32_16x16x32_bf16 v[144:147], a[24:27], v[48:51], v[144:147]
    s_cmp_lt_u32 s33, s34
    s_cselect_b32 s14, 50331648, 0
    s_waitcnt lgkmcnt(3)
    v_mfma_f32_16x16x32_bf16 v[144:147], a[36:39], v[52:55], v[144:147]
    s_add_u32 s31, s31, 13312
    v_mfma_f32_16x16x32_bf16 v[144:147], a[48:51], v[56:59], v[144:147]
    s_cmp_eq_u32 s31, 53248
    s_cselect_b32 s31, 0, s31
    v_mfma_f32_16x16x32_bf16 v[144:147], a[60:63], v[60:63], v[144:147]
    s_waitcnt lgkmcnt(0)
    v_mfma_f32_16x16x32_bf16 v[144:147], a[72:75], v[64:67], v[144:147]
    v_mfma_f32_16x16x32_bf16 v[144:147], a[84:87], v[68:71], v[144:147]
    s_add_u32 m0, s31, s26
    v_mfma_f32_16x16x32_bf16 v[144:147], a[96:99], v[72:75], v[144:147]
    buffer_load_dwordx4 v2, s[12:15], s32 offen nt lds
    v_mfma_f32_16x16x32_bf16 v[148:151], a[4:7], v[40:43], v[148:151]
    s_add_u32 m0, s31, s27
    v_mfma_f32_16x16x32_bf16 v[148:151], a[16:19], v[44:47], v[148:151]
    buffer_load_dwordx4 v3, s[12:15], s32 offen nt lds
    v_mfma_f32_16x16x32_bf16 v[148:151], a[28:31], v[48:51], v[148:151]
    s_add_u32 m0, s31, s28
    v_mfma_f32_16x16x32_bf16 v[148:151], a[40:43], v[52:55], v[148:151]
    buffer_load_dwordx4 v4, s[12:15], s32 offen nt lds
    v_mfma_f32_16x16x32_bf16 v[148:151], a[52:55], v[56:59], v[148:151]
    s_add_u32 m0, s31, s29
    v_mfma_f32_16x16x32_bf16 v[148:151], a[64:67], v[60:63], v[148:151]
    buffer_load_dwordx4 v5, s[12:15], s32 offen nt lds
    v_mfma_f32_16x16x32_bf16 v[148:151], a[76:79], v[64:67], v[148:151]
    v_mfma_f32_16x16x32_bf16 v[148:151], a[88:91], v[68:71], v[148:151]
    v_mfma_f32_16x16x32_bf16 v[148:151], a[100:103], v[72:75], v[148:151]
    v_cvt_pk_bf16_f32 v76, v144, v145
    v_mfma_f32_16x16x32_bf16 v[152:155], a[8:11], v[40:43], v[152:155]
    ds_read_b128 v[40:43], v9 offset:3072
    v_cvt_pk_bf16_f32 v77, v146, v147
    v_mfma_f32_16x16x32_bf16 v[152:155], a[20:23], v[44:47], v[152:155]
    ds_read_b128 v[44:47], v9 offset:3136
    ds_write_b64 v12, v[76:77] offset:0
    v_mfma_f32_16x16x32_bf16 v[152:155], a[32:35], v[48:51], v[152:155]
    ds_read_b128 v[48:51], v9 offset:3200
    v_mfma_f32_16x16x32_bf16 v[152:155], a[44:47], v[52:55], v[152:155]
    ds_read_b128 v[52:55], v10 offset:3072
    v_mfma_f32_16x16x32_bf16 v[152:155], a[56:59], v[56:59], v[152:155]
    ds_read_b128 v[56:59], v10 offset:3136
    v_mfma_f32_16x16x32_bf16 v[152:155], a[68:71], v[60:63], v[152:155]
    ds_read_b128 v[60:63], v10 offset:3200
    v_mfma_f32_16x16x32_bf16 v[152:155], a[80:83], v[64:67], v[152:155]
    ds_read_b128 v[64:67], v11 offset:3072
    v_mfma_f32_16x16x32_bf16 v[152:155], a[92:95], v[68:71], v[152:155]
    ds_read_b128 v[68:71], v11 offset:3136
    v_mfma_f32_16x16x32_bf16 v[152:155], a[104:107], v[72:75], v[152:155]
    ds_read_b128 v[72:75], v11 offset:3200
    s_waitcnt lgkmcnt(6)
    v_mfma_f32_16x16x32_bf16 v[156:159], a[0:3], v[40:43], v[156:159]
    v_cvt_pk_bf16_f32 v78, v148, v149
    s_add_u32 s30, s30, 13312
    v_mfma_f32_16x16x32_bf16 v[156:159], a[12:15], v[44:47], v[156:159]
    v_cvt_pk_bf16_f32 v79, v150, v151
    v_mfma_f32_16x16x32_bf16 v[156:159], a[24:27], v[48:51], v[156:159]
    s_cmp_eq_u32 s30, 53248
    s_cselect_b32 s30, 0, s30
    v_mfma_f32_16x16x32_bf16 v[160:163], a[4:7], v[40:43], v[160:163]
    ds_write_b64 v13, v[78:79] offset:0
    v_add_u32 v9, s30, v6
    v_mfma_f32_16x16x32_bf16 v[160:163], a[16:19], v[44:47], v[160:163]
    v_add_u32 v10, s30, v7
    v_add_u32 v11, s30, v8
    v_mfma_f32_16x16x32_bf16 v[160:163], a[28:31], v[48:51], v[160:163]
    s_waitcnt vmcnt(8)
    s_barrier
    v_mfma_f32_16x16x32_bf16 v[164:167], a[8:11], v[40:43], v[164:167]
    ds_read_b128 v[40:43], v9 offset:0
    v_mfma_f32_16x16x32_bf16 v[164:167], a[20:23], v[44:47], v[164:167]
    ds_read_b128 v[44:47], v9 offset:64
    v_mfma_f32_16x16x32_bf16 v[164:167], a[32:35], v[48:51], v[164:167]
    v_cvt_pk_bf16_f32 v80, v152, v153
    s_waitcnt lgkmcnt(6)
    v_mfma_f32_16x16x32_bf16 v[156:159], a[36:39], v[52:55], v[156:159]
    ds_read_b128 v[48:51], v9 offset:128
    v_cvt_pk_bf16_f32 v81, v154, v155
    v_mfma_f32_16x16x32_bf16 v[156:159], a[48:51], v[56:59], v[156:159]
    ds_write_b64 v14, v[80:81] offset:0
    v_mfma_f32_16x16x32_bf16 v[156:159], a[60:63], v[60:63], v[156:159]
    v_mfma_f32_16x16x32_bf16 v[160:163], a[40:43], v[52:55], v[160:163]
    v_mfma_f32_16x16x32_bf16 v[160:163], a[52:55], v[56:59], v[160:163]
    v_mfma_f32_16x16x32_bf16 v[160:163], a[64:67], v[60:63], v[160:163]
    v_mfma_f32_16x16x32_bf16 v[164:167], a[44:47], v[52:55], v[164:167]
    ds_read_b128 v[52:55], v10 offset:0
    v_mfma_f32_16x16x32_bf16 v[164:167], a[56:59], v[56:59], v[164:167]
    ds_read_b128 v[56:59], v10 offset:64
    v_mfma_f32_16x16x32_bf16 v[164:167], a[68:71], v[60:63], v[164:167]
    ds_read_b128 v[60:63], v10 offset:128
    s_waitcnt lgkmcnt(8)
    v_mfma_f32_16x16x32_bf16 v[156:159], a[72:75], v[64:67], v[156:159]
    v_mfma_f32_16x16x32_bf16 v[156:159], a[84:87], v[68:71], v[156:159]
    v_mfma_f32_16x16x32_bf16 v[156:159], a[96:99], v[72:75], v[156:159]
    v_mfma_f32_16x16x32_bf16 v[160:163], a[76:79], v[64:67], v[160:163]
    v_mfma_f32_16x16x32_bf16 v[160:163], a[88:91], v[68:71], v[160:163]
    v_mfma_f32_16x16x32_bf16 v[160:163], a[100:103], v[72:75], v[160:163]
    v_mfma_f32_16x16x32_bf16 v[164:167], a[80:83], v[64:67], v[164:167]
    ds_read_b128 v[64:67], v11 offset:0
    v_mfma_f32_16x16x32_bf16 v[164:167], a[92:95], v[68:71], v[164:167]
    ds_read_b128 v[68:71], v11 offset:64
    v_mfma_f32_16x16x32_bf16 v[164:167], a[104:107], v[72:75], v[164:167]
    ds_read_b128 v[72:75], v11 offset:128
    s_nop 7
    v_cvt_pk_bf16_f32 v76, v156, v157
    v_cvt_pk_bf16_f32 v77, v158, v159
    ds_write_b64 v12, v[76:77] offset:3072
    v_cvt_pk_bf16_f32 v78, v160, v161
    v_cvt_pk_bf16_f32 v79, v162, v163
    ds_write_b64 v13, v[78:79] offset:3072
    v_cvt_pk_bf16_f32 v80, v164, v165
    v_cvt_pk_bf16_f32 v81, v166, v167
    ds_write_b64 v14, v[80:81] offset:3072
    s_waitcnt lgkmcnt(0)
    s_barrier
    s_mov_b32 s36, 13
L_loop:
    s_waitcnt lgkmcnt(6)
    v_mfma_f32_16x16x32_bf16 v[144:147], a[216:219], v[40:43], v[120:123]
    v_xor_b32 v12, 0x4000, v12
    v_mfma_f32_16x16x32_bf16 v[144:147], a[228:231], v[44:47], v[144:147]
    v_xor_b32 v13, 0x4000, v13
    v_mfma_f32_16x16x32_bf16 v[144:147], a[240:243], v[48:51], v[144:147]
    v_xor_b32 v14, 0x4000, v14
    s_waitcnt lgkmcnt(3)
    v_mfma_f32_16x16x32_bf16 v[144:147], a[252:255], v[52:55], v[144:147]
    v_mfma_f32_16x16x32_bf16 v[144:147], v[176:179], v[56:59], v[144:147]
    v_mfma_f32_16x16x32_bf16 v[144:147], v[188:191], v[60:63], v[144:147]
    s_waitcnt lgkmcnt(0)
    v_mfma_f32_16x16x32_bf16 v[144:147], v[200:203], v[64:67], v[144:147]
    ds_read_b128 v[84:87], v15
    v_mfma_f32_16x16x32_bf16 v[144:147], v[212:215], v[68:71], v[144:147]
    ds_read_b128 v[88:91], v16
    v_mfma_f32_16x16x32_bf16 v[144:147], v[224:227], v[72:75], v[144:147]
    ds_read_b128 v[92:95], v17
    v_mfma_f32_16x16x32_bf16 v[148:151], a[220:223], v[40:43], v[124:127]
    v_xor_b32 v15, 0x4000, v15
    v_mfma_f32_16x16x32_bf16 v[148:151], a[232:235], v[44:47], v[148:151]
    v_xor_b32 v16, 0x4000, v16
    v_mfma_f32_16x16x32_bf16 v[148:151], a[244:247], v[48:51], v[148:151]
    v_xor_b32 v17, 0x4000, v17
    v_mfma_f32_16x16x32_bf16 v[148:151], v[168:171], v[52:55], v[148:151]
    s_waitcnt lgkmcnt(2)
    buffer_store_dwordx4 v[84:87], v18, s[20:23], s35 offen offset:0 sc1
    v_mfma_f32_16x16x32_bf16 v[148:151], v[180:183], v[56:59], v[148:151]
    v_mfma_f32_16x16x32_bf16 v[148:151], v[192:195], v[60:63], v[148:151]
    v_mfma_f32_16x16x32_bf16 v[148:151], v[204:207], v[64:67], v[148:151]
    v_mfma_f32_16x16x32_bf16 v[148:151], v[216:219], v[68:71], v[148:151]
    v_mfma_f32_16x16x32_bf16 v[148:151], v[228:231], v[72:75], v[148:151]
    v_cvt_pk_bf16_f32 v76, v144, v145
    v_mfma_f32_16x16x32_bf16 v[152:155], a[224:227], v[40:43], v[128:131]
    v_cvt_pk_bf16_f32 v77, v146, v147
    v_mfma_f32_16x16x32_bf16 v[152:155], a[236:239], v[44:47], v[152:155]
    ds_write_b64 v12, v[76:77] offset:0
    v_mfma_f32_16x16x32_bf16 v[152:155], a[248:251], v[48:51], v[152:155]
    s_waitcnt lgkmcnt(2)
    buffer_store_dwordx4 v[88:91], v18, s[20:23], s35 offen offset:1024 sc1
    v_mfma_f32_16x16x32_bf16 v[152:155], v[172:175], v[52:55], v[152:155]
    v_mfma_f32_16x16x32_bf16 v[152:155], v[184:187], v[56:59], v[152:155]
    v_mfma_f32_16x16x32_bf16 v[152:155], v[196:199], v[60:63], v[152:155]
    v_mfma_f32_16x16x32_bf16 v[152:155], v[208:211], v[64:67], v[152:155]
    v_mfma_f32_16x16x32_bf16 v[152:155], v[220:223], v[68:71], v[152:155]
    v_mfma_f32_16x16x32_bf16 v[152:155], v[232:235], v[72:75], v[152:155]
    v_cvt_pk_bf16_f32 v78, v148, v149
    v_mfma_f32_16x16x32_bf16 v[120:123], a[108:111], v[40:43], v[96:99]
    v_cvt_pk_bf16_f32 v79, v150, v151
    v_mfma_f32_16x16x32_bf16 v[120:123], a[120:123], v[44:47], v[120:123]
    s_waitcnt lgkmcnt(1)
    buffer_store_dwordx4 v[92:95], v18, s[20:23], s35 offen offset:2048 sc1
    ds_write_b64 v13, v[78:79] offset:0
    v_mfma_f32_16x16x32_bf16 v[120:123], a[132:135], v[48:51], v[120:123]
    s_add_u32 s35, s35, 196608
    v_mfma_f32_16x16x32_bf16 v[120:123], a[144:147], v[52:55], v[120:123]
    v_mfma_f32_16x16x32_bf16 v[120:123], a[156:159], v[56:59], v[120:123]
    v_mfma_f32_16x16x32_bf16 v[120:123], a[168:171], v[60:63], v[120:123]
    v_mfma_f32_16x16x32_bf16 v[120:123], a[180:183], v[64:67], v[120:123]
    v_mfma_f32_16x16x32_bf16 v[120:123], a[192:195], v[68:71], v[120:123]
    v_mfma_f32_16x16x32_bf16 v[120:123], a[204:207], v[72:75], v[120:123]
    v_cvt_pk_bf16_f32 v80, v152, v153
    v_mfma_f32_16x16x32_bf16 v[124:127], a[112:115], v[40:43], v[100:103]
    v_cvt_pk_bf16_f32 v81, v154, v155
    v_mfma_f32_16x16x32_bf16 v[124:127], a[124:127], v[44:47], v[124:127]
    ds_write_b64 v14, v[80:81] offset:0
    v_mfma_f32_16x16x32_bf16 v[124:127], a[136:139], v[48:51], v[124:127]
    s_add_u32 s32, s32, 196608
    v_mfma_f32_16x16x32_bf16 v[124:127], a[148:151], v[52:55], v[124:127]
    s_add_u32 s33, s33, 2
    v_mfma_f32_16x16x32_bf16 v[124:127], a[160:163], v[56:59], v[124:127]
    s_cmp_lt_u32 s33, s34
    v_mfma_f32_16x16x32_bf16 v[124:127], a[172:175], v[60:63], v[124:127]
    s_cselect_b32 s14, 50331648, 0
    v_mfma_f32_16x16x32_bf16 v[124:127], a[184:187], v[64:67], v[124:127]
    s_add_u32 s31, s31, 13312
    v_mfma_f32_16x16x32_bf16 v[124:127], a[196:199], v[68:71], v[124:127]
    s_cmp_eq_u32 s31, 53248
    v_mfma_f32_16x16x32_bf16 v[124:127], a[208:211], v[72:75], v[124:127]
    s_cselect_b32 s31, 0, s31
    v_mfma_f32_16x16x32_bf16 v[128:131], a[116:119], v[40:43], v[104:107]
    v_mfma_f32_16x16x32_bf16 v[128:131], a[128:131], v[44:47], v[128:131]
    s_add_u32 m0, s31, s26
    v_mfma_f32_16x16x32_bf16 v[128:131], a[140:143], v[48:51], v[128:131]
    buffer_load_dwordx4 v2, s[12:15], s32 offen nt lds
    v_mfma_f32_16x16x32_bf16 v[128:131], a[152:155], v[52:55], v[128:131]
    v_mfma_f32_16x16x32_bf16 v[128:131], a[164:167], v[56:59], v[128:131]
    v_mfma_f32_16x16x32_bf16 v[128:131], a[176:179], v[60:63], v[128:131]
    s_add_u32 m0, s31, s27
    v_mfma_f32_16x16x32_bf16 v[128:131], a[188:191], v[64:67], v[128:131]
    buffer_load_dwordx4 v3, s[12:15], s32 offen nt lds
    v_mfma_f32_16x16x32_bf16 v[128:131], a[200:203], v[68:71], v[128:131]
    v_mfma_f32_16x16x32_bf16 v[128:131], a[212:215], v[72:75], v[128:131]
    v_mfma_f32_16x16x32_bf16 v[96:99], a[0:3], v[40:43], 0
    s_add_u32 m0, s31, s28
    v_mfma_f32_16x16x32_bf16 v[96:99], a[12:15], v[44:47], v[96:99]
    buffer_load_dwordx4 v4, s[12:15], s32 offen nt lds
    v_mfma_f32_16x16x32_bf16 v[96:99], a[24:27], v[48:51], v[96:99]
    v_mfma_f32_16x16x32_bf16 v[100:103], a[4:7], v[40:43], 0
    v_mfma_f32_16x16x32_bf16 v[100:103], a[16:19], v[44:47], v[100:103]
    s_add_u32 m0, s31, s29
    v_mfma_f32_16x16x32_bf16 v[100:103], a[28:31], v[48:51], v[100:103]
    buffer_load_dwordx4 v5, s[12:15], s32 offen nt lds
    v_mfma_f32_16x16x32_bf16 v[104:107], a[8:11], v[40:43], 0
    ds_read_b128 v[40:43], v9 offset:3072
    v_mfma_f32_16x16x32_bf16 v[104:107], a[20:23], v[44:47], v[104:107]
    ds_read_b128 v[44:47], v9 offset:3136
    v_mfma_f32_16x16x32_bf16 v[104:107], a[32:35], v[48:51], v[104:107]
    ds_read_b128 v[48:51], v9 offset:3200
    v_mfma_f32_16x16x32_bf16 v[96:99], a[36:39], v[52:55], v[96:99]
    v_mfma_f32_16x16x32_bf16 v[96:99], a[48:51], v[56:59], v[96:99]
    v_mfma_f32_16x16x32_bf16 v[96:99], a[60:63], v[60:63], v[96:99]
    v_mfma_f32_16x16x32_bf16 v[100:103], a[40:43], v[52:55], v[100:103]
    v_mfma_f32_16x16x32_bf16 v[100:103], a[52:55], v[56:59], v[100:103]
    v_mfma_f32_16x16x32_bf16 v[100:103], a[64:67], v[60:63], v[100:103]
    v_mfma_f32_16x16x32_bf16 v[104:107], a[44:47], v[52:55], v[104:107]
    ds_read_b128 v[52:55], v10 offset:3072
    v_mfma_f32_16x16x32_bf16 v[104:107], a[56:59], v[56:59], v[104:107]
    ds_read_b128 v[56:59], v10 offset:3136
    v_mfma_f32_16x16x32_bf16 v[104:107], a[68:71], v[60:63], v[104:107]
    ds_read_b128 v[60:63], v10 offset:3200
    v_mfma_f32_16x16x32_bf16 v[96:99], a[72:75], v[64:67], v[96:99]
    v_mfma_f32_16x16x32_bf16 v[96:99], a[84:87], v[68:71], v[96:99]
    v_mfma_f32_16x16x32_bf16 v[96:99], a[96:99], v[72:75], v[96:99]
    v_mfma_f32_16x16x32_bf16 v[100:103], a[76:79], v[64:67], v[100:103]
    v_mfma_f32_16x16x32_bf16 v[100:103], a[88:91], v[68:71], v[100:103]
    v_mfma_f32_16x16x32_bf16 v[100:103], a[100:103], v[72:75], v[100:103]
    v_mfma_f32_16x16x32_bf16 v[104:107], a[80:83], v[64:67], v[104:107]
    ds_read_b128 v[64:67], v11 offset:3072
    v_mfma_f32_16x16x32_bf16 v[104:107], a[92:95], v[68:71], v[104:107]
    ds_read_b128 v[68:71], v11 offset:3136
    v_mfma_f32_16x16x32_bf16 v[104:107], a[104:107], v[72:75], v[104:107]
    ds_read_b128 v[72:75], v11 offset:3200
    s_waitcnt lgkmcnt(6)
    v_mfma_f32_16x16x32_bf16 v[156:159], a[216:219], v[40:43], v[132:135]
    v_mfma_f32_16x16x32_bf16 v[156:159], a[228:231], v[44:47], v[156:159]
    v_mfma_f32_16x16x32_bf16 v[156:159], a[240:243], v[48:51], v[156:159]
    s_waitcnt lgkmcnt(3)
    v_mfma_f32_16x16x32_bf16 v[156:159], a[252:255], v[52:55], v[156:159]
    v_mfma_f32_16x16x32_bf16 v[156:159], v[176:179], v[56:59], v[156:159]
    v_mfma_f32_16x16x32_bf16 v[156:159], v[188:191], v[60:63], v[156:159]
    s_waitcnt lgkmcnt(0)
    v_mfma_f32_16x16x32_bf16 v[156:159], v[200:203], v[64:67], v[156:159]
    v_mfma_f32_16x16x32_bf16 v[156:159], v[212:215], v[68:71], v[156:159]
    v_mfma_f32_16x16x32_bf16 v[156:159], v[224:227], v[72:75], v[156:159]
    v_mfma_f32_16x16x32_bf16 v[160:163], a[220:223], v[40:43], v[136:139]
    s_add_u32 s30, s30, 13312
    v_mfma_f32_16x16x32_bf16 v[160:163], a[232:235], v[44:47], v[160:163]
    s_cmp_eq_u32 s30, 53248
    v_mfma_f32_16x16x32_bf16 v[160:163], a[244:247], v[48:51], v[160:163]
    s_cselect_b32 s30, 0, s30
    v_mfma_f32_16x16x32_bf16 v[160:163], v[168:171], v[52:55], v[160:163]
    v_add_u32 v9, s30, v6
    v_mfma_f32_16x16x32_bf16 v[160:163], v[180:183], v[56:59], v[160:163]
    v_add_u32 v10, s30, v7
    v_mfma_f32_16x16x32_bf16 v[160:163], v[192:195], v[60:63], v[160:163]
    v_add_u32 v11, s30, v8
    v_mfma_f32_16x16x32_bf16 v[160:163], v[204:207], v[64:67], v[160:163]
    v_mfma_f32_16x16x32_bf16 v[160:163], v[216:219], v[68:71], v[160:163]
    v_mfma_f32_16x16x32_bf16 v[160:163], v[228:231], v[72:75], v[160:163]
    v_cvt_pk_bf16_f32 v76, v156, v157
    v_mfma_f32_16x16x32_bf16 v[164:167], a[224:227], v[40:43], v[140:143]
    v_cvt_pk_bf16_f32 v77, v158, v159
    v_mfma_f32_16x16x32_bf16 v[164:167], a[236:239], v[44:47], v[164:167]
    ds_write_b64 v12, v[76:77] offset:3072
    v_mfma_f32_16x16x32_bf16 v[164:167], a[248:251], v[48:51], v[164:167]
    v_mfma_f32_16x16x32_bf16 v[164:167], v[172:175], v[52:55], v[164:167]
    v_mfma_f32_16x16x32_bf16 v[164:167], v[184:187], v[56:59], v[164:167]
    v_mfma_f32_16x16x32_bf16 v[164:167], v[196:199], v[60:63], v[164:167]
    v_mfma_f32_16x16x32_bf16 v[164:167], v[208:211], v[64:67], v[164:167]
    v_mfma_f32_16x16x32_bf16 v[164:167], v[220:223], v[68:71], v[164:167]
    v_mfma_f32_16x16x32_bf16 v[164:167], v[232:235], v[72:75], v[164:167]
    v_cvt_pk_bf16_f32 v78, v160, v161
    v_mfma_f32_16x16x32_bf16 v[132:135], a[108:111], v[40:43], v[108:111]
    v_cvt_pk_bf16_f32 v79, v162, v163
    v_mfma_f32_16x16x32_bf16 v[132:135], a[120:123], v[44:47], v[132:135]
    ds_write_b64 v13, v[78:79] offset:3072
    v_mfma_f32_16x16x32_bf16 v[132:135], a[132:135], v[48:51], v[132:135]
    v_mfma_f32_16x16x32_bf16 v[132:135], a[144:147], v[52:55], v[132:135]
    v_mfma_f32_16x16x32_bf16 v[132:135], a[156:159], v[56:59], v[132:135]
    v_mfma_f32_16x16x32_bf16 v[132:135], a[168:171], v[60:63], v[132:135]
    v_mfma_f32_16x16x32_bf16 v[132:135], a[180:183], v[64:67], v[132:135]
    v_mfma_f32_16x16x32_bf16 v[132:135], a[192:195], v[68:71], v[132:135]
    v_mfma_f32_16x16x32_bf16 v[132:135], a[204:207], v[72:75], v[132:135]
    v_cvt_pk_bf16_f32 v80, v164, v165
    v_mfma_f32_16x16x32_bf16 v[136:139], a[112:115], v[40:43], v[112:115]
    v_cvt_pk_bf16_f32 v81, v166, v167
    v_mfma_f32_16x16x32_bf16 v[136:139], a[124:127], v[44:47], v[136:139]
    ds_write_b64 v14, v[80:81] offset:3072
    v_mfma_f32_16x16x32_bf16 v[136:139], a[136:139], v[48:51], v[136:139]
    v_mfma_f32_16x16x32_bf16 v[136:139], a[148:151], v[52:55], v[136:139]
    v_mfma_f32_16x16x32_bf16 v[136:139], a[160:163], v[56:59], v[136:139]
    v_add_u32 v83, 1, v83
    v_mfma_f32_16x16x32_bf16 v[136:139], a[172:175], v[60:63], v[136:139]
    s_add_u32 s63, s63, 1
    v_mfma_f32_16x16x32_bf16 v[136:139], a[184:187], v[64:67], v[136:139]
    s_waitcnt vmcnt(11)
    ds_write_b32 v82, v83
    v_mfma_f32_16x16x32_bf16 v[136:139], a[196:199], v[68:71], v[136:139]
    v_mfma_f32_16x16x32_bf16 v[136:139], a[208:211], v[72:75], v[136:139]
    v_mfma_f32_16x16x32_bf16 v[140:143], a[116:119], v[40:43], v[116:119]
    v_mfma_f32_16x16x32_bf16 v[140:143], a[128:131], v[44:47], v[140:143]
    v_mfma_f32_16x16x32_bf16 v[140:143], a[140:143], v[48:51], v[140:143]
    v_mfma_f32_16x16x32_bf16 v[140:143], a[152:155], v[52:55], v[140:143]
    v_mfma_f32_16x16x32_bf16 v[140:143], a[164:167], v[56:59], v[140:143]
    v_mfma_f32_16x16x32_bf16 v[140:143], a[176:179], v[60:63], v[140:143]
    v_mfma_f32_16x16x32_bf16 v[140:143], a[188:191], v[64:67], v[140:143]
    v_mfma_f32_16x16x32_bf16 v[140:143], a[200:203], v[68:71], v[140:143]
    v_mfma_f32_16x16x32_bf16 v[140:143], a[212:215], v[72:75], v[140:143]
    ds_read_b128 v[236:239], v0
    v_mfma_f32_16x16x32_bf16 v[108:111], a[0:3], v[40:43], 0
    v_mfma_f32_16x16x32_bf16 v[108:111], a[12:15], v[44:47], v[108:111]
    v_mfma_f32_16x16x32_bf16 v[108:111], a[24:27], v[48:51], v[108:111]
    v_mfma_f32_16x16x32_bf16 v[112:115], a[4:7], v[40:43], 0
    v_mfma_f32_16x16x32_bf16 v[112:115], a[16:19], v[44:47], v[112:115]
    v_mfma_f32_16x16x32_bf16 v[112:115], a[28:31], v[48:51], v[112:115]
    s_waitcnt lgkmcnt(0)
    v_min3_u32 v1, v236, v237, v238
    v_mfma_f32_16x16x32_bf16 v[116:119], a[8:11], v[40:43], 0
    v_min_u32 v1, v1, v239
    v_mfma_f32_16x16x32_bf16 v[116:119], a[20:23], v[44:47], v[116:119]
    v_mfma_f32_16x16x32_bf16 v[116:119], a[32:35], v[48:51], v[116:119]
    v_readfirstlane_b32 s57, v1
    v_mfma_f32_16x16x32_bf16 v[108:111], a[36:39], v[52:55], v[108:111]
    v_mfma_f32_16x16x32_bf16 v[108:111], a[48:51], v[56:59], v[108:111]
    v_mfma_f32_16x16x32_bf16 v[108:111], a[60:63], v[60:63], v[108:111]
    s_cmp_ge_u32 s57, s63
    s_cbranch_scc0 L_slow
L_back:
    v_mfma_f32_16x16x32_bf16 v[112:115], a[40:43], v[52:55], v[112:115]
    ds_read_b128 v[40:43], v9 offset:0
    v_mfma_f32_16x16x32_bf16 v[112:115], a[52:55], v[56:59], v[112:115]
    ds_read_b128 v[44:47], v9 offset:64
    v_mfma_f32_16x16x32_bf16 v[112:115], a[64:67], v[60:63], v[112:115]
    ds_read_b128 v[48:51], v9 offset:128
    v_mfma_f32_16x16x32_bf16 v[116:119], a[44:47], v[52:55], v[116:119]
    ds_read_b128 v[52:55], v10 offset:0
    v_mfma_f32_16x16x32_bf16 v[116:119], a[56:59], v[56:59], v[116:119]
    ds_read_b128 v[56:59], v10 offset:64
    v_mfma_f32_16x16x32_bf16 v[116:119], a[68:71], v[60:63], v[116:119]
    ds_read_b128 v[60:63], v10 offset:128
    v_mfma_f32_16x16x32_bf16 v[108:111], a[72:75], v[64:67], v[108:111]
    v_mfma_f32_16x16x32_bf16 v[108:111], a[84:87], v[68:71], v[108:111]
    v_mfma_f32_16x16x32_bf16 v[108:111], a[96:99], v[72:75], v[108:111]
    s_sub_u32 s36, s36, 1
    v_mfma_f32_16x16x32_bf16 v[112:115], a[76:79], v[64:67], v[112:115]
    s_cmp_lg_u32 s36, 0
    v_mfma_f32_16x16x32_bf16 v[112:115], a[88:91], v[68:71], v[112:115]
    v_mfma_f32_16x16x32_bf16 v[112:115], a[100:103], v[72:75], v[112:115]
    v_mfma_f32_16x16x32_bf16 v[116:119], a[80:83], v[64:67], v[116:119]
    ds_read_b128 v[64:67], v11 offset:0
    v_mfma_f32_16x16x32_bf16 v[116:119], a[92:95], v[68:71], v[116:119]
    ds_read_b128 v[68:71], v11 offset:64
    v_mfma_f32_16x16x32_bf16 v[116:119], a[104:107], v[72:75], v[116:119]
    ds_read_b128 v[72:75], v11 offset:128
    s_cbranch_scc1 L_loop
    s_waitcnt lgkmcnt(6)
    v_mfma_f32_16x16x32_bf16 v[144:147], a[216:219], v[40:43], v[120:123]
    v_xor_b32 v12, 0x4000, v12
    v_mfma_f32_16x16x32_bf16 v[144:147], a[228:231], v[44:47], v[144:147]
    v_xor_b32 v13, 0x4000, v13
    v_mfma_f32_16x16x32_bf16 v[144:147], a[240:243], v[48:51], v[144:147]
    v_xor_b32 v14, 0x4000, v14
    s_waitcnt lgkmcnt(3)
    v_mfma_f32_16x16x32_bf16 v[144:147], a[252:255], v[52:55], v[144:147]
    v_mfma_f32_16x16x32_bf16 v[144:147], v[176:179], v[56:59], v[144:147]
    v_mfma_f32_16x16x32_bf16 v[144:147], v[188:191], v[60:63], v[144:147]
    s_waitcnt lgkmcnt(0)
    v_mfma_f32_16x16x32_bf16 v[144:147], v[200:203], v[64:67], v[144:147]
    ds_read_b128 v[84:87], v15
    v_mfma_f32_16x16x32_bf16 v[144:147], v[212:215], v[68:71], v[144:147]
    ds_read_b128 v[88:91], v16
    v_mfma_f32_16x16x32_bf16 v[144:147], v[224:227], v[72:75], v[144:147]
    ds_read_b128 v[92:95], v17
    v_mfma_f32_16x16x32_bf16 v[148:151], a[220:223], v[40:43], v[124:127]
    v_xor_b32 v15, 0x4000, v15
    v_mfma_f32_16x16x32_bf16 v[148:151], a[232:235], v[44:47], v[148:151]
    v_xor_b32 v16, 0x4000, v16
    v_mfma_f32_16x16x32_bf16 v[148:151], a[244:247], v[48:51], v[148:151]
    v_xor_b32 v17, 0x4000, v17
    v_mfma_f32_16x16x32_bf16 v[148:151], v[168:171], v[52:55], v[148:151]
    s_waitcnt lgkmcnt(2)
    buffer_store_dwordx4 v[84:87], v18, s[20:23], s35 offen offset:0 sc1
    v_mfma_f32_16x16x32_bf16 v[148:151], v[180:183], v[56:59], v[148:151]
    v_mfma_f32_16x16x32_bf16 v[148:151], v[192:195], v[60:63], v[148:151]
    v_mfma_f32_16x16x32_bf16 v[148:151], v[204:207], v[64:67], v[148:151]
    v_mfma_f32_16x16x32_bf16 v[148:151], v[216:219], v[68:71], v[148:151]
    v_mfma_f32_16x16x32_bf16 v[148:151], v[228:231], v[72:75], v[148:151]
    v_cvt_pk_bf16_f32 v76, v144, v145
    v_mfma_f32_16x16x32_bf16 v[152:155], a[224:227], v[40:43], v[128:131]
    v_cvt_pk_bf16_f32 v77, v146, v147
    v_mfma_f32_16x16x32_bf16 v[152:155], a[236:239], v[44:47], v[152:155]
    ds_write_b64 v12, v[76:77] offset:0
    v_mfma_f32_16x16x32_bf16 v[152:155], a[248:251], v[48:51], v[152:155]
    s_waitcnt lgkmcnt(2)
    buffer_store_dwordx4 v[88:91], v18, s[20:23], s35 offen offset:1024 sc1
    v_mfma_f32_16x16x32_bf16 v[152:155], v[172:175], v[52:55], v[152:155]
    v_mfma_f32_16x16x32_bf16 v[152:155], v[184:187], v[56:59], v[152:155]
    v_mfma_f32_16x16x32_bf16 v[152:155], v[196:199], v[60:63], v[152:155]
    v_mfma_f32_16x16x32_bf16 v[152:155], v[208:211], v[64:67], v[152:155]
    v_mfma_f32_16x16x32_bf16 v[152:155], v[220:223], v[68:71], v[152:155]
    v_mfma_f32_16x16x32_bf16 v[152:155], v[232:235], v[72:75], v[152:155]
    v_cvt_pk_bf16_f32 v78, v148, v149
    v_mfma_f32_16x16x32_bf16 v[120:123], a[108:111], v[40:43], v[96:99]
    v_cvt_pk_bf16_f32 v79, v150, v151
    v_mfma_f32_16x16x32_bf16 v[120:123], a[120:123], v[44:47], v[120:123]
    s_waitcnt lgkmcnt(1)
    buffer_store_dwordx4 v[92:95], v18, s[20:23], s35 offen offset:2048 sc1
    ds_write_b64 v13, v[78:79] offset:0
    v_mfma_f32_16x16x32_bf16 v[120:123], a[132:135], v[48:51], v[120:123]
    s_add_u32 s35, s35, 196608
    v_mfma_f32_16x16x32_bf16 v[124:127], a[112:115], v[40:43], v[100:103]
    v_mfma_f32_16x16x32_bf16 v[124:127], a[124:127], v[44:47], v[124:127]
    v_mfma_f32_16x16x32_bf16 v[124:127], a[136:139], v[48:51], v[124:127]
    v_mfma_f32_16x16x32_bf16 v[128:131], a[116:119], v[40:43], v[104:107]
    ds_read_b128 v[40:43], v9 offset:3072
    v_mfma_f32_16x16x32_bf16 v[128:131], a[128:131], v[44:47], v[128:131]
    ds_read_b128 v[44:47], v9 offset:3136
    v_mfma_f32_16x16x32_bf16 v[128:131], a[140:143], v[48:51], v[128:131]
    v_cvt_pk_bf16_f32 v80, v152, v153
    ds_read_b128 v[48:51], v9 offset:3200
    v_mfma_f32_16x16x32_bf16 v[120:123], a[144:147], v[52:55], v[120:123]
    v_cvt_pk_bf16_f32 v81, v154, v155
    v_mfma_f32_16x16x32_bf16 v[120:123], a[156:159], v[56:59], v[120:123]
    ds_write_b64 v14, v[80:81] offset:0
    v_mfma_f32_16x16x32_bf16 v[120:123], a[168:171], v[60:63], v[120:123]
    v_mfma_f32_16x16x32_bf16 v[124:127], a[148:151], v[52:55], v[124:127]
    v_mfma_f32_16x16x32_bf16 v[124:127], a[160:163], v[56:59], v[124:127]
    v_mfma_f32_16x16x32_bf16 v[124:127], a[172:175], v[60:63], v[124:127]
    v_mfma_f32_16x16x32_bf16 v[128:131], a[152:155], v[52:55], v[128:131]
    ds_read_b128 v[52:55], v10 offset:3072
    v_mfma_f32_16x16x32_bf16 v[128:131], a[164:167], v[56:59], v[128:131]
    ds_read_b128 v[56:59], v10 offset:3136
    v_mfma_f32_16x16x32_bf16 v[128:131], a[176:179], v[60:63], v[128:131]
    ds_read_b128 v[60:63], v10 offset:3200
    v_mfma_f32_16x16x32_bf16 v[120:123], a[180:183], v[64:67], v[120:123]
    v_mfma_f32_16x16x32_bf16 v[120:123], a[192:195], v[68:71], v[120:123]
    v_mfma_f32_16x16x32_bf16 v[120:123], a[204:207], v[72:75], v[120:123]
    v_mfma_f32_16x16x32_bf16 v[124:127], a[184:187], v[64:67], v[124:127]
    v_mfma_f32_16x16x32_bf16 v[124:127], a[196:199], v[68:71], v[124:127]
    v_mfma_f32_16x16x32_bf16 v[124:127], a[208:211], v[72:75], v[124:127]
    v_mfma_f32_16x16x32_bf16 v[128:131], a[188:191], v[64:67], v[128:131]
    ds_read_b128 v[64:67], v11 offset:3072
    v_mfma_f32_16x16x32_bf16 v[128:131], a[200:203], v[68:71], v[128:131]
    ds_read_b128 v[68:71], v11 offset:3136
    v_mfma_f32_16x16x32_bf16 v[128:131], a[212:215], v[72:75], v[128:131]
    ds_read_b128 v[72:75], v11 offset:3200
    s_waitcnt lgkmcnt(7)
    v_mfma_f32_16x16x32_bf16 v[156:159], a[216:219], v[40:43], v[132:135]
    v_mfma_f32_16x16x32_bf16 v[156:159], a[228:231], v[44:47], v[156:159]
    v_mfma_f32_16x16x32_bf16 v[156:159], a[240:243], v[48:51], v[156:159]
    s_waitcnt lgkmcnt(3)
    v_mfma_f32_16x16x32_bf16 v[156:159], a[252:255], v[52:55], v[156:159]
    v_mfma_f32_16x16x32_bf16 v[156:159], v[176:179], v[56:59], v[156:159]
    v_mfma_f32_16x16x32_bf16 v[156:159], v[188:191], v[60:63], v[156:159]
    s_waitcnt lgkmcnt(0)
    v_mfma_f32_16x16x32_bf16 v[156:159], v[200:203], v[64:67], v[156:159]
    v_mfma_f32_16x16x32_bf16 v[156:159], v[212:215], v[68:71], v[156:159]
    v_mfma_f32_16x16x32_bf16 v[156:159], v[224:227], v[72:75], v[156:159]
    v_mfma_f32_16x16x32_bf16 v[160:163], a[220:223], v[40:43], v[136:139]
    s_add_u32 s30, s30, 13312
    v_mfma_f32_16x16x32_bf16 v[160:163], a[232:235], v[44:47], v[160:163]
    s_cmp_eq_u32 s30, 53248
    v_mfma_f32_16x16x32_bf16 v[160:163], a[244:247], v[48:51], v[160:163]
    s_cselect_b32 s30, 0, s30
    v_mfma_f32_16x16x32_bf16 v[160:163], v[168:171], v[52:55], v[160:163]
    v_add_u32 v9, s30, v6
    v_mfma_f32_16x16x32_bf16 v[160:163], v[180:183], v[56:59], v[160:163]
    v_add_u32 v10, s30, v7
    v_mfma_f32_16x16x32_bf16 v[160:163], v[192:195], v[60:63], v[160:163]
    v_add_u32 v11, s30, v8
    v_mfma_f32_16x16x32_bf16 v[160:163], v[204:207], v[64:67], v[160:163]
    v_mfma_f32_16x16x32_bf16 v[160:163], v[216:219], v[68:71], v[160:163]
    v_mfma_f32_16x16x32_bf16 v[160:163], v[228:231], v[72:75], v[160:163]
    v_cvt_pk_bf16_f32 v76, v156, v157
    v_mfma_f32_16x16x32_bf16 v[164:167], a[224:227], v[40:43], v[140:143]
    v_cvt_pk_bf16_f32 v77, v158, v159
    v_mfma_f32_16x16x32_bf16 v[164:167], a[236:239], v[44:47], v[164:167]
    ds_write_b64 v12, v[76:77] offset:3072
    v_mfma_f32_16x16x32_bf16 v[164:167], a[248:251], v[48:51], v[164:167]
    v_mfma_f32_16x16x32_bf16 v[164:167], v[172:175], v[52:55], v[164:167]
    v_mfma_f32_16x16x32_bf16 v[164:167], v[184:187], v[56:59], v[164:167]
    v_mfma_f32_16x16x32_bf16 v[164:167], v[196:199], v[60:63], v[164:167]
    v_mfma_f32_16x16x32_bf16 v[164:167], v[208:211], v[64:67], v[164:167]
    v_mfma_f32_16x16x32_bf16 v[164:167], v[220:223], v[68:71], v[164:167]
    v_mfma_f32_16x16x32_bf16 v[164:167], v[232:235], v[72:75], v[164:167]
    v_cvt_pk_bf16_f32 v78, v160, v161
    v_mfma_f32_16x16x32_bf16 v[132:135], a[108:111], v[40:43], v[108:111]
    v_cvt_pk_bf16_f32 v79, v162, v163
    v_mfma_f32_16x16x32_bf16 v[132:135], a[120:123], v[44:47], v[132:135]
    ds_write_b64 v13, v[78:79] offset:3072
    v_mfma_f32_16x16x32_bf16 v[132:135], a[132:135], v[48:51], v[132:135]
    v_mfma_f32_16x16x32_bf16 v[136:139], a[112:115], v[40:43], v[112:115]
    v_mfma_f32_16x16x32_bf16 v[136:139], a[124:127], v[44:47], v[136:139]
    v_mfma_f32_16x16x32_bf16 v[136:139], a[136:139], v[48:51], v[136:139]
    v_mfma_f32_16x16x32_bf16 v[140:143], a[116:119], v[40:43], v[116:119]
    v_mfma_f32_16x16x32_bf16 v[140:143], a[128:131], v[44:47], v[140:143]
    v_mfma_f32_16x16x32_bf16 v[140:143], a[140:143], v[48:51], v[140:143]
    v_cvt_pk_bf16_f32 v80, v164, v165
    v_mfma_f32_16x16x32_bf16 v[132:135], a[144:147], v[52:55], v[132:135]
    v_cvt_pk_bf16_f32 v81, v166, v167
    v_mfma_f32_16x16x32_bf16 v[132:135], a[156:159], v[56:59], v[132:135]
    ds_write_b64 v14, v[80:81] offset:3072
    v_mfma_f32_16x16x32_bf16 v[132:135], a[168:171], v[60:63], v[132:135]
    v_mfma_f32_16x16x32_bf16 v[136:139], a[148:151], v[52:55], v[136:139]
    s_waitcnt vmcnt(10) lgkmcnt(0)
    s_barrier
    v_mfma_f32_16x16x32_bf16 v[136:139], a[160:163], v[56:59], v[136:139]
    ds_read_b128 v[40:43], v9 offset:0
    v_mfma_f32_16x16x32_bf16 v[136:139], a[172:175], v[60:63], v[136:139]
    ds_read_b128 v[44:47], v9 offset:64
    v_mfma_f32_16x16x32_bf16 v[140:143], a[152:155], v[52:55], v[140:143]
    ds_read_b128 v[48:51], v9 offset:128
    v_mfma_f32_16x16x32_bf16 v[140:143], a[164:167], v[56:59], v[140:143]
    ds_read_b128 v[52:55], v10 offset:0
    v_mfma_f32_16x16x32_bf16 v[140:143], a[176:179], v[60:63], v[140:143]
    ds_read_b128 v[56:59], v10 offset:64
    v_mfma_f32_16x16x32_bf16 v[132:135], a[180:183], v[64:67], v[132:135]
    ds_read_b128 v[60:63], v10 offset:128
    v_mfma_f32_16x16x32_bf16 v[132:135], a[192:195], v[68:71], v[132:135]
    v_mfma_f32_16x16x32_bf16 v[132:135], a[204:207], v[72:75], v[132:135]
    v_mfma_f32_16x16x32_bf16 v[136:139], a[184:187], v[64:67], v[136:139]
    v_mfma_f32_16x16x32_bf16 v[136:139], a[196:199], v[68:71], v[136:139]
    v_mfma_f32_16x16x32_bf16 v[136:139], a[208:211], v[72:75], v[136:139]
    v_mfma_f32_16x16x32_bf16 v[140:143], a[188:191], v[64:67], v[140:143]
    ds_read_b128 v[64:67], v11 offset:0
    v_mfma_f32_16x16x32_bf16 v[140:143], a[200:203], v[68:71], v[140:143]
    ds_read_b128 v[68:71], v11 offset:64
    v_mfma_f32_16x16x32_bf16 v[140:143], a[212:215], v[72:75], v[140:143]
    ds_read_b128 v[72:75], v11 offset:128
    s_waitcnt lgkmcnt(6)
    v_mfma_f32_16x16x32_bf16 v[144:147], a[216:219], v[40:43], v[120:123]
    v_xor_b32 v12, 0x4000, v12
    v_mfma_f32_16x16x32_bf16 v[144:147], a[228:231], v[44:47], v[144:147]
    v_xor_b32 v13, 0x4000, v13
    v_mfma_f32_16x16x32_bf16 v[144:147], a[240:243], v[48:51], v[144:147]
    v_xor_b32 v14, 0x4000, v14
    s_waitcnt lgkmcnt(3)
    v_mfma_f32_16x16x32_bf16 v[144:147], a[252:255], v[52:55], v[144:147]
    v_mfma_f32_16x16x32_bf16 v[144:147], v[176:179], v[56:59], v[144:147]
    v_mfma_f32_16x16x32_bf16 v[144:147], v[188:191], v[60:63], v[144:147]
    s_waitcnt lgkmcnt(0)
    v_mfma_f32_16x16x32_bf16 v[144:147], v[200:203], v[64:67], v[144:147]
    ds_read_b128 v[84:87], v15
    v_mfma_f32_16x16x32_bf16 v[144:147], v[212:215], v[68:71], v[144:147]
    ds_read_b128 v[88:91], v16
    v_mfma_f32_16x16x32_bf16 v[144:147], v[224:227], v[72:75], v[144:147]
    ds_read_b128 v[92:95], v17
    v_mfma_f32_16x16x32_bf16 v[148:151], a[220:223], v[40:43], v[124:127]
    v_xor_b32 v15, 0x4000, v15
    v_mfma_f32_16x16x32_bf16 v[148:151], a[232:235], v[44:47], v[148:151]
    v_xor_b32 v16, 0x4000, v16
    v_mfma_f32_16x16x32_bf16 v[148:151], a[244:247], v[48:51], v[148:151]
    v_xor_b32 v17, 0x4000, v17
    v_mfma_f32_16x16x32_bf16 v[148:151], v[168:171], v[52:55], v[148:151]
    s_waitcnt lgkmcnt(2)
    buffer_store_dwordx4 v[84:87], v18, s[20:23], s35 offen offset:0 sc1
    v_mfma_f32_16x16x32_bf16 v[148:151], v[180:183], v[56:59], v[148:151]
    v_mfma_f32_16x16x32_bf16 v[148:151], v[192:195], v[60:63], v[148:151]
    v_mfma_f32_16x16x32_bf16 v[148:151], v[204:207], v[64:67], v[148:151]
    v_mfma_f32_16x16x32_bf16 v[148:151], v[216:219], v[68:71], v[148:151]
    v_mfma_f32_16x16x32_bf16 v[148:151], v[228:231], v[72:75], v[148:151]
    v_cvt_pk_bf16_f32 v76, v144, v145
    v_mfma_f32_16x16x32_bf16 v[152:155], a[224:227], v[40:43], v[128:131]
    ds_read_b128 v[40:43], v9 offset:3072
    v_cvt_pk_bf16_f32 v77, v146, v147
    v_mfma_f32_16x16x32_bf16 v[152:155], a[236:239], v[44:47], v[152:155]
    ds_read_b128 v[44:47], v9 offset:3136
    ds_write_b64 v12, v[76:77] offset:0
    v_mfma_f32_16x16x32_bf16 v[152:155], a[248:251], v[48:51], v[152:155]
    s_waitcnt lgkmcnt(4)
    buffer_store_dwordx4 v[88:91], v18, s[20:23], s35 offen offset:1024 sc1
    ds_read_b128 v[48:51], v9 offset:3200
    v_mfma_f32_16x16x32_bf16 v[152:155], v[172:175], v[52:55], v[152:155]
    ds_read_b128 v[52:55], v10 offset:3072
    v_mfma_f32_16x16x32_bf16 v[152:155], v[184:187], v[56:59], v[152:155]
    ds_read_b128 v[56:59], v10 offset:3136
    v_mfma_f32_16x16x32_bf16 v[152:155], v[196:199], v[60:63], v[152:155]
    ds_read_b128 v[60:63], v10 offset:3200
    v_mfma_f32_16x16x32_bf16 v[152:155], v[208:211], v[64:67], v[152:155]
    ds_read_b128 v[64:67], v11 offset:3072
    v_mfma_f32_16x16x32_bf16 v[152:155], v[220:223], v[68:71], v[152:155]
    ds_read_b128 v[68:71], v11 offset:3136
    v_mfma_f32_16x16x32_bf16 v[152:155], v[232:235], v[72:75], v[152:155]
    ds_read_b128 v[72:75], v11 offset:3200
    v_cvt_pk_bf16_f32 v78, v148, v149
    s_waitcnt lgkmcnt(6)
    v_mfma_f32_16x16x32_bf16 v[156:159], a[216:219], v[40:43], v[132:135]
    v_cvt_pk_bf16_f32 v79, v150, v151
    v_mfma_f32_16x16x32_bf16 v[156:159], a[228:231], v[44:47], v[156:159]
    buffer_store_dwordx4 v[92:95], v18, s[20:23], s35 offen offset:2048 sc1
    ds_write_b64 v13, v[78:79] offset:0
    v_mfma_f32_16x16x32_bf16 v[156:159], a[240:243], v[48:51], v[156:159]
    s_add_u32 s35, s35, 196608
    s_waitcnt lgkmcnt(4)
    v_mfma_f32_16x16x32_bf16 v[156:159], a[252:255], v[52:55], v[156:159]
    v_mfma_f32_16x16x32_bf16 v[156:159], v[176:179], v[56:59], v[156:159]
    v_mfma_f32_16x16x32_bf16 v[156:159], v[188:191], v[60:63], v[156:159]
    s_waitcnt lgkmcnt(1)
    v_mfma_f32_16x16x32_bf16 v[156:159], v[200:203], v[64:67], v[156:159]
    v_mfma_f32_16x16x32_bf16 v[156:159], v[212:215], v[68:71], v[156:159]
    v_mfma_f32_16x16x32_bf16 v[156:159], v[224:227], v[72:75], v[156:159]
    v_cvt_pk_bf16_f32 v80, v152, v153
    v_mfma_f32_16x16x32_bf16 v[160:163], a[220:223], v[40:43], v[136:139]
    v_cvt_pk_bf16_f32 v81, v154, v155
    v_mfma_f32_16x16x32_bf16 v[160:163], a[232:235], v[44:47], v[160:163]
    ds_write_b64 v14, v[80:81] offset:0
    v_mfma_f32_16x16x32_bf16 v[160:163], a[244:247], v[48:51], v[160:163]
    v_mfma_f32_16x16x32_bf16 v[160:163], v[168:171], v[52:55], v[160:163]
    v_mfma_f32_16x16x32_bf16 v[160:163], v[180:183], v[56:59], v[160:163]
    v_mfma_f32_16x16x32_bf16 v[160:163], v[192:195], v[60:63], v[160:163]
    v_mfma_f32_16x16x32_bf16 v[160:163], v[204:207], v[64:67], v[160:163]
    v_mfma_f32_16x16x32_bf16 v[160:163], v[216:219], v[68:71], v[160:163]
    v_mfma_f32_16x16x32_bf16 v[160:163], v[228:231], v[72:75], v[160:163]
    v_cvt_pk_bf16_f32 v76, v156, v157
    v_mfma_f32_16x16x32_bf16 v[164:167], a[224:227], v[40:43], v[140:143]
    v_cvt_pk_bf16_f32 v77, v158, v159
    v_mfma_f32_16x16x32_bf16 v[164:167], a[236:239], v[44:47], v[164:167]
    ds_write_b64 v12, v[76:77] offset:3072
    v_mfma_f32_16x16x32_bf16 v[164:167], a[248:251], v[48:51], v[164:167]
    v_mfma_f32_16x16x32_bf16 v[164:167], v[172:175], v[52:55], v[164:167]
    v_mfma_f32_16x16x32_bf16 v[164:167], v[184:187], v[56:59], v[164:167]
    v_mfma_f32_16x16x32_bf16 v[164:167], v[196:199], v[60:63], v[164:167]
    v_mfma_f32_16x16x32_bf16 v[164:167], v[208:211], v[64:67], v[164:167]
    v_mfma_f32_16x16x32_bf16 v[164:167], v[220:223], v[68:71], v[164:167]
    v_mfma_f32_16x16x32_bf16 v[164:167], v[232:235], v[72:75], v[164:167]
    v_cvt_pk_bf16_f32 v78, v160, v161
    s_nop 7
    v_cvt_pk_bf16_f32 v79, v162, v163
    ds_write_b64 v13, v[78:79] offset:3072
    v_cvt_pk_bf16_f32 v80, v164, v165
    v_cvt_pk_bf16_f32 v81, v166, v167
    ds_write_b64 v14, v[80:81] offset:3072
    s_waitcnt lgkmcnt(0)
    s_barrier
    ds_read_b128 v[84:87], v15
    ds_read_b128 v[88:91], v16
    ds_read_b128 v[92:95], v17
    s_waitcnt lgkmcnt(2)
    buffer_store_dwordx4 v[84:87], v18, s[20:23], s35 offen offset:0 sc1
    s_waitcnt lgkmcnt(1)
    buffer_store_dwordx4 v[88:91], v18, s[20:23], s35 offen offset:1024 sc1
    s_waitcnt lgkmcnt(0)
    buffer_store_dwordx4 v[92:95], v18, s[20:23], s35 offen offset:2048 sc1
L_end:
    s_endpgm
L_slow:
    s_mov_b32 s38, 0
L_slowx:
    ds_read_b128 v[236:239], v0
    s_waitcnt lgkmcnt(0)
    v_min3_u32 v1, v236, v237, v238
    v_min_u32 v1, v1, v239
    s_add_u32 s38, s38, 1
    v_readfirstlane_b32 s57, v1
    s_cmp_gt_u32 s38, 0x40000
    s_cbranch_scc1 L_back
    s_cmp_ge_u32 s57, s63
    s_cbranch_scc0 L_slowx
    s_branch L_back
L_codeend:
.section .rodata,"a"
.p2align 6
.amdhsa_kernel standalone__dilated_atrous__vision_kernel
  .amdhsa_next_free_vgpr 512
  .amdhsa_next_free_sgpr 100
  .amdhsa_accum_offset 256
  .amdhsa_group_segment_fixed_size 0
  .amdhsa_kernarg_size 40
  .amdhsa_user_sgpr_count 2
  .amdhsa_user_sgpr_kernarg_segment_ptr 1
  .amdhsa_system_sgpr_workgroup_id_x 1
.end_amdhsa_kernel
```
